```python
import torch

def _softmax(x, axis=-1):
    return torch.softmax(x, dim=axis)
def _gelu(x):
    return torch.nn.functional.gelu(x, approximate="tanh")
def _silu(x):
    return torch.nn.functional.silu(x)
def _sigmoid(x):
    return torch.sigmoid(x)
def _layernorm(x, axis=-1, eps=1e-5):
    m = x.mean(dim=axis, keepdim=True)
    v = x.var(dim=axis, keepdim=True, unbiased=False)
    return (x - m) / torch.sqrt(v + eps)
def _scatter_add(tgt, idx, src, axis=0):
    return tgt.clone().index_add_(axis, idx, src)
def _segment_sum(src, seg, n):
    out = torch.zeros((n,) + src.shape[1:], dtype=src.dtype)
    return out.index_add_(0, seg, src)
def _pad(x, pw):
    flat = tuple(v for pair in reversed(pw) for v in pair)
    return torch.nn.functional.pad(x, flat)

kernel_name = 'interleave_layers__linear_attn_block__swiglu_ffn__prompt'

def setup_inputs():

    _w = (lambda a: (lambda t: t.to(torch.bfloat16) if t.is_floating_point() else t)(torch.as_tensor(a)))
    def _A_setup():
        B, S, D = 1, 2048, 640
        return {
            "x": _w((lambda *s: torch.randn(*s, dtype=torch.bfloat16) * 0.05)(B, S, D)),
            "wqkv": _w((lambda *s: torch.randn(*s, dtype=torch.bfloat16) * 0.05)(D, 3 * D)),
            "wo": _w((lambda *s: torch.randn(*s, dtype=torch.bfloat16) * 0.05)(D, D)),
        }
    _A_in = _A_setup()

    def _B_setup():
        B, S, D, F = 1, 2048, 640, 1728
        return {
            "x": _w((lambda *s: torch.randn(*s, dtype=torch.bfloat16) * 0.05)(B, S, D)),
            "w_gate": _w((lambda *s: torch.randn(*s, dtype=torch.bfloat16) * 0.05)(D, F)),
            "w_up": _w((lambda *s: torch.randn(*s, dtype=torch.bfloat16) * 0.05)(D, F)),
            "w_down": _w((lambda *s: torch.randn(*s, dtype=torch.bfloat16) * 0.05)(F, D)),
        }
    _B_in = _B_setup()

    return {
        "A_x": _A_in["x"],
        "A_wqkv": _A_in["wqkv"],
        "A_wo": _A_in["wo"],
        "B_x": _B_in["x"],
        "B_w_gate": _B_in["w_gate"],
        "B_w_up": _B_in["w_up"],
        "B_w_down": _B_in["w_down"],
    }

def reference(A_x, A_wqkv, A_wo, B_x, B_w_gate, B_w_up, B_w_down):
    def _A_ref(x, wqkv, wo):
        B, S, D = x.shape
        H = 32; Dh = D // H
        qkv = (lambda x, *d: x.permute(*d))((x @ wqkv).reshape(B, S, 3, H, Dh), 2, 0, 3, 1, 4)
        q, k, v = qkv[0], qkv[1], qkv[2]
        phi = lambda t: torch.where(t > 0, t + 1, torch.exp(t)) + 1e-6
        pq, pk = phi(q), phi(k)
        kv = torch.einsum("bhsd,bhse->bhde", pk, v)
        z = torch.einsum("bhsd->bhd", pk)
        num = torch.einsum("bhqd,bhde->bhqe", pq, kv)
        den = torch.einsum("bhqd,bhd->bhq", pq, z)[..., None] + 1e-6
        o = num / den
        return (lambda x, *d: x.permute(*d))(o, 0, 2, 1, 3).reshape(B, S, D) @ wo

    def _B_ref(x, w_gate, w_up, w_down):
        g = _silu(x @ w_gate)
        u = x @ w_up
        return (g * u) @ w_down

    x = A_x
    x = x + _A_ref(_layernorm(x, axis=-1), A_wqkv, A_wo)
    x = x + _B_ref(_layernorm(x, axis=-1), B_w_gate, B_w_up, B_w_down)
    x = x + _A_ref(_layernorm(x, axis=-1), A_wqkv, A_wo)
    x = x + _B_ref(_layernorm(x, axis=-1), B_w_gate, B_w_up, B_w_down)
    return x
```

```asm
; @launch kernel=prep_kernel grid=(259,1,1) block=(256,1,1) lds=65536
; @launch kernel=interleave_layers__linear_attn_block__swiglu_ffn__prompt_kernel grid=(256,1,1) block=(256,1,1) lds=163840
.amdgcn_target "amdgcn-amd-amdhsa--gfx950"
.text
.globl prep_kernel
.p2align 8
.type prep_kernel,@function
prep_kernel:
    s_cmp_ge_u32 s2, 259
    s_cbranch_scc1 Lp_done
    s_load_dwordx4 s[4:7], s[0:1], 0
    s_load_dwordx2 s[8:9], s[0:1], 16
    s_load_dwordx4 s[12:15], s[0:1], 32
    s_load_dwordx2 s[10:11], s[0:1], 48
    s_load_dwordx2 s[16:17], s[0:1], 72
    v_lshrrev_b32 v2, 6, v0
    v_and_b32 v1, 63, v0
    v_readfirstlane_b32 s18, v2
    v_lshlrev_b32 v3, 4, v1
    v_lshrrev_b32 v4, 2, v1
    v_and_b32 v5, 3, v1
    v_mov_b32 v8, 0x3f803f80
    v_mov_b32 v9, 0x3f803f80
    v_mov_b32 v10, 0x3f803f80
    v_mov_b32 v11, 0x3f803f80
    s_waitcnt lgkmcnt(0)
    s_mov_b32 s20, s16
    s_mov_b32 s21, s17
    s_mov_b32 s22, 50331648
    s_mov_b32 s23, 0x20000
    s_cmp_ge_u32 s2, 256
    s_cbranch_scc1 Lp_nopois
    v_mov_b32 v16, -1
    v_mov_b32 v17, -1
    v_mov_b32 v18, -1
    v_mov_b32 v19, -1
    v_lshlrev_b32 v20, 4, v0
    s_lshl_b32 s30, s2, 13
    s_add_u32 s30, s30, 1048576
    v_lshrrev_b32 v21, 5, v0
    v_lshlrev_b32 v21, 10, v21
    v_and_b32 v22, 31, v0
    v_lshlrev_b32 v22, 4, v22
    v_add_u32 v21, v21, v22
    buffer_store_dwordx4 v[16:19], v21, s[20:23], s30 offen
Lp_nopois:
    s_cmp_ge_u32 s2, 258
    s_cbranch_scc1 Lp_zero
    s_cmp_ge_u32 s2, 194
    s_cbranch_scc1 Lp_x
    s_cmp_ge_u32 s2, 140
    s_cbranch_scc1 Lp_wd
    s_cmp_ge_u32 s2, 120
    s_cbranch_scc1 Lp_wo
    s_cmp_ge_u32 s2, 40
    s_cbranch_scc1 Lp_wgu
    s_mov_b32 s24, s6
    s_mov_b32 s25, s7
    s_mov_b32 s26, 2457600
    s_mov_b32 s27, 0x20000
    s_lshr_b32 s30, s2, 1
    s_and_b32 s31, s2, 1
    s_mul_i32 s32, s30, 13
    s_lshr_b32 s32, s32, 6
    s_mul_i32 s33, s32, 5
    s_sub_u32 s33, s30, s33
    s_lshr_b32 s34, s18, 1
    s_mov_b32 s35, 0x47520
    s_cmp_eq_u32 s34, 0
    s_cselect_b32 s35, s35, 0x98631
    s_lshl_b32 s46, s33, 2
    s_lshr_b32 s35, s35, s46
    s_and_b32 s35, s35, 15
    s_mul_i32 s36, s32, 10
    s_add_u32 s35, s35, s36
    s_lshl_b32 s35, s35, 4
    s_and_b32 s36, s18, 1
    s_lshl_b32 s36, s36, 3
    s_add_u32 s35, s35, s36
    s_mul_i32 s35, s35, 3840
    s_mul_i32 s36, s31, 640
    s_add_u32 s35, s35, s36
    s_mul_i32 s37, s18, 15616
    s_mov_b32 exec_lo, -1
    s_mov_b32 exec_hi, 0xff
    s_add_u32 m0, s37, 0
    s_add_u32 s29, s35, 0
    buffer_load_dwordx4 v3, s[24:27], s29 offen lds
    s_add_u32 m0, s37, 640
    s_add_u32 s29, s35, 1280
    buffer_load_dwordx4 v3, s[24:27], s29 offen lds
    s_add_u32 m0, s37, 1280
    s_add_u32 s29, s35, 2560
    buffer_load_dwordx4 v3, s[24:27], s29 offen lds
    s_add_u32 m0, s37, 1952
    s_add_u32 s29, s35, 3840
    buffer_load_dwordx4 v3, s[24:27], s29 offen lds
    s_add_u32 m0, s37, 2592
    s_add_u32 s29, s35, 5120
    buffer_load_dwordx4 v3, s[24:27], s29 offen lds
    s_add_u32 m0, s37, 3232
    s_add_u32 s29, s35, 6400
    buffer_load_dwordx4 v3, s[24:27], s29 offen lds
    s_add_u32 m0, s37, 3904
    s_add_u32 s29, s35, 7680
    buffer_load_dwordx4 v3, s[24:27], s29 offen lds
    s_add_u32 m0, s37, 4544
    s_add_u32 s29, s35, 8960
    buffer_load_dwordx4 v3, s[24:27], s29 offen lds
    s_add_u32 m0, s37, 5184
    s_add_u32 s29, s35, 10240
    buffer_load_dwordx4 v3, s[24:27], s29 offen lds
    s_add_u32 m0, s37, 5856
    s_add_u32 s29, s35, 11520
    buffer_load_dwordx4 v3, s[24:27], s29 offen lds
    s_add_u32 m0, s37, 6496
    s_add_u32 s29, s35, 12800
    buffer_load_dwordx4 v3, s[24:27], s29 offen lds
    s_add_u32 m0, s37, 7136
    s_add_u32 s29, s35, 14080
    buffer_load_dwordx4 v3, s[24:27], s29 offen lds
    s_add_u32 m0, s37, 7808
    s_add_u32 s29, s35, 15360
    buffer_load_dwordx4 v3, s[24:27], s29 offen lds
    s_add_u32 m0, s37, 8448
    s_add_u32 s29, s35, 16640
    buffer_load_dwordx4 v3, s[24:27], s29 offen lds
    s_add_u32 m0, s37, 9088
    s_add_u32 s29, s35, 17920
    buffer_load_dwordx4 v3, s[24:27], s29 offen lds
    s_add_u32 m0, s37, 9760
    s_add_u32 s29, s35, 19200
    buffer_load_dwordx4 v3, s[24:27], s29 offen lds
    s_add_u32 m0, s37, 10400
    s_add_u32 s29, s35, 20480
    buffer_load_dwordx4 v3, s[24:27], s29 offen lds
    s_add_u32 m0, s37, 11040
    s_add_u32 s29, s35, 21760
    buffer_load_dwordx4 v3, s[24:27], s29 offen lds
    s_add_u32 m0, s37, 11712
    s_add_u32 s29, s35, 23040
    buffer_load_dwordx4 v3, s[24:27], s29 offen lds
    s_add_u32 m0, s37, 12352
    s_add_u32 s29, s35, 24320
    buffer_load_dwordx4 v3, s[24:27], s29 offen lds
    s_add_u32 m0, s37, 12992
    s_add_u32 s29, s35, 25600
    buffer_load_dwordx4 v3, s[24:27], s29 offen lds
    s_add_u32 m0, s37, 13664
    s_add_u32 s29, s35, 26880
    buffer_load_dwordx4 v3, s[24:27], s29 offen lds
    s_add_u32 m0, s37, 14304
    s_add_u32 s29, s35, 28160
    buffer_load_dwordx4 v3, s[24:27], s29 offen lds
    s_add_u32 m0, s37, 14944
    s_add_u32 s29, s35, 29440
    buffer_load_dwordx4 v3, s[24:27], s29 offen lds
    s_mov_b64 exec, -1
    s_waitcnt vmcnt(0)
    s_barrier
    v_mul_u32_u24 v6, 1952, v4
    s_mul_i32 s36, s18, 160
    v_add_u32 v6, s36, v6
    v_lshlrev_b32 v16, 3, v5
    v_add_u32 v12, v6, v16
    v_and_b32 v16, 1, v5
    v_mul_u32_u24 v16, 40, v16
    v_add_u32 v13, v6, v16
    v_lshrrev_b32 v16, 1, v5
    v_mul_u32_u24 v16, 640, v16
    v_add_u32 v14, v13, v16
    s_mov_b32 s40, 0x00010001
    s_mov_b32 s41, 0x00010001
    v_and_b32 v7, 0x30, v1
    s_lshl_b32 s36, s31, 3
    s_lshl_b32 s38, s18, 1
    s_add_u32 s36, s36, s38
    s_mul_i32 s38, s36, 163840
    s_add_u32 s38, s38, 35651584
    s_mul_i32 s39, s30, 5120
    s_add_u32 s39, s39, s38
    s_mul_i32 s42, s30, 3072
    s_add_u32 s42, s42, s38
    s_add_u32 s42, s42, 102400
    s_lshl_b32 s43, s30, 4
    s_add_u32 s43, s43, s36
    s_lshl_b32 s43, s43, 9
    s_add_u32 s43, s43, 65536
    ds_read_b64_tr_b16 v[16:17], v12 offset:640
    ds_read_b64_tr_b16 v[18:19], v12 offset:31872
    ds_read_b64_tr_b16 v[20:21], v12 offset:680
    ds_read_b64_tr_b16 v[22:23], v12 offset:31912
    ds_read_b64_tr_b16 v[24:25], v12 offset:1280
    ds_read_b64_tr_b16 v[26:27], v12 offset:32512
    ds_read_b64_tr_b16 v[28:29], v12 offset:1320
    ds_read_b64_tr_b16 v[30:31], v12 offset:32552
    ds_read_b64_tr_b16 v[32:33], v14 offset:672
    ds_read_b64_tr_b16 v[34:35], v14 offset:31904
    ds_read_b64_tr_b16 v[36:37], v12 offset:0
    ds_read_b64_tr_b16 v[38:39], v12 offset:31232
    ds_read_b64_tr_b16 v[40:41], v12 offset:40
    ds_read_b64_tr_b16 v[42:43], v12 offset:31272
    ds_read_b64_tr_b16 v[44:45], v13 offset:32
    ds_read_b64_tr_b16 v[46:47], v13 offset:31264
    ds_read_b64_tr_b16 v[48:49], v12 offset:720
    ds_read_b64_tr_b16 v[50:51], v12 offset:31952
    ds_read_b64_tr_b16 v[52:53], v12 offset:760
    ds_read_b64_tr_b16 v[54:55], v12 offset:31992
    ds_read_b64_tr_b16 v[56:57], v12 offset:1360
    ds_read_b64_tr_b16 v[58:59], v12 offset:32592
    ds_read_b64_tr_b16 v[60:61], v12 offset:1400
    ds_read_b64_tr_b16 v[62:63], v12 offset:32632
    ds_read_b64_tr_b16 v[64:65], v14 offset:752
    ds_read_b64_tr_b16 v[66:67], v14 offset:31984
    ds_read_b64_tr_b16 v[68:69], v12 offset:80
    ds_read_b64_tr_b16 v[70:71], v12 offset:31312
    ds_read_b64_tr_b16 v[72:73], v12 offset:120
    ds_read_b64_tr_b16 v[74:75], v12 offset:31352
    ds_read_b64_tr_b16 v[76:77], v13 offset:112
    ds_read_b64_tr_b16 v[78:79], v13 offset:31344
    s_add_u32 s29, s39, 0
    s_waitcnt lgkmcnt(15)
    buffer_store_dwordx4 v[16:19], v3, s[20:23], s29 offen
    v_mfma_f32_16x16x32_bf16 v[96:99], v[16:19], v[8:11], 0
    s_add_u32 s29, s39, 1024
    buffer_store_dwordx4 v[20:23], v3, s[20:23], s29 offen
    v_mfma_f32_16x16x32_bf16 v[100:103], v[20:23], v[8:11], 0
    s_add_u32 s29, s39, 2048
    buffer_store_dwordx4 v[24:27], v3, s[20:23], s29 offen
    v_mfma_f32_16x16x32_bf16 v[104:107], v[24:27], v[8:11], 0
    s_add_u32 s29, s39, 3072
    buffer_store_dwordx4 v[28:31], v3, s[20:23], s29 offen
    v_mfma_f32_16x16x32_bf16 v[108:111], v[28:31], v[8:11], 0
    s_add_u32 s29, s43, 0
    s_mov_b64 exec, s[40:41]
    buffer_store_dwordx4 v[96:99], v7, s[20:23], s29 offen
    s_mov_b64 exec, -1
    s_add_u32 s29, s43, 64
    s_mov_b64 exec, s[40:41]
    buffer_store_dwordx4 v[100:103], v7, s[20:23], s29 offen
    s_mov_b64 exec, -1
    s_add_u32 s29, s43, 128
    s_mov_b64 exec, s[40:41]
    buffer_store_dwordx4 v[104:107], v7, s[20:23], s29 offen
    s_mov_b64 exec, -1
    s_add_u32 s29, s43, 192
    s_mov_b64 exec, s[40:41]
    buffer_store_dwordx4 v[108:111], v7, s[20:23], s29 offen
    s_mov_b64 exec, -1
    s_add_u32 s29, s39, 4096
    buffer_store_dwordx4 v[32:35], v3, s[20:23], s29 offen
    v_mfma_f32_16x16x32_bf16 v[96:99], v[32:35], v[8:11], 0
    s_add_u32 s29, s42, 0
    buffer_store_dwordx4 v[36:39], v3, s[20:23], s29 offen
    v_mfma_f32_16x16x32_bf16 v[100:103], v[36:39], v[8:11], 0
    s_add_u32 s29, s42, 1024
    buffer_store_dwordx4 v[40:43], v3, s[20:23], s29 offen
    v_mfma_f32_16x16x32_bf16 v[104:107], v[40:43], v[8:11], 0
    s_add_u32 s29, s42, 2048
    buffer_store_dwordx4 v[44:47], v3, s[20:23], s29 offen
    v_mfma_f32_16x16x32_bf16 v[108:111], v[44:47], v[8:11], 0
    s_add_u32 s29, s43, 256
    s_mov_b64 exec, s[40:41]
    buffer_store_dwordx4 v[96:99], v7, s[20:23], s29 offen
    s_mov_b64 exec, -1
    s_add_u32 s29, s43, 320
    s_mov_b64 exec, s[40:41]
    buffer_store_dwordx4 v[100:103], v7, s[20:23], s29 offen
    s_mov_b64 exec, -1
    s_add_u32 s29, s43, 384
    s_mov_b64 exec, s[40:41]
    buffer_store_dwordx4 v[104:107], v7, s[20:23], s29 offen
    s_mov_b64 exec, -1
    s_add_u32 s29, s43, 448
    s_mov_b64 exec, s[40:41]
    buffer_store_dwordx4 v[108:111], v7, s[20:23], s29 offen
    s_mov_b64 exec, -1
    s_add_u32 s29, s39, 163840
    s_waitcnt lgkmcnt(14)
    buffer_store_dwordx4 v[48:51], v3, s[20:23], s29 offen
    v_mfma_f32_16x16x32_bf16 v[96:99], v[48:51], v[8:11], 0
    s_add_u32 s29, s39, 164864
    s_waitcnt lgkmcnt(12)
    buffer_store_dwordx4 v[52:55], v3, s[20:23], s29 offen
    v_mfma_f32_16x16x32_bf16 v[100:103], v[52:55], v[8:11], 0
    s_add_u32 s29, s39, 165888
    s_waitcnt lgkmcnt(10)
    buffer_store_dwordx4 v[56:59], v3, s[20:23], s29 offen
    v_mfma_f32_16x16x32_bf16 v[104:107], v[56:59], v[8:11], 0
    s_add_u32 s29, s39, 166912
    s_waitcnt lgkmcnt(8)
    buffer_store_dwordx4 v[60:63], v3, s[20:23], s29 offen
    v_mfma_f32_16x16x32_bf16 v[108:111], v[60:63], v[8:11], 0
    s_add_u32 s29, s43, 512
    s_mov_b64 exec, s[40:41]
    buffer_store_dwordx4 v[96:99], v7, s[20:23], s29 offen
    s_mov_b64 exec, -1
    s_add_u32 s29, s43, 576
    s_mov_b64 exec, s[40:41]
    buffer_store_dwordx4 v[100:103], v7, s[20:23], s29 offen
    s_mov_b64 exec, -1
    s_add_u32 s29, s43, 640
    s_mov_b64 exec, s[40:41]
    buffer_store_dwordx4 v[104:107], v7, s[20:23], s29 offen
    s_mov_b64 exec, -1
    s_add_u32 s29, s43, 704
    s_mov_b64 exec, s[40:41]
    buffer_store_dwordx4 v[108:111], v7, s[20:23], s29 offen
    s_mov_b64 exec, -1
    s_add_u32 s29, s39, 167936
    s_waitcnt lgkmcnt(6)
    buffer_store_dwordx4 v[64:67], v3, s[20:23], s29 offen
    v_mfma_f32_16x16x32_bf16 v[96:99], v[64:67], v[8:11], 0
    s_add_u32 s29, s42, 163840
    s_waitcnt lgkmcnt(4)
    buffer_store_dwordx4 v[68:71], v3, s[20:23], s29 offen
    v_mfma_f32_16x16x32_bf16 v[100:103], v[68:71], v[8:11], 0
    s_add_u32 s29, s42, 164864
    s_waitcnt lgkmcnt(2)
    buffer_store_dwordx4 v[72:75], v3, s[20:23], s29 offen
    v_mfma_f32_16x16x32_bf16 v[104:107], v[72:75], v[8:11], 0
    s_add_u32 s29, s42, 165888
    s_waitcnt lgkmcnt(0)
    buffer_store_dwordx4 v[76:79], v3, s[20:23], s29 offen
    v_mfma_f32_16x16x32_bf16 v[108:111], v[76:79], v[8:11], 0
    s_add_u32 s29, s43, 768
    s_mov_b64 exec, s[40:41]
    buffer_store_dwordx4 v[96:99], v7, s[20:23], s29 offen
    s_mov_b64 exec, -1
    s_add_u32 s29, s43, 832
    s_mov_b64 exec, s[40:41]
    buffer_store_dwordx4 v[100:103], v7, s[20:23], s29 offen
    s_mov_b64 exec, -1
    s_add_u32 s29, s43, 896
    s_mov_b64 exec, s[40:41]
    buffer_store_dwordx4 v[104:107], v7, s[20:23], s29 offen
    s_mov_b64 exec, -1
    s_add_u32 s29, s43, 960
    s_mov_b64 exec, s[40:41]
    buffer_store_dwordx4 v[108:111], v7, s[20:23], s29 offen
    s_mov_b64 exec, -1
    s_endpgm
Lp_wgu:
    s_sub_u32 s30, s2, 40
    s_cmp_ge_u32 s30, 40
    s_cbranch_scc1 Lp_wu
    s_mov_b32 s24, s12
    s_mov_b32 s25, s13
    s_mov_b32 s26, 2211840
    s_mov_b32 s27, 0x20000
    s_mov_b32 s34, 0
    s_branch Lp_wgu2
Lp_wu:
    s_mov_b32 s24, s14
    s_mov_b32 s25, s15
    s_mov_b32 s26, 2211840
    s_mov_b32 s27, 0x20000
    s_mov_b32 s34, 1
    s_sub_u32 s30, s30, 40
Lp_wgu2:
    s_lshr_b32 s31, s30, 2
    s_and_b32 s32, s30, 3
    s_lshr_b32 s33, s18, 1
    s_lshl_b32 s35, s31, 1
    s_add_u32 s33, s33, s35
    s_mul_i32 s35, s33, 13
    s_lshr_b32 s35, s35, 6
    s_mul_i32 s36, s35, 5
    s_sub_u32 s36, s33, s36
    s_and_b32 s37, s18, 1
    s_mov_b32 s38, 0x47520
    s_cmp_eq_u32 s37, 0
    s_cselect_b32 s38, s38, 0x98631
    s_lshl_b32 s46, s36, 2
    s_lshr_b32 s38, s38, s46
    s_and_b32 s38, s38, 15
    s_mul_i32 s35, s35, 10
    s_add_u32 s38, s38, s35
    s_lshl_b32 s38, s38, 4
    s_mul_i32 s38, s38, 3456
    s_mul_i32 s35, s32, 864
    s_add_u32 s38, s38, s35
    s_mul_i32 s37, s18, 14848
    s_mov_b32 exec_lo, -1
    s_mov_b32 exec_hi, 0x3fffff
    s_add_u32 m0, s37, 0
    s_add_u32 s29, s38, 0
    buffer_load_dwordx4 v3, s[24:27], s29 offen lds
    s_add_u32 m0, s37, 928
    s_add_u32 s29, s38, 3456
    buffer_load_dwordx4 v3, s[24:27], s29 offen lds
    s_add_u32 m0, s37, 1856
    s_add_u32 s29, s38, 6912
    buffer_load_dwordx4 v3, s[24:27], s29 offen lds
    s_add_u32 m0, s37, 2784
    s_add_u32 s29, s38, 10368
    buffer_load_dwordx4 v3, s[24:27], s29 offen lds
    s_add_u32 m0, s37, 3712
    s_add_u32 s29, s38, 13824
    buffer_load_dwordx4 v3, s[24:27], s29 offen lds
    s_add_u32 m0, s37, 4640
    s_add_u32 s29, s38, 17280
    buffer_load_dwordx4 v3, s[24:27], s29 offen lds
    s_add_u32 m0, s37, 5568
    s_add_u32 s29, s38, 20736
    buffer_load_dwordx4 v3, s[24:27], s29 offen lds
    s_add_u32 m0, s37, 6496
    s_add_u32 s29, s38, 24192
    buffer_load_dwordx4 v3, s[24:27], s29 offen lds
    s_add_u32 m0, s37, 7424
    s_add_u32 s29, s38, 27648
    buffer_load_dwordx4 v3, s[24:27], s29 offen lds
    s_add_u32 m0, s37, 8352
    s_add_u32 s29, s38, 31104
    buffer_load_dwordx4 v3, s[24:27], s29 offen lds
    s_add_u32 m0, s37, 9280
    s_add_u32 s29, s38, 34560
    buffer_load_dwordx4 v3, s[24:27], s29 offen lds
    s_add_u32 m0, s37, 10208
    s_add_u32 s29, s38, 38016
    buffer_load_dwordx4 v3, s[24:27], s29 offen lds
    s_add_u32 m0, s37, 11136
    s_add_u32 s29, s38, 41472
    buffer_load_dwordx4 v3, s[24:27], s29 offen lds
    s_add_u32 m0, s37, 12064
    s_add_u32 s29, s38, 44928
    buffer_load_dwordx4 v3, s[24:27], s29 offen lds
    s_add_u32 m0, s37, 12992
    s_add_u32 s29, s38, 48384
    buffer_load_dwordx4 v3, s[24:27], s29 offen lds
    s_add_u32 m0, s37, 13920
    s_add_u32 s29, s38, 51840
    buffer_load_dwordx4 v3, s[24:27], s29 offen lds
    s_mov_b64 exec, -1
    s_waitcnt vmcnt(0)
    s_barrier
    v_mul_u32_u24 v6, 928, v4
    s_mul_i32 s36, s18, 216
    v_add_u32 v6, s36, v6
    v_lshlrev_b32 v16, 3, v5
    v_add_u32 v12, v6, v16
    s_mov_b32 s40, 0x00010001
    s_mov_b32 s41, 0x00010001
    v_and_b32 v7, 0x30, v1
    s_lshl_b32 s36, s32, 2
    s_add_u32 s36, s36, s18
    s_mul_i32 s38, s36, 286720
    s_add_u32 s38, s38, 39845888
    s_lshl_b32 s39, s34, 8
    s_add_u32 s38, s38, s39
    v_lshrrev_b32 v13, 5, v1
    v_lshlrev_b32 v13, 10, v13
    v_bfe_u32 v14, v1, 4, 1
    v_lshlrev_b32 v14, 9, v14
    v_add_u32 v13, v13, v14
    v_and_b32 v14, 15, v1
    v_lshlrev_b32 v14, 4, v14
    v_add_u32 v13, v13, v14
    s_mov_b32 s54, 4096
    s_mov_b32 s55, 40960
    s_mul_i32 s39, s31, 24576
    s_lshl_b32 s56, s31, 13
    s_add_u32 s56, s56, 81920
    s_cmp_lt_u32 s31, 5
    s_cselect_b32 s54, 12288, s54
    s_cselect_b32 s55, 4096, s55
    s_cselect_b32 s39, s39, s56
    s_add_u32 s48, s38, s39
    s_add_u32 s49, s48, s55
    s_add_u32 s50, s49, s55
    s_add_u32 s51, s48, s54
    s_add_u32 s52, s49, s54
    s_add_u32 s53, s50, s54
    s_lshl_b32 s39, s31, 12
    s_add_u32 s44, s38, s39
    s_add_u32 s44, s44, 245760
    s_lshl_b32 s45, s31, 4
    s_add_u32 s45, s45, s36
    s_mul_i32 s45, s45, 14
    s_add_u32 s45, s45, s34
    s_lshl_b32 s45, s45, 6
    s_add_u32 s45, s45, 229376
    ds_read_b64_tr_b16 v[16:17], v12 offset:0
    ds_read_b64_tr_b16 v[18:19], v12 offset:14848
    ds_read_b64_tr_b16 v[20:21], v12 offset:29696
    ds_read_b64_tr_b16 v[22:23], v12 offset:44544
    ds_read_b64_tr_b16 v[24:25], v12 offset:32
    ds_read_b64_tr_b16 v[26:27], v12 offset:14880
    ds_read_b64_tr_b16 v[28:29], v12 offset:29728
    ds_read_b64_tr_b16 v[30:31], v12 offset:44576
    ds_read_b64_tr_b16 v[32:33], v12 offset:64
    ds_read_b64_tr_b16 v[34:35], v12 offset:14912
    ds_read_b64_tr_b16 v[36:37], v12 offset:29760
    ds_read_b64_tr_b16 v[38:39], v12 offset:44608
    ds_read_b64_tr_b16 v[40:41], v12 offset:96
    ds_read_b64_tr_b16 v[42:43], v12 offset:14944
    ds_read_b64_tr_b16 v[44:45], v12 offset:29792
    ds_read_b64_tr_b16 v[46:47], v12 offset:44640
    ds_read_b64_tr_b16 v[48:49], v12 offset:128
    ds_read_b64_tr_b16 v[50:51], v12 offset:14976
    ds_read_b64_tr_b16 v[52:53], v12 offset:29824
    ds_read_b64_tr_b16 v[54:55], v12 offset:44672
    ds_read_b64_tr_b16 v[56:57], v12 offset:160
    ds_read_b64_tr_b16 v[58:59], v12 offset:15008
    ds_read_b64_tr_b16 v[60:61], v12 offset:29856
    ds_read_b64_tr_b16 v[62:63], v12 offset:44704
    ds_read_b64_tr_b16 v[64:65], v12 offset:192
    ds_read_b64_tr_b16 v[66:67], v12 offset:15040
    ds_read_b64_tr_b16 v[68:69], v12 offset:29888
    ds_read_b64_tr_b16 v[70:71], v12 offset:44736
    s_add_u32 s29, s48, 0
    s_waitcnt lgkmcnt(15)
    buffer_store_dwordx4 v[16:19], v13, s[20:23], s29 offen
    v_mfma_f32_16x16x32_bf16 v[96:99], v[16:19], v[8:11], 0
    s_add_u32 s29, s51, 0
    buffer_store_dwordx4 v[20:23], v13, s[20:23], s29 offen
    v_mfma_f32_16x16x32_bf16 v[96:99], v[20:23], v[8:11], v[96:99]
    s_add_u32 s29, s48, 2048
    buffer_store_dwordx4 v[24:27], v13, s[20:23], s29 offen
    v_mfma_f32_16x16x32_bf16 v[100:103], v[24:27], v[8:11], 0
    s_add_u32 s29, s51, 2048
    buffer_store_dwordx4 v[28:31], v13, s[20:23], s29 offen
    v_mfma_f32_16x16x32_bf16 v[100:103], v[28:31], v[8:11], v[100:103]
    s_add_u32 s29, s49, 0
    buffer_store_dwordx4 v[32:35], v13, s[20:23], s29 offen
    v_mfma_f32_16x16x32_bf16 v[104:107], v[32:35], v[8:11], 0
    s_add_u32 s29, s52, 0
    buffer_store_dwordx4 v[36:39], v13, s[20:23], s29 offen
    v_mfma_f32_16x16x32_bf16 v[104:107], v[36:39], v[8:11], v[104:107]
    s_add_u32 s29, s49, 2048
    s_waitcnt lgkmcnt(14)
    buffer_store_dwordx4 v[40:43], v13, s[20:23], s29 offen
    v_mfma_f32_16x16x32_bf16 v[108:111], v[40:43], v[8:11], 0
    s_add_u32 s29, s52, 2048
    s_waitcnt lgkmcnt(12)
    buffer_store_dwordx4 v[44:47], v13, s[20:23], s29 offen
    v_mfma_f32_16x16x32_bf16 v[108:111], v[44:47], v[8:11], v[108:111]
    s_add_u32 s29, s45, 0
    s_mov_b64 exec, s[40:41]
    buffer_store_dwordx4 v[96:99], v7, s[20:23], s29 offen
    s_mov_b64 exec, -1
    s_add_u32 s29, s45, 128
    s_mov_b64 exec, s[40:41]
    buffer_store_dwordx4 v[100:103], v7, s[20:23], s29 offen
    s_mov_b64 exec, -1
    s_add_u32 s29, s45, 256
    s_mov_b64 exec, s[40:41]
    buffer_store_dwordx4 v[104:107], v7, s[20:23], s29 offen
    s_mov_b64 exec, -1
    s_add_u32 s29, s45, 384
    s_mov_b64 exec, s[40:41]
    buffer_store_dwordx4 v[108:111], v7, s[20:23], s29 offen
    s_mov_b64 exec, -1
    s_add_u32 s29, s50, 0
    s_waitcnt lgkmcnt(10)
    buffer_store_dwordx4 v[48:51], v13, s[20:23], s29 offen
    v_mfma_f32_16x16x32_bf16 v[96:99], v[48:51], v[8:11], 0
    s_add_u32 s29, s53, 0
    s_waitcnt lgkmcnt(8)
    buffer_store_dwordx4 v[52:55], v13, s[20:23], s29 offen
    v_mfma_f32_16x16x32_bf16 v[96:99], v[52:55], v[8:11], v[96:99]
    s_add_u32 s29, s50, 2048
    s_waitcnt lgkmcnt(6)
    buffer_store_dwordx4 v[56:59], v13, s[20:23], s29 offen
    v_mfma_f32_16x16x32_bf16 v[100:103], v[56:59], v[8:11], 0
    s_add_u32 s29, s53, 2048
    s_waitcnt lgkmcnt(4)
    buffer_store_dwordx4 v[60:63], v13, s[20:23], s29 offen
    v_mfma_f32_16x16x32_bf16 v[100:103], v[60:63], v[8:11], v[100:103]
    s_add_u32 s29, s44, 0
    s_waitcnt lgkmcnt(2)
    buffer_store_dwordx4 v[64:67], v13, s[20:23], s29 offen
    v_mfma_f32_16x16x32_bf16 v[104:107], v[64:67], v[8:11], 0
    s_add_u32 s29, s44, 2048
    s_waitcnt lgkmcnt(0)
    buffer_store_dwordx4 v[68:71], v13, s[20:23], s29 offen
    v_mfma_f32_16x16x32_bf16 v[104:107], v[68:71], v[8:11], v[104:107]
    s_add_u32 s29, s45, 512
    s_mov_b64 exec, s[40:41]
    buffer_store_dwordx4 v[96:99], v7, s[20:23], s29 offen
    s_mov_b64 exec, -1
    s_add_u32 s29, s45, 640
    s_mov_b64 exec, s[40:41]
    buffer_store_dwordx4 v[100:103], v7, s[20:23], s29 offen
    s_mov_b64 exec, -1
    s_add_u32 s29, s45, 768
    s_mov_b64 exec, s[40:41]
    buffer_store_dwordx4 v[104:107], v7, s[20:23], s29 offen
    s_mov_b64 exec, -1
    s_endpgm
Lp_wo:
    s_mov_b32 s24, s8
    s_mov_b32 s25, s9
    s_mov_b32 s26, 819200
    s_mov_b32 s27, 0x20000
    s_sub_u32 s30, s2, 120
    s_mul_i32 s37, s18, 10496
    s_mov_b32 exec_lo, -1
    s_mov_b32 exec_hi, 0xff
    s_cmp_ge_u32 s30, 16
    s_cbranch_scc1 Lp_wo2
    s_mul_i32 s31, s30, 40
    s_lshr_b32 s32, s18, 1
    s_mul_i32 s32, s32, 20
    s_add_u32 s31, s31, s32
    s_and_b32 s32, s18, 1
    s_lshl_b32 s32, s32, 3
    s_add_u32 s31, s31, s32
    s_mul_i32 s31, s31, 1280
    s_add_u32 m0, s37, 0
    s_add_u32 s29, s31, 0
    buffer_load_dwordx4 v3, s[24:27], s29 offen lds
    s_add_u32 m0, s37, 640
    s_add_u32 s29, s31, 640
    buffer_load_dwordx4 v3, s[24:27], s29 offen lds
    s_add_u32 m0, s37, 1312
    s_add_u32 s29, s31, 1280
    buffer_load_dwordx4 v3, s[24:27], s29 offen lds
    s_add_u32 m0, s37, 1952
    s_add_u32 s29, s31, 1920
    buffer_load_dwordx4 v3, s[24:27], s29 offen lds
    s_add_u32 m0, s37, 2624
    s_add_u32 s29, s31, 2560
    buffer_load_dwordx4 v3, s[24:27], s29 offen lds
    s_add_u32 m0, s37, 3264
    s_add_u32 s29, s31, 3200
    buffer_load_dwordx4 v3, s[24:27], s29 offen lds
    s_add_u32 m0, s37, 3936
    s_add_u32 s29, s31, 3840
    buffer_load_dwordx4 v3, s[24:27], s29 offen lds
    s_add_u32 m0, s37, 4576
    s_add_u32 s29, s31, 4480
    buffer_load_dwordx4 v3, s[24:27], s29 offen lds
    s_add_u32 m0, s37, 5248
    s_add_u32 s29, s31, 5120
    buffer_load_dwordx4 v3, s[24:27], s29 offen lds
    s_add_u32 m0, s37, 5888
    s_add_u32 s29, s31, 5760
    buffer_load_dwordx4 v3, s[24:27], s29 offen lds
    s_add_u32 m0, s37, 6560
    s_add_u32 s29, s31, 6400
    buffer_load_dwordx4 v3, s[24:27], s29 offen lds
    s_add_u32 m0, s37, 7200
    s_add_u32 s29, s31, 7040
    buffer_load_dwordx4 v3, s[24:27], s29 offen lds
    s_add_u32 m0, s37, 7872
    s_add_u32 s29, s31, 7680
    buffer_load_dwordx4 v3, s[24:27], s29 offen lds
    s_add_u32 m0, s37, 8512
    s_add_u32 s29, s31, 8320
    buffer_load_dwordx4 v3, s[24:27], s29 offen lds
    s_add_u32 m0, s37, 9184
    s_add_u32 s29, s31, 8960
    buffer_load_dwordx4 v3, s[24:27], s29 offen lds
    s_add_u32 m0, s37, 9824
    s_add_u32 s29, s31, 9600
    buffer_load_dwordx4 v3, s[24:27], s29 offen lds
    s_branch Lp_wo3
Lp_wo2:
    s_sub_u32 s31, s30, 16
    s_mul_i32 s31, s31, 160
    s_mul_i32 s32, s18, 40
    s_add_u32 s31, s31, s32
    s_mul_i32 s31, s31, 1280
    s_add_u32 m0, s37, 0
    s_add_u32 s29, s31, 20480
    buffer_load_dwordx4 v3, s[24:27], s29 offen lds
    s_add_u32 m0, s37, 640
    s_add_u32 s29, s31, 21120
    buffer_load_dwordx4 v3, s[24:27], s29 offen lds
    s_add_u32 m0, s37, 1312
    s_add_u32 s29, s31, 21760
    buffer_load_dwordx4 v3, s[24:27], s29 offen lds
    s_add_u32 m0, s37, 1952
    s_add_u32 s29, s31, 22400
    buffer_load_dwordx4 v3, s[24:27], s29 offen lds
    s_add_u32 m0, s37, 2624
    s_add_u32 s29, s31, 23040
    buffer_load_dwordx4 v3, s[24:27], s29 offen lds
    s_add_u32 m0, s37, 3264
    s_add_u32 s29, s31, 23680
    buffer_load_dwordx4 v3, s[24:27], s29 offen lds
    s_add_u32 m0, s37, 3936
    s_add_u32 s29, s31, 24320
    buffer_load_dwordx4 v3, s[24:27], s29 offen lds
    s_add_u32 m0, s37, 4576
    s_add_u32 s29, s31, 24960
    buffer_load_dwordx4 v3, s[24:27], s29 offen lds
    s_add_u32 m0, s37, 5248
    s_add_u32 s29, s31, 46080
    buffer_load_dwordx4 v3, s[24:27], s29 offen lds
    s_add_u32 m0, s37, 5888
    s_add_u32 s29, s31, 46720
    buffer_load_dwordx4 v3, s[24:27], s29 offen lds
    s_add_u32 m0, s37, 6560
    s_add_u32 s29, s31, 47360
    buffer_load_dwordx4 v3, s[24:27], s29 offen lds
    s_add_u32 m0, s37, 7200
    s_add_u32 s29, s31, 48000
    buffer_load_dwordx4 v3, s[24:27], s29 offen lds
    s_add_u32 m0, s37, 7872
    s_add_u32 s29, s31, 48640
    buffer_load_dwordx4 v3, s[24:27], s29 offen lds
    s_add_u32 m0, s37, 8512
    s_add_u32 s29, s31, 49280
    buffer_load_dwordx4 v3, s[24:27], s29 offen lds
    s_add_u32 m0, s37, 9184
    s_add_u32 s29, s31, 49920
    buffer_load_dwordx4 v3, s[24:27], s29 offen lds
    s_add_u32 m0, s37, 9824
    s_add_u32 s29, s31, 50560
    buffer_load_dwordx4 v3, s[24:27], s29 offen lds
Lp_wo3:
    s_mov_b64 exec, -1
    s_waitcnt vmcnt(0)
    s_barrier
    v_mul_u32_u24 v6, 1312, v4
    s_mul_i32 s36, s18, 320
    v_add_u32 v6, s36, v6
    v_lshlrev_b32 v16, 3, v5
    v_add_u32 v12, v6, v16
    s_lshl_b32 s36, s18, 1
    s_mul_i32 s38, s36, 102400
    s_add_u32 s38, s38, 38273024
    s_mul_i32 s39, s30, 5120
    s_add_u32 s38, s38, s39
    ds_read_b64_tr_b16 v[16:17], v12 offset:0
    ds_read_b64_tr_b16 v[18:19], v12 offset:20992
    ds_read_b64_tr_b16 v[20:21], v12 offset:32
    ds_read_b64_tr_b16 v[22:23], v12 offset:21024
    ds_read_b64_tr_b16 v[24:25], v12 offset:64
    ds_read_b64_tr_b16 v[26:27], v12 offset:21056
    ds_read_b64_tr_b16 v[28:29], v12 offset:96
    ds_read_b64_tr_b16 v[30:31], v12 offset:21088
    ds_read_b64_tr_b16 v[32:33], v12 offset:128
    ds_read_b64_tr_b16 v[34:35], v12 offset:21120
    ds_read_b64_tr_b16 v[36:37], v12 offset:160
    ds_read_b64_tr_b16 v[38:39], v12 offset:21152
    ds_read_b64_tr_b16 v[40:41], v12 offset:192
    ds_read_b64_tr_b16 v[42:43], v12 offset:21184
    ds_read_b64_tr_b16 v[44:45], v12 offset:224
    ds_read_b64_tr_b16 v[46:47], v12 offset:21216
    ds_read_b64_tr_b16 v[48:49], v12 offset:256
    ds_read_b64_tr_b16 v[50:51], v12 offset:21248
    ds_read_b64_tr_b16 v[52:53], v12 offset:288
    ds_read_b64_tr_b16 v[54:55], v12 offset:21280
    s_add_u32 s29, s38, 0
    s_waitcnt lgkmcnt(15)
    buffer_store_dwordx4 v[16:19], v3, s[20:23], s29 offen
    s_add_u32 s29, s38, 1024
    buffer_store_dwordx4 v[20:23], v3, s[20:23], s29 offen
    s_add_u32 s29, s38, 2048
    s_waitcnt lgkmcnt(14)
    buffer_store_dwordx4 v[24:27], v3, s[20:23], s29 offen
    s_add_u32 s29, s38, 3072
    s_waitcnt lgkmcnt(12)
    buffer_store_dwordx4 v[28:31], v3, s[20:23], s29 offen
    s_add_u32 s29, s38, 4096
    s_waitcnt lgkmcnt(10)
    buffer_store_dwordx4 v[32:35], v3, s[20:23], s29 offen
    s_add_u32 s29, s38, 102400
    s_waitcnt lgkmcnt(8)
    buffer_store_dwordx4 v[36:39], v3, s[20:23], s29 offen
    s_add_u32 s29, s38, 103424
    s_waitcnt lgkmcnt(6)
    buffer_store_dwordx4 v[40:43], v3, s[20:23], s29 offen
    s_add_u32 s29, s38, 104448
    s_waitcnt lgkmcnt(4)
    buffer_store_dwordx4 v[44:47], v3, s[20:23], s29 offen
    s_add_u32 s29, s38, 105472
    s_waitcnt lgkmcnt(2)
    buffer_store_dwordx4 v[48:51], v3, s[20:23], s29 offen
    s_add_u32 s29, s38, 106496
    s_waitcnt lgkmcnt(0)
    buffer_store_dwordx4 v[52:55], v3, s[20:23], s29 offen
    s_endpgm
Lp_wd:
    s_mov_b32 s24, s10
    s_mov_b32 s25, s11
    s_mov_b32 s26, 2211840
    s_mov_b32 s27, 0x20000
    s_sub_u32 s30, s2, 140
    s_mul_i32 s37, s18, 10496
    s_mov_b32 exec_lo, -1
    s_mov_b32 exec_hi, 0xff
    s_cmp_ge_u32 s30, 48
    s_cbranch_scc1 Lp_wd2
    s_and_b32 s31, s30, 15
    s_mul_i32 s31, s31, 108
    s_lshr_b32 s32, s30, 4
    s_lshl_b32 s32, s32, 5
    s_add_u32 s31, s31, s32
    s_and_b32 s32, s18, 1
    s_lshl_b32 s32, s32, 4
    s_add_u32 s31, s31, s32
    s_lshr_b32 s32, s18, 1
    s_lshl_b32 s32, s32, 3
    s_add_u32 s31, s31, s32
    s_mul_i32 s31, s31, 1280
    s_add_u32 m0, s37, 0
    s_add_u32 s29, s31, 0
    buffer_load_dwordx4 v3, s[24:27], s29 offen lds
    s_add_u32 m0, s37, 640
    s_add_u32 s29, s31, 640
    buffer_load_dwordx4 v3, s[24:27], s29 offen lds
    s_add_u32 m0, s37, 1312
    s_add_u32 s29, s31, 1280
    buffer_load_dwordx4 v3, s[24:27], s29 offen lds
    s_add_u32 m0, s37, 1952
    s_add_u32 s29, s31, 1920
    buffer_load_dwordx4 v3, s[24:27], s29 offen lds
    s_add_u32 m0, s37, 2624
    s_add_u32 s29, s31, 2560
    buffer_load_dwordx4 v3, s[24:27], s29 offen lds
    s_add_u32 m0, s37, 3264
    s_add_u32 s29, s31, 3200
    buffer_load_dwordx4 v3, s[24:27], s29 offen lds
    s_add_u32 m0, s37, 3936
    s_add_u32 s29, s31, 3840
    buffer_load_dwordx4 v3, s[24:27], s29 offen lds
    s_add_u32 m0, s37, 4576
    s_add_u32 s29, s31, 4480
    buffer_load_dwordx4 v3, s[24:27], s29 offen lds
    s_add_u32 m0, s37, 5248
    s_add_u32 s29, s31, 5120
    buffer_load_dwordx4 v3, s[24:27], s29 offen lds
    s_add_u32 m0, s37, 5888
    s_add_u32 s29, s31, 5760
    buffer_load_dwordx4 v3, s[24:27], s29 offen lds
    s_add_u32 m0, s37, 6560
    s_add_u32 s29, s31, 6400
    buffer_load_dwordx4 v3, s[24:27], s29 offen lds
    s_add_u32 m0, s37, 7200
    s_add_u32 s29, s31, 7040
    buffer_load_dwordx4 v3, s[24:27], s29 offen lds
    s_add_u32 m0, s37, 7872
    s_add_u32 s29, s31, 7680
    buffer_load_dwordx4 v3, s[24:27], s29 offen lds
    s_add_u32 m0, s37, 8512
    s_add_u32 s29, s31, 8320
    buffer_load_dwordx4 v3, s[24:27], s29 offen lds
    s_add_u32 m0, s37, 9184
    s_add_u32 s29, s31, 8960
    buffer_load_dwordx4 v3, s[24:27], s29 offen lds
    s_add_u32 m0, s37, 9824
    s_add_u32 s29, s31, 9600
    buffer_load_dwordx4 v3, s[24:27], s29 offen lds
    s_branch Lp_wd3
Lp_wd2:
    s_sub_u32 s31, s30, 48
    s_lshl_b32 s31, s31, 3
    s_lshl_b32 s32, s18, 1
    s_add_u32 s31, s31, s32
    s_add_u32 s31, s31, 0
    s_mul_i32 s32, s31, 43
    s_lshr_b32 s32, s32, 7
    s_mul_i32 s33, s32, 3
    s_sub_u32 s33, s31, s33
    s_lshl_b32 s33, s33, 2
    s_mul_i32 s32, s32, 108
    s_add_u32 s32, s32, s33
    s_add_u32 s32, s32, 96
    s_mul_i32 s32, s32, 1280
    s_add_u32 m0, s37, 0
    s_add_u32 s29, s32, 0
    buffer_load_dwordx4 v3, s[24:27], s29 offen lds
    s_add_u32 m0, s37, 640
    s_add_u32 s29, s32, 640
    buffer_load_dwordx4 v3, s[24:27], s29 offen lds
    s_add_u32 m0, s37, 1312
    s_add_u32 s29, s32, 1280
    buffer_load_dwordx4 v3, s[24:27], s29 offen lds
    s_add_u32 m0, s37, 1952
    s_add_u32 s29, s32, 1920
    buffer_load_dwordx4 v3, s[24:27], s29 offen lds
    s_add_u32 m0, s37, 2624
    s_add_u32 s29, s32, 2560
    buffer_load_dwordx4 v3, s[24:27], s29 offen lds
    s_add_u32 m0, s37, 3264
    s_add_u32 s29, s32, 3200
    buffer_load_dwordx4 v3, s[24:27], s29 offen lds
    s_add_u32 m0, s37, 3936
    s_add_u32 s29, s32, 3840
    buffer_load_dwordx4 v3, s[24:27], s29 offen lds
    s_add_u32 m0, s37, 4576
    s_add_u32 s29, s32, 4480
    buffer_load_dwordx4 v3, s[24:27], s29 offen lds
    s_sub_u32 s31, s30, 48
    s_lshl_b32 s31, s31, 3
    s_lshl_b32 s32, s18, 1
    s_add_u32 s31, s31, s32
    s_add_u32 s31, s31, 1
    s_mul_i32 s32, s31, 43
    s_lshr_b32 s32, s32, 7
    s_mul_i32 s33, s32, 3
    s_sub_u32 s33, s31, s33
    s_lshl_b32 s33, s33, 2
    s_mul_i32 s32, s32, 108
    s_add_u32 s32, s32, s33
    s_add_u32 s32, s32, 96
    s_mul_i32 s32, s32, 1280
    s_add_u32 m0, s37, 5248
    s_add_u32 s29, s32, 0
    buffer_load_dwordx4 v3, s[24:27], s29 offen lds
    s_add_u32 m0, s37, 5888
    s_add_u32 s29, s32, 640
    buffer_load_dwordx4 v3, s[24:27], s29 offen lds
    s_add_u32 m0, s37, 6560
    s_add_u32 s29, s32, 1280
    buffer_load_dwordx4 v3, s[24:27], s29 offen lds
    s_add_u32 m0, s37, 7200
    s_add_u32 s29, s32, 1920
    buffer_load_dwordx4 v3, s[24:27], s29 offen lds
    s_add_u32 m0, s37, 7872
    s_add_u32 s29, s32, 2560
    buffer_load_dwordx4 v3, s[24:27], s29 offen lds
    s_add_u32 m0, s37, 8512
    s_add_u32 s29, s32, 3200
    buffer_load_dwordx4 v3, s[24:27], s29 offen lds
    s_add_u32 m0, s37, 9184
    s_add_u32 s29, s32, 3840
    buffer_load_dwordx4 v3, s[24:27], s29 offen lds
    s_add_u32 m0, s37, 9824
    s_add_u32 s29, s32, 4480
    buffer_load_dwordx4 v3, s[24:27], s29 offen lds
Lp_wd3:
    s_mov_b64 exec, -1
    s_waitcnt vmcnt(0)
    s_barrier
    v_mul_u32_u24 v6, 1312, v4
    s_mul_i32 s36, s18, 320
    v_add_u32 v6, s36, v6
    v_lshlrev_b32 v16, 3, v5
    v_add_u32 v12, v6, v16
    s_lshl_b32 s36, s18, 1
    s_mul_i32 s38, s36, 276480
    s_add_u32 s38, s38, 45088768
    s_mul_i32 s39, s30, 5120
    s_add_u32 s38, s38, s39
    ds_read_b64_tr_b16 v[16:17], v12 offset:0
    ds_read_b64_tr_b16 v[18:19], v12 offset:20992
    ds_read_b64_tr_b16 v[20:21], v12 offset:32
    ds_read_b64_tr_b16 v[22:23], v12 offset:21024
    ds_read_b64_tr_b16 v[24:25], v12 offset:64
    ds_read_b64_tr_b16 v[26:27], v12 offset:21056
    ds_read_b64_tr_b16 v[28:29], v12 offset:96
    ds_read_b64_tr_b16 v[30:31], v12 offset:21088
    ds_read_b64_tr_b16 v[32:33], v12 offset:128
    ds_read_b64_tr_b16 v[34:35], v12 offset:21120
    ds_read_b64_tr_b16 v[36:37], v12 offset:160
    ds_read_b64_tr_b16 v[38:39], v12 offset:21152
    ds_read_b64_tr_b16 v[40:41], v12 offset:192
    ds_read_b64_tr_b16 v[42:43], v12 offset:21184
    ds_read_b64_tr_b16 v[44:45], v12 offset:224
    ds_read_b64_tr_b16 v[46:47], v12 offset:21216
    ds_read_b64_tr_b16 v[48:49], v12 offset:256
    ds_read_b64_tr_b16 v[50:51], v12 offset:21248
    ds_read_b64_tr_b16 v[52:53], v12 offset:288
    ds_read_b64_tr_b16 v[54:55], v12 offset:21280
    s_add_u32 s29, s38, 0
    s_waitcnt lgkmcnt(15)
    buffer_store_dwordx4 v[16:19], v3, s[20:23], s29 offen
    s_add_u32 s29, s38, 1024
    buffer_store_dwordx4 v[20:23], v3, s[20:23], s29 offen
    s_add_u32 s29, s38, 2048
    s_waitcnt lgkmcnt(14)
    buffer_store_dwordx4 v[24:27], v3, s[20:23], s29 offen
    s_add_u32 s29, s38, 3072
    s_waitcnt lgkmcnt(12)
    buffer_store_dwordx4 v[28:31], v3, s[20:23], s29 offen
    s_add_u32 s29, s38, 4096
    s_waitcnt lgkmcnt(10)
    buffer_store_dwordx4 v[32:35], v3, s[20:23], s29 offen
    s_add_u32 s29, s38, 276480
    s_waitcnt lgkmcnt(8)
    buffer_store_dwordx4 v[36:39], v3, s[20:23], s29 offen
    s_add_u32 s29, s38, 277504
    s_waitcnt lgkmcnt(6)
    buffer_store_dwordx4 v[40:43], v3, s[20:23], s29 offen
    s_add_u32 s29, s38, 278528
    s_waitcnt lgkmcnt(4)
    buffer_store_dwordx4 v[44:47], v3, s[20:23], s29 offen
    s_add_u32 s29, s38, 279552
    s_waitcnt lgkmcnt(2)
    buffer_store_dwordx4 v[48:51], v3, s[20:23], s29 offen
    s_add_u32 s29, s38, 280576
    s_waitcnt lgkmcnt(0)
    buffer_store_dwordx4 v[52:55], v3, s[20:23], s29 offen
    s_endpgm
Lp_x:
    s_mov_b32 s24, s4
    s_mov_b32 s25, s5
    s_mov_b32 s26, 2621440
    s_mov_b32 s27, 0x20000
    s_sub_u32 s30, s2, 194
    s_lshl_b32 s31, s30, 5
    s_lshl_b32 s32, s18, 3
    s_add_u32 s31, s31, s32
    s_mul_i32 s31, s31, 1280
    s_mul_i32 s37, s18, 10368
    s_mov_b32 exec_lo, -1
    s_mov_b32 exec_hi, 0xff
    s_add_u32 m0, s37, 0
    s_add_u32 s29, s31, 0
    buffer_load_dwordx4 v3, s[24:27], s29 offen lds
    s_add_u32 m0, s37, 640
    s_add_u32 s29, s31, 640
    buffer_load_dwordx4 v3, s[24:27], s29 offen lds
    s_add_u32 m0, s37, 1296
    s_add_u32 s29, s31, 1280
    buffer_load_dwordx4 v3, s[24:27], s29 offen lds
    s_add_u32 m0, s37, 1936
    s_add_u32 s29, s31, 1920
    buffer_load_dwordx4 v3, s[24:27], s29 offen lds
    s_add_u32 m0, s37, 2592
    s_add_u32 s29, s31, 2560
    buffer_load_dwordx4 v3, s[24:27], s29 offen lds
    s_add_u32 m0, s37, 3232
    s_add_u32 s29, s31, 3200
    buffer_load_dwordx4 v3, s[24:27], s29 offen lds
    s_add_u32 m0, s37, 3888
    s_add_u32 s29, s31, 3840
    buffer_load_dwordx4 v3, s[24:27], s29 offen lds
    s_add_u32 m0, s37, 4528
    s_add_u32 s29, s31, 4480
    buffer_load_dwordx4 v3, s[24:27], s29 offen lds
    s_add_u32 m0, s37, 5184
    s_add_u32 s29, s31, 5120
    buffer_load_dwordx4 v3, s[24:27], s29 offen lds
    s_add_u32 m0, s37, 5824
    s_add_u32 s29, s31, 5760
    buffer_load_dwordx4 v3, s[24:27], s29 offen lds
    s_add_u32 m0, s37, 6480
    s_add_u32 s29, s31, 6400
    buffer_load_dwordx4 v3, s[24:27], s29 offen lds
    s_add_u32 m0, s37, 7120
    s_add_u32 s29, s31, 7040
    buffer_load_dwordx4 v3, s[24:27], s29 offen lds
    s_add_u32 m0, s37, 7776
    s_add_u32 s29, s31, 7680
    buffer_load_dwordx4 v3, s[24:27], s29 offen lds
    s_add_u32 m0, s37, 8416
    s_add_u32 s29, s31, 8320
    buffer_load_dwordx4 v3, s[24:27], s29 offen lds
    s_add_u32 m0, s37, 9072
    s_add_u32 s29, s31, 8960
    buffer_load_dwordx4 v3, s[24:27], s29 offen lds
    s_add_u32 m0, s37, 9712
    s_add_u32 s29, s31, 9600
    buffer_load_dwordx4 v3, s[24:27], s29 offen lds
    s_mov_b64 exec, -1
    s_waitcnt vmcnt(0)
    s_barrier
    v_and_b32 v16, 15, v1
    v_mul_u32_u24 v12, 1296, v16
    v_lshrrev_b32 v17, 4, v1
    v_lshlrev_b32 v18, 3, v17
    v_add_u32 v12, v12, v18
    s_lshr_b32 s33, s18, 1
    s_and_b32 s34, s18, 1
    s_mul_i32 s35, s33, 20736
    s_mul_i32 s36, s34, 640
    s_add_u32 s35, s35, s36
    v_add_u32 v12, s35, v12
    s_lshl_b32 s35, s30, 1
    s_add_u32 s35, s35, s33
    s_mul_i32 s36, s35, 20480
    s_mul_i32 s38, s34, 10240
    s_add_u32 s36, s36, s38
    s_add_u32 s36, s36, 4194304
    ds_read_b64 v[20:21], v12 offset:0
    ds_read_b64 v[22:23], v12 offset:32
    ds_read_b64 v[24:25], v12 offset:64
    ds_read_b64 v[26:27], v12 offset:96
    ds_read_b64 v[28:29], v12 offset:160
    ds_read_b64 v[30:31], v12 offset:192
    ds_read_b64 v[32:33], v12 offset:224
    ds_read_b64 v[34:35], v12 offset:256
    ds_read_b64 v[36:37], v12 offset:128
    ds_read_b64 v[38:39], v12 offset:288
    ds_read_b64 v[40:41], v12 offset:320
    ds_read_b64 v[42:43], v12 offset:352
    ds_read_b64 v[44:45], v12 offset:384
    ds_read_b64 v[46:47], v12 offset:416
    ds_read_b64 v[48:49], v12 offset:480
    ds_read_b64 v[50:51], v12 offset:512
    ds_read_b64 v[52:53], v12 offset:544
    ds_read_b64 v[54:55], v12 offset:576
    ds_read_b64 v[56:57], v12 offset:448
    ds_read_b64 v[58:59], v12 offset:608
    s_add_u32 s29, s36, 0
    s_waitcnt lgkmcnt(15)
    buffer_store_dwordx4 v[20:23], v3, s[20:23], s29 offen
    v_mfma_f32_16x16x32_bf16 v[96:99], v[8:11], v[20:23], 0
    v_mfma_f32_16x16x32_bf16 v[100:103], v[20:23], v[20:23], 0
    s_add_u32 s29, s36, 1024
    buffer_store_dwordx4 v[24:27], v3, s[20:23], s29 offen
    v_mfma_f32_16x16x32_bf16 v[96:99], v[8:11], v[24:27], v[96:99]
    v_mfma_f32_16x16x32_bf16 v[100:103], v[24:27], v[24:27], v[100:103]
    s_add_u32 s29, s36, 2048
    s_waitcnt lgkmcnt(14)
    buffer_store_dwordx4 v[28:31], v3, s[20:23], s29 offen
    v_mfma_f32_16x16x32_bf16 v[96:99], v[8:11], v[28:31], v[96:99]
    v_mfma_f32_16x16x32_bf16 v[100:103], v[28:31], v[28:31], v[100:103]
    s_add_u32 s29, s36, 3072
    s_waitcnt lgkmcnt(12)
    buffer_store_dwordx4 v[32:35], v3, s[20:23], s29 offen
    v_mfma_f32_16x16x32_bf16 v[96:99], v[8:11], v[32:35], v[96:99]
    v_mfma_f32_16x16x32_bf16 v[100:103], v[32:35], v[32:35], v[100:103]
    s_add_u32 s29, s36, 4096
    s_waitcnt lgkmcnt(10)
    buffer_store_dwordx4 v[36:39], v3, s[20:23], s29 offen
    v_mfma_f32_16x16x32_bf16 v[96:99], v[8:11], v[36:39], v[96:99]
    v_mfma_f32_16x16x32_bf16 v[100:103], v[36:39], v[36:39], v[100:103]
    s_add_u32 s29, s36, 5120
    s_waitcnt lgkmcnt(8)
    buffer_store_dwordx4 v[40:43], v3, s[20:23], s29 offen
    v_mfma_f32_16x16x32_bf16 v[96:99], v[8:11], v[40:43], v[96:99]
    v_mfma_f32_16x16x32_bf16 v[100:103], v[40:43], v[40:43], v[100:103]
    s_add_u32 s29, s36, 6144
    s_waitcnt lgkmcnt(6)
    buffer_store_dwordx4 v[44:47], v3, s[20:23], s29 offen
    v_mfma_f32_16x16x32_bf16 v[96:99], v[8:11], v[44:47], v[96:99]
    v_mfma_f32_16x16x32_bf16 v[100:103], v[44:47], v[44:47], v[100:103]
    s_add_u32 s29, s36, 7168
    s_waitcnt lgkmcnt(4)
    buffer_store_dwordx4 v[48:51], v3, s[20:23], s29 offen
    v_mfma_f32_16x16x32_bf16 v[96:99], v[8:11], v[48:51], v[96:99]
    v_mfma_f32_16x16x32_bf16 v[100:103], v[48:51], v[48:51], v[100:103]
    s_add_u32 s29, s36, 8192
    s_waitcnt lgkmcnt(2)
    buffer_store_dwordx4 v[52:55], v3, s[20:23], s29 offen
    v_mfma_f32_16x16x32_bf16 v[96:99], v[8:11], v[52:55], v[96:99]
    v_mfma_f32_16x16x32_bf16 v[100:103], v[52:55], v[52:55], v[100:103]
    s_add_u32 s29, s36, 9216
    s_waitcnt lgkmcnt(0)
    buffer_store_dwordx4 v[56:59], v3, s[20:23], s29 offen
    v_mfma_f32_16x16x32_bf16 v[96:99], v[8:11], v[56:59], v[96:99]
    v_mfma_f32_16x16x32_bf16 v[100:103], v[56:59], v[56:59], v[100:103]
    v_and_b32 v18, 3, v16
    v_cmp_eq_u32 vcc, 1, v18
    s_nop 5
    v_cndmask_b32 v104, v100, v101, vcc
    v_cmp_eq_u32 vcc, 2, v18
    s_nop 1
    v_cndmask_b32 v104, v104, v102, vcc
    v_cmp_eq_u32 vcc, 3, v18
    s_nop 1
    v_cndmask_b32 v105, v104, v103, vcc
    v_mov_b32 v104, v96
    v_mov_b32 v106, 0
    v_mov_b32 v107, 0
    s_lshl_b32 s38, s35, 10
    s_add_u32 s38, s38, 393216
    s_lshl_b32 s39, s34, 7
    s_add_u32 s39, s39, s38
    s_mul_i32 s42, s34, 384
    s_add_u32 s42, s42, s38
    v_lshlrev_b32 v19, 3, v16
    v_lshrrev_b32 v18, 2, v16
    v_cmp_eq_u32 vcc, v17, v18
    s_nop 3
    s_and_saveexec_b64 s[40:41], vcc
    buffer_store_dwordx2 v[104:105], v19, s[20:23], s39 offen
    buffer_store_dwordx2 v[106:107], v19, s[20:23], s42 offen offset:256
    buffer_store_dwordx2 v[106:107], v19, s[20:23], s42 offen offset:384
    buffer_store_dwordx2 v[106:107], v19, s[20:23], s42 offen offset:512
    s_mov_b64 exec, s[40:41]
    s_endpgm
Lp_zero:
    v_mov_b32 v16, 0
    v_mov_b32 v17, 0
    v_mov_b32 v18, 0
    v_mov_b32 v19, 0
    v_lshlrev_b32 v20, 4, v0
    s_mov_b32 s30, 0
    buffer_store_dwordx4 v[16:19], v20, s[20:23], s30 offen
    s_mov_b32 s30, 4096
    buffer_store_dwordx4 v[16:19], v20, s[20:23], s30 offen
    s_mov_b32 s30, 8192
    buffer_store_dwordx4 v[16:19], v20, s[20:23], s30 offen
    s_mov_b32 s30, 12288
    buffer_store_dwordx4 v[16:19], v20, s[20:23], s30 offen
Lp_done:
    s_endpgm
.globl interleave_layers__linear_attn_block__swiglu_ffn__prompt_kernel
.p2align 8
.type interleave_layers__linear_attn_block__swiglu_ffn__prompt_kernel,@function
interleave_layers__linear_attn_block__swiglu_ffn__prompt_kernel:
    s_cmp_ge_u32 s2, 256
    s_cbranch_scc1 Lm_done
    s_load_dwordx2 s[8:9], s[0:1], 56
    s_load_dwordx2 s[10:11], s[0:1], 64
    s_load_dwordx2 s[4:5], s[0:1], 72
    v_lshrrev_b32 v2, 6, v0
    v_and_b32 v0, 63, v0
    v_readfirstlane_b32 s16, v2
    v_lshlrev_b32 v1, 4, v0
    s_and_b32 s33, s2, 7
    s_lshr_b32 s34, s2, 3
    s_and_b32 s35, s34, 1
    s_lshr_b32 s18, s34, 1
    s_lshl_b32 s33, s33, 1
    s_add_u32 s17, s33, s35
    s_and_b32 s19, s18, 1
    s_lshr_b32 s20, s18, 1
    s_lshl_b32 s22, s16, 12
    s_lshl_b32 s23, s16, 10
    s_lshl_b32 s24, s16, 11
    s_mul_i32 s25, s18, 163840
    s_add_u32 s25, s25, 35651584
    s_add_u32 s25, s25, s22
    s_mul_i32 s26, s20, 102400
    s_add_u32 s26, s26, 38273024
    s_add_u32 s26, s26, s22
    s_mul_i32 s27, s18, 286720
    s_add_u32 s27, s27, 39845888
    s_add_u32 s27, s27, s22
    s_mul_i32 s28, s20, 276480
    s_add_u32 s28, s28, 45088768
    s_add_u32 s28, s28, s22
    s_mul_i32 s29, s20, 102400
    s_add_u32 s29, s29, 38273024
    s_add_u32 s29, s29, s23
    s_mul_i32 s30, s18, 286720
    s_add_u32 s30, s30, 39845888
    s_add_u32 s30, s30, s24
    s_waitcnt lgkmcnt(0)
    s_mov_b32 s6, 50331648
    s_mov_b32 s7, 0x20000
    s_mov_b32 s10, 2621440
    s_mov_b32 s11, 0x20000
    s_mov_b32 s12, s4
    s_mov_b32 s13, s5
    s_mov_b32 s14, 50331648
    s_mov_b32 s15, 0x20000
    s_and_b32 s33, s17, 1
    s_lshl_b32 s33, s33, 1
    s_add_u32 s33, s33, s19
    s_lshl_b32 s84, s33, 2
    s_add_u32 s84, s84, 4
    s_mul_i32 s85, s33, 12
    s_add_u32 s85, s85, 2
    s_cmp_ge_u32 s33, 2
    s_cselect_b32 s33, 4, 0
    s_add_u32 s85, s85, s33
    s_lshl_b32 s33, s17, 3
    s_lshl_b32 s34, s16, 1
    s_add_u32 s42, s33, s34
    v_add_u32 v4, 20480, v1
    s_mul_i32 s32, s42, 20480
    s_add_u32 s32, s32, 4194304
    s_add_u32 m0, s22, 0
    s_add_u32 s31, s25, 0
    buffer_load_dwordx4 v1, s[4:7], s31 offen offset:0 lds
    buffer_load_dwordx4 v1, s[4:7], s31 offen offset:1024 lds
    buffer_load_dwordx4 v1, s[4:7], s31 offen offset:2048 lds
    buffer_load_dwordx4 v1, s[4:7], s31 offen offset:3072 lds
    buffer_load_dwordx4 a[0:3], v1, s[4:7], s32 offen offset:0
    buffer_load_dwordx4 a[80:83], v4, s[4:7], s32 offen offset:0
    buffer_load_dwordx4 a[4:7], v1, s[4:7], s32 offen offset:1024
    buffer_load_dwordx4 a[84:87], v4, s[4:7], s32 offen offset:1024
    buffer_load_dwordx4 a[8:11], v1, s[4:7], s32 offen offset:2048
    buffer_load_dwordx4 a[88:91], v4, s[4:7], s32 offen offset:2048
    s_add_u32 m0, s22, 16384
    s_add_u32 s31, s25, 16384
    buffer_load_dwordx4 v1, s[4:7], s31 offen offset:0 lds
    buffer_load_dwordx4 v1, s[4:7], s31 offen offset:1024 lds
    buffer_load_dwordx4 v1, s[4:7], s31 offen offset:2048 lds
    buffer_load_dwordx4 v1, s[4:7], s31 offen offset:3072 lds
    buffer_load_dwordx4 a[12:15], v1, s[4:7], s32 offen offset:3072
    buffer_load_dwordx4 a[92:95], v4, s[4:7], s32 offen offset:3072
    s_add_u32 s32, s32, 4096
    buffer_load_dwordx4 a[16:19], v1, s[4:7], s32 offen offset:0
    buffer_load_dwordx4 a[96:99], v4, s[4:7], s32 offen offset:0
    buffer_load_dwordx4 a[20:23], v1, s[4:7], s32 offen offset:1024
    buffer_load_dwordx4 a[100:103], v4, s[4:7], s32 offen offset:1024
    s_lshl_b32 s33, s17, 7
    s_add_u32 s38, s33, 0
    s_lshl_b32 s34, s18, 2
    s_add_u32 s37, s38, s34
    s_lshl_b32 s33, s18, 7
    s_add_u32 s40, s33, 4096
    s_lshl_b32 s34, s17, 2
    s_add_u32 s39, s40, s34
    s_lshl_b32 s33, s17, 3
    s_lshl_b32 s34, s16, 1
    s_add_u32 s42, s33, s34
    s_lshl_b32 s34, s19, 2
    s_add_u32 s34, s34, s16
    s_add_u32 s43, s33, s34
    s_cmp_eq_u32 s16, 0
    s_cselect_b32 s44, 1, 0
    s_mov_b32 s45, 0
    s_mov_b32 s21, 0
    s_mov_b32 s41, 0
    s_mov_b32 s60, 0
    s_mov_b32 s61, 897988541
    s_and_b32 s64, s20, 1
    s_lshr_b32 s33, s20, 1
    s_mul_i32 s33, s33, 5
    s_lshl_b32 s34, s64, 1
    s_add_u32 s34, s34, s33
    s_lshl_b32 s34, s34, 10
    s_add_u32 s33, s33, 4
    s_lshl_b32 s33, s33, 10
    s_sub_u32 s91, s33, s34
    s_mul_i32 s35, s43, 20480
    s_add_u32 s34, s34, s35
    s_add_u32 s65, s34, 4194304
    s_lshl_b32 s33, s43, 10
    s_lshl_b32 s34, s20, 7
    s_add_u32 s33, s33, s34
    s_add_u32 s98, s33, 393216
    s_mul_i32 s33, s42, 55296
    s_add_u32 s99, s33, 20971520
    s_mul_i32 s33, s42, 20480
    s_add_u32 s3, s33, 14680064
    s_mov_b32 s48, 0xffff
    s_mov_b32 s49, 0x0
    s_mov_b32 s50, 0xffff0000
    s_mov_b32 s51, 0x0
    s_mov_b32 s52, 0xf000f00
    s_mov_b32 s53, 0xf000f00
    s_mov_b32 s54, 0xf000f000
    s_mov_b32 s55, 0xf000f000
    s_mov_b32 s56, 0xf00
    s_mov_b32 s57, 0x0
    s_mov_b32 s58, 0xf0000000
    s_mov_b32 s59, 0x0
    s_mov_b32 s66, 0xf0f0f0f0
    s_mov_b32 s67, 0xf0f0f0f0
    s_mov_b32 s68, 0xff00ff
    s_mov_b32 s69, 0xff00ff
    s_mov_b32 s70, 0x0
    s_mov_b32 s71, 0xffffffff
    s_mov_b32 s72, 0x0
    s_mov_b32 s73, 0xffff0000
    s_mov_b32 s74, 0xffffffff
    s_mov_b32 s75, 0x0
    s_getreg_b32 s46, hwreg(HW_REG_XCC_ID)
    s_and_b32 s46, s46, 0xffff
    s_add_u32 s46, s46, 1
    v_mov_b32 v254, s46
    v_mov_b32 v255, 0
    s_add_u32 s33, s37, 8192
    s_mov_b64 exec, s[44:45]
    buffer_store_dword v254, v255, s[4:7], s33 offen sc1
    s_mov_b64 exec, -1
    v_and_b32 v212, 15, v0
    v_lshrrev_b32 v213, 4, v0
    v_add_u32 v2, 0x10000, v1
    v_add_u32 v3, 0x20000, v1
    v_add_u32 v4, 20480, v1
    v_lshlrev_b32 v5, 2, v212
    v_add_u32 v5, 0x20000, v5
    s_lshl_b32 s33, s16, 8
    v_add_u32 v6, s33, v5
    v_lshlrev_b32 v7, 4, v213
    v_add_u32 v7, 0x20000, v7
    v_add_u32 v8, s33, v7
    v_lshrrev_b32 v214, 5, v0
    v_bfe_u32 v215, v0, 4, 1
    v_lshlrev_b32 v216, 8, v214
    v_lshlrev_b32 v217, 4, v212
    v_add_u32 v216, v216, v217
    v_mul_u32_u24 v217, 20480, v215
    v_add_u32 v9, v216, v217
    v_mul_u32_u24 v217, 55296, v215
    v_add_u32 v10, v216, v217
    v_lshlrev_b32 v250, 4, v214
    v_add_u32 v250, 0x20000, v250
    v_lshlrev_b32 v11, 3, v0
    v_add_u32 v11, 0x20000, v11
    v_lshlrev_b32 v12, 8, v213
    v_lshlrev_b32 v214, 3, v212
    v_add_u32 v12, v12, v214
    s_mul_i32 s33, s18, 3
    v_lshrrev_b32 v214, 5, v0
    v_add_u32 v214, s33, v214
    v_lshrrev_b32 v215, 3, v214
    v_add_u32 v215, 48, v215
    v_lshlrev_b32 v215, 10, v215
    v_and_b32 v216, 3, v214
    v_lshlrev_b32 v216, 8, v216
    v_add_u32 v215, v215, v216
    v_lshlrev_b32 v216, 4, v212
    v_add_u32 v215, v215, v216
    v_bfe_u32 v216, v214, 2, 1
    v_lshlrev_b32 v216, 3, v216
    v_add_u32 v215, v215, v216
    v_bfe_u32 v216, v0, 4, 1
    v_mul_u32_u24 v216, 55296, v216
    v_add_u32 v13, v215, v216
    s_lshr_b32 s33, s18, 2
    s_add_u32 s33, s33, 16
    s_lshl_b32 s33, s33, 10
    s_and_b32 s34, s18, 1
    s_lshl_b32 s34, s34, 9
    s_add_u32 s33, s33, s34
    s_bfe_u32 s34, s18, 0x10001
    s_lshl_b32 s34, s34, 3
    s_add_u32 s33, s33, s34
    s_sub_u32 s33, s33, 512
    v_lshlrev_b32 v215, 8, v213
    v_lshlrev_b32 v216, 4, v212
    v_add_u32 v215, v215, v216
    v_add_u32 v14, s33, v215
    v_mul_u32_u24 v215, 1280, v212
    v_lshlrev_b32 v216, 3, v213
    v_add_u32 v15, v215, v216
    s_mul_i32 s33, s18, 512
    s_add_u32 s33, s33, 65536
    s_mul_i32 s34, s18, 896
    s_add_u32 s34, s34, 229376
    v_and_b32 v214, 31, v0
    v_lshlrev_b32 v214, 4, v214
    v_lshrrev_b32 v215, 5, v0
    v_mul_u32_u24 v215, 81920, v215
    v_add_u32 v214, v214, v215
    v_add_u32 v214, s33, v214
    v_add_u32 v215, s34, v1
    v_mov_b32 v216, 0x7ffffff0
    v_cmp_gt_u32 vcc, 56, v0
    s_nop 1
    v_cndmask_b32 v215, v216, v215, vcc
    s_cmp_eq_u32 s16, 0
    s_mov_b32 s36, 14336
    s_cselect_b32 s36, 8192, s36
    s_cselect_b64 vcc, -1, 0
    v_cndmask_b32 v214, v215, v214, vcc
    s_cmp_ge_u32 s16, 2
    s_cselect_b64 vcc, -1, 0
    v_cndmask_b32 v214, v214, v216, vcc
    buffer_load_dwordx4 v[140:143], v214, s[4:7], 0 offen
    v_add_u32 v214, s36, v214
    buffer_load_dwordx4 v[144:147], v214, s[4:7], 0 offen
    v_add_u32 v214, s36, v214
    buffer_load_dwordx4 v[148:151], v214, s[4:7], 0 offen
    v_add_u32 v214, s36, v214
    buffer_load_dwordx4 v[152:155], v214, s[4:7], 0 offen
    v_add_u32 v214, s36, v214
    buffer_load_dwordx4 v[156:159], v214, s[4:7], 0 offen
    v_add_u32 v214, s36, v214
    buffer_load_dwordx4 v[160:163], v214, s[4:7], 0 offen
    v_add_u32 v214, s36, v214
    buffer_load_dwordx4 v[164:167], v214, s[4:7], 0 offen
    v_add_u32 v214, s36, v214
    buffer_load_dwordx4 v[168:171], v214, s[4:7], 0 offen
    v_add_u32 v214, s36, v214
    buffer_load_dwordx4 v[172:175], v214, s[4:7], 0 offen
    v_add_u32 v214, s36, v214
    buffer_load_dwordx4 v[176:179], v214, s[4:7], 0 offen
    s_lshr_b32 s33, s20, 1
    s_mul_i32 s33, s33, 5
    s_lshl_b32 s34, s64, 1
    s_add_u32 s34, s34, s33
    s_mul_i32 s35, s43, 20480
    s_add_u32 s35, s35, 4194304
    s_lshl_b32 s34, s34, 10
    s_add_u32 s34, s34, s35
    buffer_load_dwordx4 v[180:183], v1, s[4:7], s34 offen
    buffer_load_dwordx4 v[184:187], v1, s[4:7], s34 offen offset:1024
    s_add_u32 s33, s33, 4
    s_lshl_b32 s33, s33, 10
    s_add_u32 s33, s33, s35
    s_lshl_b32 s34, s64, 3
    s_add_u32 s33, s33, s34
    buffer_load_dwordx2 v[188:189], v1, s[4:7], s33 offen
    s_add_u32 s33, s38, 8192
    v_subrev_u32 v252, 0x20000, v5
    buffer_load_dword v251, v252, s[4:7], s33 offen sc1
    s_mul_i32 s62, s60, 131072
    s_lshl_b32 s63, s42, 10
    s_add_u32 s62, s62, s63
    s_add_u32 s62, s62, 393216
    buffer_load_dwordx2 v[212:213], v12, s[4:7], s62 offen offset:0
    buffer_load_dwordx2 v[214:215], v12, s[4:7], s62 offen offset:128
    buffer_load_dwordx2 v[216:217], v12, s[4:7], s62 offen offset:1024
    buffer_load_dwordx2 v[218:219], v12, s[4:7], s62 offen offset:1152
    s_waitcnt vmcnt(33)
    s_barrier
    ds_read_b128 v[36:39], v1 offset:0
    ds_read_b128 v[40:43], v1 offset:1024
    ds_read_b128 v[44:47], v1 offset:2048
    ds_read_b128 v[48:51], v1 offset:3072
    ds_read_b128 v[52:55], v1 offset:4096
    buffer_load_dwordx4 a[24:27], v1, s[4:7], s32 offen offset:2048
    buffer_load_dwordx4 a[104:107], v4, s[4:7], s32 offen offset:2048
    s_add_u32 m0, s22, 32768
    s_add_u32 s31, s25, 32768
    buffer_load_dwordx4 v1, s[4:7], s31 offen offset:0 lds
    buffer_load_dwordx4 v1, s[4:7], s31 offen offset:1024 lds
    buffer_load_dwordx4 v1, s[4:7], s31 offen offset:2048 lds
    buffer_load_dwordx4 v1, s[4:7], s31 offen offset:3072 lds
    buffer_load_dwordx4 a[28:31], v1, s[4:7], s32 offen offset:3072
    buffer_load_dwordx4 a[108:111], v4, s[4:7], s32 offen offset:3072
    s_add_u32 m0, s22, 49152
    s_add_u32 s31, s25, 49152
    buffer_load_dwordx4 v1, s[4:7], s31 offen offset:0 lds
    buffer_load_dwordx4 v1, s[4:7], s31 offen offset:1024 lds
    s_waitcnt vmcnt(41) lgkmcnt(0)
    v_mfma_f32_16x16x32_bf16 v[100:103], a[0:3], v[36:39], 0
    ds_read_b128 v[56:59], v1 offset:5120
    ds_read_b128 v[60:63], v1 offset:6144
    v_mfma_f32_16x16x32_bf16 v[104:107], a[80:83], v[36:39], 0
    ds_read_b128 v[64:67], v1 offset:7168
    ds_read_b128 v[68:71], v1 offset:8192
    v_mfma_f32_16x16x32_bf16 v[108:111], a[0:3], v[40:43], 0
    ds_read_b128 v[72:75], v1 offset:9216
    buffer_load_dwordx4 v1, s[4:7], s31 offen offset:2048 lds
    v_mfma_f32_16x16x32_bf16 v[112:115], a[80:83], v[40:43], 0
    v_mfma_f32_16x16x32_bf16 v[116:119], a[0:3], v[44:47], 0
    v_mfma_f32_16x16x32_bf16 v[120:123], a[80:83], v[44:47], 0
    buffer_load_dwordx4 v1, s[4:7], s31 offen offset:3072 lds
    v_mfma_f32_16x16x32_bf16 v[124:127], a[0:3], v[48:51], 0
    v_mfma_f32_16x16x32_bf16 v[128:131], a[80:83], v[48:51], 0
    v_mfma_f32_16x16x32_bf16 v[132:135], a[0:3], v[52:55], 0
    v_mfma_f32_16x16x32_bf16 v[136:139], a[80:83], v[52:55], 0
    ds_read_b128 v[76:79], v1 offset:10240
    s_waitcnt vmcnt(41) lgkmcnt(1)
    v_mfma_f32_16x16x32_bf16 v[100:103], a[4:7], v[56:59], v[100:103]
    ds_read_b128 v[80:83], v1 offset:11264
    ds_read_b128 v[84:87], v1 offset:12288
    v_mfma_f32_16x16x32_bf16 v[104:107], a[84:87], v[56:59], v[104:107]
    ds_read_b128 v[88:91], v1 offset:13312
    ds_read_b128 v[92:95], v1 offset:14336
    v_mfma_f32_16x16x32_bf16 v[108:111], a[4:7], v[60:63], v[108:111]
    s_add_u32 s32, s32, 4096
    buffer_load_dwordx4 a[32:35], v1, s[4:7], s32 offen offset:0
    v_mfma_f32_16x16x32_bf16 v[112:115], a[84:87], v[60:63], v[112:115]
    buffer_load_dwordx4 a[112:115], v4, s[4:7], s32 offen offset:0
    v_mfma_f32_16x16x32_bf16 v[116:119], a[4:7], v[64:67], v[116:119]
    v_mfma_f32_16x16x32_bf16 v[120:123], a[84:87], v[64:67], v[120:123]
    v_mfma_f32_16x16x32_bf16 v[124:127], a[4:7], v[68:71], v[124:127]
    v_mfma_f32_16x16x32_bf16 v[128:131], a[84:87], v[68:71], v[128:131]
    buffer_load_dwordx4 a[36:39], v1, s[4:7], s32 offen offset:1024
    v_mfma_f32_16x16x32_bf16 v[132:135], a[4:7], v[72:75], v[132:135]
    v_mfma_f32_16x16x32_bf16 v[136:139], a[84:87], v[72:75], v[136:139]
    ds_read_b128 v[96:99], v1 offset:15360
    s_waitcnt vmcnt(42) lgkmcnt(1)
    v_mfma_f32_16x16x32_bf16 v[100:103], a[8:11], v[76:79], v[100:103]
    s_waitcnt vmcnt(38)
    s_barrier
    ds_read_b128 v[36:39], v1 offset:16384
    v_mfma_f32_16x16x32_bf16 v[104:107], a[88:91], v[76:79], v[104:107]
    ds_read_b128 v[40:43], v1 offset:17408
    ds_read_b128 v[44:47], v1 offset:18432
    v_mfma_f32_16x16x32_bf16 v[108:111], a[8:11], v[80:83], v[108:111]
    ds_read_b128 v[48:51], v1 offset:19456
    buffer_load_dwordx4 a[116:119], v4, s[4:7], s32 offen offset:1024
    v_mfma_f32_16x16x32_bf16 v[112:115], a[88:91], v[80:83], v[112:115]
    v_mfma_f32_16x16x32_bf16 v[116:119], a[8:11], v[84:87], v[116:119]
    buffer_load_dwordx4 a[40:43], v1, s[4:7], s32 offen offset:2048
    v_mfma_f32_16x16x32_bf16 v[120:123], a[88:91], v[84:87], v[120:123]
    v_mfma_f32_16x16x32_bf16 v[124:127], a[8:11], v[88:91], v[124:127]
    v_mfma_f32_16x16x32_bf16 v[128:131], a[88:91], v[88:91], v[128:131]
    v_mfma_f32_16x16x32_bf16 v[132:135], a[8:11], v[92:95], v[132:135]
    buffer_load_dwordx4 a[120:123], v4, s[4:7], s32 offen offset:2048
    v_mfma_f32_16x16x32_bf16 v[136:139], a[88:91], v[92:95], v[136:139]
    ds_read_b128 v[52:55], v1 offset:20480
    s_waitcnt vmcnt(39) lgkmcnt(1)
    v_mfma_f32_16x16x32_bf16 v[100:103], a[12:15], v[96:99], v[100:103]
    ds_read_b128 v[56:59], v1 offset:21504
    ds_read_b128 v[60:63], v1 offset:22528
    v_mfma_f32_16x16x32_bf16 v[104:107], a[92:95], v[96:99], v[104:107]
    ds_read_b128 v[64:67], v1 offset:23552
    ds_read_b128 v[68:71], v1 offset:24576
    v_mfma_f32_16x16x32_bf16 v[108:111], a[12:15], v[36:39], v[108:111]
    s_add_u32 m0, s22, 65536
    s_add_u32 s31, s25, 65536
    buffer_load_dwordx4 v1, s[4:7], s31 offen offset:0 lds
    v_mfma_f32_16x16x32_bf16 v[112:115], a[92:95], v[36:39], v[112:115]
    v_mfma_f32_16x16x32_bf16 v[116:119], a[12:15], v[40:43], v[116:119]
    v_mfma_f32_16x16x32_bf16 v[120:123], a[92:95], v[40:43], v[120:123]
    v_mfma_f32_16x16x32_bf16 v[124:127], a[12:15], v[44:47], v[124:127]
    buffer_load_dwordx4 v1, s[4:7], s31 offen offset:1024 lds
    v_mfma_f32_16x16x32_bf16 v[128:131], a[92:95], v[44:47], v[128:131]
    v_mfma_f32_16x16x32_bf16 v[132:135], a[12:15], v[48:51], v[132:135]
    v_mfma_f32_16x16x32_bf16 v[136:139], a[92:95], v[48:51], v[136:139]
    ds_read_b128 v[72:75], v1 offset:25600
    s_waitcnt vmcnt(39) lgkmcnt(1)
    v_mfma_f32_16x16x32_bf16 v[100:103], a[16:19], v[52:55], v[100:103]
    ds_read_b128 v[76:79], v1 offset:26624
    ds_read_b128 v[80:83], v1 offset:27648
    v_mfma_f32_16x16x32_bf16 v[104:107], a[96:99], v[52:55], v[104:107]
    ds_read_b128 v[84:87], v1 offset:28672
    ds_read_b128 v[88:91], v1 offset:29696
    v_mfma_f32_16x16x32_bf16 v[108:111], a[16:19], v[56:59], v[108:111]
    buffer_load_dwordx4 v1, s[4:7], s31 offen offset:2048 lds
    v_mfma_f32_16x16x32_bf16 v[112:115], a[96:99], v[56:59], v[112:115]
    buffer_load_dwordx4 v1, s[4:7], s31 offen offset:3072 lds
    v_mfma_f32_16x16x32_bf16 v[116:119], a[16:19], v[60:63], v[116:119]
    v_mfma_f32_16x16x32_bf16 v[120:123], a[96:99], v[60:63], v[120:123]
    v_mfma_f32_16x16x32_bf16 v[124:127], a[16:19], v[64:67], v[124:127]
    v_mfma_f32_16x16x32_bf16 v[128:131], a[96:99], v[64:67], v[128:131]
    buffer_load_dwordx4 a[44:47], v1, s[4:7], s32 offen offset:3072
    v_mfma_f32_16x16x32_bf16 v[132:135], a[16:19], v[68:71], v[132:135]
    v_mfma_f32_16x16x32_bf16 v[136:139], a[96:99], v[68:71], v[136:139]
    ds_read_b128 v[92:95], v1 offset:30720
    buffer_load_dwordx4 a[124:127], v4, s[4:7], s32 offen offset:3072
    s_waitcnt vmcnt(41) lgkmcnt(1)
    v_mfma_f32_16x16x32_bf16 v[100:103], a[20:23], v[72:75], v[100:103]
    ds_read_b128 v[96:99], v1 offset:31744
    s_waitcnt vmcnt(18)
    s_barrier
    ds_read_b128 v[36:39], v1 offset:32768
    v_mfma_f32_16x16x32_bf16 v[104:107], a[100:103], v[72:75], v[104:107]
    ds_read_b128 v[40:43], v1 offset:33792
    ds_read_b128 v[44:47], v1 offset:34816
    v_mfma_f32_16x16x32_bf16 v[108:111], a[20:23], v[76:79], v[108:111]
    v_mfma_f32_16x16x32_bf16 v[112:115], a[100:103], v[76:79], v[112:115]
    v_mfma_f32_16x16x32_bf16 v[116:119], a[20:23], v[80:83], v[116:119]
    v_mfma_f32_16x16x32_bf16 v[120:123], a[100:103], v[80:83], v[120:123]
    s_add_u32 s32, s32, 4096
    buffer_load_dwordx4 a[48:51], v1, s[4:7], s32 offen offset:0
    v_mfma_f32_16x16x32_bf16 v[124:127], a[20:23], v[84:87], v[124:127]
    v_mfma_f32_16x16x32_bf16 v[128:131], a[100:103], v[84:87], v[128:131]
    v_mfma_f32_16x16x32_bf16 v[132:135], a[20:23], v[88:91], v[132:135]
    buffer_load_dwordx4 a[128:131], v4, s[4:7], s32 offen offset:0
    v_mfma_f32_16x16x32_bf16 v[136:139], a[100:103], v[88:91], v[136:139]
    ds_read_b128 v[48:51], v1 offset:35840
    s_waitcnt lgkmcnt(1)
    v_mfma_f32_16x16x32_bf16 v[100:103], a[24:27], v[92:95], v[100:103]
    ds_read_b128 v[52:55], v1 offset:36864
    ds_read_b128 v[56:59], v1 offset:37888
    v_mfma_f32_16x16x32_bf16 v[104:107], a[104:107], v[92:95], v[104:107]
    ds_read_b128 v[60:63], v1 offset:38912
    ds_read_b128 v[64:67], v1 offset:39936
    v_mfma_f32_16x16x32_bf16 v[108:111], a[24:27], v[96:99], v[108:111]
    buffer_load_dwordx4 a[52:55], v1, s[4:7], s32 offen offset:1024
    v_mfma_f32_16x16x32_bf16 v[112:115], a[104:107], v[96:99], v[112:115]
    v_mfma_f32_16x16x32_bf16 v[116:119], a[24:27], v[36:39], v[116:119]
    v_mfma_f32_16x16x32_bf16 v[120:123], a[104:107], v[36:39], v[120:123]
    v_mfma_f32_16x16x32_bf16 v[124:127], a[24:27], v[40:43], v[124:127]
    buffer_load_dwordx4 a[132:135], v4, s[4:7], s32 offen offset:1024
    v_mfma_f32_16x16x32_bf16 v[128:131], a[104:107], v[40:43], v[128:131]
    v_mfma_f32_16x16x32_bf16 v[132:135], a[24:27], v[44:47], v[132:135]
    v_mfma_f32_16x16x32_bf16 v[136:139], a[104:107], v[44:47], v[136:139]
    ds_read_b128 v[68:71], v1 offset:40960
    s_waitcnt vmcnt(20) lgkmcnt(1)
    v_mfma_f32_16x16x32_bf16 v[100:103], a[28:31], v[48:51], v[100:103]
    ds_read_b128 v[72:75], v1 offset:41984
    ds_read_b128 v[76:79], v1 offset:43008
    v_mfma_f32_16x16x32_bf16 v[104:107], a[108:111], v[48:51], v[104:107]
    ds_read_b128 v[80:83], v1 offset:44032
    ds_read_b128 v[84:87], v1 offset:45056
    v_mfma_f32_16x16x32_bf16 v[108:111], a[28:31], v[52:55], v[108:111]
    s_add_u32 m0, s22, 81920
    s_add_u32 s31, s25, 81920
    buffer_load_dwordx4 v1, s[4:7], s31 offen offset:0 lds
    v_mfma_f32_16x16x32_bf16 v[112:115], a[108:111], v[52:55], v[112:115]
    v_add_f32 v212, v212, v214
    v_add_f32 v213, v213, v215
    v_mfma_f32_16x16x32_bf16 v[116:119], a[28:31], v[56:59], v[116:119]
    buffer_load_dwordx4 v1, s[4:7], s31 offen offset:1024 lds
    v_mov_b32 v224, v212
    v_mfma_f32_16x16x32_bf16 v[120:123], a[108:111], v[56:59], v[120:123]
    v_mov_b32 v225, v213
    v_permlane32_swap_b32 v212, v224
    v_mfma_f32_16x16x32_bf16 v[124:127], a[28:31], v[60:63], v[124:127]
    v_permlane32_swap_b32 v213, v225
    v_add_f32 v212, v212, v224
    v_mfma_f32_16x16x32_bf16 v[128:131], a[108:111], v[60:63], v[128:131]
    buffer_load_dwordx4 v1, s[4:7], s31 offen offset:2048 lds
    v_add_f32 v213, v213, v225
    v_mfma_f32_16x16x32_bf16 v[132:135], a[28:31], v[64:67], v[132:135]
    v_mov_b32 v224, v212
    v_mov_b32 v225, v213
    v_mfma_f32_16x16x32_bf16 v[136:139], a[108:111], v[64:67], v[136:139]
    ds_read_b128 v[88:91], v1 offset:46080
    buffer_load_dwordx4 a[56:59], v1, s[4:7], s32 offen offset:2048
    buffer_load_dwordx4 a[136:139], v4, s[4:7], s32 offen offset:2048
    s_waitcnt vmcnt(19) lgkmcnt(1)
    v_mfma_f32_16x16x32_bf16 v[100:103], a[32:35], v[68:71], v[100:103]
    ds_read_b128 v[92:95], v1 offset:47104
    ds_read_b128 v[96:99], v1 offset:48128
    v_mfma_f32_16x16x32_bf16 v[104:107], a[112:115], v[68:71], v[104:107]
    s_barrier
    ds_read_b128 v[36:39], v1 offset:49152
    v_mfma_f32_16x16x32_bf16 v[108:111], a[32:35], v[72:75], v[108:111]
    ds_read_b128 v[40:43], v1 offset:50176
    v_permlane16_swap_b32 v212, v224
    v_mfma_f32_16x16x32_bf16 v[112:115], a[112:115], v[72:75], v[112:115]
    v_permlane16_swap_b32 v213, v225
    v_add_f32 v212, v212, v224
    v_mfma_f32_16x16x32_bf16 v[116:119], a[32:35], v[76:79], v[116:119]
    v_add_f32 v213, v213, v225
    v_mul_f32 v220, 0xbacccccd, v212
    v_mfma_f32_16x16x32_bf16 v[120:123], a[112:115], v[76:79], v[120:123]
    v_mul_f32 v213, 0x3acccccd, v213
    v_fma_f32 v213, -v220, v220, v213
    v_mfma_f32_16x16x32_bf16 v[124:127], a[32:35], v[80:83], v[124:127]
    v_max_f32 v213, 0, v213
    v_add_f32 v213, 0x3727c5ac, v213
    v_mfma_f32_16x16x32_bf16 v[128:131], a[112:115], v[80:83], v[128:131]
    v_rsq_f32 v221, v213
    v_mfma_f32_16x16x32_bf16 v[132:135], a[32:35], v[84:87], v[132:135]
    v_add_f32 v216, v216, v218
    v_add_f32 v217, v217, v219
    v_mfma_f32_16x16x32_bf16 v[136:139], a[112:115], v[84:87], v[136:139]
    ds_read_b128 v[44:47], v1 offset:51200
    buffer_load_dwordx4 a[60:63], v1, s[4:7], s32 offen offset:3072
    buffer_load_dwordx4 a[140:143], v4, s[4:7], s32 offen offset:3072
    s_waitcnt vmcnt(19) lgkmcnt(1)
    v_mfma_f32_16x16x32_bf16 v[100:103], a[36:39], v[88:91], v[100:103]
    ds_read_b128 v[48:51], v1 offset:52224
    ds_read_b128 v[52:55], v1 offset:53248
    v_mfma_f32_16x16x32_bf16 v[104:107], a[116:119], v[88:91], v[104:107]
    ds_read_b128 v[56:59], v1 offset:54272
    ds_read_b128 v[60:63], v1 offset:55296
    v_mfma_f32_16x16x32_bf16 v[108:111], a[36:39], v[92:95], v[108:111]
    v_mov_b32 v224, v216
    v_mov_b32 v225, v217
    v_mfma_f32_16x16x32_bf16 v[112:115], a[116:119], v[92:95], v[112:115]
    v_permlane32_swap_b32 v216, v224
    v_permlane32_swap_b32 v217, v225
    v_mfma_f32_16x16x32_bf16 v[116:119], a[36:39], v[96:99], v[116:119]
    v_add_f32 v216, v216, v224
    v_add_f32 v217, v217, v225
    v_mfma_f32_16x16x32_bf16 v[120:123], a[116:119], v[96:99], v[120:123]
    v_mov_b32 v224, v216
    v_mov_b32 v225, v217
    v_mfma_f32_16x16x32_bf16 v[124:127], a[36:39], v[36:39], v[124:127]
    buffer_load_dwordx4 v1, s[4:7], s31 offen offset:3072 lds
    v_permlane16_swap_b32 v216, v224
    v_mfma_f32_16x16x32_bf16 v[128:131], a[116:119], v[36:39], v[128:131]
    v_permlane16_swap_b32 v217, v225
    v_add_f32 v216, v216, v224
    v_mfma_f32_16x16x32_bf16 v[132:135], a[36:39], v[40:43], v[132:135]
    v_add_f32 v217, v217, v225
    v_mul_f32 v222, 0xbacccccd, v216
    v_mfma_f32_16x16x32_bf16 v[136:139], a[116:119], v[40:43], v[136:139]
    ds_read_b128 v[64:67], v1 offset:56320
    s_add_u32 s32, s32, 4096
    buffer_load_dwordx4 a[64:67], v1, s[4:7], s32 offen offset:0
    buffer_load_dwordx4 a[144:147], v4, s[4:7], s32 offen offset:0
    s_waitcnt vmcnt(20) lgkmcnt(1)
    v_mfma_f32_16x16x32_bf16 v[100:103], a[40:43], v[44:47], v[100:103]
    ds_read_b128 v[68:71], v1 offset:57344
    ds_read_b128 v[72:75], v1 offset:58368
    v_mfma_f32_16x16x32_bf16 v[104:107], a[120:123], v[44:47], v[104:107]
    ds_read_b128 v[76:79], v1 offset:59392
    ds_read_b128 v[80:83], v1 offset:60416
    v_mfma_f32_16x16x32_bf16 v[108:111], a[40:43], v[48:51], v[108:111]
    v_mul_f32 v217, 0x3acccccd, v217
    v_fma_f32 v217, -v222, v222, v217
    v_mfma_f32_16x16x32_bf16 v[112:115], a[120:123], v[48:51], v[112:115]
    v_max_f32 v217, 0, v217
    v_add_f32 v217, 0x3727c5ac, v217
    v_mfma_f32_16x16x32_bf16 v[116:119], a[40:43], v[52:55], v[116:119]
    v_rsq_f32 v223, v217
    v_mfma_f32_16x16x32_bf16 v[120:123], a[120:123], v[52:55], v[120:123]
    ds_write_b32 v6, v220 offset:17920
    ds_write_b32 v6, v221 offset:17984
    v_mfma_f32_16x16x32_bf16 v[124:127], a[40:43], v[56:59], v[124:127]
    ds_write_b32 v6, v222 offset:18048
    ds_write_b32 v6, v223 offset:18112
    v_mfma_f32_16x16x32_bf16 v[128:131], a[120:123], v[56:59], v[128:131]
    s_waitcnt lgkmcnt(0)
    ds_read_b128 v[226:229], v8 offset:17920
    ds_read_b128 v[230:233], v8 offset:17984
    v_mfma_f32_16x16x32_bf16 v[132:135], a[40:43], v[60:63], v[132:135]
    s_add_u32 m0, s22, 98304
    s_add_u32 s31, s25, 98304
    buffer_load_dwordx4 v1, s[4:7], s31 offen offset:0 lds
    v_mfma_f32_16x16x32_bf16 v[136:139], a[120:123], v[60:63], v[136:139]
    ds_read_b128 v[84:87], v1 offset:61440
    buffer_load_dwordx4 a[68:71], v1, s[4:7], s32 offen offset:1024
    buffer_load_dwordx4 a[148:151], v4, s[4:7], s32 offen offset:1024
    s_waitcnt vmcnt(17)
    v_mfma_f32_16x16x32_bf16 v[100:103], a[44:47], v[64:67], v[100:103]
    ds_read_b128 v[88:91], v1 offset:62464
    ds_read_b128 v[92:95], v1 offset:63488
    v_add_f32 v140, v140, v144
    v_add_f32 v141, v141, v145
    v_mfma_f32_16x16x32_bf16 v[104:107], a[124:127], v[64:67], v[104:107]
    ds_read_b128 v[96:99], v1 offset:64512
    s_barrier
    ds_read_b128 v[36:39], v2 offset:0
    v_mfma_f32_16x16x32_bf16 v[108:111], a[44:47], v[68:71], v[108:111]
    ds_read_b128 v[234:237], v8 offset:18048
    ds_read_b128 v[238:241], v8 offset:18112
    v_add_f32 v142, v142, v146
    v_add_f32 v143, v143, v147
    v_mfma_f32_16x16x32_bf16 v[112:115], a[124:127], v[68:71], v[112:115]
    s_waitcnt lgkmcnt(0)
    v_mul_f32 v242, 0x3fb8aa3b, v230
    v_mul_f32 v243, 0x3fb8aa3b, v231
    v_add_f32 v140, v140, v148
    v_add_f32 v141, v141, v149
    v_mfma_f32_16x16x32_bf16 v[116:119], a[44:47], v[72:75], v[116:119]
    v_mul_f32 v244, 0x3fb8aa3b, v232
    v_mul_f32 v245, 0x3fb8aa3b, v233
    v_add_f32 v142, v142, v150
    v_add_f32 v143, v143, v151
    v_mfma_f32_16x16x32_bf16 v[120:123], a[124:127], v[72:75], v[120:123]
    v_mul_f32 v246, 0x3fb8aa3b, v238
    v_mul_f32 v247, 0x3fb8aa3b, v239
    v_add_f32 v140, v140, v152
    v_add_f32 v141, v141, v153
    v_mfma_f32_16x16x32_bf16 v[124:127], a[44:47], v[76:79], v[124:127]
    v_mul_f32 v248, 0x3fb8aa3b, v240
    v_mul_f32 v249, 0x3fb8aa3b, v241
    v_add_f32 v142, v142, v154
    v_add_f32 v143, v143, v155
    v_mfma_f32_16x16x32_bf16 v[128:131], a[124:127], v[76:79], v[128:131]
    v_add_f32 v140, v140, v156
    v_add_f32 v141, v141, v157
    v_add_f32 v142, v142, v158
    v_add_f32 v143, v143, v159
    v_mfma_f32_16x16x32_bf16 v[132:135], a[44:47], v[80:83], v[132:135]
    v_add_f32 v140, v140, v160
    v_add_f32 v141, v141, v161
    v_add_f32 v142, v142, v162
    v_add_f32 v143, v143, v163
    v_mfma_f32_16x16x32_bf16 v[136:139], a[124:127], v[80:83], v[136:139]
    ds_read_b128 v[40:43], v2 offset:1024
    buffer_load_dwordx4 a[72:75], v1, s[4:7], s32 offen offset:2048
    buffer_load_dwordx4 a[152:155], v4, s[4:7], s32 offen offset:2048
    s_waitcnt vmcnt(17)
    v_mfma_f32_16x16x32_bf16 v[100:103], a[48:51], v[84:87], v[100:103]
    ds_read_b128 v[44:47], v2 offset:2048
    ds_read_b128 v[48:51], v2 offset:3072
    v_add_f32 v140, v140, v164
    v_add_f32 v141, v141, v165
    v_mfma_f32_16x16x32_bf16 v[104:107], a[128:131], v[84:87], v[104:107]
    ds_read_b128 v[52:55], v2 offset:4096
    ds_read_b128 v[56:59], v2 offset:5120
    v_add_f32 v142, v142, v166
    v_add_f32 v143, v143, v167
    v_mfma_f32_16x16x32_bf16 v[108:111], a[48:51], v[88:91], v[108:111]
    v_add_f32 v140, v140, v168
    v_add_f32 v141, v141, v169
    v_add_f32 v142, v142, v170
    v_add_f32 v143, v143, v171
    v_mfma_f32_16x16x32_bf16 v[112:115], a[128:131], v[88:91], v[112:115]
    v_add_f32 v140, v140, v172
    v_add_f32 v141, v141, v173
    v_add_f32 v142, v142, v174
    v_add_f32 v143, v143, v175
    v_mfma_f32_16x16x32_bf16 v[116:119], a[48:51], v[92:95], v[116:119]
    v_add_f32 v140, v140, v176
    v_add_f32 v141, v141, v177
    v_add_f32 v142, v142, v178
    v_add_f32 v143, v143, v179
    v_mfma_f32_16x16x32_bf16 v[120:123], a[128:131], v[92:95], v[120:123]
    v_mov_b32 v144, v140
    v_mov_b32 v148, v140
    v_mov_b32 v145, v141
    v_mov_b32 v149, v141
    v_mfma_f32_16x16x32_bf16 v[124:127], a[48:51], v[96:99], v[124:127]
    v_mov_b32 v146, v142
    v_mov_b32 v150, v142
    v_mov_b32 v147, v143
    v_mov_b32 v151, v143
    v_mfma_f32_16x16x32_bf16 v[128:131], a[128:131], v[96:99], v[128:131]
    buffer_load_dwordx4 v1, s[4:7], s31 offen offset:1024 lds
    v_permlane32_swap_b32 v144, v148
    v_permlane32_swap_b32 v145, v149
    v_permlane32_swap_b32 v146, v150
    v_mfma_f32_16x16x32_bf16 v[132:135], a[48:51], v[36:39], v[132:135]
    v_permlane32_swap_b32 v147, v151
    s_cmp_eq_u32 s16, 0
    s_cselect_b64 vcc, -1, 0
    v_add_f32 v144, v144, v148
    v_mfma_f32_16x16x32_bf16 v[136:139], a[128:131], v[36:39], v[136:139]
    ds_read_b128 v[60:63], v2 offset:6144
    buffer_load_dwordx4 a[76:79], v1, s[4:7], s32 offen offset:3072
    buffer_load_dwordx4 a[156:159], v4, s[4:7], s32 offen offset:3072
    s_waitcnt vmcnt(18) lgkmcnt(1)
    v_mfma_f32_16x16x32_bf16 v[100:103], a[52:55], v[40:43], v[100:103]
    ds_read_b128 v[64:67], v2 offset:7168
    ds_read_b128 v[68:71], v2 offset:8192
    v_cndmask_b32 v140, v140, v144, vcc
    v_add_f32 v145, v145, v149
    v_mfma_f32_16x16x32_bf16 v[104:107], a[132:135], v[40:43], v[104:107]
    ds_read_b128 v[72:75], v2 offset:9216
    ds_read_b128 v[76:79], v2 offset:10240
    v_cndmask_b32 v141, v141, v145, vcc
    v_add_f32 v146, v146, v150
    v_mfma_f32_16x16x32_bf16 v[108:111], a[52:55], v[44:47], v[108:111]
    v_cndmask_b32 v142, v142, v146, vcc
    v_add_f32 v147, v147, v151
    v_cndmask_b32 v143, v143, v147, vcc
    v_lshlrev_b32 v16, 16, v180
    v_mfma_f32_16x16x32_bf16 v[112:115], a[132:135], v[44:47], v[112:115]
    v_and_b32 v17, 0xffff0000, v180
    v_lshlrev_b32 v18, 16, v181
    v_and_b32 v19, 0xffff0000, v181
    v_lshlrev_b32 v20, 16, v182
    v_mfma_f32_16x16x32_bf16 v[116:119], a[52:55], v[48:51], v[116:119]
    v_and_b32 v21, 0xffff0000, v182
    v_lshlrev_b32 v22, 16, v183
    v_and_b32 v23, 0xffff0000, v183
    v_lshlrev_b32 v24, 16, v184
    v_mfma_f32_16x16x32_bf16 v[120:123], a[132:135], v[48:51], v[120:123]
    v_and_b32 v25, 0xffff0000, v184
    v_lshlrev_b32 v26, 16, v185
    v_and_b32 v27, 0xffff0000, v185
    v_lshlrev_b32 v28, 16, v186
    v_mfma_f32_16x16x32_bf16 v[124:127], a[52:55], v[52:55], v[124:127]
    v_and_b32 v29, 0xffff0000, v186
    v_lshlrev_b32 v30, 16, v187
    v_and_b32 v31, 0xffff0000, v187
    v_lshlrev_b32 v32, 16, v188
    v_mfma_f32_16x16x32_bf16 v[128:131], a[132:135], v[52:55], v[128:131]
    v_and_b32 v33, 0xffff0000, v188
    v_lshlrev_b32 v34, 16, v189
    v_and_b32 v35, 0xffff0000, v189
    v_mfma_f32_16x16x32_bf16 v[132:135], a[52:55], v[56:59], v[132:135]
    buffer_load_dwordx4 v1, s[4:7], s31 offen offset:2048 lds
    s_cmp_eq_u32 s16, 0
    s_mov_b32 s33, 16896
    s_cselect_b32 s33, 16384, s33
    s_cselect_b32 s34, 32, 56
    s_cmp_ge_u32 s16, 2
    s_cselect_b32 s34, 0, s34
    v_add_u32 v254, s33, v3
    v_lshrrev_b32 v255, 4, v1
    v_cmp_gt_u32 vcc, s34, v255
    s_nop 3
    s_and_saveexec_b64 s[34:35], vcc
    ds_write_b128 v254, v[140:143]
    s_mov_b64 exec, s[34:35]
    v_mfma_f32_16x16x32_bf16 v[136:139], a[132:135], v[56:59], v[136:139]
    ds_read_b128 v[80:83], v2 offset:11264
    s_waitcnt vmcnt(14) lgkmcnt(2)
    v_mfma_f32_16x16x32_bf16 v[100:103], a[56:59], v[60:63], v[100:103]
    ds_read_b128 v[84:87], v2 offset:12288
    ds_read_b128 v[88:91], v2 offset:13312
    v_mfma_f32_16x16x32_bf16 v[104:107], a[136:139], v[60:63], v[104:107]
    ds_read_b128 v[92:95], v2 offset:14336
    ds_read_b128 v[96:99], v2 offset:15360
    v_mfma_f32_16x16x32_bf16 v[108:111], a[56:59], v[64:67], v[108:111]
    buffer_load_dwordx4 v1, s[4:7], s31 offen offset:3072 lds
    v_mfma_f32_16x16x32_bf16 v[112:115], a[136:139], v[64:67], v[112:115]
    v_mfma_f32_16x16x32_bf16 v[116:119], a[56:59], v[68:71], v[116:119]
    v_mfma_f32_16x16x32_bf16 v[120:123], a[136:139], v[68:71], v[120:123]
    v_mfma_f32_16x16x32_bf16 v[124:127], a[56:59], v[72:75], v[124:127]
    s_add_u32 m0, s22, 114688
    s_add_u32 s31, s25, 114688
    buffer_load_dwordx4 v1, s[4:7], s31 offen offset:0 lds
    v_mfma_f32_16x16x32_bf16 v[128:131], a[136:139], v[72:75], v[128:131]
    v_mfma_f32_16x16x32_bf16 v[132:135], a[56:59], v[76:79], v[132:135]
    v_mfma_f32_16x16x32_bf16 v[136:139], a[136:139], v[76:79], v[136:139]
    s_waitcnt vmcnt(13)
    s_barrier
    ds_read_b128 v[36:39], v2 offset:16384
    s_waitcnt lgkmcnt(1)
    v_mfma_f32_16x16x32_bf16 v[100:103], a[60:63], v[80:83], v[100:103]
    ds_read_b128 v[40:43], v2 offset:17408
    ds_read_b128 v[44:47], v2 offset:18432
    v_mfma_f32_16x16x32_bf16 v[104:107], a[140:143], v[80:83], v[104:107]
    ds_read_b128 v[48:51], v2 offset:19456
    ds_read_b128 v[52:55], v2 offset:20480
    v_mfma_f32_16x16x32_bf16 v[108:111], a[60:63], v[84:87], v[108:111]
    buffer_load_dwordx4 v1, s[4:7], s31 offen offset:1024 lds
    v_mfma_f32_16x16x32_bf16 v[112:115], a[140:143], v[84:87], v[112:115]
    v_mfma_f32_16x16x32_bf16 v[116:119], a[60:63], v[88:91], v[116:119]
    buffer_load_dwordx4 v1, s[4:7], s31 offen offset:2048 lds
    v_mfma_f32_16x16x32_bf16 v[120:123], a[140:143], v[88:91], v[120:123]
    v_mfma_f32_16x16x32_bf16 v[124:127], a[60:63], v[92:95], v[124:127]
    v_mfma_f32_16x16x32_bf16 v[128:131], a[140:143], v[92:95], v[128:131]
    buffer_load_dwordx4 v1, s[4:7], s31 offen offset:3072 lds
    v_mfma_f32_16x16x32_bf16 v[132:135], a[60:63], v[96:99], v[132:135]
    v_mfma_f32_16x16x32_bf16 v[136:139], a[140:143], v[96:99], v[136:139]
    ds_read_b128 v[56:59], v2 offset:21504
    s_waitcnt vmcnt(14) lgkmcnt(1)
    v_mfma_f32_16x16x32_bf16 v[100:103], a[64:67], v[36:39], v[100:103]
    ds_read_b128 v[60:63], v2 offset:22528
    ds_read_b128 v[64:67], v2 offset:23552
    v_mfma_f32_16x16x32_bf16 v[104:107], a[144:147], v[36:39], v[104:107]
    ds_read_b128 v[68:71], v2 offset:24576
    ds_read_b128 v[72:75], v2 offset:25600
    v_mfma_f32_16x16x32_bf16 v[108:111], a[64:67], v[40:43], v[108:111]
    s_add_u32 m0, s22, 131072
    s_add_u32 s31, s25, 131072
    buffer_load_dwordx4 v1, s[4:7], s31 offen offset:0 lds
    v_mfma_f32_16x16x32_bf16 v[112:115], a[144:147], v[40:43], v[112:115]
    v_mfma_f32_16x16x32_bf16 v[116:119], a[64:67], v[44:47], v[116:119]
    v_mfma_f32_16x16x32_bf16 v[120:123], a[144:147], v[44:47], v[120:123]
    buffer_load_dwordx4 v1, s[4:7], s31 offen offset:1024 lds
    v_mfma_f32_16x16x32_bf16 v[124:127], a[64:67], v[48:51], v[124:127]
    v_mfma_f32_16x16x32_bf16 v[128:131], a[144:147], v[48:51], v[128:131]
    v_mfma_f32_16x16x32_bf16 v[132:135], a[64:67], v[52:55], v[132:135]
    v_mfma_f32_16x16x32_bf16 v[136:139], a[144:147], v[52:55], v[136:139]
    ds_read_b128 v[76:79], v2 offset:26624
    s_waitcnt vmcnt(13) lgkmcnt(1)
    v_mfma_f32_16x16x32_bf16 v[100:103], a[68:71], v[56:59], v[100:103]
    ds_read_b128 v[80:83], v2 offset:27648
    ds_read_b128 v[84:87], v2 offset:28672
    v_mfma_f32_16x16x32_bf16 v[104:107], a[148:151], v[56:59], v[104:107]
    ds_read_b128 v[88:91], v2 offset:29696
    ds_read_b128 v[92:95], v2 offset:30720
    v_mfma_f32_16x16x32_bf16 v[108:111], a[68:71], v[60:63], v[108:111]
    buffer_load_dwordx4 v1, s[4:7], s31 offen offset:2048 lds
    v_mfma_f32_16x16x32_bf16 v[112:115], a[148:151], v[60:63], v[112:115]
    buffer_load_dwordx4 v1, s[4:7], s31 offen offset:3072 lds
    v_mfma_f32_16x16x32_bf16 v[116:119], a[68:71], v[64:67], v[116:119]
    v_mfma_f32_16x16x32_bf16 v[120:123], a[148:151], v[64:67], v[120:123]
    v_mfma_f32_16x16x32_bf16 v[124:127], a[68:71], v[68:71], v[124:127]
    v_mfma_f32_16x16x32_bf16 v[128:131], a[148:151], v[68:71], v[128:131]
    v_mfma_f32_16x16x32_bf16 v[132:135], a[68:71], v[72:75], v[132:135]
    v_mfma_f32_16x16x32_bf16 v[136:139], a[148:151], v[72:75], v[136:139]
    ds_read_b128 v[96:99], v2 offset:31744
    s_waitcnt vmcnt(13) lgkmcnt(1)
    v_mfma_f32_16x16x32_bf16 v[100:103], a[72:75], v[76:79], v[100:103]
    s_waitcnt vmcnt(8)
    s_barrier
    ds_read_b128 v[36:39], v2 offset:32768
    v_mfma_f32_16x16x32_bf16 v[104:107], a[152:155], v[76:79], v[104:107]
    ds_read_b128 v[40:43], v2 offset:33792
    ds_read_b128 v[44:47], v2 offset:34816
    v_mfma_f32_16x16x32_bf16 v[108:111], a[72:75], v[80:83], v[108:111]
    ds_read_b128 v[48:51], v2 offset:35840
    v_mfma_f32_16x16x32_bf16 v[112:115], a[152:155], v[80:83], v[112:115]
    v_mfma_f32_16x16x32_bf16 v[116:119], a[72:75], v[84:87], v[116:119]
    v_mfma_f32_16x16x32_bf16 v[120:123], a[152:155], v[84:87], v[120:123]
    v_mfma_f32_16x16x32_bf16 v[124:127], a[72:75], v[88:91], v[124:127]
    v_mfma_f32_16x16x32_bf16 v[128:131], a[152:155], v[88:91], v[128:131]
    v_mfma_f32_16x16x32_bf16 v[132:135], a[72:75], v[92:95], v[132:135]
    v_mfma_f32_16x16x32_bf16 v[136:139], a[152:155], v[92:95], v[136:139]
    s_waitcnt lgkmcnt(0)
    v_mfma_f32_16x16x32_bf16 v[100:103], a[76:79], v[96:99], v[100:103]
    v_mfma_f32_16x16x32_bf16 v[104:107], a[156:159], v[96:99], v[104:107]
    v_mfma_f32_16x16x32_bf16 v[108:111], a[76:79], v[36:39], v[108:111]
    v_mfma_f32_16x16x32_bf16 v[112:115], a[156:159], v[36:39], v[112:115]
    v_mfma_f32_16x16x32_bf16 v[116:119], a[76:79], v[40:43], v[116:119]
    v_mfma_f32_16x16x32_bf16 v[120:123], a[156:159], v[40:43], v[120:123]
    v_mfma_f32_16x16x32_bf16 v[124:127], a[76:79], v[44:47], v[124:127]
    v_mfma_f32_16x16x32_bf16 v[128:131], a[156:159], v[44:47], v[128:131]
    v_mfma_f32_16x16x32_bf16 v[132:135], a[76:79], v[48:51], v[132:135]
    v_mfma_f32_16x16x32_bf16 v[136:139], a[156:159], v[48:51], v[136:139]
    s_add_u32 s34, s38, 8192
    v_mov_b32 v253, v251
    v_cmp_gt_u32 vcc, 1, v253
    s_nop 4
    s_cbranch_vccz Lx1_p_x
    s_mov_b32 s47, 0
    v_subrev_u32 v252, 0x20000, v5
Lx1_p:
    buffer_load_dword v253, v252, s[4:7], s34 offen sc1
    s_waitcnt vmcnt(0)
    v_cmp_gt_u32 vcc, 1, v253
    s_add_u32 s47, s47, 1
    s_cmp_gt_u32 s47, 20000
    s_cbranch_scc1 Lx1_p_x
    s_nop 1
    s_cbranch_vccnz Lx1_p
Lx1_p_x:
    v_cmp_ne_u32 vcc, s46, v253
    s_nop 4
    s_cbranch_vccnz Lk1_nocsS
    s_branch Lk1_nocsF
Lm_layerF:
    s_cmp_eq_u32 s21, 1
    s_cselect_b32 s14, 0, 50331648
    s_mul_i32 s32, s60, 2621440
    s_mul_i32 s33, s42, 20480
    s_add_u32 s32, s32, s33
    s_add_u32 s32, s32, 4194304
    s_mul_i32 s62, s60, 131072
    s_lshl_b32 s63, s42, 10
    s_add_u32 s62, s62, s63
    s_add_u32 s62, s62, 393216
    buffer_load_dwordx2 v[212:213], v12, s[4:7], s62 offen offset:0 sc1
    buffer_load_dwordx2 v[214:215], v12, s[4:7], s62 offen offset:128 sc1
    buffer_load_dwordx2 v[216:217], v12, s[4:7], s62 offen offset:1024 sc1
    buffer_load_dwordx2 v[218:219], v12, s[4:7], s62 offen offset:1152 sc1
    s_waitcnt vmcnt(16)
    s_barrier
    ds_read_b128 v[36:39], v1 offset:0
    ds_read_b128 v[40:43], v1 offset:1024
    ds_read_b128 v[44:47], v1 offset:2048
    ds_read_b128 v[48:51], v1 offset:3072
    ds_read_b128 v[52:55], v1 offset:4096
    buffer_load_dwordx4 a[0:3], v1, s[4:7], s32 offen offset:0 sc1
    buffer_load_dwordx4 a[80:83], v4, s[4:7], s32 offen offset:0 sc1
    buffer_load_dwordx4 a[4:7], v1, s[4:7], s32 offen offset:1024 sc1
    buffer_load_dwordx4 a[84:87], v4, s[4:7], s32 offen offset:1024 sc1
    buffer_load_dwordx4 a[8:11], v1, s[4:7], s32 offen offset:2048 sc1
    buffer_load_dwordx4 a[88:91], v4, s[4:7], s32 offen offset:2048 sc1
    buffer_load_dwordx4 a[12:15], v1, s[4:7], s32 offen offset:3072 sc1
    buffer_load_dwordx4 a[92:95], v4, s[4:7], s32 offen offset:3072 sc1
    s_add_u32 s32, s32, 4096
    buffer_load_dwordx4 a[16:19], v1, s[4:7], s32 offen offset:0 sc1
    buffer_load_dwordx4 a[96:99], v4, s[4:7], s32 offen offset:0 sc1
    s_waitcnt vmcnt(8) lgkmcnt(0)
    v_mfma_f32_16x16x32_bf16 v[100:103], a[0:3], v[36:39], 0
    ds_read_b128 v[56:59], v1 offset:5120
    ds_read_b128 v[60:63], v1 offset:6144
    v_mfma_f32_16x16x32_bf16 v[104:107], a[80:83], v[36:39], 0
    ds_read_b128 v[64:67], v1 offset:7168
    ds_read_b128 v[68:71], v1 offset:8192
    v_mfma_f32_16x16x32_bf16 v[108:111], a[0:3], v[40:43], 0
    ds_read_b128 v[72:75], v1 offset:9216
    buffer_load_dwordx4 a[20:23], v1, s[4:7], s32 offen offset:1024 sc1
    v_mfma_f32_16x16x32_bf16 v[112:115], a[80:83], v[40:43], 0
    v_mfma_f32_16x16x32_bf16 v[116:119], a[0:3], v[44:47], 0
    v_mfma_f32_16x16x32_bf16 v[120:123], a[80:83], v[44:47], 0
    buffer_load_dwordx4 a[100:103], v4, s[4:7], s32 offen offset:1024 sc1
    v_mfma_f32_16x16x32_bf16 v[124:127], a[0:3], v[48:51], 0
    v_mfma_f32_16x16x32_bf16 v[128:131], a[80:83], v[48:51], 0
    v_mfma_f32_16x16x32_bf16 v[132:135], a[0:3], v[52:55], 0
    v_mfma_f32_16x16x32_bf16 v[136:139], a[80:83], v[52:55], 0
    ds_read_b128 v[76:79], v1 offset:10240
    s_waitcnt vmcnt(8) lgkmcnt(1)
    v_mfma_f32_16x16x32_bf16 v[100:103], a[4:7], v[56:59], v[100:103]
    ds_read_b128 v[80:83], v1 offset:11264
    ds_read_b128 v[84:87], v1 offset:12288
    v_mfma_f32_16x16x32_bf16 v[104:107], a[84:87], v[56:59], v[104:107]
    ds_read_b128 v[88:91], v1 offset:13312
    ds_read_b128 v[92:95], v1 offset:14336
    v_mfma_f32_16x16x32_bf16 v[108:111], a[4:7], v[60:63], v[108:111]
    buffer_load_dwordx4 a[24:27], v1, s[4:7], s32 offen offset:2048 sc1
    v_mfma_f32_16x16x32_bf16 v[112:115], a[84:87], v[60:63], v[112:115]
    buffer_load_dwordx4 a[104:107], v4, s[4:7], s32 offen offset:2048 sc1
    v_mfma_f32_16x16x32_bf16 v[116:119], a[4:7], v[64:67], v[116:119]
    v_mfma_f32_16x16x32_bf16 v[120:123], a[84:87], v[64:67], v[120:123]
    v_mfma_f32_16x16x32_bf16 v[124:127], a[4:7], v[68:71], v[124:127]
    v_mfma_f32_16x16x32_bf16 v[128:131], a[84:87], v[68:71], v[128:131]
    buffer_load_dwordx4 a[28:31], v1, s[4:7], s32 offen offset:3072 sc1
    v_mfma_f32_16x16x32_bf16 v[132:135], a[4:7], v[72:75], v[132:135]
    v_mfma_f32_16x16x32_bf16 v[136:139], a[84:87], v[72:75], v[136:139]
    ds_read_b128 v[96:99], v1 offset:15360
    s_waitcnt vmcnt(9) lgkmcnt(1)
    v_mfma_f32_16x16x32_bf16 v[100:103], a[8:11], v[76:79], v[100:103]
    ds_read_b128 v[36:39], v1 offset:16384
    ds_read_b128 v[40:43], v1 offset:17408
    v_mfma_f32_16x16x32_bf16 v[104:107], a[88:91], v[76:79], v[104:107]
    ds_read_b128 v[44:47], v1 offset:18432
    ds_read_b128 v[48:51], v1 offset:19456
    v_mfma_f32_16x16x32_bf16 v[108:111], a[8:11], v[80:83], v[108:111]
    buffer_load_dwordx4 a[108:111], v4, s[4:7], s32 offen offset:3072 sc1
    v_mfma_f32_16x16x32_bf16 v[112:115], a[88:91], v[80:83], v[112:115]
    v_mfma_f32_16x16x32_bf16 v[116:119], a[8:11], v[84:87], v[116:119]
    s_add_u32 m0, s22, 81920
    s_add_u32 s31, s25, 81920
    buffer_load_dwordx4 v1, s[4:7], s31 offen offset:0 lds
    v_mfma_f32_16x16x32_bf16 v[120:123], a[88:91], v[84:87], v[120:123]
    v_mfma_f32_16x16x32_bf16 v[124:127], a[8:11], v[88:91], v[124:127]
    v_mfma_f32_16x16x32_bf16 v[128:131], a[88:91], v[88:91], v[128:131]
    v_mfma_f32_16x16x32_bf16 v[132:135], a[8:11], v[92:95], v[132:135]
    buffer_load_dwordx4 v1, s[4:7], s31 offen offset:1024 lds
    v_mfma_f32_16x16x32_bf16 v[136:139], a[88:91], v[92:95], v[136:139]
    ds_read_b128 v[52:55], v1 offset:20480
    s_waitcnt vmcnt(10) lgkmcnt(1)
    v_mfma_f32_16x16x32_bf16 v[100:103], a[12:15], v[96:99], v[100:103]
    ds_read_b128 v[56:59], v1 offset:21504
    ds_read_b128 v[60:63], v1 offset:22528
    v_mfma_f32_16x16x32_bf16 v[104:107], a[92:95], v[96:99], v[104:107]
    ds_read_b128 v[64:67], v1 offset:23552
    ds_read_b128 v[68:71], v1 offset:24576
    v_mfma_f32_16x16x32_bf16 v[108:111], a[12:15], v[36:39], v[108:111]
    buffer_load_dwordx4 v1, s[4:7], s31 offen offset:2048 lds
    v_mfma_f32_16x16x32_bf16 v[112:115], a[92:95], v[36:39], v[112:115]
    v_mfma_f32_16x16x32_bf16 v[116:119], a[12:15], v[40:43], v[116:119]
    v_mfma_f32_16x16x32_bf16 v[120:123], a[92:95], v[40:43], v[120:123]
    v_mfma_f32_16x16x32_bf16 v[124:127], a[12:15], v[44:47], v[124:127]
    buffer_load_dwordx4 v1, s[4:7], s31 offen offset:3072 lds
    v_mfma_f32_16x16x32_bf16 v[128:131], a[92:95], v[44:47], v[128:131]
    v_mfma_f32_16x16x32_bf16 v[132:135], a[12:15], v[48:51], v[132:135]
    v_mfma_f32_16x16x32_bf16 v[136:139], a[92:95], v[48:51], v[136:139]
    ds_read_b128 v[72:75], v1 offset:25600
    s_waitcnt vmcnt(10) lgkmcnt(1)
    v_mfma_f32_16x16x32_bf16 v[100:103], a[16:19], v[52:55], v[100:103]
    ds_read_b128 v[76:79], v1 offset:26624
    ds_read_b128 v[80:83], v1 offset:27648
    v_mfma_f32_16x16x32_bf16 v[104:107], a[96:99], v[52:55], v[104:107]
    ds_read_b128 v[84:87], v1 offset:28672
    ds_read_b128 v[88:91], v1 offset:29696
    v_mfma_f32_16x16x32_bf16 v[108:111], a[16:19], v[56:59], v[108:111]
    s_add_u32 s32, s32, 4096
    buffer_load_dwordx4 a[32:35], v1, s[4:7], s32 offen offset:0 sc1
    v_mfma_f32_16x16x32_bf16 v[112:115], a[96:99], v[56:59], v[112:115]
    buffer_load_dwordx4 a[112:115], v4, s[4:7], s32 offen offset:0 sc1
    v_add_f32 v212, v212, v214
    v_mfma_f32_16x16x32_bf16 v[116:119], a[16:19], v[60:63], v[116:119]
    v_add_f32 v213, v213, v215
    v_mov_b32 v224, v212
    v_mfma_f32_16x16x32_bf16 v[120:123], a[96:99], v[60:63], v[120:123]
    v_mov_b32 v225, v213
    v_permlane32_swap_b32 v212, v224
    v_mfma_f32_16x16x32_bf16 v[124:127], a[16:19], v[64:67], v[124:127]
    v_permlane32_swap_b32 v213, v225
    v_add_f32 v212, v212, v224
    v_mfma_f32_16x16x32_bf16 v[128:131], a[96:99], v[64:67], v[128:131]
    buffer_load_dwordx4 a[36:39], v1, s[4:7], s32 offen offset:1024 sc1
    v_add_f32 v213, v213, v225
    v_mfma_f32_16x16x32_bf16 v[132:135], a[16:19], v[68:71], v[132:135]
    v_mov_b32 v224, v212
    v_mov_b32 v225, v213
    v_mfma_f32_16x16x32_bf16 v[136:139], a[96:99], v[68:71], v[136:139]
    ds_read_b128 v[92:95], v1 offset:30720
    s_waitcnt vmcnt(11) lgkmcnt(1)
    v_mfma_f32_16x16x32_bf16 v[100:103], a[20:23], v[72:75], v[100:103]
    ds_read_b128 v[96:99], v1 offset:31744
    s_barrier
    ds_read_b128 v[36:39], v1 offset:32768
    v_mfma_f32_16x16x32_bf16 v[104:107], a[100:103], v[72:75], v[104:107]
    ds_read_b128 v[40:43], v1 offset:33792
    ds_read_b128 v[44:47], v1 offset:34816
    v_mfma_f32_16x16x32_bf16 v[108:111], a[20:23], v[76:79], v[108:111]
    buffer_load_dwordx4 a[116:119], v4, s[4:7], s32 offen offset:1024 sc1
    v_permlane16_swap_b32 v212, v224
    v_mfma_f32_16x16x32_bf16 v[112:115], a[100:103], v[76:79], v[112:115]
    v_permlane16_swap_b32 v213, v225
    v_add_f32 v212, v212, v224
    v_mfma_f32_16x16x32_bf16 v[116:119], a[20:23], v[80:83], v[116:119]
    v_add_f32 v213, v213, v225
    v_mul_f32 v220, 0xbacccccd, v212
    v_mfma_f32_16x16x32_bf16 v[120:123], a[100:103], v[80:83], v[120:123]
    buffer_load_dwordx4 a[40:43], v1, s[4:7], s32 offen offset:2048 sc1
    v_mul_f32 v213, 0x3acccccd, v213
    v_mfma_f32_16x16x32_bf16 v[124:127], a[20:23], v[84:87], v[124:127]
    v_fma_f32 v213, -v220, v220, v213
    v_max_f32 v213, 0, v213
    v_mfma_f32_16x16x32_bf16 v[128:131], a[100:103], v[84:87], v[128:131]
    v_add_f32 v213, 0x3727c5ac, v213
    v_mfma_f32_16x16x32_bf16 v[132:135], a[20:23], v[88:91], v[132:135]
    buffer_load_dwordx4 a[120:123], v4, s[4:7], s32 offen offset:2048 sc1
    v_mfma_f32_16x16x32_bf16 v[136:139], a[100:103], v[88:91], v[136:139]
    ds_read_b128 v[48:51], v1 offset:35840
    s_waitcnt vmcnt(12) lgkmcnt(1)
    v_mfma_f32_16x16x32_bf16 v[100:103], a[24:27], v[92:95], v[100:103]
    ds_read_b128 v[52:55], v1 offset:36864
    ds_read_b128 v[56:59], v1 offset:37888
    v_mfma_f32_16x16x32_bf16 v[104:107], a[104:107], v[92:95], v[104:107]
    ds_read_b128 v[60:63], v1 offset:38912
    ds_read_b128 v[64:67], v1 offset:39936
    v_mfma_f32_16x16x32_bf16 v[108:111], a[24:27], v[96:99], v[108:111]
    buffer_load_dwordx4 a[44:47], v1, s[4:7], s32 offen offset:3072 sc1
    v_mfma_f32_16x16x32_bf16 v[112:115], a[104:107], v[96:99], v[112:115]
    v_rsq_f32 v221, v213
    v_mfma_f32_16x16x32_bf16 v[116:119], a[24:27], v[36:39], v[116:119]
    v_add_f32 v216, v216, v218
    v_add_f32 v217, v217, v219
    v_mfma_f32_16x16x32_bf16 v[120:123], a[104:107], v[36:39], v[120:123]
    v_mov_b32 v224, v216
    v_mov_b32 v225, v217
    v_mfma_f32_16x16x32_bf16 v[124:127], a[24:27], v[40:43], v[124:127]
    buffer_load_dwordx4 a[124:127], v4, s[4:7], s32 offen offset:3072 sc1
    v_permlane32_swap_b32 v216, v224
    v_mfma_f32_16x16x32_bf16 v[128:131], a[104:107], v[40:43], v[128:131]
    v_permlane32_swap_b32 v217, v225
    v_add_f32 v216, v216, v224
    v_mfma_f32_16x16x32_bf16 v[132:135], a[24:27], v[44:47], v[132:135]
    v_add_f32 v217, v217, v225
    v_mov_b32 v224, v216
    v_mfma_f32_16x16x32_bf16 v[136:139], a[104:107], v[44:47], v[136:139]
    ds_read_b128 v[68:71], v1 offset:40960
    s_waitcnt vmcnt(12) lgkmcnt(1)
    v_mfma_f32_16x16x32_bf16 v[100:103], a[28:31], v[48:51], v[100:103]
    ds_read_b128 v[72:75], v1 offset:41984
    ds_read_b128 v[76:79], v1 offset:43008
    v_mfma_f32_16x16x32_bf16 v[104:107], a[108:111], v[48:51], v[104:107]
    ds_read_b128 v[80:83], v1 offset:44032
    ds_read_b128 v[84:87], v1 offset:45056
    v_mfma_f32_16x16x32_bf16 v[108:111], a[28:31], v[52:55], v[108:111]
    s_add_u32 s32, s32, 4096
    buffer_load_dwordx4 a[48:51], v1, s[4:7], s32 offen offset:0 sc1
    v_mfma_f32_16x16x32_bf16 v[112:115], a[108:111], v[52:55], v[112:115]
    v_mov_b32 v225, v217
    v_permlane16_swap_b32 v216, v224
    v_mfma_f32_16x16x32_bf16 v[116:119], a[28:31], v[56:59], v[116:119]
    buffer_load_dwordx4 a[128:131], v4, s[4:7], s32 offen offset:0 sc1
    v_permlane16_swap_b32 v217, v225
    v_mfma_f32_16x16x32_bf16 v[120:123], a[108:111], v[56:59], v[120:123]
    v_add_f32 v216, v216, v224
    v_add_f32 v217, v217, v225
    v_mfma_f32_16x16x32_bf16 v[124:127], a[28:31], v[60:63], v[124:127]
    v_mul_f32 v222, 0xbacccccd, v216
    v_mul_f32 v217, 0x3acccccd, v217
    v_mfma_f32_16x16x32_bf16 v[128:131], a[108:111], v[60:63], v[128:131]
    buffer_load_dwordx4 a[52:55], v1, s[4:7], s32 offen offset:1024 sc1
    v_fma_f32 v217, -v222, v222, v217
    v_mfma_f32_16x16x32_bf16 v[132:135], a[28:31], v[64:67], v[132:135]
    v_max_f32 v217, 0, v217
    v_add_f32 v217, 0x3727c5ac, v217
    v_mfma_f32_16x16x32_bf16 v[136:139], a[108:111], v[64:67], v[136:139]
    ds_read_b128 v[88:91], v1 offset:46080
    s_waitcnt vmcnt(9) lgkmcnt(1)
    v_mfma_f32_16x16x32_bf16 v[100:103], a[32:35], v[68:71], v[100:103]
    ds_read_b128 v[92:95], v1 offset:47104
    ds_read_b128 v[96:99], v1 offset:48128
    v_mfma_f32_16x16x32_bf16 v[104:107], a[112:115], v[68:71], v[104:107]
    ds_read_b128 v[36:39], v1 offset:49152
    ds_read_b128 v[40:43], v1 offset:50176
    v_mfma_f32_16x16x32_bf16 v[108:111], a[32:35], v[72:75], v[108:111]
    buffer_load_dwordx4 a[132:135], v4, s[4:7], s32 offen offset:1024 sc1
    v_mfma_f32_16x16x32_bf16 v[112:115], a[112:115], v[72:75], v[112:115]
    v_rsq_f32 v223, v217
    v_mfma_f32_16x16x32_bf16 v[116:119], a[32:35], v[76:79], v[116:119]
    ds_write_b32 v6, v220 offset:17920
    ds_write_b32 v6, v221 offset:17984
    v_mfma_f32_16x16x32_bf16 v[120:123], a[112:115], v[76:79], v[120:123]
    s_add_u32 m0, s22, 98304
    s_add_u32 s31, s25, 98304
    buffer_load_dwordx4 v1, s[4:7], s31 offen offset:0 lds
    v_mfma_f32_16x16x32_bf16 v[124:127], a[32:35], v[80:83], v[124:127]
    ds_write_b32 v6, v222 offset:18048
    ds_write_b32 v6, v223 offset:18112
    v_mfma_f32_16x16x32_bf16 v[128:131], a[112:115], v[80:83], v[128:131]
    s_waitcnt lgkmcnt(0)
    ds_read_b128 v[226:229], v8 offset:17920
    ds_read_b128 v[230:233], v8 offset:17984
    v_mfma_f32_16x16x32_bf16 v[132:135], a[32:35], v[84:87], v[132:135]
    ds_read_b128 v[234:237], v8 offset:18048
    ds_read_b128 v[238:241], v8 offset:18112
    v_mfma_f32_16x16x32_bf16 v[136:139], a[112:115], v[84:87], v[136:139]
    ds_read_b128 v[44:47], v1 offset:51200
    s_waitcnt vmcnt(9)
    v_mfma_f32_16x16x32_bf16 v[100:103], a[36:39], v[88:91], v[100:103]
    ds_read_b128 v[48:51], v1 offset:52224
    ds_read_b128 v[52:55], v1 offset:53248
    v_mfma_f32_16x16x32_bf16 v[104:107], a[116:119], v[88:91], v[104:107]
    ds_read_b128 v[56:59], v1 offset:54272
    ds_read_b128 v[60:63], v1 offset:55296
    v_mfma_f32_16x16x32_bf16 v[108:111], a[36:39], v[92:95], v[108:111]
    buffer_load_dwordx4 v1, s[4:7], s31 offen offset:1024 lds
    s_waitcnt lgkmcnt(5)
    v_mul_f32 v242, 0x3fb8aa3b, v230
    v_mfma_f32_16x16x32_bf16 v[112:115], a[116:119], v[92:95], v[112:115]
    buffer_load_dwordx4 v1, s[4:7], s31 offen offset:2048 lds
    v_mul_f32 v243, 0x3fb8aa3b, v231
    v_mfma_f32_16x16x32_bf16 v[116:119], a[36:39], v[96:99], v[116:119]
    v_mul_f32 v244, 0x3fb8aa3b, v232
    v_mul_f32 v245, 0x3fb8aa3b, v233
    v_mfma_f32_16x16x32_bf16 v[120:123], a[116:119], v[96:99], v[120:123]
    v_mul_f32 v246, 0x3fb8aa3b, v238
    v_mul_f32 v247, 0x3fb8aa3b, v239
    v_mfma_f32_16x16x32_bf16 v[124:127], a[36:39], v[36:39], v[124:127]
    buffer_load_dwordx4 v1, s[4:7], s31 offen offset:3072 lds
    v_mul_f32 v248, 0x3fb8aa3b, v240
    v_mfma_f32_16x16x32_bf16 v[128:131], a[116:119], v[36:39], v[128:131]
    v_mul_f32 v249, 0x3fb8aa3b, v241
    v_mfma_f32_16x16x32_bf16 v[132:135], a[36:39], v[40:43], v[132:135]
    v_mfma_f32_16x16x32_bf16 v[136:139], a[116:119], v[40:43], v[136:139]
    ds_read_b128 v[64:67], v1 offset:56320
    s_waitcnt vmcnt(10) lgkmcnt(1)
    v_mfma_f32_16x16x32_bf16 v[100:103], a[40:43], v[44:47], v[100:103]
    ds_read_b128 v[68:71], v1 offset:57344
    ds_read_b128 v[72:75], v1 offset:58368
    v_mfma_f32_16x16x32_bf16 v[104:107], a[120:123], v[44:47], v[104:107]
    ds_read_b128 v[76:79], v1 offset:59392
    ds_read_b128 v[80:83], v1 offset:60416
    v_mfma_f32_16x16x32_bf16 v[108:111], a[40:43], v[48:51], v[108:111]
    buffer_load_dwordx4 a[56:59], v1, s[4:7], s32 offen offset:2048 sc1
    v_mfma_f32_16x16x32_bf16 v[112:115], a[120:123], v[48:51], v[112:115]
    v_mfma_f32_16x16x32_bf16 v[116:119], a[40:43], v[52:55], v[116:119]
    buffer_load_dwordx4 a[136:139], v4, s[4:7], s32 offen offset:2048 sc1
    v_mfma_f32_16x16x32_bf16 v[120:123], a[120:123], v[52:55], v[120:123]
    v_mfma_f32_16x16x32_bf16 v[124:127], a[40:43], v[56:59], v[124:127]
    v_mfma_f32_16x16x32_bf16 v[128:131], a[120:123], v[56:59], v[128:131]
    v_mfma_f32_16x16x32_bf16 v[132:135], a[40:43], v[60:63], v[132:135]
    buffer_load_dwordx4 a[60:63], v1, s[4:7], s32 offen offset:3072 sc1
    v_mfma_f32_16x16x32_bf16 v[136:139], a[120:123], v[60:63], v[136:139]
    ds_read_b128 v[84:87], v1 offset:61440
    s_waitcnt vmcnt(11) lgkmcnt(1)
    v_mfma_f32_16x16x32_bf16 v[100:103], a[44:47], v[64:67], v[100:103]
    ds_read_b128 v[88:91], v1 offset:62464
    ds_read_b128 v[92:95], v1 offset:63488
    v_mfma_f32_16x16x32_bf16 v[104:107], a[124:127], v[64:67], v[104:107]
    ds_read_b128 v[96:99], v1 offset:64512
    s_barrier
    ds_read_b128 v[36:39], v2 offset:0
    v_mfma_f32_16x16x32_bf16 v[108:111], a[44:47], v[68:71], v[108:111]
    buffer_load_dwordx4 a[140:143], v4, s[4:7], s32 offen offset:3072 sc1
    v_mfma_f32_16x16x32_bf16 v[112:115], a[124:127], v[68:71], v[112:115]
    v_mfma_f32_16x16x32_bf16 v[116:119], a[44:47], v[72:75], v[116:119]
    v_mfma_f32_16x16x32_bf16 v[120:123], a[124:127], v[72:75], v[120:123]
    s_add_u32 s32, s32, 4096
    buffer_load_dwordx4 a[64:67], v1, s[4:7], s32 offen offset:0 sc1
    v_mfma_f32_16x16x32_bf16 v[124:127], a[44:47], v[76:79], v[124:127]
    v_mfma_f32_16x16x32_bf16 v[128:131], a[124:127], v[76:79], v[128:131]
    v_mfma_f32_16x16x32_bf16 v[132:135], a[44:47], v[80:83], v[132:135]
    v_mfma_f32_16x16x32_bf16 v[136:139], a[124:127], v[80:83], v[136:139]
    ds_read_b128 v[40:43], v2 offset:1024
    s_waitcnt vmcnt(11) lgkmcnt(1)
    v_mfma_f32_16x16x32_bf16 v[100:103], a[48:51], v[84:87], v[100:103]
    ds_read_b128 v[44:47], v2 offset:2048
    ds_read_b128 v[48:51], v2 offset:3072
    v_mfma_f32_16x16x32_bf16 v[104:107], a[128:131], v[84:87], v[104:107]
    ds_read_b128 v[52:55], v2 offset:4096
    ds_read_b128 v[56:59], v2 offset:5120
    v_mfma_f32_16x16x32_bf16 v[108:111], a[48:51], v[88:91], v[108:111]
    buffer_load_dwordx4 a[144:147], v4, s[4:7], s32 offen offset:0 sc1
    v_mfma_f32_16x16x32_bf16 v[112:115], a[128:131], v[88:91], v[112:115]
    buffer_load_dwordx4 a[68:71], v1, s[4:7], s32 offen offset:1024 sc1
    v_mfma_f32_16x16x32_bf16 v[116:119], a[48:51], v[92:95], v[116:119]
    v_mfma_f32_16x16x32_bf16 v[120:123], a[128:131], v[92:95], v[120:123]
    v_mfma_f32_16x16x32_bf16 v[124:127], a[48:51], v[96:99], v[124:127]
    v_mfma_f32_16x16x32_bf16 v[128:131], a[128:131], v[96:99], v[128:131]
    buffer_load_dwordx4 a[148:151], v4, s[4:7], s32 offen offset:1024 sc1
    v_mfma_f32_16x16x32_bf16 v[132:135], a[48:51], v[36:39], v[132:135]
    v_mfma_f32_16x16x32_bf16 v[136:139], a[128:131], v[36:39], v[136:139]
    ds_read_b128 v[60:63], v2 offset:6144
    s_waitcnt vmcnt(12) lgkmcnt(1)
    v_mfma_f32_16x16x32_bf16 v[100:103], a[52:55], v[40:43], v[100:103]
    ds_read_b128 v[64:67], v2 offset:7168
    ds_read_b128 v[68:71], v2 offset:8192
    v_mfma_f32_16x16x32_bf16 v[104:107], a[132:135], v[40:43], v[104:107]
    ds_read_b128 v[72:75], v2 offset:9216
    ds_read_b128 v[76:79], v2 offset:10240
    v_mfma_f32_16x16x32_bf16 v[108:111], a[52:55], v[44:47], v[108:111]
    buffer_load_dwordx4 a[72:75], v1, s[4:7], s32 offen offset:2048 sc1
    v_mfma_f32_16x16x32_bf16 v[112:115], a[132:135], v[44:47], v[112:115]
    v_mfma_f32_16x16x32_bf16 v[116:119], a[52:55], v[48:51], v[116:119]
    v_mfma_f32_16x16x32_bf16 v[120:123], a[132:135], v[48:51], v[120:123]
    buffer_load_dwordx4 a[152:155], v4, s[4:7], s32 offen offset:2048 sc1
    v_mfma_f32_16x16x32_bf16 v[124:127], a[52:55], v[52:55], v[124:127]
    v_mfma_f32_16x16x32_bf16 v[128:131], a[132:135], v[52:55], v[128:131]
    v_mfma_f32_16x16x32_bf16 v[132:135], a[52:55], v[56:59], v[132:135]
    buffer_load_dwordx4 a[76:79], v1, s[4:7], s32 offen offset:3072 sc1
    v_mfma_f32_16x16x32_bf16 v[136:139], a[132:135], v[56:59], v[136:139]
    ds_read_b128 v[80:83], v2 offset:11264
    s_waitcnt vmcnt(9) lgkmcnt(1)
    v_mfma_f32_16x16x32_bf16 v[100:103], a[56:59], v[60:63], v[100:103]
    ds_read_b128 v[84:87], v2 offset:12288
    ds_read_b128 v[88:91], v2 offset:13312
    v_mfma_f32_16x16x32_bf16 v[104:107], a[136:139], v[60:63], v[104:107]
    ds_read_b128 v[92:95], v2 offset:14336
    ds_read_b128 v[96:99], v2 offset:15360
    v_mfma_f32_16x16x32_bf16 v[108:111], a[56:59], v[64:67], v[108:111]
    buffer_load_dwordx4 a[156:159], v4, s[4:7], s32 offen offset:3072 sc1
    v_mfma_f32_16x16x32_bf16 v[112:115], a[136:139], v[64:67], v[112:115]
    v_mfma_f32_16x16x32_bf16 v[116:119], a[56:59], v[68:71], v[116:119]
    v_mfma_f32_16x16x32_bf16 v[120:123], a[136:139], v[68:71], v[120:123]
    v_mfma_f32_16x16x32_bf16 v[124:127], a[56:59], v[72:75], v[124:127]
    s_add_u32 m0, s22, 114688
    s_add_u32 s31, s25, 114688
    buffer_load_dwordx4 v1, s[4:7], s31 offen offset:0 lds
    v_mfma_f32_16x16x32_bf16 v[128:131], a[136:139], v[72:75], v[128:131]
    v_mfma_f32_16x16x32_bf16 v[132:135], a[56:59], v[76:79], v[132:135]
    v_mfma_f32_16x16x32_bf16 v[136:139], a[136:139], v[76:79], v[136:139]
    ds_read_b128 v[36:39], v2 offset:16384
    s_waitcnt vmcnt(9) lgkmcnt(1)
    v_mfma_f32_16x16x32_bf16 v[100:103], a[60:63], v[80:83], v[100:103]
    ds_read_b128 v[40:43], v2 offset:17408
    ds_read_b128 v[44:47], v2 offset:18432
    v_mfma_f32_16x16x32_bf16 v[104:107], a[140:143], v[80:83], v[104:107]
    ds_read_b128 v[48:51], v2 offset:19456
    ds_read_b128 v[52:55], v2 offset:20480
    v_mfma_f32_16x16x32_bf16 v[108:111], a[60:63], v[84:87], v[108:111]
    buffer_load_dwordx4 v1, s[4:7], s31 offen offset:1024 lds
    v_mfma_f32_16x16x32_bf16 v[112:115], a[140:143], v[84:87], v[112:115]
    v_mfma_f32_16x16x32_bf16 v[116:119], a[60:63], v[88:91], v[116:119]
    buffer_load_dwordx4 v1, s[4:7], s31 offen offset:2048 lds
    v_mfma_f32_16x16x32_bf16 v[120:123], a[140:143], v[88:91], v[120:123]
    v_mfma_f32_16x16x32_bf16 v[124:127], a[60:63], v[92:95], v[124:127]
    v_mfma_f32_16x16x32_bf16 v[128:131], a[140:143], v[92:95], v[128:131]
    buffer_load_dwordx4 v1, s[4:7], s31 offen offset:3072 lds
    v_mfma_f32_16x16x32_bf16 v[132:135], a[60:63], v[96:99], v[132:135]
    v_mfma_f32_16x16x32_bf16 v[136:139], a[140:143], v[96:99], v[136:139]
    ds_read_b128 v[56:59], v2 offset:21504
    s_waitcnt vmcnt(10) lgkmcnt(1)
    v_mfma_f32_16x16x32_bf16 v[100:103], a[64:67], v[36:39], v[100:103]
    ds_read_b128 v[60:63], v2 offset:22528
    ds_read_b128 v[64:67], v2 offset:23552
    v_mfma_f32_16x16x32_bf16 v[104:107], a[144:147], v[36:39], v[104:107]
    ds_read_b128 v[68:71], v2 offset:24576
    ds_read_b128 v[72:75], v2 offset:25600
    v_mfma_f32_16x16x32_bf16 v[108:111], a[64:67], v[40:43], v[108:111]
    s_add_u32 m0, s22, 131072
    s_add_u32 s31, s25, 131072
    buffer_load_dwordx4 v1, s[4:7], s31 offen offset:0 lds
    v_mfma_f32_16x16x32_bf16 v[112:115], a[144:147], v[40:43], v[112:115]
    v_mfma_f32_16x16x32_bf16 v[116:119], a[64:67], v[44:47], v[116:119]
    v_mfma_f32_16x16x32_bf16 v[120:123], a[144:147], v[44:47], v[120:123]
    buffer_load_dwordx4 v1, s[4:7], s31 offen offset:1024 lds
    v_mfma_f32_16x16x32_bf16 v[124:127], a[64:67], v[48:51], v[124:127]
    v_mfma_f32_16x16x32_bf16 v[128:131], a[144:147], v[48:51], v[128:131]
    v_mfma_f32_16x16x32_bf16 v[132:135], a[64:67], v[52:55], v[132:135]
    v_mfma_f32_16x16x32_bf16 v[136:139], a[144:147], v[52:55], v[136:139]
    ds_read_b128 v[76:79], v2 offset:26624
    s_waitcnt vmcnt(10) lgkmcnt(1)
    v_mfma_f32_16x16x32_bf16 v[100:103], a[68:71], v[56:59], v[100:103]
    ds_read_b128 v[80:83], v2 offset:27648
    ds_read_b128 v[84:87], v2 offset:28672
    v_mfma_f32_16x16x32_bf16 v[104:107], a[148:151], v[56:59], v[104:107]
    ds_read_b128 v[88:91], v2 offset:29696
    ds_read_b128 v[92:95], v2 offset:30720
    v_mfma_f32_16x16x32_bf16 v[108:111], a[68:71], v[60:63], v[108:111]
    buffer_load_dwordx4 v1, s[4:7], s31 offen offset:2048 lds
    v_mfma_f32_16x16x32_bf16 v[112:115], a[148:151], v[60:63], v[112:115]
    buffer_load_dwordx4 v1, s[4:7], s31 offen offset:3072 lds
    v_mfma_f32_16x16x32_bf16 v[116:119], a[68:71], v[64:67], v[116:119]
    v_mfma_f32_16x16x32_bf16 v[120:123], a[148:151], v[64:67], v[120:123]
    v_mfma_f32_16x16x32_bf16 v[124:127], a[68:71], v[68:71], v[124:127]
    v_mfma_f32_16x16x32_bf16 v[128:131], a[148:151], v[68:71], v[128:131]
    v_mfma_f32_16x16x32_bf16 v[132:135], a[68:71], v[72:75], v[132:135]
    v_mfma_f32_16x16x32_bf16 v[136:139], a[148:151], v[72:75], v[136:139]
    ds_read_b128 v[96:99], v2 offset:31744
    s_waitcnt vmcnt(10) lgkmcnt(1)
    v_mfma_f32_16x16x32_bf16 v[100:103], a[72:75], v[76:79], v[100:103]
    s_barrier
    ds_read_b128 v[36:39], v2 offset:32768
    v_mfma_f32_16x16x32_bf16 v[104:107], a[152:155], v[76:79], v[104:107]
    ds_read_b128 v[40:43], v2 offset:33792
    ds_read_b128 v[44:47], v2 offset:34816
    v_mfma_f32_16x16x32_bf16 v[108:111], a[72:75], v[80:83], v[108:111]
    ds_read_b128 v[48:51], v2 offset:35840
    v_mfma_f32_16x16x32_bf16 v[112:115], a[152:155], v[80:83], v[112:115]
    v_mfma_f32_16x16x32_bf16 v[116:119], a[72:75], v[84:87], v[116:119]
    v_mfma_f32_16x16x32_bf16 v[120:123], a[152:155], v[84:87], v[120:123]
    v_mfma_f32_16x16x32_bf16 v[124:127], a[72:75], v[88:91], v[124:127]
    v_mfma_f32_16x16x32_bf16 v[128:131], a[152:155], v[88:91], v[128:131]
    v_mfma_f32_16x16x32_bf16 v[132:135], a[72:75], v[92:95], v[132:135]
    v_mfma_f32_16x16x32_bf16 v[136:139], a[152:155], v[92:95], v[136:139]
    s_waitcnt vmcnt(8) lgkmcnt(0)
    v_mfma_f32_16x16x32_bf16 v[100:103], a[76:79], v[96:99], v[100:103]
    v_mfma_f32_16x16x32_bf16 v[104:107], a[156:159], v[96:99], v[104:107]
    v_mfma_f32_16x16x32_bf16 v[108:111], a[76:79], v[36:39], v[108:111]
    v_mfma_f32_16x16x32_bf16 v[112:115], a[156:159], v[36:39], v[112:115]
    v_mfma_f32_16x16x32_bf16 v[116:119], a[76:79], v[40:43], v[116:119]
    v_mfma_f32_16x16x32_bf16 v[120:123], a[156:159], v[40:43], v[120:123]
    v_mfma_f32_16x16x32_bf16 v[124:127], a[76:79], v[44:47], v[124:127]
    v_mfma_f32_16x16x32_bf16 v[128:131], a[156:159], v[44:47], v[128:131]
    v_mfma_f32_16x16x32_bf16 v[132:135], a[76:79], v[48:51], v[132:135]
    v_mfma_f32_16x16x32_bf16 v[136:139], a[156:159], v[48:51], v[136:139]
Lk1_nocsF:
    s_waitcnt lgkmcnt(0)
    ds_read_b32 v140, v5 offset:16384
    ds_read_b32 v141, v5 offset:16448
    ds_read_b32 v142, v5 offset:16512
    ds_read_b32 v143, v5 offset:16576
    ds_read_b32 v144, v5 offset:16640
    s_mul_i32 s62, s21, 1048576
    s_lshl_b32 s63, s18, 16
    s_add_u32 s62, s62, s63
    s_add_u32 s62, s62, 1048576
    s_add_u32 s62, s62, s23
    s_lshl_b32 s63, s17, 12
    s_add_u32 s63, s63, s62
    v_add_u32 v254, s23, v2
    v_add_u32 v255, s22, v2
    ds_read_b128 v[52:55], v2 offset:36864
    ds_read_b128 v[56:59], v2 offset:37888
    ds_read_b128 v[60:63], v2 offset:38912
    s_waitcnt lgkmcnt(3)
    v_fmac_f32 v100, v226, v140
    s_add_u32 m0, s22, 0
    s_add_u32 s31, s25, 147456
    buffer_load_dwordx4 v1, s[4:7], s31 offen offset:0 lds
    s_waitcnt lgkmcnt(0)
    v_mfma_f32_16x16x32_bf16 v[188:191], v[52:55], a[0:3], 0
    ds_read_b128 v[64:67], v2 offset:39936
    ds_read_b128 v[68:71], v2 offset:40960
    v_fmac_f32 v101, v227, v140
    v_fmac_f32 v102, v228, v140
    v_fmac_f32 v103, v229, v140
    buffer_load_dwordx4 v1, s[4:7], s31 offen offset:1024 lds
    v_mfma_f32_16x16x32_bf16 v[192:195], v[52:55], a[80:83], 0
    ds_read_b128 v[72:75], v2 offset:41984
    ds_read_b128 v[76:79], v2 offset:43008
    v_mul_f32 v180, v100, v242
    v_mul_f32 v181, v101, v243
    v_mul_f32 v182, v102, v244
    v_mfma_f32_16x16x32_bf16 v[196:199], v[56:59], a[0:3], 0
    ds_read_b128 v[80:83], v2 offset:44032
    ds_read_b128 v[84:87], v2 offset:45056
    v_mul_f32 v183, v103, v245
    v_exp_f32 v180, v180 clamp
    buffer_load_dwordx4 v1, s[4:7], s31 offen offset:2048 lds
    v_mfma_f32_16x16x32_bf16 v[200:203], v[56:59], a[80:83], 0
    v_exp_f32 v181, v181 clamp
    v_exp_f32 v182, v182 clamp
    v_mfma_f32_16x16x32_bf16 v[204:207], v[60:63], a[0:3], 0
    v_exp_f32 v183, v183 clamp
    v_max_f32 v100, 0, v100
    v_max_f32 v101, 0, v101
    v_max_f32 v102, 0, v102
    v_mfma_f32_16x16x32_bf16 v[208:211], v[60:63], a[80:83], 0
    v_max_f32 v103, 0, v103
    v_add_f32 v180, 0x358637bd, v180
    v_add_f32 v181, 0x358637bd, v181
    v_add_f32 v182, 0x358637bd, v182
    s_waitcnt lgkmcnt(3)
    v_mfma_f32_16x16x32_bf16 v[188:191], v[64:67], a[4:7], v[188:191]
    v_add_f32 v183, 0x358637bd, v183
    v_fma_f32 v100, v100, v230, v180
    v_fma_f32 v101, v101, v231, v181
    v_fma_f32 v102, v102, v232, v182
    v_fma_f32 v103, v103, v233, v183
    buffer_load_dwordx4 v1, s[4:7], s31 offen offset:3072 lds
    v_mfma_f32_16x16x32_bf16 v[192:195], v[64:67], a[84:87], v[192:195]
    ds_read_b128 v[88:91], v2 offset:46080
    ds_read_b128 v[92:95], v2 offset:47104
    v_fmac_f32 v104, v234, v140
    v_fmac_f32 v105, v235, v140
    v_fmac_f32 v106, v236, v140
    v_mfma_f32_16x16x32_bf16 v[196:199], v[68:71], a[4:7], v[196:199]
    ds_read_b128 v[96:99], v2 offset:48128
    v_fmac_f32 v107, v237, v140
    v_mul_f32 v184, v104, v246
    v_mul_f32 v185, v105, v247
    v_mul_f32 v186, v106, v248
    v_mfma_f32_16x16x32_bf16 v[200:203], v[68:71], a[84:87], v[200:203]
    v_mul_f32 v187, v107, v249
    v_exp_f32 v184, v184 clamp
    v_exp_f32 v185, v185 clamp
    s_add_u32 m0, s22, 16384
    s_add_u32 s31, s26, 0
    buffer_load_dwordx4 v1, s[4:7], s31 offen offset:0 lds
    v_mfma_f32_16x16x32_bf16 v[204:207], v[72:75], a[4:7], v[204:207]
    v_exp_f32 v186, v186 clamp
    v_exp_f32 v187, v187 clamp
    v_max_f32 v104, 0, v104
    v_mfma_f32_16x16x32_bf16 v[208:211], v[72:75], a[84:87], v[208:211]
    v_max_f32 v105, 0, v105
    v_max_f32 v106, 0, v106
    v_max_f32 v107, 0, v107
    v_add_f32 v184, 0x358637bd, v184
    s_waitcnt lgkmcnt(3)
    v_mfma_f32_16x16x32_bf16 v[188:191], v[76:79], a[8:11], v[188:191]
    v_add_f32 v185, 0x358637bd, v185
    v_add_f32 v186, 0x358637bd, v186
    v_add_f32 v187, 0x358637bd, v187
    v_fma_f32 v104, v104, v238, v184
    v_fma_f32 v105, v105, v239, v185
    v_mfma_f32_16x16x32_bf16 v[192:195], v[76:79], a[88:91], v[192:195]
    s_waitcnt vmcnt(5)
    s_barrier
    ds_read_b128 v[36:39], v2 offset:49152
    v_fma_f32 v106, v106, v240, v186
    v_fma_f32 v107, v107, v241, v187
    buffer_load_dwordx4 v1, s[4:7], s31 offen offset:1024 lds
    v_mfma_f32_16x16x32_bf16 v[196:199], v[80:83], a[8:11], v[196:199]
    ds_read_b128 v[40:43], v2 offset:50176
    ds_read_b128 v[44:47], v2 offset:51200
    v_fmac_f32 v108, v226, v141
    v_fmac_f32 v109, v227, v141
    v_fmac_f32 v110, v228, v141
    v_mfma_f32_16x16x32_bf16 v[200:203], v[80:83], a[88:91], v[200:203]
    v_fmac_f32 v111, v229, v141
    v_mul_f32 v180, v108, v242
    v_mul_f32 v181, v109, v243
    v_mul_f32 v182, v110, v244
    v_mul_f32 v183, v111, v245
    v_mfma_f32_16x16x32_bf16 v[204:207], v[84:87], a[8:11], v[204:207]
    v_exp_f32 v180, v180 clamp
    v_exp_f32 v181, v181 clamp
    buffer_load_dwordx4 v1, s[4:7], s31 offen offset:2048 lds
    v_mfma_f32_16x16x32_bf16 v[208:211], v[84:87], a[88:91], v[208:211]
    v_exp_f32 v182, v182 clamp
    v_exp_f32 v183, v183 clamp
    s_waitcnt lgkmcnt(3)
    v_mfma_f32_16x16x32_bf16 v[188:191], v[88:91], a[12:15], v[188:191]
    v_max_f32 v108, 0, v108
    v_max_f32 v109, 0, v109
    v_max_f32 v110, 0, v110
    v_max_f32 v111, 0, v111
    v_add_f32 v180, 0x358637bd, v180
    v_mfma_f32_16x16x32_bf16 v[192:195], v[88:91], a[92:95], v[192:195]
    ds_read_b128 v[48:51], v2 offset:52224
    ds_read_b128 v[52:55], v2 offset:53248
    v_add_f32 v181, 0x358637bd, v181
    v_add_f32 v182, 0x358637bd, v182
    v_add_f32 v183, 0x358637bd, v183
    v_mfma_f32_16x16x32_bf16 v[196:199], v[92:95], a[12:15], v[196:199]
    ds_read_b128 v[56:59], v2 offset:54272
    v_fma_f32 v108, v108, v230, v180
    v_fma_f32 v109, v109, v231, v181
    v_fma_f32 v110, v110, v232, v182
    v_fma_f32 v111, v111, v233, v183
    buffer_load_dwordx4 v1, s[4:7], s31 offen offset:3072 lds
    v_mfma_f32_16x16x32_bf16 v[200:203], v[92:95], a[92:95], v[200:203]
    v_fmac_f32 v112, v234, v141
    v_fmac_f32 v113, v235, v141
    v_fmac_f32 v114, v236, v141
    v_fmac_f32 v115, v237, v141
    v_mul_f32 v184, v112, v246
    v_mfma_f32_16x16x32_bf16 v[204:207], v[96:99], a[12:15], v[204:207]
    v_mul_f32 v185, v113, v247
    v_mul_f32 v186, v114, v248
    v_mul_f32 v187, v115, v249
    v_exp_f32 v184, v184 clamp
    v_mfma_f32_16x16x32_bf16 v[208:211], v[96:99], a[92:95], v[208:211]
    v_exp_f32 v185, v185 clamp
    v_exp_f32 v186, v186 clamp
    s_add_u32 m0, s22, 32768
    s_add_u32 s31, s26, 16384
    buffer_load_dwordx4 v1, s[4:7], s31 offen offset:0 lds
    s_waitcnt lgkmcnt(3)
    v_mfma_f32_16x16x32_bf16 v[188:191], v[36:39], a[16:19], v[188:191]
    v_exp_f32 v187, v187 clamp
    v_max_f32 v112, 0, v112
    v_max_f32 v113, 0, v113
    v_max_f32 v114, 0, v114
    v_mfma_f32_16x16x32_bf16 v[192:195], v[36:39], a[96:99], v[192:195]
    ds_read_b128 v[60:63], v2 offset:55296
    ds_read_b128 v[64:67], v2 offset:56320
    v_max_f32 v115, 0, v115
    v_add_f32 v184, 0x358637bd, v184
    v_add_f32 v185, 0x358637bd, v185
    v_mfma_f32_16x16x32_bf16 v[196:199], v[40:43], a[16:19], v[196:199]
    ds_read_b128 v[68:71], v2 offset:57344
    v_add_f32 v186, 0x358637bd, v186
    v_add_f32 v187, 0x358637bd, v187
    v_fma_f32 v112, v112, v238, v184
    v_fma_f32 v113, v113, v239, v185
    v_mfma_f32_16x16x32_bf16 v[200:203], v[40:43], a[96:99], v[200:203]
    v_fma_f32 v114, v114, v240, v186
    v_fma_f32 v115, v115, v241, v187
    v_fmac_f32 v132, v226, v144
    v_fmac_f32 v133, v227, v144
    v_fmac_f32 v134, v228, v144
    buffer_load_dwordx4 v1, s[4:7], s31 offen offset:1024 lds
    v_mfma_f32_16x16x32_bf16 v[204:207], v[44:47], a[16:19], v[204:207]
    v_fmac_f32 v135, v229, v144
    v_mul_f32 v172, v132, v230
    v_mul_f32 v173, v133, v231
    v_mul_f32 v174, v134, v232
    v_mul_f32 v175, v135, v233
    v_mfma_f32_16x16x32_bf16 v[208:211], v[44:47], a[96:99], v[208:211]
    v_mul_f32 v180, v132, v242
    v_mul_f32 v181, v133, v243
    v_mul_f32 v182, v134, v244
    v_mul_f32 v183, v135, v245
    s_waitcnt lgkmcnt(3)
    v_mfma_f32_16x16x32_bf16 v[188:191], v[48:51], a[20:23], v[188:191]
    v_exp_f32 v180, v180 clamp
    v_exp_f32 v181, v181 clamp
    buffer_load_dwordx4 v1, s[4:7], s31 offen offset:2048 lds
    v_mfma_f32_16x16x32_bf16 v[192:195], v[48:51], a[100:103], v[192:195]
    ds_read_b128 v[72:75], v2 offset:58368
    ds_read_b128 v[76:79], v2 offset:59392
    v_exp_f32 v182, v182 clamp
    v_mfma_f32_16x16x32_bf16 v[196:199], v[52:55], a[20:23], v[196:199]
    ds_read_b128 v[80:83], v2 offset:60416
    v_exp_f32 v183, v183 clamp
    v_max_f32 v132, 0, v132
    v_max_f32 v133, 0, v133
    v_mfma_f32_16x16x32_bf16 v[200:203], v[52:55], a[100:103], v[200:203]
    v_max_f32 v134, 0, v134
    v_max_f32 v135, 0, v135
    v_add_f32 v180, 0x358637bd, v180
    v_add_f32 v181, 0x358637bd, v181
    v_add_f32 v182, 0x358637bd, v182
    v_mfma_f32_16x16x32_bf16 v[204:207], v[56:59], a[20:23], v[204:207]
    v_add_f32 v183, 0x358637bd, v183
    v_fma_f32 v132, v132, v230, v180
    v_fma_f32 v133, v133, v231, v181
    v_fma_f32 v134, v134, v232, v182
    v_fma_f32 v135, v135, v233, v183
    buffer_load_dwordx4 v1, s[4:7], s31 offen offset:3072 lds
    v_mfma_f32_16x16x32_bf16 v[208:211], v[56:59], a[100:103], v[208:211]
    v_fmac_f32 v136, v234, v144
    v_fmac_f32 v137, v235, v144
    v_fmac_f32 v138, v236, v144
    v_fmac_f32 v139, v237, v144
    s_waitcnt lgkmcnt(3)
    v_mfma_f32_16x16x32_bf16 v[188:191], v[60:63], a[24:27], v[188:191]
    v_mul_f32 v176, v136, v238
    v_mul_f32 v177, v137, v239
    v_mul_f32 v178, v138, v240
    v_mul_f32 v179, v139, v241
    v_mul_f32 v184, v136, v246
    v_mfma_f32_16x16x32_bf16 v[192:195], v[60:63], a[104:107], v[192:195]
    ds_read_b128 v[84:87], v2 offset:61440
    ds_read_b128 v[88:91], v2 offset:62464
    v_mul_f32 v185, v137, v247
    v_mul_f32 v186, v138, v248
    v_mul_f32 v187, v139, v249
    s_add_u32 m0, s22, 49152
    s_add_u32 s31, s26, 32768
    buffer_load_dwordx4 v1, s[4:7], s31 offen offset:0 lds
    v_mfma_f32_16x16x32_bf16 v[196:199], v[64:67], a[24:27], v[196:199]
    ds_read_b128 v[92:95], v2 offset:63488
    v_exp_f32 v184, v184 clamp
    v_exp_f32 v185, v185 clamp
    v_mfma_f32_16x16x32_bf16 v[200:203], v[64:67], a[104:107], v[200:203]
    v_exp_f32 v186, v186 clamp
    v_exp_f32 v187, v187 clamp
    v_max_f32 v136, 0, v136
    v_mfma_f32_16x16x32_bf16 v[204:207], v[68:71], a[24:27], v[204:207]
    v_max_f32 v137, 0, v137
    v_max_f32 v138, 0, v138
    v_max_f32 v139, 0, v139
    v_add_f32 v184, 0x358637bd, v184
    v_add_f32 v185, 0x358637bd, v185
    v_mfma_f32_16x16x32_bf16 v[208:211], v[68:71], a[104:107], v[208:211]
    v_add_f32 v186, 0x358637bd, v186
    v_add_f32 v187, 0x358637bd, v187
    v_fma_f32 v136, v136, v238, v184
    v_fma_f32 v137, v137, v239, v185
    s_mul_i32 s88, 0, 2621440
    s_add_u32 s88, s88, s3
    buffer_load_dword a255, v14, s[4:7], s88 offen offset:0
    s_waitcnt lgkmcnt(3)
    v_mfma_f32_16x16x32_bf16 v[188:191], v[72:75], a[28:31], v[188:191]
    v_fma_f32 v138, v138, v240, v186
    v_fma_f32 v139, v139, v241, v187
    v_fmac_f32 v116, v226, v142
    v_fmac_f32 v117, v227, v142
    v_fmac_f32 v118, v228, v142
    v_mfma_f32_16x16x32_bf16 v[192:195], v[72:75], a[108:111], v[192:195]
    ds_read_b128 v[96:99], v2 offset:64512
    ds_read_b128 v[36:39], v3 offset:0
    v_fmac_f32 v119, v229, v142
    v_mul_f32 v116, v116, v230
    v_mul_f32 v117, v117, v231
    v_mfma_f32_16x16x32_bf16 v[196:199], v[76:79], a[28:31], v[196:199]
    ds_read_b128 v[40:43], v3 offset:1024
    v_mul_f32 v118, v118, v232
    v_mul_f32 v119, v119, v233
    v_fmac_f32 v120, v234, v142
    v_fmac_f32 v121, v235, v142
    s_add_u32 s88, s88, 20480
    buffer_load_dword a255, v14, s[4:7], s88 offen offset:0
    v_mfma_f32_16x16x32_bf16 v[200:203], v[76:79], a[108:111], v[200:203]
    v_fmac_f32 v122, v236, v142
    v_fmac_f32 v123, v237, v142
    v_mul_f32 v120, v120, v238
    v_mul_f32 v121, v121, v239
    v_mul_f32 v122, v122, v240
    v_mfma_f32_16x16x32_bf16 v[204:207], v[80:83], a[28:31], v[204:207]
    v_mul_f32 v123, v123, v241
    v_fmac_f32 v124, v226, v143
    v_fmac_f32 v125, v227, v143
    v_fmac_f32 v126, v228, v143
    v_fmac_f32 v127, v229, v143
    v_mfma_f32_16x16x32_bf16 v[208:211], v[80:83], a[108:111], v[208:211]
    v_mul_f32 v124, v124, v230
    v_mul_f32 v125, v125, v231
    v_mul_f32 v126, v126, v232
    v_mul_f32 v127, v127, v233
    s_waitcnt lgkmcnt(3)
    v_mfma_f32_16x16x32_bf16 v[188:191], v[84:87], a[32:35], v[188:191]
    v_fmac_f32 v128, v234, v143
    v_fmac_f32 v129, v235, v143
    v_fmac_f32 v130, v236, v143
    v_fmac_f32 v131, v237, v143
    v_mul_f32 v128, v128, v238
    s_lshl_b32 s89, s18, 10
    s_add_u32 s88, s88, s89
    buffer_load_dword a255, v1, s[4:7], s88 offen offset:0
    v_mfma_f32_16x16x32_bf16 v[192:195], v[84:87], a[112:115], v[192:195]
    ds_read_b128 v[44:47], v3 offset:2048
    ds_read_b128 v[48:51], v3 offset:3072
    v_mul_f32 v129, v129, v239
    v_mul_f32 v130, v130, v240
    v_mul_f32 v131, v131, v241
    v_mfma_f32_16x16x32_bf16 v[196:199], v[88:91], a[32:35], v[196:199]
    ds_read_b128 v[52:55], v3 offset:4096
    v_cndmask_b32 v172, v172, 1.0, s[68:69]
    v_cndmask_b32 v173, v173, 1.0, s[68:69]
    v_cndmask_b32 v174, v174, 1.0, s[68:69]
    v_cndmask_b32 v175, v175, 1.0, s[68:69]
    v_mfma_f32_16x16x32_bf16 v[200:203], v[88:91], a[112:115], v[200:203]
    v_cndmask_b32 v176, v176, 1.0, s[68:69]
    v_cndmask_b32 v177, v177, 1.0, s[68:69]
    v_cndmask_b32 v178, v178, 1.0, s[68:69]
    v_cndmask_b32 v179, v179, 1.0, s[68:69]
    v_cvt_pk_bf16_f32 v148, v100, v101
    s_sub_u32 s88, s88, 20480
    buffer_load_dword a255, v1, s[4:7], s88 offen offset:0
    v_mfma_f32_16x16x32_bf16 v[204:207], v[92:95], a[32:35], v[204:207]
    v_cvt_pk_bf16_f32 v149, v102, v103
    v_cvt_pk_bf16_f32 v150, v104, v105
    v_cvt_pk_bf16_f32 v151, v106, v107
    v_cvt_pk_bf16_f32 v152, v108, v109
    v_cvt_pk_bf16_f32 v153, v110, v111
    v_mfma_f32_16x16x32_bf16 v[208:211], v[92:95], a[112:115], v[208:211]
    v_cvt_pk_bf16_f32 v154, v112, v113
    v_cvt_pk_bf16_f32 v155, v114, v115
    v_cvt_pk_bf16_f32 v164, v132, v133
    v_cvt_pk_bf16_f32 v165, v134, v135
    s_waitcnt lgkmcnt(3)
    v_mfma_f32_16x16x32_bf16 v[188:191], v[96:99], a[36:39], v[188:191]
    v_cvt_pk_bf16_f32 v166, v136, v137
    v_cvt_pk_bf16_f32 v167, v138, v139
    v_cvt_pk_bf16_f32 v156, v116, v117
    v_cvt_pk_bf16_f32 v157, v118, v119
    v_cvt_pk_bf16_f32 v158, v120, v121
    v_mfma_f32_16x16x32_bf16 v[192:195], v[96:99], a[116:119], v[192:195]
    ds_read_b128 v[56:59], v3 offset:5120
    ds_read_b128 v[60:63], v3 offset:6144
    v_cvt_pk_bf16_f32 v159, v122, v123
    v_cvt_pk_bf16_f32 v160, v124, v125
    v_cvt_pk_bf16_f32 v161, v126, v127
    s_mov_b32 s88, 1
    s_mul_i32 s89, s88, 2621440
    s_add_u32 s89, s89, s65
    buffer_load_dword a255, v1, s[4:7], s89 offen offset:0
    v_mfma_f32_16x16x32_bf16 v[196:199], v[36:39], a[36:39], v[196:199]
    ds_read_b128 v[64:67], v3 offset:7168
    v_cvt_pk_bf16_f32 v162, v128, v129
    v_cvt_pk_bf16_f32 v163, v130, v131
    v_cvt_pk_bf16_f32 v168, v172, v173
    v_cvt_pk_bf16_f32 v169, v174, v175
    v_mfma_f32_16x16x32_bf16 v[200:203], v[36:39], a[116:119], v[200:203]
    v_cvt_pk_bf16_f32 v170, v176, v177
    v_cvt_pk_bf16_f32 v171, v178, v179
    v_mfma_f32_16x16x32_bf16 v[204:207], v[40:43], a[36:39], v[204:207]
    v_mfma_f32_16x16x32_bf16 v[100:103], v[148:151], v[156:159], 0
    v_mfma_f32_16x16x32_bf16 v[104:107], v[152:155], v[160:163], 0
    buffer_load_dword a255, v1, s[4:7], s89 offen offset:1024
    v_mfma_f32_16x16x32_bf16 v[208:211], v[40:43], a[116:119], v[208:211]
    v_mfma_f32_16x16x32_bf16 v[108:111], v[164:167], v[156:159], 0
    v_mfma_f32_16x16x32_bf16 v[112:115], v[164:167], v[160:163], 0
    s_waitcnt lgkmcnt(3)
    v_mfma_f32_16x16x32_bf16 v[188:191], v[44:47], a[40:43], v[188:191]
    v_mfma_f32_16x16x32_bf16 v[116:119], v[148:151], v[168:171], 0
    v_mfma_f32_16x16x32_bf16 v[120:123], v[152:155], v[168:171], 0
    v_mfma_f32_16x16x32_bf16 v[192:195], v[44:47], a[120:123], v[192:195]
    ds_read_b128 v[68:71], v3 offset:8192
    ds_read_b128 v[72:75], v3 offset:9216
    v_mfma_f32_16x16x32_bf16 v[124:127], v[164:167], v[168:171], 0
    v_mfma_f32_16x16x32_bf16 v[196:199], v[48:51], a[40:43], v[196:199]
    ds_read_b128 v[76:79], v3 offset:10240
    s_add_u32 s89, s89, s91
    buffer_load_dword a255, v1, s[4:7], s89 offen offset:0
    v_mfma_f32_16x16x32_bf16 v[200:203], v[48:51], a[120:123], v[200:203]
    ds_write_b128 v254, v[100:103] offset:16384
    ds_write_b128 v254, v[104:107] offset:20480
    v_cndmask_b32 v116, v116, v120, s[66:67]
    v_cndmask_b32 v117, v117, v121, s[66:67]
    v_cndmask_b32 v118, v118, v122, s[66:67]
    v_mfma_f32_16x16x32_bf16 v[204:207], v[52:55], a[40:43], v[204:207]
    v_cndmask_b32 v119, v119, v123, s[66:67]
    v_cndmask_b32 v108, v108, v112, s[50:51]
    v_cndmask_b32 v109, v109, v113, s[50:51]
    v_cndmask_b32 v110, v110, v114, s[50:51]
    v_cndmask_b32 v111, v111, v115, s[50:51]
    v_mfma_f32_16x16x32_bf16 v[208:211], v[52:55], a[120:123], v[208:211]
    ds_write_b128 v254, v[116:119] offset:24576
    v_permlane32_swap_b32 v108, v124
    v_permlane32_swap_b32 v109, v125
    v_permlane32_swap_b32 v110, v126
    s_mul_i32 s88, s88, 131072
    s_add_u32 s88, s88, s98
    buffer_load_dword a255, off, s[4:7], s88 offset:0
    s_waitcnt lgkmcnt(6)
    v_mfma_f32_16x16x32_bf16 v[188:191], v[56:59], a[44:47], v[188:191]
    v_permlane32_swap_b32 v111, v127
    v_mfma_f32_16x16x32_bf16 v[192:195], v[56:59], a[124:127], v[192:195]
    ds_read_b128 v[80:83], v3 offset:11264
    ds_read_b128 v[84:87], v3 offset:12288
    ds_write_b128 v254, v[108:111] offset:28672
    v_mfma_f32_16x16x32_bf16 v[196:199], v[60:63], a[44:47], v[196:199]
    ds_read_b128 v[88:91], v3 offset:13312
    v_mfma_f32_16x16x32_bf16 v[200:203], v[60:63], a[124:127], v[200:203]
    buffer_load_dwordx4 v1, s[4:7], s31 offen offset:1024 lds
    v_mfma_f32_16x16x32_bf16 v[204:207], v[64:67], a[44:47], v[204:207]
    s_waitcnt vmcnt(18) lgkmcnt(1)
    s_barrier
    ds_read_b128 v[100:103], v255 offset:16384
    ds_read_b128 v[104:107], v255 offset:17408
    ds_read_b128 v[108:111], v255 offset:18432
    ds_read_b128 v[112:115], v255 offset:19456
    v_mfma_f32_16x16x32_bf16 v[208:211], v[64:67], a[124:127], v[208:211]
    v_mfma_f32_16x16x32_bf16 v[188:191], v[68:71], a[48:51], v[188:191]
    buffer_load_dwordx4 v1, s[4:7], s31 offen offset:2048 lds
    v_mfma_f32_16x16x32_bf16 v[192:195], v[68:71], a[128:131], v[192:195]
    ds_read_b128 v[92:95], v3 offset:14336
    ds_read_b128 v[96:99], v3 offset:15360
    v_mfma_f32_16x16x32_bf16 v[196:199], v[72:75], a[48:51], v[196:199]
    v_lshrrev_b32 v254, 1, v1
    s_waitcnt lgkmcnt(4)
    v_add_f32 v100, v100, v104
    v_add_f32 v101, v101, v105
    v_add_f32 v102, v102, v106
    v_mfma_f32_16x16x32_bf16 v[200:203], v[72:75], a[128:131], v[200:203]
    v_add_f32 v103, v103, v107
    s_waitcnt lgkmcnt(2)
    v_add_f32 v108, v108, v112
    v_add_f32 v109, v109, v113
    v_add_f32 v110, v110, v114
    v_mfma_f32_16x16x32_bf16 v[204:207], v[76:79], a[48:51], v[204:207]
    v_add_f32 v111, v111, v115
    v_add_f32 v100, v100, v108
    v_add_f32 v101, v101, v109
    v_add_f32 v102, v102, v110
    buffer_load_dwordx4 v1, s[4:7], s31 offen offset:3072 lds
    v_mfma_f32_16x16x32_bf16 v[208:211], v[76:79], a[128:131], v[208:211]
    v_add_f32 v103, v103, v111
    v_cvt_pk_bf16_f32 v100, v100, v101
    v_cvt_pk_bf16_f32 v101, v102, v103
    v_mfma_f32_16x16x32_bf16 v[188:191], v[80:83], a[52:55], v[188:191]
    buffer_store_dwordx2 v[100:101], v254, s[4:7], s63 offen sc1
    ds_read_b128 v[36:39], v1 offset:0
    v_mfma_f32_16x16x32_bf16 v[192:195], v[80:83], a[132:135], v[192:195]
    ds_read_b128 v[40:43], v1 offset:1024
    ds_read_b128 v[44:47], v1 offset:2048
    s_add_u32 m0, s22, 65536
    s_add_u32 s31, s26, 49152
    buffer_load_dwordx4 v1, s[4:7], s31 offen offset:0 lds
    v_mfma_f32_16x16x32_bf16 v[196:199], v[84:87], a[52:55], v[196:199]
    ds_read_b128 v[48:51], v1 offset:3072
    ds_read_b128 v[140:143], v7 offset:16704
    v_mfma_f32_16x16x32_bf16 v[200:203], v[84:87], a[132:135], v[200:203]
    ds_read_b128 v[144:147], v7 offset:16768
    ds_read_b128 v[148:151], v7 offset:16832
    v_mfma_f32_16x16x32_bf16 v[204:207], v[88:91], a[52:55], v[204:207]
    v_mul_f32 v152, 0x3fb8aa3b, v221
    v_mul_f32 v153, 0x3fb8aa3b, v223
    v_mfma_f32_16x16x32_bf16 v[208:211], v[88:91], a[132:135], v[208:211]
    buffer_load_dwordx4 v1, s[4:7], s31 offen offset:1024 lds
    s_waitcnt lgkmcnt(6)
    v_mfma_f32_16x16x32_bf16 v[188:191], v[92:95], a[56:59], v[188:191]
    v_mfma_f32_16x16x32_bf16 v[192:195], v[92:95], a[136:139], v[192:195]
    ds_read_b128 v[52:55], v1 offset:4096
    ds_read_b128 v[56:59], v1 offset:5120
    v_mfma_f32_16x16x32_bf16 v[196:199], v[96:99], a[56:59], v[196:199]
    ds_read_b128 v[60:63], v1 offset:6144
    buffer_load_dwordx4 v1, s[4:7], s31 offen offset:2048 lds
    v_mfma_f32_16x16x32_bf16 v[200:203], v[96:99], a[136:139], v[200:203]
    v_mfma_f32_16x16x32_bf16 v[204:207], v[36:39], a[56:59], v[204:207]
    v_mfma_f32_16x16x32_bf16 v[208:211], v[36:39], a[136:139], v[208:211]
    s_waitcnt lgkmcnt(6)
    v_mfma_f32_16x16x32_bf16 v[188:191], v[40:43], a[60:63], v[188:191]
    buffer_load_dwordx4 v1, s[4:7], s31 offen offset:3072 lds
    v_mfma_f32_16x16x32_bf16 v[192:195], v[40:43], a[140:143], v[192:195]
    ds_read_b128 v[64:67], v1 offset:7168
    ds_read_b128 v[68:71], v1 offset:8192
    v_mfma_f32_16x16x32_bf16 v[196:199], v[44:47], a[60:63], v[196:199]
    ds_read_b128 v[72:75], v1 offset:9216
    v_mfma_f32_16x16x32_bf16 v[200:203], v[44:47], a[140:143], v[200:203]
    s_add_u32 m0, s22, 81920
    s_add_u32 s31, s26, 65536
    buffer_load_dwordx4 v1, s[4:7], s31 offen offset:0 lds
    v_mfma_f32_16x16x32_bf16 v[204:207], v[48:51], a[60:63], v[204:207]
    v_mfma_f32_16x16x32_bf16 v[208:211], v[48:51], a[140:143], v[208:211]
    s_waitcnt lgkmcnt(3)
    v_mfma_f32_16x16x32_bf16 v[188:191], v[52:55], a[64:67], v[188:191]
    v_mfma_f32_16x16x32_bf16 v[192:195], v[52:55], a[144:147], v[192:195]
    ds_read_b128 v[76:79], v1 offset:10240
    ds_read_b128 v[80:83], v1 offset:11264
    buffer_load_dwordx4 v1, s[4:7], s31 offen offset:1024 lds
    v_mfma_f32_16x16x32_bf16 v[196:199], v[56:59], a[64:67], v[196:199]
    ds_read_b128 v[84:87], v1 offset:12288
    v_mfma_f32_16x16x32_bf16 v[200:203], v[56:59], a[144:147], v[200:203]
    v_mfma_f32_16x16x32_bf16 v[204:207], v[60:63], a[64:67], v[204:207]
    buffer_load_dwordx4 v1, s[4:7], s31 offen offset:2048 lds
    v_mfma_f32_16x16x32_bf16 v[208:211], v[60:63], a[144:147], v[208:211]
    s_waitcnt lgkmcnt(3)
    v_mfma_f32_16x16x32_bf16 v[188:191], v[64:67], a[68:71], v[188:191]
    v_mfma_f32_16x16x32_bf16 v[192:195], v[64:67], a[148:151], v[192:195]
    ds_read_b128 v[88:91], v1 offset:13312
    ds_read_b128 v[92:95], v1 offset:14336
    v_mfma_f32_16x16x32_bf16 v[196:199], v[68:71], a[68:71], v[196:199]
    ds_read_b128 v[96:99], v1 offset:15360
    buffer_load_dwordx4 v1, s[4:7], s31 offen offset:3072 lds
    v_mfma_f32_16x16x32_bf16 v[200:203], v[68:71], a[148:151], v[200:203]
    v_mfma_f32_16x16x32_bf16 v[204:207], v[72:75], a[68:71], v[204:207]
    v_mfma_f32_16x16x32_bf16 v[208:211], v[72:75], a[148:151], v[208:211]
    s_waitcnt lgkmcnt(3)
    v_mfma_f32_16x16x32_bf16 v[188:191], v[76:79], a[72:75], v[188:191]
    v_mfma_f32_16x16x32_bf16 v[192:195], v[76:79], a[152:155], v[192:195]
    v_mfma_f32_16x16x32_bf16 v[196:199], v[80:83], a[72:75], v[196:199]
    v_mfma_f32_16x16x32_bf16 v[200:203], v[80:83], a[152:155], v[200:203]
    v_mfma_f32_16x16x32_bf16 v[204:207], v[84:87], a[72:75], v[204:207]
    v_mfma_f32_16x16x32_bf16 v[208:211], v[84:87], a[152:155], v[208:211]
    s_waitcnt lgkmcnt(0)
    v_mfma_f32_16x16x32_bf16 v[188:191], v[88:91], a[76:79], v[188:191]
    v_mfma_f32_16x16x32_bf16 v[192:195], v[88:91], a[156:159], v[192:195]
    v_mfma_f32_16x16x32_bf16 v[196:199], v[92:95], a[76:79], v[196:199]
    v_mfma_f32_16x16x32_bf16 v[200:203], v[92:95], a[156:159], v[200:203]
    v_mfma_f32_16x16x32_bf16 v[204:207], v[96:99], a[76:79], v[204:207]
    v_mfma_f32_16x16x32_bf16 v[208:211], v[96:99], a[156:159], v[208:211]
    v_and_b32 v254, 0x200, v1
    v_lshlrev_b32 v254, 3, v254
    v_and_b32 v255, 0x1f0, v1
    v_add_u32 v255, v255, v254
    s_add_u32 s63, s62, 0
    buffer_load_dwordx4 v[36:39], v255, s[4:7], s63 offen
    v_fmac_f32 v188, v220, v140
    v_fmac_f32 v189, v220, v141
    v_fmac_f32 v190, v220, v142
    v_fmac_f32 v191, v220, v143
    v_mul_f32 v180, v188, v152
    v_mul_f32 v181, v189, v152
    s_add_u32 s63, s62, 8192
    buffer_load_dwordx4 v[40:43], v255, s[4:7], s63 offen
    v_mul_f32 v182, v190, v152
    v_mul_f32 v183, v191, v152
    v_exp_f32 v180, v180 clamp
    v_exp_f32 v181, v181 clamp
    v_exp_f32 v182, v182 clamp
    v_exp_f32 v183, v183 clamp
    s_add_u32 s63, s62, 16384
    buffer_load_dwordx4 v[44:47], v255, s[4:7], s63 offen
    v_max_f32 v188, 0, v188
    v_max_f32 v189, 0, v189
    v_max_f32 v190, 0, v190
    v_max_f32 v191, 0, v191
    v_add_f32 v180, 0x358637bd, v180
    v_add_f32 v181, 0x358637bd, v181
    s_add_u32 s63, s62, 24576
    buffer_load_dwordx4 v[48:51], v255, s[4:7], s63 offen
    v_add_f32 v182, 0x358637bd, v182
    v_add_f32 v183, 0x358637bd, v183
    v_fma_f32 v188, v188, v221, v180
    v_fma_f32 v189, v189, v221, v181
    v_fma_f32 v190, v190, v221, v182
    v_fma_f32 v191, v191, v221, v183
    s_add_u32 s63, s62, 32768
    buffer_load_dwordx4 v[52:55], v255, s[4:7], s63 offen
    v_fmac_f32 v192, v222, v140
    v_fmac_f32 v193, v222, v141
    v_fmac_f32 v194, v222, v142
    v_fmac_f32 v195, v222, v143
    v_mul_f32 v184, v192, v153
    v_mul_f32 v185, v193, v153
    s_add_u32 s63, s62, 40960
    buffer_load_dwordx4 v[56:59], v255, s[4:7], s63 offen
    v_mul_f32 v186, v194, v153
    v_mul_f32 v187, v195, v153
    v_exp_f32 v184, v184 clamp
    v_exp_f32 v185, v185 clamp
    v_exp_f32 v186, v186 clamp
    v_exp_f32 v187, v187 clamp
    s_add_u32 s63, s62, 49152
    buffer_load_dwordx4 v[60:63], v255, s[4:7], s63 offen
    v_max_f32 v192, 0, v192
    v_max_f32 v193, 0, v193
    v_max_f32 v194, 0, v194
    v_max_f32 v195, 0, v195
    v_add_f32 v184, 0x358637bd, v184
    v_add_f32 v185, 0x358637bd, v185
    s_add_u32 s63, s62, 57344
    buffer_load_dwordx4 v[64:67], v255, s[4:7], s63 offen
    v_add_f32 v186, 0x358637bd, v186
    v_add_f32 v187, 0x358637bd, v187
    v_fma_f32 v192, v192, v223, v184
    v_fma_f32 v193, v193, v223, v185
    v_fma_f32 v194, v194, v223, v186
    v_fma_f32 v195, v195, v223, v187
    v_fmac_f32 v196, v220, v144
    v_fmac_f32 v197, v220, v145
    v_fmac_f32 v198, v220, v146
    v_fmac_f32 v199, v220, v147
    v_mul_f32 v180, v196, v152
    v_mul_f32 v181, v197, v152
    v_mul_f32 v182, v198, v152
    v_mul_f32 v183, v199, v152
    v_exp_f32 v180, v180 clamp
    v_exp_f32 v181, v181 clamp
    v_exp_f32 v182, v182 clamp
    v_exp_f32 v183, v183 clamp
    v_max_f32 v196, 0, v196
    v_max_f32 v197, 0, v197
    v_max_f32 v198, 0, v198
    v_max_f32 v199, 0, v199
    v_add_f32 v180, 0x358637bd, v180
    v_add_f32 v181, 0x358637bd, v181
    v_add_f32 v182, 0x358637bd, v182
    v_add_f32 v183, 0x358637bd, v183
    v_fma_f32 v196, v196, v221, v180
    v_fma_f32 v197, v197, v221, v181
    v_fma_f32 v198, v198, v221, v182
    v_fma_f32 v199, v199, v221, v183
    v_fmac_f32 v200, v222, v144
    v_fmac_f32 v201, v222, v145
    v_fmac_f32 v202, v222, v146
    v_fmac_f32 v203, v222, v147
    v_mul_f32 v184, v200, v153
    v_mul_f32 v185, v201, v153
    v_mul_f32 v186, v202, v153
    v_mul_f32 v187, v203, v153
    v_exp_f32 v184, v184 clamp
    v_exp_f32 v185, v185 clamp
    v_exp_f32 v186, v186 clamp
    v_exp_f32 v187, v187 clamp
    v_max_f32 v200, 0, v200
    v_max_f32 v201, 0, v201
    v_max_f32 v202, 0, v202
    v_max_f32 v203, 0, v203
    v_add_f32 v184, 0x358637bd, v184
    v_add_f32 v185, 0x358637bd, v185
    v_add_f32 v186, 0x358637bd, v186
    v_add_f32 v187, 0x358637bd, v187
    v_fma_f32 v200, v200, v223, v184
    v_fma_f32 v201, v201, v223, v185
    v_fma_f32 v202, v202, v223, v186
    v_fma_f32 v203, v203, v223, v187
    v_fmac_f32 v204, v220, v148
    v_fmac_f32 v205, v220, v149
    v_fmac_f32 v206, v220, v150
    v_fmac_f32 v207, v220, v151
    v_mul_f32 v180, v204, v152
    v_mul_f32 v181, v205, v152
    v_mul_f32 v182, v206, v152
    v_mul_f32 v183, v207, v152
    v_exp_f32 v180, v180 clamp
    v_exp_f32 v181, v181 clamp
    v_exp_f32 v182, v182 clamp
    v_exp_f32 v183, v183 clamp
    v_max_f32 v204, 0, v204
    v_max_f32 v205, 0, v205
    v_max_f32 v206, 0, v206
    v_max_f32 v207, 0, v207
    v_add_f32 v180, 0x358637bd, v180
    v_add_f32 v181, 0x358637bd, v181
    v_add_f32 v182, 0x358637bd, v182
    v_add_f32 v183, 0x358637bd, v183
    v_fma_f32 v204, v204, v221, v180
    v_fma_f32 v205, v205, v221, v181
    v_fma_f32 v206, v206, v221, v182
    v_fma_f32 v207, v207, v221, v183
    v_fmac_f32 v208, v222, v148
    v_fmac_f32 v209, v222, v149
    v_fmac_f32 v210, v222, v150
    v_fmac_f32 v211, v222, v151
    v_mul_f32 v184, v208, v153
    v_mul_f32 v185, v209, v153
    v_mul_f32 v186, v210, v153
    v_mul_f32 v187, v211, v153
    v_exp_f32 v184, v184 clamp
    v_exp_f32 v185, v185 clamp
    v_exp_f32 v186, v186 clamp
    v_exp_f32 v187, v187 clamp
    v_max_f32 v208, 0, v208
    v_max_f32 v209, 0, v209
    v_max_f32 v210, 0, v210
    v_max_f32 v211, 0, v211
    v_add_f32 v184, 0x358637bd, v184
    v_add_f32 v185, 0x358637bd, v185
    v_add_f32 v186, 0x358637bd, v186
    v_add_f32 v187, 0x358637bd, v187
    v_fma_f32 v208, v208, v223, v184
    v_fma_f32 v209, v209, v223, v185
    v_fma_f32 v210, v210, v223, v186
    v_fma_f32 v211, v211, v223, v187
    v_cvt_pk_bf16_f32 v156, v188, v189
    v_cvt_pk_bf16_f32 v157, v190, v191
    v_cvt_pk_bf16_f32 v158, v204, v205
    v_cvt_pk_bf16_f32 v159, v206, v207
    v_cvt_pk_bf16_f32 v160, v196, v197
    v_cvt_pk_bf16_f32 v161, v198, v199
    v_mov_b32 v162, v158
    v_mov_b32 v163, v159
    v_cvt_pk_bf16_f32 v164, v192, v193
    v_cvt_pk_bf16_f32 v165, v194, v195
    v_cvt_pk_bf16_f32 v166, v208, v209
    v_cvt_pk_bf16_f32 v167, v210, v211
    v_cvt_pk_bf16_f32 v168, v200, v201
    v_cvt_pk_bf16_f32 v169, v202, v203
    v_mov_b32 v170, v166
    v_mov_b32 v171, v167
    s_mov_b32 s47, 0
    s_mov_b32 s88, 0x3f80
    s_mov_b32 s89, 0x3f800000
    s_waitcnt vmcnt(7)
Lkv2_s:
    v_mov_b32 v68, 0
    v_mov_b32 v69, 0
    v_mov_b32 v70, 0
    v_mov_b32 v71, 0
    v_mov_b32 v72, 0
    v_mov_b32 v73, 0
    v_mov_b32 v74, 0
    v_mov_b32 v75, 0
    v_dot2c_f32_bf16 v68, s88, v36
    v_dot2c_f32_bf16 v69, s89, v36
    v_dot2c_f32_bf16 v70, s88, v37
    v_dot2c_f32_bf16 v71, s89, v37
    v_dot2c_f32_bf16 v72, s88, v38
    v_dot2c_f32_bf16 v73, s89, v38
    v_dot2c_f32_bf16 v74, s88, v39
    v_dot2c_f32_bf16 v75, s89, v39
    s_waitcnt vmcnt(6)
    v_dot2c_f32_bf16 v68, s88, v40
    v_dot2c_f32_bf16 v69, s89, v40
    v_dot2c_f32_bf16 v70, s88, v41
    v_dot2c_f32_bf16 v71, s89, v41
    v_dot2c_f32_bf16 v72, s88, v42
    v_dot2c_f32_bf16 v73, s89, v42
    v_dot2c_f32_bf16 v74, s88, v43
    v_dot2c_f32_bf16 v75, s89, v43
    s_waitcnt vmcnt(5)
    v_dot2c_f32_bf16 v68, s88, v44
    v_dot2c_f32_bf16 v69, s89, v44
    v_dot2c_f32_bf16 v70, s88, v45
    v_dot2c_f32_bf16 v71, s89, v45
    v_dot2c_f32_bf16 v72, s88, v46
    v_dot2c_f32_bf16 v73, s89, v46
    v_dot2c_f32_bf16 v74, s88, v47
    v_dot2c_f32_bf16 v75, s89, v47
    s_waitcnt vmcnt(4)
    v_dot2c_f32_bf16 v68, s88, v48
    v_dot2c_f32_bf16 v69, s89, v48
    v_dot2c_f32_bf16 v70, s88, v49
    v_dot2c_f32_bf16 v71, s89, v49
    v_dot2c_f32_bf16 v72, s88, v50
    v_dot2c_f32_bf16 v73, s89, v50
    v_dot2c_f32_bf16 v74, s88, v51
    v_dot2c_f32_bf16 v75, s89, v51
    s_waitcnt vmcnt(3)
    v_dot2c_f32_bf16 v68, s88, v52
    v_dot2c_f32_bf16 v69, s89, v52
    v_dot2c_f32_bf16 v70, s88, v53
    v_dot2c_f32_bf16 v71, s89, v53
    v_dot2c_f32_bf16 v72, s88, v54
    v_dot2c_f32_bf16 v73, s89, v54
    v_dot2c_f32_bf16 v74, s88, v55
    v_dot2c_f32_bf16 v75, s89, v55
    s_waitcnt vmcnt(2)
    v_dot2c_f32_bf16 v68, s88, v56
    v_dot2c_f32_bf16 v69, s89, v56
    v_dot2c_f32_bf16 v70, s88, v57
    v_dot2c_f32_bf16 v71, s89, v57
    v_dot2c_f32_bf16 v72, s88, v58
    v_dot2c_f32_bf16 v73, s89, v58
    v_dot2c_f32_bf16 v74, s88, v59
    v_dot2c_f32_bf16 v75, s89, v59
    s_waitcnt vmcnt(1)
    v_dot2c_f32_bf16 v68, s88, v60
    v_dot2c_f32_bf16 v69, s89, v60
    v_dot2c_f32_bf16 v70, s88, v61
    v_dot2c_f32_bf16 v71, s89, v61
    v_dot2c_f32_bf16 v72, s88, v62
    v_dot2c_f32_bf16 v73, s89, v62
    v_dot2c_f32_bf16 v74, s88, v63
    v_dot2c_f32_bf16 v75, s89, v63
    s_waitcnt vmcnt(0)
    v_dot2c_f32_bf16 v68, s88, v64
    v_dot2c_f32_bf16 v69, s89, v64
    v_dot2c_f32_bf16 v70, s88, v65
    v_dot2c_f32_bf16 v71, s89, v65
    v_dot2c_f32_bf16 v72, s88, v66
    v_dot2c_f32_bf16 v73, s89, v66
    v_dot2c_f32_bf16 v74, s88, v67
    v_dot2c_f32_bf16 v75, s89, v67
    v_cmp_u_f32 vcc, v68, v70
    s_nop 0
    v_cmp_u_f32 s[34:35], v72, v74
    s_nop 3
    s_or_b64 vcc, vcc, s[34:35]
    s_cbranch_vccz Lkv2_o
    s_add_u32 s47, s47, 1
    s_cmp_gt_u32 s47, 20000
    s_cbranch_scc1 Lkv2_o
    s_add_u32 s63, s62, 0
    buffer_load_dwordx4 v[36:39], v255, s[4:7], s63 offen sc1
    s_add_u32 s63, s62, 8192
    buffer_load_dwordx4 v[40:43], v255, s[4:7], s63 offen sc1
    s_add_u32 s63, s62, 16384
    buffer_load_dwordx4 v[44:47], v255, s[4:7], s63 offen sc1
    s_add_u32 s63, s62, 24576
    buffer_load_dwordx4 v[48:51], v255, s[4:7], s63 offen sc1
    s_add_u32 s63, s62, 32768
    buffer_load_dwordx4 v[52:55], v255, s[4:7], s63 offen sc1
    s_add_u32 s63, s62, 40960
    buffer_load_dwordx4 v[56:59], v255, s[4:7], s63 offen sc1
    s_add_u32 s63, s62, 49152
    buffer_load_dwordx4 v[60:63], v255, s[4:7], s63 offen sc1
    s_add_u32 s63, s62, 57344
    buffer_load_dwordx4 v[64:67], v255, s[4:7], s63 offen sc1
    s_waitcnt vmcnt(0)
    s_branch Lkv2_s
Lkv2_o:
    v_permlane32_swap_b32 v68, v72
    v_permlane32_swap_b32 v69, v73
    v_permlane32_swap_b32 v70, v74
    v_permlane32_swap_b32 v71, v75
    v_add_f32 v68, v68, v72
    v_add_f32 v69, v69, v73
    v_add_f32 v70, v70, v74
    v_add_f32 v71, v71, v75
    v_cvt_pk_bf16_f32 v36, v68, v69
    v_cvt_pk_bf16_f32 v37, v70, v71
    v_and_b32 v254, 0x1f0, v1
    v_lshrrev_b32 v255, 6, v1
    v_and_b32 v255, 8, v255
    v_add_u32 v254, v254, v255
    s_lshl_b32 s33, s16, 9
    s_add_u32 s33, s33, 0x20000
    v_add_u32 v254, s33, v254
    ds_write_b64 v254, v[36:37] offset:24576
    s_waitcnt lgkmcnt(0)
    s_barrier
    s_add_u32 m0, s22, 98304
    s_add_u32 s31, s26, 81920
    buffer_load_dwordx4 v1, s[4:7], s31 offen offset:0 lds
    buffer_load_dwordx4 v1, s[4:7], s31 offen offset:1024 lds
    buffer_load_dwordx4 v1, s[4:7], s31 offen offset:2048 lds
    buffer_load_dwordx4 v1, s[4:7], s31 offen offset:3072 lds
    s_add_u32 m0, s23, 114688
    s_add_u32 s31, s29, 98304
    buffer_load_dwordx4 v1, s[4:7], s31 offen offset:0 lds
    s_add_u32 m0, s22, 131072
    s_add_u32 s31, s27, 0
    buffer_load_dwordx4 v1, s[4:7], s31 offen offset:0 lds
    buffer_load_dwordx4 v1, s[4:7], s31 offen offset:1024 lds
    buffer_load_dwordx4 v1, s[4:7], s31 offen offset:2048 lds
    buffer_load_dwordx4 v1, s[4:7], s31 offen offset:3072 lds
    s_add_u32 m0, s22, 0
    s_add_u32 s31, s27, 16384
    buffer_load_dwordx4 v1, s[4:7], s31 offen offset:0 lds
    buffer_load_dwordx4 v1, s[4:7], s31 offen offset:1024 lds
    buffer_load_dwordx4 v1, s[4:7], s31 offen offset:2048 lds
    buffer_load_dwordx4 v1, s[4:7], s31 offen offset:3072 lds
    ds_read_b64 v[176:177], v11 offset:24576
    ds_read_b64 v[178:179], v11 offset:25088
    ds_read_b64 v[180:181], v11 offset:25600
    ds_read_b64 v[182:183], v11 offset:26112
    v_xor_b32 v254, 256, v11
    ds_read_b64 v[184:185], v254 offset:26112
    v_lshlrev_b32 v254, 3, v7
    v_and_b32 v254, 0x3ff, v254
    v_add_u32 v254, 0x20000, v254
    ds_read_b64 v[186:187], v254 offset:25600
    ds_read_b64 v[188:189], v254 offset:25632
    v_mov_b32 v255, 0x20000
    ds_read_b64 v[190:191], v255 offset:26368
    ds_read_b64 v[192:193], v255 offset:26528
    s_waitcnt lgkmcnt(0)
    v_mov_b32 v196, v176
    v_mov_b32 v197, v177
    v_cndmask_b32 v198, 0, v182, s[48:49]
    v_cndmask_b32 v199, 0, v183, s[48:49]
    v_mov_b32 v200, v178
    v_mov_b32 v201, v179
    v_cndmask_b32 v202, 0, v182, s[50:51]
    v_cndmask_b32 v203, 0, v183, s[50:51]
    v_cndmask_b32 v204, 0, v180, s[52:53]
    v_cndmask_b32 v205, 0, v181, s[52:53]
    v_cndmask_b32 v206, 0, v184, s[56:57]
    v_cndmask_b32 v207, 0, v185, s[56:57]
    v_cndmask_b32 v208, 0, v180, s[54:55]
    v_cndmask_b32 v209, 0, v181, s[54:55]
    v_cndmask_b32 v210, 0, v184, s[58:59]
    v_cndmask_b32 v211, 0, v185, s[58:59]
    v_mov_b32 v212, v186
    v_mov_b32 v213, v187
    v_cndmask_b32 v214, 0, v190, s[48:49]
    v_cndmask_b32 v215, 0, v191, s[48:49]
    v_mov_b32 v216, v188
    v_mov_b32 v217, v189
    v_cndmask_b32 v218, 0, v192, s[50:51]
    v_cndmask_b32 v219, 0, v193, s[50:51]
    v_mfma_f32_16x16x32_bf16 v[112:115], v[212:215], v[156:159], 0
    s_nop 0
    v_mfma_f32_16x16x32_bf16 v[116:119], v[216:219], v[160:163], 0
    v_mfma_f32_16x16x32_bf16 v[100:103], v[196:199], v[156:159], 0
    v_mfma_f32_16x16x32_bf16 v[104:107], v[200:203], v[160:163], 0
    v_mfma_f32_16x16x32_bf16 v[108:111], v[204:207], v[156:159], 0
    v_mfma_f32_16x16x32_bf16 v[108:111], v[208:211], v[160:163], v[108:111]
    v_mfma_f32_16x16x32_bf16 v[132:135], v[212:215], v[164:167], 0
    v_mfma_f32_16x16x32_bf16 v[136:139], v[216:219], v[168:171], 0
    v_mfma_f32_16x16x32_bf16 v[120:123], v[196:199], v[164:167], 0
    v_mfma_f32_16x16x32_bf16 v[124:127], v[200:203], v[168:171], 0
    v_mfma_f32_16x16x32_bf16 v[128:131], v[204:207], v[164:167], 0
    v_mfma_f32_16x16x32_bf16 v[128:131], v[208:211], v[168:171], v[128:131]
    s_mul_i32 s62, 0, 2621440
    s_mul_i32 s63, s42, 20480
    s_add_u32 s62, s62, s63
    s_add_u32 s62, s62, 14680064
    s_lshl_b32 s63, s18, 10
    s_add_u32 s63, s63, s62
    v_add_f32 v112, 0x358637bd, v112
    v_add_f32 v116, 0x358637bd, v116
    v_rcp_f32 v112, v112
    v_rcp_f32 v116, v116
    s_nop 0
    v_cndmask_b32 v113, v112, v116, s[72:73]
    v_mul_f32 v100, v100, v112
    v_mul_f32 v104, v104, v116
    v_mul_f32 v108, v108, v113
    v_mul_f32 v101, v101, v112
    v_mul_f32 v105, v105, v116
    v_mul_f32 v109, v109, v113
    v_mul_f32 v102, v102, v112
    v_mul_f32 v106, v106, v116
    v_mul_f32 v110, v110, v113
    v_mul_f32 v103, v103, v112
    v_mul_f32 v107, v107, v116
    v_mul_f32 v111, v111, v113
    v_cvt_pk_bf16_f32 v100, v100, v101
    v_cvt_pk_bf16_f32 v101, v102, v103
    v_cvt_pk_bf16_f32 v102, v104, v105
    v_cvt_pk_bf16_f32 v103, v106, v107
    v_cvt_pk_bf16_f32 v108, v108, v109
    v_cvt_pk_bf16_f32 v109, v110, v111
    buffer_store_dwordx4 v[100:103], v1, s[4:7], s63 offen
    s_mov_b64 exec, s[70:71]
    buffer_store_dwordx2 v[108:109], v14, s[4:7], s62 offen
    s_mov_b64 exec, -1
    v_add_f32 v132, 0x358637bd, v132
    v_add_f32 v136, 0x358637bd, v136
    v_rcp_f32 v132, v132
    v_rcp_f32 v136, v136
    s_nop 0
    v_cndmask_b32 v133, v132, v136, s[72:73]
    v_mul_f32 v120, v120, v132
    v_mul_f32 v124, v124, v136
    v_mul_f32 v128, v128, v133
    v_mul_f32 v121, v121, v132
    v_mul_f32 v125, v125, v136
    v_mul_f32 v129, v129, v133
    v_mul_f32 v122, v122, v132
    v_mul_f32 v126, v126, v136
    v_mul_f32 v130, v130, v133
    v_mul_f32 v123, v123, v132
    v_mul_f32 v127, v127, v136
    v_mul_f32 v131, v131, v133
    v_cvt_pk_bf16_f32 v120, v120, v121
    v_cvt_pk_bf16_f32 v121, v122, v123
    v_cvt_pk_bf16_f32 v122, v124, v125
    v_cvt_pk_bf16_f32 v123, v126, v127
    v_cvt_pk_bf16_f32 v128, v128, v129
    v_cvt_pk_bf16_f32 v129, v130, v131
    buffer_store_dwordx4 v[120:123], v4, s[4:7], s63 offen
    s_add_u32 s62, s62, 20480
    s_mov_b64 exec, s[70:71]
    buffer_store_dwordx2 v[128:129], v14, s[4:7], s62 offen
    s_mov_b64 exec, -1
    s_waitcnt vmcnt(0)
    s_barrier
    s_add_u32 s33, s41, 1
    v_mov_b32 v254, s33
    v_mov_b32 v255, 0
    s_mov_b64 exec, s[44:45]
    buffer_store_dword v254, v255, s[4:7], s37 offen
    s_mov_b64 exec, -1
    s_cmp_lg_u32 s16, 0
    s_cbranch_scc1 Lt3_o
    s_add_u32 s33, s41, 1
    s_mov_b32 s47, 0
    v_subrev_u32 v252, 0x20000, v5
Lt3_p:
    buffer_load_dword v253, v252, s[4:7], s38 offen sc1
    s_waitcnt vmcnt(0)
    v_cmp_gt_u32 vcc, s33, v253
    s_add_u32 s47, s47, 1
    s_cmp_gt_u32 s47, 20000
    s_cbranch_scc1 Lt3_p_x
    s_nop 1
    s_cbranch_vccnz Lt3_p
Lt3_p_x:
Lt3_o:
    s_barrier
    s_mul_i32 s32, 0, 2621440
    s_mul_i32 s33, s43, 20480
    s_add_u32 s32, s32, s33
    s_add_u32 s32, s32, 14680064
    ds_read_b128 v[36:39], v1 offset:16384
    ds_read_b128 v[40:43], v1 offset:17408
    ds_read_b128 v[44:47], v1 offset:18432
    ds_read_b128 v[48:51], v1 offset:19456
    ds_read_b128 v[52:55], v1 offset:20480
    buffer_load_dwordx4 a[0:3], v1, s[4:7], s32 offen offset:0 sc1
    buffer_load_dwordx4 a[4:7], v1, s[4:7], s32 offen offset:1024 sc1
    buffer_load_dwordx4 a[8:11], v1, s[4:7], s32 offen offset:2048 sc1
    buffer_load_dwordx4 a[12:15], v1, s[4:7], s32 offen offset:3072 sc1
    s_add_u32 s32, s32, 4096
    buffer_load_dwordx4 a[16:19], v1, s[4:7], s32 offen offset:0 sc1
    buffer_load_dwordx4 a[20:23], v1, s[4:7], s32 offen offset:1024 sc1
    buffer_load_dwordx4 a[24:27], v1, s[4:7], s32 offen offset:2048 sc1
    buffer_load_dwordx4 a[28:31], v1, s[4:7], s32 offen offset:3072 sc1
    s_add_u32 s32, s32, 4096
    buffer_load_dwordx4 a[32:35], v1, s[4:7], s32 offen offset:0 sc1
    buffer_load_dwordx4 a[36:39], v1, s[4:7], s32 offen offset:1024 sc1
    buffer_load_dwordx4 a[40:43], v1, s[4:7], s32 offen offset:2048 sc1
    s_waitcnt vmcnt(10) lgkmcnt(0)
    v_mfma_f32_16x16x32_bf16 v[16:19], v[36:39], a[0:3], v[16:19]
    ds_read_b128 v[56:59], v1 offset:21504
    ds_read_b128 v[60:63], v1 offset:22528
    v_mfma_f32_16x16x32_bf16 v[20:23], v[40:43], a[0:3], v[20:23]
    ds_read_b128 v[64:67], v1 offset:23552
    ds_read_b128 v[68:71], v1 offset:24576
    v_mfma_f32_16x16x32_bf16 v[24:27], v[44:47], a[0:3], v[24:27]
    ds_read_b128 v[72:75], v1 offset:25600
    ds_read_b128 v[76:79], v1 offset:26624
    v_mfma_f32_16x16x32_bf16 v[28:31], v[48:51], a[0:3], v[28:31]
    ds_read_b128 v[80:83], v1 offset:27648
    ds_read_b128 v[84:87], v1 offset:28672
    v_mfma_f32_16x16x32_bf16 v[32:35], v[52:55], a[0:3], v[32:35]
    ds_read_b128 v[88:91], v1 offset:29696
    s_waitcnt vmcnt(9) lgkmcnt(4)
    v_mfma_f32_16x16x32_bf16 v[16:19], v[56:59], a[4:7], v[16:19]
    ds_read_b128 v[92:95], v1 offset:30720
    ds_read_b128 v[96:99], v1 offset:31744
    v_mfma_f32_16x16x32_bf16 v[20:23], v[60:63], a[4:7], v[20:23]
    ds_read_b128 v[36:39], v1 offset:32768
    ds_read_b128 v[40:43], v1 offset:33792
    v_mfma_f32_16x16x32_bf16 v[24:27], v[64:67], a[4:7], v[24:27]
    ds_read_b128 v[44:47], v1 offset:34816
    buffer_load_dwordx4 a[44:47], v1, s[4:7], s32 offen offset:3072 sc1
    v_mfma_f32_16x16x32_bf16 v[28:31], v[68:71], a[4:7], v[28:31]
    ds_read_b128 v[48:51], v1 offset:35840
    s_add_u32 s32, s32, 4096
    buffer_load_dwordx4 a[48:51], v1, s[4:7], s32 offen offset:0 sc1
    v_mfma_f32_16x16x32_bf16 v[32:35], v[72:75], a[4:7], v[32:35]
    ds_read_b128 v[52:55], v1 offset:36864
    s_waitcnt vmcnt(10) lgkmcnt(6)
    v_mfma_f32_16x16x32_bf16 v[16:19], v[76:79], a[8:11], v[16:19]
    ds_read_b128 v[56:59], v1 offset:37888
    buffer_load_dwordx4 a[52:55], v1, s[4:7], s32 offen offset:1024 sc1
    v_mfma_f32_16x16x32_bf16 v[20:23], v[80:83], a[8:11], v[20:23]
    ds_read_b128 v[60:63], v1 offset:38912
    v_mfma_f32_16x16x32_bf16 v[24:27], v[84:87], a[8:11], v[24:27]
    ds_read_b128 v[64:67], v1 offset:39936
    buffer_load_dwordx4 a[56:59], v1, s[4:7], s32 offen offset:2048 sc1
    v_mfma_f32_16x16x32_bf16 v[28:31], v[88:91], a[8:11], v[28:31]
    ds_read_b128 v[68:71], v1 offset:40960
    v_mfma_f32_16x16x32_bf16 v[32:35], v[92:95], a[8:11], v[32:35]
    ds_read_b128 v[72:75], v1 offset:41984
    s_waitcnt vmcnt(11) lgkmcnt(6)
    v_mfma_f32_16x16x32_bf16 v[16:19], v[96:99], a[12:15], v[16:19]
    ds_read_b128 v[76:79], v1 offset:43008
    v_mfma_f32_16x16x32_bf16 v[20:23], v[36:39], a[12:15], v[20:23]
    ds_read_b128 v[80:83], v1 offset:44032
    buffer_load_dwordx4 a[60:63], v1, s[4:7], s32 offen offset:3072 sc1
    v_mfma_f32_16x16x32_bf16 v[24:27], v[40:43], a[12:15], v[24:27]
    ds_read_b128 v[84:87], v1 offset:45056
    v_mfma_f32_16x16x32_bf16 v[28:31], v[44:47], a[12:15], v[28:31]
    ds_read_b128 v[88:91], v1 offset:46080
    v_mfma_f32_16x16x32_bf16 v[32:35], v[48:51], a[12:15], v[32:35]
    ds_read_b128 v[92:95], v1 offset:47104
    s_waitcnt vmcnt(11) lgkmcnt(6)
    v_mfma_f32_16x16x32_bf16 v[16:19], v[52:55], a[16:19], v[16:19]
    ds_read_b128 v[96:99], v1 offset:48128
    s_add_u32 s32, s32, 4096
    buffer_load_dwordx4 a[64:67], v1, s[4:7], s32 offen offset:0 sc1
    v_mfma_f32_16x16x32_bf16 v[20:23], v[56:59], a[16:19], v[20:23]
    ds_read_b128 v[36:39], v1 offset:49152
    v_mfma_f32_16x16x32_bf16 v[24:27], v[60:63], a[16:19], v[24:27]
    ds_read_b128 v[40:43], v1 offset:50176
    v_mfma_f32_16x16x32_bf16 v[28:31], v[64:67], a[16:19], v[28:31]
    ds_read_b128 v[44:47], v1 offset:51200
    buffer_load_dwordx4 a[68:71], v1, s[4:7], s32 offen offset:1024 sc1
    v_mfma_f32_16x16x32_bf16 v[32:35], v[68:71], a[16:19], v[32:35]
    ds_read_b128 v[48:51], v1 offset:52224
    s_waitcnt vmcnt(12) lgkmcnt(6)
    v_mfma_f32_16x16x32_bf16 v[16:19], v[72:75], a[20:23], v[16:19]
    ds_read_b128 v[52:55], v1 offset:53248
    v_mfma_f32_16x16x32_bf16 v[20:23], v[76:79], a[20:23], v[20:23]
    ds_read_b128 v[56:59], v1 offset:54272
    buffer_load_dwordx4 a[72:75], v1, s[4:7], s32 offen offset:2048 sc1
    v_mfma_f32_16x16x32_bf16 v[24:27], v[80:83], a[20:23], v[24:27]
    ds_read_b128 v[60:63], v1 offset:55296
    v_mfma_f32_16x16x32_bf16 v[28:31], v[84:87], a[20:23], v[28:31]
    ds_read_b128 v[64:67], v1 offset:56320
    v_mfma_f32_16x16x32_bf16 v[32:35], v[88:91], a[20:23], v[32:35]
    ds_read_b128 v[68:71], v1 offset:57344
    s_waitcnt vmcnt(12) lgkmcnt(6)
    v_mfma_f32_16x16x32_bf16 v[16:19], v[92:95], a[24:27], v[16:19]
    ds_read_b128 v[72:75], v1 offset:58368
    buffer_load_dwordx4 a[76:79], v1, s[4:7], s32 offen offset:3072 sc1
    v_mfma_f32_16x16x32_bf16 v[20:23], v[96:99], a[24:27], v[20:23]
    ds_read_b128 v[76:79], v1 offset:59392
    v_mfma_f32_16x16x32_bf16 v[24:27], v[36:39], a[24:27], v[24:27]
    ds_read_b128 v[80:83], v1 offset:60416
    v_mfma_f32_16x16x32_bf16 v[28:31], v[40:43], a[24:27], v[28:31]
    ds_read_b128 v[84:87], v1 offset:61440
    v_mfma_f32_16x16x32_bf16 v[32:35], v[44:47], a[24:27], v[32:35]
    ds_read_b128 v[88:91], v1 offset:62464
    s_waitcnt vmcnt(12) lgkmcnt(6)
    v_mfma_f32_16x16x32_bf16 v[16:19], v[48:51], a[28:31], v[16:19]
    ds_read_b128 v[92:95], v1 offset:63488
    v_mfma_f32_16x16x32_bf16 v[20:23], v[52:55], a[28:31], v[20:23]
    ds_read_b128 v[96:99], v1 offset:64512
    v_mfma_f32_16x16x32_bf16 v[24:27], v[56:59], a[28:31], v[24:27]
    s_barrier
    ds_read_b128 v[36:39], v2 offset:0
    v_mfma_f32_16x16x32_bf16 v[28:31], v[60:63], a[28:31], v[28:31]
    ds_read_b128 v[40:43], v2 offset:1024
    s_add_u32 m0, s22, 16384
    s_add_u32 s31, s27, 32768
    buffer_load_dwordx4 v1, s[4:7], s31 offen offset:0 lds
    v_mfma_f32_16x16x32_bf16 v[32:35], v[64:67], a[28:31], v[32:35]
    ds_read_b128 v[44:47], v2 offset:2048
    s_waitcnt vmcnt(12) lgkmcnt(6)
    v_mfma_f32_16x16x32_bf16 v[16:19], v[68:71], a[32:35], v[16:19]
    ds_read_b128 v[48:51], v2 offset:3072
    buffer_load_dwordx4 v1, s[4:7], s31 offen offset:1024 lds
    v_mfma_f32_16x16x32_bf16 v[20:23], v[72:75], a[32:35], v[20:23]
    ds_read_b128 v[52:55], v2 offset:4096
    buffer_load_dwordx4 v1, s[4:7], s31 offen offset:2048 lds
    v_mfma_f32_16x16x32_bf16 v[24:27], v[76:79], a[32:35], v[24:27]
    ds_read_b128 v[56:59], v2 offset:5120
    v_mfma_f32_16x16x32_bf16 v[28:31], v[80:83], a[32:35], v[28:31]
    ds_read_b128 v[60:63], v2 offset:6144
    v_mfma_f32_16x16x32_bf16 v[32:35], v[84:87], a[32:35], v[32:35]
    ds_read_b128 v[64:67], v2 offset:7168
    s_waitcnt vmcnt(13) lgkmcnt(6)
    v_mfma_f32_16x16x32_bf16 v[16:19], v[88:91], a[36:39], v[16:19]
    ds_read_b128 v[68:71], v2 offset:8192
    buffer_load_dwordx4 v1, s[4:7], s31 offen offset:3072 lds
    v_mfma_f32_16x16x32_bf16 v[20:23], v[92:95], a[36:39], v[20:23]
    ds_read_b128 v[72:75], v2 offset:9216
    v_mfma_f32_16x16x32_bf16 v[24:27], v[96:99], a[36:39], v[24:27]
    ds_read_b128 v[76:79], v2 offset:10240
    s_add_u32 m0, s22, 32768
    s_add_u32 s31, s27, 49152
    buffer_load_dwordx4 v1, s[4:7], s31 offen offset:0 lds
    v_mfma_f32_16x16x32_bf16 v[28:31], v[36:39], a[36:39], v[28:31]
    ds_read_b128 v[80:83], v2 offset:11264
    v_mfma_f32_16x16x32_bf16 v[32:35], v[40:43], a[36:39], v[32:35]
    ds_read_b128 v[84:87], v2 offset:12288
    s_waitcnt vmcnt(14) lgkmcnt(6)
    v_mfma_f32_16x16x32_bf16 v[16:19], v[44:47], a[40:43], v[16:19]
    ds_read_b128 v[88:91], v2 offset:13312
    v_mfma_f32_16x16x32_bf16 v[20:23], v[48:51], a[40:43], v[20:23]
    ds_read_b128 v[92:95], v2 offset:14336
    buffer_load_dwordx4 v1, s[4:7], s31 offen offset:1024 lds
    v_mfma_f32_16x16x32_bf16 v[24:27], v[52:55], a[40:43], v[24:27]
    ds_read_b128 v[96:99], v2 offset:15360
    v_mfma_f32_16x16x32_bf16 v[28:31], v[56:59], a[40:43], v[28:31]
    s_barrier
    ds_read_b128 v[36:39], v2 offset:16384
    v_mfma_f32_16x16x32_bf16 v[32:35], v[60:63], a[40:43], v[32:35]
    ds_read_b128 v[40:43], v2 offset:17408
    s_waitcnt vmcnt(14) lgkmcnt(6)
    v_mfma_f32_16x16x32_bf16 v[16:19], v[64:67], a[44:47], v[16:19]
    ds_read_b128 v[44:47], v2 offset:18432
    buffer_load_dwordx4 v1, s[4:7], s31 offen offset:2048 lds
    v_mfma_f32_16x16x32_bf16 v[20:23], v[68:71], a[44:47], v[20:23]
    ds_read_b128 v[48:51], v2 offset:19456
    v_mfma_f32_16x16x32_bf16 v[24:27], v[72:75], a[44:47], v[24:27]
    ds_read_b128 v[52:55], v2 offset:20480
    v_mfma_f32_16x16x32_bf16 v[28:31], v[76:79], a[44:47], v[28:31]
    ds_read_b128 v[56:59], v2 offset:21504
    buffer_load_dwordx4 v1, s[4:7], s31 offen offset:3072 lds
    v_mfma_f32_16x16x32_bf16 v[32:35], v[80:83], a[44:47], v[32:35]
    ds_read_b128 v[60:63], v2 offset:22528
    s_waitcnt vmcnt(15) lgkmcnt(6)
    v_mfma_f32_16x16x32_bf16 v[16:19], v[84:87], a[48:51], v[16:19]
    ds_read_b128 v[64:67], v2 offset:23552
    v_mfma_f32_16x16x32_bf16 v[20:23], v[88:91], a[48:51], v[20:23]
    ds_read_b128 v[68:71], v2 offset:24576
    s_add_u32 m0, s22, 49152
    s_add_u32 s31, s27, 65536
    buffer_load_dwordx4 v1, s[4:7], s31 offen offset:0 lds
    v_mfma_f32_16x16x32_bf16 v[24:27], v[92:95], a[48:51], v[24:27]
    ds_read_b128 v[72:75], v2 offset:25600
    v_mfma_f32_16x16x32_bf16 v[28:31], v[96:99], a[48:51], v[28:31]
    ds_read_b128 v[76:79], v2 offset:26624
    v_mfma_f32_16x16x32_bf16 v[32:35], v[36:39], a[48:51], v[32:35]
    ds_read_b128 v[80:83], v2 offset:27648
    s_waitcnt vmcnt(15) lgkmcnt(6)
    v_mfma_f32_16x16x32_bf16 v[16:19], v[40:43], a[52:55], v[16:19]
    ds_read_b128 v[84:87], v2 offset:28672
    buffer_load_dwordx4 v1, s[4:7], s31 offen offset:1024 lds
    v_mfma_f32_16x16x32_bf16 v[20:23], v[44:47], a[52:55], v[20:23]
    ds_read_b128 v[88:91], v2 offset:29696
    v_mfma_f32_16x16x32_bf16 v[24:27], v[48:51], a[52:55], v[24:27]
    ds_read_b128 v[92:95], v2 offset:30720
    v_mfma_f32_16x16x32_bf16 v[28:31], v[52:55], a[52:55], v[28:31]
    ds_read_b128 v[96:99], v2 offset:31744
    buffer_load_dwordx4 v1, s[4:7], s31 offen offset:2048 lds
    v_mfma_f32_16x16x32_bf16 v[32:35], v[56:59], a[52:55], v[32:35]
    ds_read_b128 v[36:39], v2 offset:32768
    s_waitcnt vmcnt(16) lgkmcnt(6)
    v_mfma_f32_16x16x32_bf16 v[16:19], v[60:63], a[56:59], v[16:19]
    ds_read_b128 v[40:43], v2 offset:33792
    v_mfma_f32_16x16x32_bf16 v[20:23], v[64:67], a[56:59], v[20:23]
    ds_read_b128 v[44:47], v2 offset:34816
    v_mfma_f32_16x16x32_bf16 v[24:27], v[68:71], a[56:59], v[24:27]
    ds_read_b128 v[48:51], v2 offset:35840
    v_mfma_f32_16x16x32_bf16 v[28:31], v[72:75], a[56:59], v[28:31]
    ds_read_b128 v[52:55], v2 offset:36864
    v_mfma_f32_16x16x32_bf16 v[32:35], v[76:79], a[56:59], v[32:35]
    ds_read_b128 v[56:59], v2 offset:37888
    s_waitcnt vmcnt(15) lgkmcnt(6)
    v_mfma_f32_16x16x32_bf16 v[16:19], v[80:83], a[60:63], v[16:19]
    ds_read_b128 v[60:63], v2 offset:38912
    v_mfma_f32_16x16x32_bf16 v[20:23], v[84:87], a[60:63], v[20:23]
    ds_read_b128 v[64:67], v2 offset:39936
    v_mfma_f32_16x16x32_bf16 v[24:27], v[88:91], a[60:63], v[24:27]
    ds_read_b128 v[68:71], v2 offset:40960
    v_mfma_f32_16x16x32_bf16 v[28:31], v[92:95], a[60:63], v[28:31]
    ds_read_b128 v[72:75], v2 offset:41984
    v_mfma_f32_16x16x32_bf16 v[32:35], v[96:99], a[60:63], v[32:35]
    ds_read_b128 v[76:79], v2 offset:43008
    s_waitcnt vmcnt(14) lgkmcnt(6)
    v_mfma_f32_16x16x32_bf16 v[16:19], v[36:39], a[64:67], v[16:19]
    ds_read_b128 v[80:83], v2 offset:44032
    v_mfma_f32_16x16x32_bf16 v[20:23], v[40:43], a[64:67], v[20:23]
    ds_read_b128 v[84:87], v2 offset:45056
    v_mfma_f32_16x16x32_bf16 v[24:27], v[44:47], a[64:67], v[24:27]
    ds_read_b128 v[88:91], v2 offset:46080
    v_mfma_f32_16x16x32_bf16 v[28:31], v[48:51], a[64:67], v[28:31]
    ds_read_b128 v[92:95], v2 offset:47104
    v_mfma_f32_16x16x32_bf16 v[32:35], v[52:55], a[64:67], v[32:35]
    ds_read_b128 v[96:99], v2 offset:48128
    s_waitcnt vmcnt(13) lgkmcnt(6)
    v_mfma_f32_16x16x32_bf16 v[16:19], v[56:59], a[68:71], v[16:19]
    ds_read_b128 v[36:39], v2 offset:49152
    v_mfma_f32_16x16x32_bf16 v[20:23], v[60:63], a[68:71], v[20:23]
    ds_read_b128 v[40:43], v2 offset:50176
    v_mfma_f32_16x16x32_bf16 v[24:27], v[64:67], a[68:71], v[24:27]
    ds_read_b128 v[44:47], v2 offset:51200
    v_mfma_f32_16x16x32_bf16 v[28:31], v[68:71], a[68:71], v[28:31]
    ds_read_b128 v[48:51], v2 offset:52224
    v_mfma_f32_16x16x32_bf16 v[32:35], v[72:75], a[68:71], v[32:35]
    s_waitcnt vmcnt(12) lgkmcnt(5)
    v_mfma_f32_16x16x32_bf16 v[16:19], v[76:79], a[72:75], v[16:19]
    v_mfma_f32_16x16x32_bf16 v[20:23], v[80:83], a[72:75], v[20:23]
    v_mfma_f32_16x16x32_bf16 v[24:27], v[84:87], a[72:75], v[24:27]
    v_mfma_f32_16x16x32_bf16 v[28:31], v[88:91], a[72:75], v[28:31]
    v_mfma_f32_16x16x32_bf16 v[32:35], v[92:95], a[72:75], v[32:35]
    s_waitcnt vmcnt(11) lgkmcnt(0)
    v_mfma_f32_16x16x32_bf16 v[16:19], v[96:99], a[76:79], v[16:19]
    v_mfma_f32_16x16x32_bf16 v[20:23], v[36:39], a[76:79], v[20:23]
    v_mfma_f32_16x16x32_bf16 v[24:27], v[40:43], a[76:79], v[24:27]
    v_mfma_f32_16x16x32_bf16 v[28:31], v[44:47], a[76:79], v[28:31]
    v_mfma_f32_16x16x32_bf16 v[32:35], v[48:51], a[76:79], v[32:35]
    s_nop 3
    v_cvt_pk_bf16_f32 v212, v16, v17
    v_cvt_pk_bf16_f32 v213, v18, v19
    v_cvt_pk_bf16_f32 v214, v20, v21
    v_cvt_pk_bf16_f32 v215, v22, v23
    v_cvt_pk_bf16_f32 v216, v24, v25
    v_cvt_pk_bf16_f32 v217, v26, v27
    v_cvt_pk_bf16_f32 v218, v28, v29
    v_cvt_pk_bf16_f32 v219, v30, v31
    v_cvt_pk_bf16_f32 v220, v32, v33
    v_cvt_pk_bf16_f32 v221, v34, v35
    s_mov_b32 s60, 1
    s_mul_i32 s62, s60, 2621440
    s_mul_i32 s33, s43, 20480
    s_add_u32 s62, s62, s33
    s_add_u32 s62, s62, 4194304
    s_lshr_b32 s33, s20, 1
    s_mul_i32 s33, s33, 5
    s_lshl_b32 s34, s64, 1
    s_add_u32 s34, s34, s33
    s_lshl_b32 s34, s34, 10
    s_add_u32 s34, s34, s62
    buffer_store_dwordx4 v[212:215], v1, s[4:7], s34 offen
    buffer_store_dwordx4 v[216:219], v1, s[4:7], s34 offen offset:1024
    s_add_u32 s33, s33, 4
    s_lshl_b32 s33, s33, 10
    s_add_u32 s33, s33, s62
    s_lshl_b32 s34, s64, 3
    s_add_u32 s33, s33, s34
    buffer_store_dwordx2 v[220:221], v1, s[4:7], s33 offen
    v_add_f32 v224, v16, v17
    v_mul_f32 v225, v16, v16
    v_fmac_f32 v225, v17, v17
    v_add_f32 v226, v18, v19
    v_mul_f32 v227, v18, v18
    v_fmac_f32 v227, v19, v19
    v_add_f32 v224, v224, v20
    v_fmac_f32 v225, v20, v20
    v_add_f32 v226, v226, v21
    v_fmac_f32 v227, v21, v21
    v_add_f32 v224, v224, v22
    v_fmac_f32 v225, v22, v22
    v_add_f32 v226, v226, v23
    v_fmac_f32 v227, v23, v23
    v_add_f32 v224, v224, v24
    v_fmac_f32 v225, v24, v24
    v_add_f32 v226, v226, v25
    v_fmac_f32 v227, v25, v25
    v_add_f32 v224, v224, v26
    v_fmac_f32 v225, v26, v26
    v_add_f32 v226, v226, v27
    v_fmac_f32 v227, v27, v27
    v_add_f32 v224, v224, v28
    v_fmac_f32 v225, v28, v28
    v_add_f32 v226, v226, v29
    v_fmac_f32 v227, v29, v29
    v_add_f32 v224, v224, v30
    v_fmac_f32 v225, v30, v30
    v_add_f32 v226, v226, v31
    v_fmac_f32 v227, v31, v31
    v_add_f32 v224, v224, v32
    v_fmac_f32 v225, v32, v32
    v_add_f32 v226, v226, v33
    v_fmac_f32 v227, v33, v33
    v_add_f32 v224, v224, v34
    v_fmac_f32 v225, v34, v34
    v_add_f32 v226, v226, v35
    v_fmac_f32 v227, v35, v35
    v_add_f32 v224, v224, v226
    v_add_f32 v225, v225, v227
    v_mov_b32 v226, v224
    v_mov_b32 v227, v225
    s_nop 0
    v_permlane32_swap_b32 v224, v226
    v_permlane32_swap_b32 v225, v227
    v_add_f32 v224, v224, v226
    v_add_f32 v225, v225, v227
    v_mov_b32 v226, v224
    v_mov_b32 v227, v225
    s_nop 0
    v_permlane16_swap_b32 v224, v226
    v_permlane16_swap_b32 v225, v227
    v_add_f32 v224, v224, v226
    v_add_f32 v225, v225, v227
    s_mul_i32 s62, s60, 131072
    s_lshl_b32 s33, s43, 10
    s_add_u32 s62, s62, s33
    s_lshl_b32 s33, s20, 7
    s_add_u32 s62, s62, s33
    s_add_u32 s62, s62, 393216
    s_mov_b64 exec, s[48:49]
    buffer_store_dwordx2 v[224:225], v12, s[4:7], s62 offen
    s_mov_b64 exec, -1
    s_cmp_lg_u32 s16, 0
    s_cbranch_scc1 Lt5_a
    s_waitcnt vmcnt(0)
    s_branch Lt5_b
Lt5_a:
    s_waitcnt vmcnt(0)
Lt5_b:
    s_barrier
    s_add_u32 s33, s41, 2
    v_mov_b32 v254, s33
    v_mov_b32 v255, 0
    s_mov_b64 exec, s[44:45]
    buffer_store_dword v254, v255, s[4:7], s37 offen
    s_mov_b64 exec, -1
    s_cmp_lg_u32 s16, 0
    s_cbranch_scc1 Lt5_c
    s_add_u32 s33, s41, 2
    s_mov_b32 s47, 0
    v_subrev_u32 v252, 0x20000, v5
Lt5_p:
    buffer_load_dword v253, v252, s[4:7], s38 offen sc1
    s_waitcnt vmcnt(0)
    v_cmp_gt_u32 vcc, s33, v253
    s_add_u32 s47, s47, 1
    s_cmp_gt_u32 s47, 20000
    s_cbranch_scc1 Lt5_p_x
    s_nop 1
    s_cbranch_vccnz Lt5_p
Lt5_p_x:
    s_branch Lt5_o
Lt5_c:
Lt5_o:
    s_barrier
    s_mul_i32 s32, s60, 2621440
    s_mul_i32 s33, s42, 20480
    s_add_u32 s32, s32, s33
    s_add_u32 s32, s32, 4194304
    ds_read_b128 v[52:55], v3 offset:0
    ds_read_b128 v[56:59], v3 offset:1024
    ds_read_b128 v[60:63], v3 offset:2048
    ds_read_b128 v[64:67], v3 offset:3072
    ds_read_b128 v[68:71], v3 offset:4096
    buffer_load_dwordx4 a[0:3], v9, s[4:7], s32 offen offset:0 sc1
    buffer_load_dwordx4 a[4:7], v9, s[4:7], s32 offen offset:512 sc1
    buffer_load_dwordx4 a[8:11], v9, s[4:7], s32 offen offset:1024 sc1
    buffer_load_dwordx4 a[12:15], v9, s[4:7], s32 offen offset:1536 sc1
    buffer_load_dwordx4 v1, s[4:7], s31 offen offset:3072 lds
    s_add_u32 m0, s22, 65536
    s_add_u32 s31, s27, 81920
    buffer_load_dwordx4 v1, s[4:7], s31 offen offset:0 lds
    buffer_load_dwordx4 v1, s[4:7], s31 offen offset:1024 lds
    buffer_load_dwordx4 v1, s[4:7], s31 offen offset:2048 lds
    buffer_load_dwordx4 v1, s[4:7], s31 offen offset:3072 lds
    buffer_load_dwordx4 a[16:19], v9, s[4:7], s32 offen offset:2048 sc1
    s_waitcnt vmcnt(8) lgkmcnt(1)
    v_mfma_f32_32x32x16_bf16 v[100:115], v[52:55], a[0:3], 0
    ds_read_b128 v[72:75], v3 offset:5120
    ds_read_b128 v[76:79], v3 offset:6144
    ds_read_b128 v[80:83], v3 offset:7168
    buffer_load_dwordx4 a[20:23], v9, s[4:7], s32 offen offset:2560 sc1
    v_mfma_f32_32x32x16_bf16 v[116:131], v[60:63], a[0:3], 0
    v_and_b32 v223, 0xf0, v1
    v_lshrrev_b32 v223, 1, v223
    v_and_b32 v220, 0x200, v1
    v_add_u32 v223, v223, v220
    v_and_b32 v220, 0x100, v1
    v_lshlrev_b32 v220, 2, v220
    v_mfma_f32_32x32x16_bf16 v[100:115], v[56:59], a[4:7], v[100:115]
    ds_read_b128 v[84:87], v3 offset:8192
    ds_read_b128 v[88:91], v3 offset:9216
    ds_read_b128 v[92:95], v3 offset:10240
    ds_read_b128 v[96:99], v3 offset:11264
    s_add_u32 m0, s22, 81920
    s_add_u32 s31, s27, 98304
    buffer_load_dwordx4 v1, s[4:7], s31 offen offset:0 lds
    v_mfma_f32_32x32x16_bf16 v[116:131], v[64:67], a[4:7], v[116:131]
    v_add_u32 v223, v223, v220
    s_mul_i32 s62, s60, 131072
    s_lshl_b32 s63, s42, 10
    s_add_u32 s62, s62, s63
    s_add_u32 s62, s62, 393216
    s_waitcnt lgkmcnt(4)
    v_mfma_f32_32x32x16_bf16 v[132:147], v[68:71], a[0:3], 0
    buffer_load_dwordx4 v1, s[4:7], s31 offen offset:1024 lds
    buffer_load_dwordx2 v[212:213], v223, s[4:7], s62 offen offset:0 sc1
    buffer_load_dwordx2 v[214:215], v223, s[4:7], s62 offen offset:128 sc1
    buffer_load_dwordx2 v[216:217], v223, s[4:7], s62 offen offset:256 sc1
    buffer_load_dwordx2 v[218:219], v223, s[4:7], s62 offen offset:384 sc1
    v_mfma_f32_32x32x16_bf16 v[148:163], v[76:79], a[0:3], 0
    v_mfma_f32_32x32x16_bf16 v[132:147], v[72:75], a[4:7], v[132:147]
    ds_read_b128 v[36:39], v3 offset:12288
    ds_read_b128 v[40:43], v3 offset:13312
    ds_read_b128 v[44:47], v3 offset:14336
    ds_read_b128 v[48:51], v3 offset:15360
    buffer_load_dwordx4 v1, s[4:7], s31 offen offset:2048 lds
    v_mfma_f32_32x32x16_bf16 v[148:163], v[80:83], a[4:7], v[148:163]
    s_waitcnt lgkmcnt(4)
    v_mfma_f32_32x32x16_bf16 v[164:179], v[84:87], a[0:3], 0
    buffer_load_dwordx4 v1, s[4:7], s31 offen offset:3072 lds
    v_mfma_f32_32x32x16_bf16 v[180:195], v[92:95], a[0:3], 0
    v_mfma_f32_32x32x16_bf16 v[164:179], v[88:91], a[4:7], v[164:179]
    ds_read_b128 v[52:55], v1 offset:0
    ds_read_b128 v[56:59], v1 offset:1024
    ds_read_b128 v[60:63], v1 offset:2048
    ds_read_b128 v[64:67], v1 offset:3072
    s_add_u32 m0, s22, 98304
    s_add_u32 s31, s27, 114688
    buffer_load_dwordx4 v1, s[4:7], s31 offen offset:0 lds
    v_mfma_f32_32x32x16_bf16 v[180:195], v[96:99], a[4:7], v[180:195]
    s_waitcnt vmcnt(16) lgkmcnt(4)
    v_mfma_f32_32x32x16_bf16 v[100:115], v[36:39], a[8:11], v[100:115]
    buffer_load_dwordx4 v1, s[4:7], s31 offen offset:1024 lds
    v_mfma_f32_32x32x16_bf16 v[116:131], v[44:47], a[8:11], v[116:131]
    v_mfma_f32_32x32x16_bf16 v[100:115], v[40:43], a[12:15], v[100:115]
    ds_read_b128 v[68:71], v1 offset:4096
    ds_read_b128 v[72:75], v1 offset:5120
    ds_read_b128 v[76:79], v1 offset:6144
    ds_read_b128 v[80:83], v1 offset:7168
    buffer_load_dwordx4 v1, s[4:7], s31 offen offset:2048 lds
    v_mfma_f32_32x32x16_bf16 v[116:131], v[48:51], a[12:15], v[116:131]
    s_waitcnt lgkmcnt(4)
    v_mfma_f32_32x32x16_bf16 v[132:147], v[52:55], a[8:11], v[132:147]
    buffer_load_dwordx4 v1, s[4:7], s31 offen offset:3072 lds
    v_mfma_f32_32x32x16_bf16 v[148:163], v[60:63], a[8:11], v[148:163]
    v_mfma_f32_32x32x16_bf16 v[132:147], v[56:59], a[12:15], v[132:147]
    ds_read_b128 v[84:87], v1 offset:8192
    ds_read_b128 v[88:91], v1 offset:9216
    ds_read_b128 v[92:95], v1 offset:10240
    ds_read_b128 v[96:99], v1 offset:11264
    buffer_load_dwordx4 a[24:27], v9, s[4:7], s32 offen offset:3072 sc1
    v_mfma_f32_32x32x16_bf16 v[148:163], v[64:67], a[12:15], v[148:163]
    buffer_load_dwordx4 a[28:31], v9, s[4:7], s32 offen offset:3584 sc1
    s_waitcnt lgkmcnt(4)
    v_mfma_f32_32x32x16_bf16 v[164:179], v[68:71], a[8:11], v[164:179]
    v_mfma_f32_32x32x16_bf16 v[180:195], v[76:79], a[8:11], v[180:195]
    s_add_u32 s32, s32, 4096
    buffer_load_dwordx4 a[32:35], v9, s[4:7], s32 offen offset:0 sc1
    v_mfma_f32_32x32x16_bf16 v[164:179], v[72:75], a[12:15], v[164:179]
    ds_read_b128 v[36:39], v1 offset:12288
    ds_read_b128 v[40:43], v1 offset:13312
    ds_read_b128 v[44:47], v1 offset:14336
    ds_read_b128 v[48:51], v1 offset:15360
    v_mfma_f32_32x32x16_bf16 v[180:195], v[80:83], a[12:15], v[180:195]
    buffer_load_dwordx4 a[36:39], v9, s[4:7], s32 offen offset:512 sc1
    s_waitcnt vmcnt(16) lgkmcnt(4)
    v_mfma_f32_32x32x16_bf16 v[100:115], v[84:87], a[16:19], v[100:115]
    v_mfma_f32_32x32x16_bf16 v[116:131], v[92:95], a[16:19], v[116:131]
    buffer_load_dwordx4 a[40:43], v9, s[4:7], s32 offen offset:1024 sc1
    v_mfma_f32_32x32x16_bf16 v[100:115], v[88:91], a[20:23], v[100:115]
    s_barrier
    ds_read_b128 v[52:55], v1 offset:16384
    ds_read_b128 v[56:59], v1 offset:17408
    ds_read_b128 v[60:63], v1 offset:18432
    ds_read_b128 v[64:67], v1 offset:19456
    v_mfma_f32_32x32x16_bf16 v[116:131], v[96:99], a[20:23], v[116:131]
    buffer_load_dwordx4 a[44:47], v9, s[4:7], s32 offen offset:1536 sc1
    s_waitcnt lgkmcnt(4)
    v_mfma_f32_32x32x16_bf16 v[132:147], v[36:39], a[16:19], v[132:147]
    v_mfma_f32_32x32x16_bf16 v[148:163], v[44:47], a[16:19], v[148:163]
    s_add_u32 m0, s22, 114688
    s_add_u32 s31, s27, 131072
    buffer_load_dwordx4 v1, s[4:7], s31 offen offset:0 lds
    s_waitcnt vmcnt(13)
    v_add_f32 v212, v212, v214
    v_add_f32 v213, v213, v215
    v_add_f32 v216, v216, v218
    v_mfma_f32_32x32x16_bf16 v[132:147], v[40:43], a[20:23], v[132:147]
    ds_read_b128 v[68:71], v1 offset:20480
    ds_read_b128 v[72:75], v1 offset:21504
    ds_read_b128 v[76:79], v1 offset:22528
    ds_read_b128 v[80:83], v1 offset:23552
    v_add_f32 v217, v217, v219
    v_add_f32 v212, v212, v216
    v_mfma_f32_32x32x16_bf16 v[148:163], v[48:51], a[20:23], v[148:163]
    buffer_load_dwordx4 v1, s[4:7], s31 offen offset:1024 lds
    v_add_f32 v213, v213, v217
    v_mov_b32 v214, v212
    v_mov_b32 v215, v213
    s_nop 0
    v_permlane32_swap_b32 v212, v214
    s_waitcnt lgkmcnt(4)
    v_mfma_f32_32x32x16_bf16 v[164:179], v[52:55], a[16:19], v[164:179]
    v_permlane32_swap_b32 v213, v215
    v_add_f32 v212, v212, v214
    v_add_f32 v213, v213, v215
    v_mul_f32 v220, 0xbacccccd, v212
    v_mul_f32 v222, 0x3acccccd, v213
    v_fma_f32 v222, -v220, v220, v222
    v_mfma_f32_32x32x16_bf16 v[180:195], v[60:63], a[16:19], v[180:195]
    buffer_load_dwordx4 v1, s[4:7], s31 offen offset:2048 lds
    v_max_f32 v222, 0, v222
    v_add_f32 v222, 0x3727c5ac, v222
    v_rsq_f32 v221, v222
    s_nop 0
    v_mul_f32 v221, 0xbfb8aa3b, v221
    v_mfma_f32_32x32x16_bf16 v[164:179], v[56:59], a[20:23], v[164:179]
    ds_read_b128 v[84:87], v1 offset:24576
    ds_read_b128 v[88:91], v1 offset:25600
    ds_read_b128 v[92:95], v1 offset:26624
    ds_read_b128 v[96:99], v1 offset:27648
    v_mfma_f32_32x32x16_bf16 v[180:195], v[64:67], a[20:23], v[180:195]
    buffer_load_dwordx4 v1, s[4:7], s31 offen offset:3072 lds
    s_waitcnt vmcnt(8) lgkmcnt(4)
    v_mfma_f32_32x32x16_bf16 v[100:115], v[68:71], a[24:27], v[100:115]
    v_mfma_f32_32x32x16_bf16 v[116:131], v[76:79], a[24:27], v[116:131]
    s_add_u32 m0, s22, 131072
    s_add_u32 s31, s27, 147456
    buffer_load_dwordx4 v1, s[4:7], s31 offen offset:0 lds
    v_mfma_f32_32x32x16_bf16 v[100:115], v[72:75], a[28:31], v[100:115]
    ds_read_b128 v[36:39], v1 offset:28672
    ds_read_b128 v[40:43], v1 offset:29696
    ds_read_b128 v[44:47], v1 offset:30720
    ds_read_b128 v[48:51], v1 offset:31744
    buffer_load_dwordx4 v1, s[4:7], s31 offen offset:1024 lds
    v_mfma_f32_32x32x16_bf16 v[116:131], v[80:83], a[28:31], v[116:131]
    s_waitcnt lgkmcnt(4)
    v_mfma_f32_32x32x16_bf16 v[132:147], v[84:87], a[24:27], v[132:147]
    buffer_load_dwordx4 v1, s[4:7], s31 offen offset:2048 lds
    v_mfma_f32_32x32x16_bf16 v[148:163], v[92:95], a[24:27], v[148:163]
    v_mfma_f32_32x32x16_bf16 v[132:147], v[88:91], a[28:31], v[132:147]
    ds_read_b128 v[52:55], v1 offset:32768
    ds_read_b128 v[56:59], v1 offset:33792
    ds_read_b128 v[60:63], v1 offset:34816
    ds_read_b128 v[64:67], v1 offset:35840
    buffer_load_dwordx4 v1, s[4:7], s31 offen offset:3072 lds
    v_mfma_f32_32x32x16_bf16 v[148:163], v[96:99], a[28:31], v[148:163]
    s_waitcnt lgkmcnt(4)
    v_mfma_f32_32x32x16_bf16 v[164:179], v[36:39], a[24:27], v[164:179]
    buffer_load_dwordx4 a[48:51], v9, s[4:7], s32 offen offset:2048 sc1
    v_mfma_f32_32x32x16_bf16 v[180:195], v[44:47], a[24:27], v[180:195]
    v_mfma_f32_32x32x16_bf16 v[164:179], v[40:43], a[28:31], v[164:179]
    ds_read_b128 v[68:71], v1 offset:36864
    ds_read_b128 v[72:75], v1 offset:37888
    ds_read_b128 v[76:79], v1 offset:38912
    ds_read_b128 v[80:83], v1 offset:39936
    buffer_load_dwordx4 a[52:55], v9, s[4:7], s32 offen offset:2560 sc1
    v_mfma_f32_32x32x16_bf16 v[180:195], v[48:51], a[28:31], v[180:195]
    s_waitcnt vmcnt(12) lgkmcnt(4)
    v_mfma_f32_32x32x16_bf16 v[100:115], v[52:55], a[32:35], v[100:115]
    buffer_load_dwordx4 a[56:59], v9, s[4:7], s32 offen offset:3072 sc1
    v_mfma_f32_32x32x16_bf16 v[116:131], v[60:63], a[32:35], v[116:131]
    s_mul_i32 s62, 0, 7077888
    s_mul_i32 s63, s42, 55296
    s_add_u32 s62, s62, s63
    s_add_u32 s62, s62, 20971520
    s_lshl_b32 s63, s18, 10
    s_add_u32 s63, s63, s62
    v_mfma_f32_32x32x16_bf16 v[100:115], v[56:59], a[36:39], v[100:115]
    ds_read_b128 v[84:87], v1 offset:40960
    ds_read_b128 v[88:91], v1 offset:41984
    ds_read_b128 v[92:95], v1 offset:43008
    ds_read_b128 v[96:99], v1 offset:44032
    buffer_load_dwordx4 a[60:63], v9, s[4:7], s32 offen offset:3584 sc1
    v_mfma_f32_32x32x16_bf16 v[116:131], v[64:67], a[36:39], v[116:131]
    s_waitcnt lgkmcnt(4)
    v_mfma_f32_32x32x16_bf16 v[132:147], v[68:71], a[32:35], v[132:147]
    s_add_u32 s32, s32, 4096
    buffer_load_dwordx4 a[64:67], v9, s[4:7], s32 offen offset:0 sc1
    v_mfma_f32_32x32x16_bf16 v[148:163], v[76:79], a[32:35], v[148:163]
    v_mfma_f32_32x32x16_bf16 v[132:147], v[72:75], a[36:39], v[132:147]
    ds_read_b128 v[36:39], v1 offset:45056
    ds_read_b128 v[40:43], v1 offset:46080
    ds_read_b128 v[44:47], v1 offset:47104
    ds_read_b128 v[48:51], v1 offset:48128
    buffer_load_dwordx4 a[68:71], v9, s[4:7], s32 offen offset:512 sc1
    v_mfma_f32_32x32x16_bf16 v[148:163], v[80:83], a[36:39], v[148:163]
    s_waitcnt lgkmcnt(4)
    v_mfma_f32_32x32x16_bf16 v[164:179], v[84:87], a[32:35], v[164:179]
    buffer_load_dwordx4 a[72:75], v9, s[4:7], s32 offen offset:1024 sc1
    v_mfma_f32_32x32x16_bf16 v[180:195], v[92:95], a[32:35], v[180:195]
    buffer_load_dwordx4 a[76:79], v9, s[4:7], s32 offen offset:1536 sc1
    v_mfma_f32_32x32x16_bf16 v[164:179], v[88:91], a[36:39], v[164:179]
    s_barrier
    ds_read_b128 v[52:55], v1 offset:49152
    ds_read_b128 v[56:59], v1 offset:50176
    ds_read_b128 v[60:63], v1 offset:51200
    ds_read_b128 v[64:67], v1 offset:52224
    v_mfma_f32_32x32x16_bf16 v[180:195], v[96:99], a[36:39], v[180:195]
    s_add_u32 m0, s22, 0
    s_add_u32 s31, s27, 163840
    buffer_load_dwordx4 v1, s[4:7], s31 offen offset:0 lds
    s_waitcnt vmcnt(17) lgkmcnt(4)
    v_mfma_f32_32x32x16_bf16 v[100:115], v[36:39], a[40:43], v[100:115]
    v_mfma_f32_32x32x16_bf16 v[116:131], v[44:47], a[40:43], v[116:131]
    buffer_load_dwordx4 v1, s[4:7], s31 offen offset:1024 lds
    v_mfma_f32_32x32x16_bf16 v[100:115], v[40:43], a[44:47], v[100:115]
    ds_read_b128 v[68:71], v1 offset:53248
    ds_read_b128 v[72:75], v1 offset:54272
    ds_read_b128 v[76:79], v1 offset:55296
    ds_read_b128 v[80:83], v1 offset:56320
    v_mfma_f32_32x32x16_bf16 v[116:131], v[48:51], a[44:47], v[116:131]
    buffer_load_dwordx4 v1, s[4:7], s31 offen offset:2048 lds
    s_waitcnt lgkmcnt(4)
    v_mfma_f32_32x32x16_bf16 v[132:147], v[52:55], a[40:43], v[132:147]
    v_mfma_f32_32x32x16_bf16 v[148:163], v[60:63], a[40:43], v[148:163]
    buffer_load_dwordx4 v1, s[4:7], s31 offen offset:3072 lds
    v_mfma_f32_32x32x16_bf16 v[132:147], v[56:59], a[44:47], v[132:147]
    ds_read_b128 v[84:87], v1 offset:57344
    ds_read_b128 v[88:91], v1 offset:58368
    ds_read_b128 v[92:95], v1 offset:59392
    ds_read_b128 v[96:99], v1 offset:60416
    v_mfma_f32_32x32x16_bf16 v[148:163], v[64:67], a[44:47], v[148:163]
    s_add_u32 m0, s22, 16384
    s_add_u32 s31, s27, 180224
    buffer_load_dwordx4 v1, s[4:7], s31 offen offset:0 lds
    s_waitcnt lgkmcnt(4)
    v_mfma_f32_32x32x16_bf16 v[164:179], v[68:71], a[40:43], v[164:179]
    v_mfma_f32_32x32x16_bf16 v[180:195], v[76:79], a[40:43], v[180:195]
    buffer_load_dwordx4 v1, s[4:7], s31 offen offset:1024 lds
    v_mfma_f32_32x32x16_bf16 v[164:179], v[72:75], a[44:47], v[164:179]
    ds_read_b128 v[36:39], v1 offset:61440
    ds_read_b128 v[40:43], v1 offset:62464
    ds_read_b128 v[44:47], v1 offset:63488
    ds_read_b128 v[48:51], v1 offset:64512
    v_mfma_f32_32x32x16_bf16 v[180:195], v[80:83], a[44:47], v[180:195]
    buffer_load_dwordx4 v1, s[4:7], s31 offen offset:2048 lds
    s_waitcnt vmcnt(13) lgkmcnt(4)
    v_mfma_f32_32x32x16_bf16 v[100:115], v[84:87], a[48:51], v[100:115]
    v_mfma_f32_32x32x16_bf16 v[116:131], v[92:95], a[48:51], v[116:131]
    buffer_load_dwordx4 v1, s[4:7], s31 offen offset:3072 lds
    v_mfma_f32_32x32x16_bf16 v[100:115], v[88:91], a[52:55], v[100:115]
    ds_read_b128 v[52:55], v2 offset:0
    ds_read_b128 v[56:59], v2 offset:1024
    ds_read_b128 v[60:63], v2 offset:2048
    ds_read_b128 v[64:67], v2 offset:3072
    v_mfma_f32_32x32x16_bf16 v[116:131], v[96:99], a[52:55], v[116:131]
    buffer_load_dwordx4 a[80:83], v9, s[4:7], s32 offen offset:2048 sc1
    s_waitcnt lgkmcnt(4)
    v_mfma_f32_32x32x16_bf16 v[132:147], v[36:39], a[48:51], v[132:147]
    v_mfma_f32_32x32x16_bf16 v[148:163], v[44:47], a[48:51], v[148:163]
    buffer_load_dwordx4 a[84:87], v9, s[4:7], s32 offen offset:2560 sc1
    v_mfma_f32_32x32x16_bf16 v[132:147], v[40:43], a[52:55], v[132:147]
    ds_read_b128 v[68:71], v2 offset:4096
    ds_read_b128 v[72:75], v2 offset:5120
    ds_read_b128 v[76:79], v2 offset:6144
    ds_read_b128 v[80:83], v2 offset:7168
    buffer_load_dwordx4 a[88:91], v9, s[4:7], s32 offen offset:3072 sc1
    v_mfma_f32_32x32x16_bf16 v[148:163], v[48:51], a[52:55], v[148:163]
    s_waitcnt lgkmcnt(4)
    v_mfma_f32_32x32x16_bf16 v[164:179], v[52:55], a[48:51], v[164:179]
    buffer_load_dwordx4 a[92:95], v9, s[4:7], s32 offen offset:3584 sc1
    v_mfma_f32_32x32x16_bf16 v[180:195], v[60:63], a[48:51], v[180:195]
    v_mfma_f32_32x32x16_bf16 v[164:179], v[56:59], a[52:55], v[164:179]
    ds_read_b128 v[84:87], v2 offset:8192
    ds_read_b128 v[88:91], v2 offset:9216
    ds_read_b128 v[92:95], v2 offset:10240
    ds_read_b128 v[96:99], v2 offset:11264
    s_add_u32 s32, s32, 4096
    buffer_load_dwordx4 a[96:99], v9, s[4:7], s32 offen offset:0 sc1
    v_mfma_f32_32x32x16_bf16 v[180:195], v[64:67], a[52:55], v[180:195]
    s_waitcnt vmcnt(17) lgkmcnt(4)
    v_mfma_f32_32x32x16_bf16 v[100:115], v[68:71], a[56:59], v[100:115]
    buffer_load_dwordx4 a[100:103], v9, s[4:7], s32 offen offset:512 sc1
    v_mfma_f32_32x32x16_bf16 v[116:131], v[76:79], a[56:59], v[116:131]
    v_mfma_f32_32x32x16_bf16 v[100:115], v[72:75], a[60:63], v[100:115]
    ds_read_b128 v[36:39], v2 offset:12288
    ds_read_b128 v[40:43], v2 offset:13312
    ds_read_b128 v[44:47], v2 offset:14336
    ds_read_b128 v[48:51], v2 offset:15360
    buffer_load_dwordx4 a[104:107], v9, s[4:7], s32 offen offset:1024 sc1
    v_mfma_f32_32x32x16_bf16 v[116:131], v[80:83], a[60:63], v[116:131]
    s_waitcnt lgkmcnt(4)
    v_mfma_f32_32x32x16_bf16 v[132:147], v[84:87], a[56:59], v[132:147]
    buffer_load_dwordx4 a[108:111], v9, s[4:7], s32 offen offset:1536 sc1
    v_mfma_f32_32x32x16_bf16 v[148:163], v[92:95], a[56:59], v[148:163]
    v_mfma_f32_32x32x16_bf16 v[132:147], v[88:91], a[60:63], v[132:147]
    s_barrier
    ds_read_b128 v[52:55], v2 offset:16384
    ds_read_b128 v[56:59], v2 offset:17408
    ds_read_b128 v[60:63], v2 offset:18432
    ds_read_b128 v[64:67], v2 offset:19456
    v_mfma_f32_32x32x16_bf16 v[148:163], v[96:99], a[60:63], v[148:163]
    s_add_u32 m0, s22, 32768
    s_add_u32 s31, s27, 196608
    buffer_load_dwordx4 v1, s[4:7], s31 offen offset:0 lds
    s_waitcnt lgkmcnt(4)
    v_mfma_f32_32x32x16_bf16 v[164:179], v[36:39], a[56:59], v[164:179]
    buffer_load_dwordx4 v1, s[4:7], s31 offen offset:1024 lds
    v_mfma_f32_32x32x16_bf16 v[180:195], v[44:47], a[56:59], v[180:195]
    v_mfma_f32_32x32x16_bf16 v[164:179], v[40:43], a[60:63], v[164:179]
    ds_read_b128 v[68:71], v2 offset:20480
    ds_read_b128 v[72:75], v2 offset:21504
    ds_read_b128 v[76:79], v2 offset:22528
    ds_read_b128 v[80:83], v2 offset:23552
    buffer_load_dwordx4 v1, s[4:7], s31 offen offset:2048 lds
    v_mfma_f32_32x32x16_bf16 v[180:195], v[48:51], a[60:63], v[180:195]
    s_waitcnt vmcnt(21) lgkmcnt(4)
    v_mfma_f32_32x32x16_bf16 v[100:115], v[52:55], a[64:67], v[100:115]
    buffer_load_dwordx4 v1, s[4:7], s31 offen offset:3072 lds
    v_mfma_f32_32x32x16_bf16 v[116:131], v[60:63], a[64:67], v[116:131]
    s_add_u32 m0, s22, 49152
    s_add_u32 s31, s27, 212992
    buffer_load_dwordx4 v1, s[4:7], s31 offen offset:0 lds
    v_mfma_f32_32x32x16_bf16 v[100:115], v[56:59], a[68:71], v[100:115]
    ds_read_b128 v[84:87], v2 offset:24576
    ds_read_b128 v[88:91], v2 offset:25600
    ds_read_b128 v[92:95], v2 offset:26624
    ds_read_b128 v[96:99], v2 offset:27648
    v_mfma_f32_32x32x16_bf16 v[116:131], v[64:67], a[68:71], v[116:131]
    buffer_load_dwordx4 v1, s[4:7], s31 offen offset:1024 lds
    s_waitcnt lgkmcnt(4)
    v_mfma_f32_32x32x16_bf16 v[132:147], v[68:71], a[64:67], v[132:147]
    v_mfma_f32_32x32x16_bf16 v[148:163], v[76:79], a[64:67], v[148:163]
    buffer_load_dwordx4 v1, s[4:7], s31 offen offset:2048 lds
    v_mfma_f32_32x32x16_bf16 v[132:147], v[72:75], a[68:71], v[132:147]
    ds_read_b128 v[36:39], v2 offset:28672
    ds_read_b128 v[40:43], v2 offset:29696
    ds_read_b128 v[44:47], v2 offset:30720
    ds_read_b128 v[48:51], v2 offset:31744
    v_mfma_f32_32x32x16_bf16 v[148:163], v[80:83], a[68:71], v[148:163]
    buffer_load_dwordx4 v1, s[4:7], s31 offen offset:3072 lds
    s_waitcnt lgkmcnt(4)
    v_mfma_f32_32x32x16_bf16 v[164:179], v[84:87], a[64:67], v[164:179]
    v_mfma_f32_32x32x16_bf16 v[180:195], v[92:95], a[64:67], v[180:195]
    buffer_load_dwordx4 a[112:115], v9, s[4:7], s32 offen offset:2048 sc1
    v_mfma_f32_32x32x16_bf16 v[164:179], v[88:91], a[68:71], v[164:179]
    ds_read_b128 v[52:55], v2 offset:32768
    ds_read_b128 v[56:59], v2 offset:33792
    ds_read_b128 v[60:63], v2 offset:34816
    ds_read_b128 v[64:67], v2 offset:35840
    v_mfma_f32_32x32x16_bf16 v[180:195], v[96:99], a[68:71], v[180:195]
    buffer_load_dwordx4 a[116:119], v9, s[4:7], s32 offen offset:2560 sc1
    s_waitcnt vmcnt(26) lgkmcnt(4)
    v_mfma_f32_32x32x16_bf16 v[100:115], v[36:39], a[72:75], v[100:115]
    v_mfma_f32_32x32x16_bf16 v[116:131], v[44:47], a[72:75], v[116:131]
    buffer_load_dwordx4 a[120:123], v9, s[4:7], s32 offen offset:3072 sc1
    v_mfma_f32_32x32x16_bf16 v[100:115], v[40:43], a[76:79], v[100:115]
    ds_read_b128 v[68:71], v2 offset:36864
    ds_read_b128 v[72:75], v2 offset:37888
    ds_read_b128 v[76:79], v2 offset:38912
    ds_read_b128 v[80:83], v2 offset:39936
    v_mfma_f32_32x32x16_bf16 v[116:131], v[48:51], a[76:79], v[116:131]
    buffer_load_dwordx4 a[124:127], v9, s[4:7], s32 offen offset:3584 sc1
    s_waitcnt lgkmcnt(4)
    v_mfma_f32_32x32x16_bf16 v[132:147], v[52:55], a[72:75], v[132:147]
    v_mfma_f32_32x32x16_bf16 v[148:163], v[60:63], a[72:75], v[148:163]
    s_add_u32 s32, s32, 4096
    buffer_load_dwordx4 a[128:131], v9, s[4:7], s32 offen offset:0 sc1
    v_mfma_f32_32x32x16_bf16 v[132:147], v[56:59], a[76:79], v[132:147]
    ds_read_b128 v[84:87], v2 offset:40960
    ds_read_b128 v[88:91], v2 offset:41984
    ds_read_b128 v[92:95], v2 offset:43008
    ds_read_b128 v[96:99], v2 offset:44032
    v_mfma_f32_32x32x16_bf16 v[148:163], v[64:67], a[76:79], v[148:163]
    buffer_load_dwordx4 a[132:135], v9, s[4:7], s32 offen offset:512 sc1
    s_waitcnt lgkmcnt(4)
    v_mfma_f32_32x32x16_bf16 v[164:179], v[68:71], a[72:75], v[164:179]
    buffer_load_dwordx4 a[136:139], v9, s[4:7], s32 offen offset:1024 sc1
    v_mfma_f32_32x32x16_bf16 v[180:195], v[76:79], a[72:75], v[180:195]
    v_mfma_f32_32x32x16_bf16 v[164:179], v[72:75], a[76:79], v[164:179]
    ds_read_b128 v[36:39], v2 offset:45056
    ds_read_b128 v[40:43], v2 offset:46080
    ds_read_b128 v[44:47], v2 offset:47104
    ds_read_b128 v[48:51], v2 offset:48128
    buffer_load_dwordx4 a[140:143], v9, s[4:7], s32 offen offset:1536 sc1
    v_mfma_f32_32x32x16_bf16 v[180:195], v[80:83], a[76:79], v[180:195]
    s_waitcnt vmcnt(22) lgkmcnt(4)
    v_mfma_f32_32x32x16_bf16 v[100:115], v[84:87], a[80:83], v[100:115]
    buffer_load_dwordx4 a[144:147], v9, s[4:7], s32 offen offset:2048 sc1
    v_mfma_f32_32x32x16_bf16 v[116:131], v[92:95], a[80:83], v[116:131]
    v_mfma_f32_32x32x16_bf16 v[100:115], v[88:91], a[84:87], v[100:115]
    s_barrier
    ds_read_b128 v[52:55], v2 offset:49152
    ds_read_b128 v[56:59], v2 offset:50176
    ds_read_b128 v[60:63], v2 offset:51200
    ds_read_b128 v[64:67], v2 offset:52224
    v_mfma_f32_32x32x16_bf16 v[116:131], v[96:99], a[84:87], v[116:131]
    buffer_load_dwordx4 a[148:151], v9, s[4:7], s32 offen offset:2560 sc1
    s_waitcnt vmcnt(22) lgkmcnt(4)
    v_mfma_f32_32x32x16_bf16 v[100:115], v[36:39], a[88:91], v[100:115]
    buffer_load_dwordx4 a[152:155], v9, s[4:7], s32 offen offset:3072 sc1
    v_mfma_f32_32x32x16_bf16 v[116:131], v[44:47], a[88:91], v[116:131]
    v_mfma_f32_32x32x16_bf16 v[100:115], v[40:43], a[92:95], v[100:115]
    ds_read_b128 v[68:71], v2 offset:53248
    ds_read_b128 v[72:75], v2 offset:54272
    ds_read_b128 v[76:79], v2 offset:55296
    ds_read_b128 v[80:83], v2 offset:56320
    buffer_load_dwordx4 a[156:159], v9, s[4:7], s32 offen offset:3584 sc1
    v_mfma_f32_32x32x16_bf16 v[116:131], v[48:51], a[92:95], v[116:131]
    s_waitcnt vmcnt(22) lgkmcnt(4)
    v_mfma_f32_32x32x16_bf16 v[100:115], v[52:55], a[96:99], v[100:115]
    s_add_u32 m0, s22, 65536
    s_add_u32 s31, s27, 229376
    buffer_load_dwordx4 v1, s[4:7], s31 offen offset:0 lds
    v_mfma_f32_32x32x16_bf16 v[116:131], v[60:63], a[96:99], v[116:131]
    v_mfma_f32_32x32x16_bf16 v[100:115], v[56:59], a[100:103], v[100:115]
    ds_read_b128 v[84:87], v2 offset:57344
    ds_read_b128 v[88:91], v2 offset:58368
    ds_read_b128 v[92:95], v2 offset:59392
    ds_read_b128 v[96:99], v2 offset:60416
    buffer_load_dwordx4 v1, s[4:7], s31 offen offset:1024 lds
    v_mfma_f32_32x32x16_bf16 v[116:131], v[64:67], a[100:103], v[116:131]
    s_waitcnt vmcnt(22) lgkmcnt(4)
    v_mfma_f32_32x32x16_bf16 v[100:115], v[68:71], a[104:107], v[100:115]
    buffer_load_dwordx4 v1, s[4:7], s31 offen offset:2048 lds
    v_mfma_f32_32x32x16_bf16 v[116:131], v[76:79], a[104:107], v[116:131]
    v_mfma_f32_32x32x16_bf16 v[100:115], v[72:75], a[108:111], v[100:115]
    ds_read_b128 v[36:39], v2 offset:61440
    ds_read_b128 v[40:43], v2 offset:62464
    ds_read_b128 v[44:47], v2 offset:63488
    ds_read_b128 v[48:51], v2 offset:64512
    buffer_load_dwordx4 v1, s[4:7], s31 offen offset:3072 lds
    v_mfma_f32_32x32x16_bf16 v[116:131], v[80:83], a[108:111], v[116:131]
    s_add_u32 m0, s22, 81920
    s_add_u32 s31, s27, 245760
    buffer_load_dwordx4 v1, s[4:7], s31 offen offset:0 lds
    s_waitcnt vmcnt(15) lgkmcnt(4)
    v_mfma_f32_32x32x16_bf16 v[100:115], v[84:87], a[112:115], v[100:115]
    v_mfma_f32_32x32x16_bf16 v[116:131], v[92:95], a[112:115], v[116:131]
    buffer_load_dwordx4 v1, s[4:7], s31 offen offset:1024 lds
    v_mfma_f32_32x32x16_bf16 v[100:115], v[88:91], a[116:119], v[100:115]
    ds_read_b128 v[52:55], v3 offset:0
    ds_read_b128 v[56:59], v3 offset:1024
    ds_read_b128 v[60:63], v3 offset:2048
    ds_read_b128 v[64:67], v3 offset:3072
    v_mfma_f32_32x32x16_bf16 v[116:131], v[96:99], a[116:119], v[116:131]
    buffer_load_dwordx4 v1, s[4:7], s31 offen offset:2048 lds
    s_waitcnt vmcnt(15) lgkmcnt(4)
    v_mfma_f32_32x32x16_bf16 v[100:115], v[36:39], a[120:123], v[100:115]
    v_mfma_f32_32x32x16_bf16 v[116:131], v[44:47], a[120:123], v[116:131]
    buffer_load_dwordx4 v1, s[4:7], s31 offen offset:3072 lds
    v_mfma_f32_32x32x16_bf16 v[100:115], v[40:43], a[124:127], v[100:115]
    ds_read_b128 v[68:71], v3 offset:4096
    ds_read_b128 v[72:75], v3 offset:5120
    ds_read_b128 v[76:79], v3 offset:6144
    ds_read_b128 v[80:83], v3 offset:7168
    v_mfma_f32_32x32x16_bf16 v[116:131], v[48:51], a[124:127], v[116:131]
    s_waitcnt vmcnt(14) lgkmcnt(4)
    v_mfma_f32_32x32x16_bf16 v[100:115], v[52:55], a[128:131], v[100:115]
    v_mfma_f32_32x32x16_bf16 v[116:131], v[60:63], a[128:131], v[116:131]
    v_mfma_f32_32x32x16_bf16 v[100:115], v[56:59], a[132:135], v[100:115]
    ds_read_b128 v[84:87], v3 offset:8192
    ds_read_b128 v[88:91], v3 offset:9216
    ds_read_b128 v[92:95], v3 offset:10240
    ds_read_b128 v[96:99], v3 offset:11264
    v_mfma_f32_32x32x16_bf16 v[116:131], v[64:67], a[132:135], v[116:131]
    s_waitcnt vmcnt(12) lgkmcnt(4)
    v_mfma_f32_32x32x16_bf16 v[100:115], v[68:71], a[136:139], v[100:115]
    v_mfma_f32_32x32x16_bf16 v[116:131], v[76:79], a[136:139], v[116:131]
    v_mfma_f32_32x32x16_bf16 v[100:115], v[72:75], a[140:143], v[100:115]
    ds_read_b128 v[36:39], v3 offset:12288
    ds_read_b128 v[40:43], v3 offset:13312
    ds_read_b128 v[44:47], v3 offset:14336
    ds_read_b128 v[48:51], v3 offset:15360
    v_mfma_f32_32x32x16_bf16 v[116:131], v[80:83], a[140:143], v[116:131]
    s_waitcnt vmcnt(10) lgkmcnt(4)
    v_mfma_f32_32x32x16_bf16 v[100:115], v[84:87], a[144:147], v[100:115]
    v_mfma_f32_32x32x16_bf16 v[116:131], v[92:95], a[144:147], v[116:131]
    v_mfma_f32_32x32x16_bf16 v[100:115], v[88:91], a[148:151], v[100:115]
    s_barrier
    ds_read_b128 v[52:55], v1 offset:0
    ds_read_b128 v[56:59], v1 offset:1024
    ds_read_b128 v[60:63], v1 offset:2048
    ds_read_b128 v[64:67], v1 offset:3072
    v_mfma_f32_32x32x16_bf16 v[116:131], v[96:99], a[148:151], v[116:131]
    s_add_u32 m0, s22, 98304
    s_add_u32 s31, s27, 262144
    buffer_load_dwordx4 v1, s[4:7], s31 offen offset:0 lds
    s_waitcnt vmcnt(9) lgkmcnt(4)
    v_mfma_f32_32x32x16_bf16 v[100:115], v[36:39], a[152:155], v[100:115]
    buffer_load_dwordx4 v1, s[4:7], s31 offen offset:1024 lds
    v_mfma_f32_32x32x16_bf16 v[116:131], v[44:47], a[152:155], v[116:131]
    buffer_load_dwordx4 v1, s[4:7], s31 offen offset:2048 lds
    v_mfma_f32_32x32x16_bf16 v[100:115], v[40:43], a[156:159], v[100:115]
    ds_read_b128 v[68:71], v1 offset:4096
    ds_read_b128 v[72:75], v1 offset:5120
    ds_read_b128 v[76:79], v1 offset:6144
    ds_read_b128 v[80:83], v1 offset:7168
    buffer_load_dwordx4 v1, s[4:7], s31 offen offset:3072 lds
    v_mfma_f32_32x32x16_bf16 v[116:131], v[48:51], a[156:159], v[116:131]
    s_add_u32 m0, s24, 114688
    s_add_u32 s31, s30, 278528
    buffer_load_dwordx4 v1, s[4:7], s31 offen offset:0 lds
    s_waitcnt lgkmcnt(4)
    v_mfma_f32_32x32x16_bf16 v[132:147], v[52:55], a[80:83], v[132:147]
    buffer_load_dwordx4 v1, s[4:7], s31 offen offset:1024 lds
    v_mfma_f32_32x32x16_bf16 v[148:163], v[60:63], a[80:83], v[148:163]
    v_mfma_f32_32x32x16_bf16 v[132:147], v[56:59], a[84:87], v[132:147]
    ds_read_b128 v[84:87], v1 offset:8192
    ds_read_b128 v[88:91], v1 offset:9216
    ds_read_b128 v[92:95], v1 offset:10240
    ds_read_b128 v[96:99], v1 offset:11264
    ds_read_b128 v[226:229], v250 offset:16896
    ds_read_b128 v[230:233], v250 offset:16928
    v_mfma_f32_32x32x16_bf16 v[148:163], v[64:67], a[84:87], v[148:163]
    ds_read_b128 v[234:237], v250 offset:16960
    ds_read_b128 v[238:241], v250 offset:16992
    s_waitcnt lgkmcnt(0)
    v_fmac_f32 v100, v220, v226
    v_fmac_f32 v108, v220, v234
    v_fmac_f32 v101, v220, v227
    v_mfma_f32_32x32x16_bf16 v[132:147], v[68:71], a[88:91], v[132:147]
    v_fmac_f32 v109, v220, v235
    v_fmac_f32 v102, v220, v228
    v_fmac_f32 v110, v220, v236
    v_fmac_f32 v103, v220, v229
    v_fmac_f32 v111, v220, v237
    v_fmac_f32 v104, v220, v230
    v_mfma_f32_32x32x16_bf16 v[148:163], v[76:79], a[88:91], v[148:163]
    v_fmac_f32 v112, v220, v238
    v_fmac_f32 v105, v220, v231
    v_fmac_f32 v113, v220, v239
    v_fmac_f32 v106, v220, v232
    v_fmac_f32 v114, v220, v240
    v_fmac_f32 v107, v220, v233
    v_mfma_f32_32x32x16_bf16 v[132:147], v[72:75], a[92:95], v[132:147]
    ds_read_b128 v[36:39], v1 offset:12288
    ds_read_b128 v[40:43], v1 offset:13312
    ds_read_b128 v[44:47], v1 offset:14336
    ds_read_b128 v[48:51], v1 offset:15360
    v_fmac_f32 v115, v220, v241
    v_mul_f32 v242, v100, v221
    v_mfma_f32_32x32x16_bf16 v[148:163], v[80:83], a[92:95], v[148:163]
    v_mul_f32 v243, v101, v221
    v_mul_f32 v244, v102, v221
    v_mul_f32 v245, v103, v221
    v_exp_f32 v242, v242
    v_mfma_f32_32x32x16_bf16 v[132:147], v[84:87], a[96:99], v[132:147]
    v_exp_f32 v243, v243
    v_exp_f32 v244, v244
    v_exp_f32 v245, v245
    v_mfma_f32_32x32x16_bf16 v[148:163], v[92:95], a[96:99], v[148:163]
    v_mul_f32 v100, v100, v108
    v_mul_f32 v101, v101, v109
    v_mul_f32 v102, v102, v110
    v_mul_f32 v103, v103, v111
    v_fma_f32 v242, v242, v222, v222
    v_fma_f32 v243, v243, v222, v222
    v_mfma_f32_32x32x16_bf16 v[132:147], v[88:91], a[100:103], v[132:147]
    ds_read_b128 v[52:55], v1 offset:16384
    ds_read_b128 v[56:59], v1 offset:17408
    ds_read_b128 v[60:63], v1 offset:18432
    ds_read_b128 v[64:67], v1 offset:19456
    v_fma_f32 v244, v244, v222, v222
    v_fma_f32 v245, v245, v222, v222
    v_mfma_f32_32x32x16_bf16 v[148:163], v[96:99], a[100:103], v[148:163]
    v_rcp_f32 v242, v242
    v_rcp_f32 v243, v243
    s_waitcnt lgkmcnt(4)
    v_mfma_f32_32x32x16_bf16 v[132:147], v[36:39], a[104:107], v[132:147]
    v_rcp_f32 v244, v244
    v_rcp_f32 v245, v245
    v_mul_f32 v100, v100, v242
    v_mul_f32 v101, v101, v243
    v_mfma_f32_32x32x16_bf16 v[148:163], v[44:47], a[104:107], v[148:163]
    v_mul_f32 v102, v102, v244
    v_mul_f32 v103, v103, v245
    v_mul_f32 v246, v104, v221
    v_mul_f32 v247, v105, v221
    v_mul_f32 v248, v106, v221
    v_mul_f32 v249, v107, v221
    v_mfma_f32_32x32x16_bf16 v[132:147], v[40:43], a[108:111], v[132:147]
    ds_read_b128 v[68:71], v1 offset:20480
    ds_read_b128 v[72:75], v1 offset:21504
    ds_read_b128 v[76:79], v1 offset:22528
    ds_read_b128 v[80:83], v1 offset:23552
    v_exp_f32 v246, v246
    v_mfma_f32_32x32x16_bf16 v[148:163], v[48:51], a[108:111], v[148:163]
    v_exp_f32 v247, v247
    v_exp_f32 v248, v248
    s_waitcnt lgkmcnt(4)
    v_mfma_f32_32x32x16_bf16 v[132:147], v[52:55], a[112:115], v[132:147]
    v_exp_f32 v249, v249
    v_mul_f32 v104, v104, v112
    v_mul_f32 v105, v105, v113
    v_mul_f32 v106, v106, v114
    v_mul_f32 v107, v107, v115
    v_mfma_f32_32x32x16_bf16 v[148:163], v[60:63], a[112:115], v[148:163]
    v_fma_f32 v246, v246, v222, v222
    v_fma_f32 v247, v247, v222, v222
    v_fma_f32 v248, v248, v222, v222
    v_fma_f32 v249, v249, v222, v222
    v_rcp_f32 v246, v246
    v_mfma_f32_32x32x16_bf16 v[132:147], v[56:59], a[116:119], v[132:147]
    ds_read_b128 v[84:87], v1 offset:24576
    ds_read_b128 v[88:91], v1 offset:25600
    ds_read_b128 v[92:95], v1 offset:26624
    ds_read_b128 v[96:99], v1 offset:27648
    v_rcp_f32 v247, v247
    v_mfma_f32_32x32x16_bf16 v[148:163], v[64:67], a[116:119], v[148:163]
    v_rcp_f32 v248, v248
    v_rcp_f32 v249, v249
    v_mul_f32 v104, v104, v246
    s_waitcnt lgkmcnt(4)
    v_mfma_f32_32x32x16_bf16 v[132:147], v[68:71], a[120:123], v[132:147]
    v_mul_f32 v105, v105, v247
    v_mul_f32 v106, v106, v248
    v_mul_f32 v107, v107, v249
    v_cvt_pk_bf16_f32 v108, v100, v101
    v_cvt_pk_bf16_f32 v109, v102, v103
    v_cvt_pk_bf16_f32 v110, v104, v105
    v_mfma_f32_32x32x16_bf16 v[148:163], v[76:79], a[120:123], v[148:163]
    v_cvt_pk_bf16_f32 v111, v106, v107
    s_add_u32 s33, s63, 0
    buffer_store_dwordx4 v[108:111], v10, s[4:7], s33 offen sc1
    ds_read_b128 v[226:229], v250 offset:17024
    ds_read_b128 v[230:233], v250 offset:17056
    ds_read_b128 v[234:237], v250 offset:17088
    v_mfma_f32_32x32x16_bf16 v[132:147], v[72:75], a[124:127], v[132:147]
    ds_read_b128 v[36:39], v1 offset:28672
    ds_read_b128 v[40:43], v1 offset:29696
    ds_read_b128 v[44:47], v1 offset:30720
    ds_read_b128 v[48:51], v1 offset:31744
    ds_read_b128 v[238:241], v250 offset:17120
    s_waitcnt lgkmcnt(0)
    v_fmac_f32 v116, v220, v226
    v_mfma_f32_32x32x16_bf16 v[148:163], v[80:83], a[124:127], v[148:163]
    v_fmac_f32 v124, v220, v234
    v_fmac_f32 v117, v220, v227
    v_fmac_f32 v125, v220, v235
    v_fmac_f32 v118, v220, v228
    v_fmac_f32 v126, v220, v236
    v_mfma_f32_32x32x16_bf16 v[132:147], v[84:87], a[128:131], v[132:147]
    v_fmac_f32 v119, v220, v229
    v_fmac_f32 v127, v220, v237
    v_fmac_f32 v120, v220, v230
    v_fmac_f32 v128, v220, v238
    v_fmac_f32 v121, v220, v231
    v_fmac_f32 v129, v220, v239
    v_mfma_f32_32x32x16_bf16 v[148:163], v[92:95], a[128:131], v[148:163]
    v_fmac_f32 v122, v220, v232
    v_fmac_f32 v130, v220, v240
    v_fmac_f32 v123, v220, v233
    v_fmac_f32 v131, v220, v241
    v_mul_f32 v242, v116, v221
    v_mul_f32 v243, v117, v221
    v_mfma_f32_32x32x16_bf16 v[132:147], v[88:91], a[132:135], v[132:147]
    s_barrier
    ds_read_b128 v[52:55], v1 offset:32768
    ds_read_b128 v[56:59], v1 offset:33792
    ds_read_b128 v[60:63], v1 offset:34816
    ds_read_b128 v[64:67], v1 offset:35840
    v_mfma_f32_32x32x16_bf16 v[148:163], v[96:99], a[132:135], v[148:163]
    s_add_u32 m0, s22, 131072
    s_add_u32 s31, s28, 0
    buffer_load_dwordx4 v1, s[4:7], s31 offen offset:0 lds
    v_mul_f32 v244, v118, v221
    v_mul_f32 v245, v119, v221
    v_mfma_f32_32x32x16_bf16 v[132:147], v[36:39], a[136:139], v[132:147]
    buffer_load_dwordx4 v1, s[4:7], s31 offen offset:1024 lds
    v_exp_f32 v242, v242
    v_exp_f32 v243, v243
    v_mfma_f32_32x32x16_bf16 v[148:163], v[44:47], a[136:139], v[148:163]
    buffer_load_dwordx4 v1, s[4:7], s31 offen offset:2048 lds
    v_exp_f32 v244, v244
    v_exp_f32 v245, v245
    v_mul_f32 v116, v116, v124
    v_mfma_f32_32x32x16_bf16 v[132:147], v[40:43], a[140:143], v[132:147]
    ds_read_b128 v[68:71], v1 offset:36864
    ds_read_b128 v[72:75], v1 offset:37888
    ds_read_b128 v[76:79], v1 offset:38912
    ds_read_b128 v[80:83], v1 offset:39936
    buffer_load_dwordx4 v1, s[4:7], s31 offen offset:3072 lds
    v_mul_f32 v117, v117, v125
    v_mfma_f32_32x32x16_bf16 v[148:163], v[48:51], a[140:143], v[148:163]
    s_add_u32 m0, s22, 0
    s_add_u32 s31, s28, 16384
    buffer_load_dwordx4 v1, s[4:7], s31 offen offset:0 lds
    v_mul_f32 v118, v118, v126
    v_mul_f32 v119, v119, v127
    s_waitcnt lgkmcnt(4)
    v_mfma_f32_32x32x16_bf16 v[132:147], v[52:55], a[144:147], v[132:147]
    buffer_load_dwordx4 v1, s[4:7], s31 offen offset:1024 lds
    v_fma_f32 v242, v242, v222, v222
    v_fma_f32 v243, v243, v222, v222
    v_fma_f32 v244, v244, v222, v222
    v_fma_f32 v245, v245, v222, v222
    v_mfma_f32_32x32x16_bf16 v[148:163], v[60:63], a[144:147], v[148:163]
    buffer_load_dwordx4 v1, s[4:7], s31 offen offset:2048 lds
    v_rcp_f32 v242, v242
    v_rcp_f32 v243, v243
    v_mfma_f32_32x32x16_bf16 v[132:147], v[56:59], a[148:151], v[132:147]
    ds_read_b128 v[84:87], v1 offset:40960
    ds_read_b128 v[88:91], v1 offset:41984
    ds_read_b128 v[92:95], v1 offset:43008
    ds_read_b128 v[96:99], v1 offset:44032
    buffer_load_dwordx4 v1, s[4:7], s31 offen offset:3072 lds
    v_mfma_f32_32x32x16_bf16 v[148:163], v[64:67], a[148:151], v[148:163]
    v_rcp_f32 v244, v244
    v_rcp_f32 v245, v245
    v_mul_f32 v116, v116, v242
    s_waitcnt lgkmcnt(4)
    v_mfma_f32_32x32x16_bf16 v[132:147], v[68:71], a[152:155], v[132:147]
    v_mul_f32 v117, v117, v243
    v_mul_f32 v118, v118, v244
    v_mul_f32 v119, v119, v245
    v_mul_f32 v246, v120, v221
    v_mul_f32 v247, v121, v221
    v_mul_f32 v248, v122, v221
    v_mfma_f32_32x32x16_bf16 v[148:163], v[76:79], a[152:155], v[148:163]
    v_mul_f32 v249, v123, v221
    v_exp_f32 v246, v246
    v_exp_f32 v247, v247
    v_mfma_f32_32x32x16_bf16 v[132:147], v[72:75], a[156:159], v[132:147]
    ds_read_b128 v[36:39], v1 offset:45056
    ds_read_b128 v[40:43], v1 offset:46080
    ds_read_b128 v[44:47], v1 offset:47104
    ds_read_b128 v[48:51], v1 offset:48128
    v_exp_f32 v248, v248
    v_mfma_f32_32x32x16_bf16 v[148:163], v[80:83], a[156:159], v[148:163]
    v_exp_f32 v249, v249
    v_mul_f32 v120, v120, v128
    v_mul_f32 v121, v121, v129
    v_mul_f32 v122, v122, v130
    s_waitcnt lgkmcnt(4)
    v_mfma_f32_32x32x16_bf16 v[164:179], v[84:87], a[80:83], v[164:179]
    v_mul_f32 v123, v123, v131
    v_fma_f32 v246, v246, v222, v222
    v_fma_f32 v247, v247, v222, v222
    v_fma_f32 v248, v248, v222, v222
    v_fma_f32 v249, v249, v222, v222
    v_mfma_f32_32x32x16_bf16 v[180:195], v[92:95], a[80:83], v[180:195]
    v_rcp_f32 v246, v246
    v_rcp_f32 v247, v247
    v_rcp_f32 v248, v248
    v_mfma_f32_32x32x16_bf16 v[164:179], v[88:91], a[84:87], v[164:179]
    ds_read_b128 v[52:55], v1 offset:49152
    ds_read_b128 v[56:59], v1 offset:50176
    ds_read_b128 v[60:63], v1 offset:51200
    ds_read_b128 v[64:67], v1 offset:52224
    v_rcp_f32 v249, v249
    v_mfma_f32_32x32x16_bf16 v[180:195], v[96:99], a[84:87], v[180:195]
    v_mul_f32 v120, v120, v246
    v_mul_f32 v121, v121, v247
    v_mul_f32 v122, v122, v248
    v_mul_f32 v123, v123, v249
    v_cvt_pk_bf16_f32 v124, v116, v117
    s_waitcnt lgkmcnt(4)
    v_mfma_f32_32x32x16_bf16 v[164:179], v[36:39], a[88:91], v[164:179]
    v_cvt_pk_bf16_f32 v125, v118, v119
    v_cvt_pk_bf16_f32 v126, v120, v121
    v_cvt_pk_bf16_f32 v127, v122, v123
    s_add_u32 s33, s63, 512
    buffer_store_dwordx4 v[124:127], v10, s[4:7], s33 offen sc1
    ds_read_b128 v[226:229], v250 offset:17152
    v_mfma_f32_32x32x16_bf16 v[180:195], v[44:47], a[88:91], v[180:195]
    ds_read_b128 v[230:233], v250 offset:17184
    ds_read_b128 v[234:237], v250 offset:17216
    ds_read_b128 v[238:241], v250 offset:17248
    s_waitcnt lgkmcnt(0)
    v_fmac_f32 v132, v220, v226
    v_fmac_f32 v140, v220, v234
    v_fmac_f32 v133, v220, v227
    v_mfma_f32_32x32x16_bf16 v[164:179], v[40:43], a[92:95], v[164:179]
    ds_read_b128 v[68:71], v1 offset:53248
    ds_read_b128 v[72:75], v1 offset:54272
    ds_read_b128 v[76:79], v1 offset:55296
    ds_read_b128 v[80:83], v1 offset:56320
    v_fmac_f32 v141, v220, v235
    v_fmac_f32 v134, v220, v228
    v_mfma_f32_32x32x16_bf16 v[180:195], v[48:51], a[92:95], v[180:195]
    v_fmac_f32 v142, v220, v236
    v_fmac_f32 v135, v220, v229
    v_fmac_f32 v143, v220, v237
    v_fmac_f32 v136, v220, v230
    v_fmac_f32 v144, v220, v238
    v_mfma_f32_32x32x16_bf16 v[164:179], v[52:55], a[96:99], v[164:179]
    v_fmac_f32 v137, v220, v231
    v_fmac_f32 v145, v220, v239
    v_fmac_f32 v138, v220, v232
    v_fmac_f32 v146, v220, v240
    v_fmac_f32 v139, v220, v233
    v_fmac_f32 v147, v220, v241
    v_mfma_f32_32x32x16_bf16 v[180:195], v[60:63], a[96:99], v[180:195]
    v_mul_f32 v242, v132, v221
    v_mul_f32 v243, v133, v221
    v_mul_f32 v244, v134, v221
    v_mul_f32 v245, v135, v221
    v_exp_f32 v242, v242
    v_mfma_f32_32x32x16_bf16 v[164:179], v[56:59], a[100:103], v[164:179]
    ds_read_b128 v[84:87], v1 offset:57344
    ds_read_b128 v[88:91], v1 offset:58368
    ds_read_b128 v[92:95], v1 offset:59392
    ds_read_b128 v[96:99], v1 offset:60416
    v_exp_f32 v243, v243
    v_mfma_f32_32x32x16_bf16 v[180:195], v[64:67], a[100:103], v[180:195]
    v_exp_f32 v244, v244
    v_exp_f32 v245, v245
    v_mul_f32 v132, v132, v140
    s_waitcnt lgkmcnt(4)
    v_mfma_f32_32x32x16_bf16 v[164:179], v[68:71], a[104:107], v[164:179]
    v_mul_f32 v133, v133, v141
    v_mul_f32 v134, v134, v142
    v_mul_f32 v135, v135, v143
    v_fma_f32 v242, v242, v222, v222
    v_fma_f32 v243, v243, v222, v222
    v_fma_f32 v244, v244, v222, v222
    v_mfma_f32_32x32x16_bf16 v[180:195], v[76:79], a[104:107], v[180:195]
    v_fma_f32 v245, v245, v222, v222
    v_rcp_f32 v242, v242
    v_rcp_f32 v243, v243
    v_mfma_f32_32x32x16_bf16 v[164:179], v[72:75], a[108:111], v[164:179]
    ds_read_b128 v[36:39], v1 offset:61440
    ds_read_b128 v[40:43], v1 offset:62464
    ds_read_b128 v[44:47], v1 offset:63488
    ds_read_b128 v[48:51], v1 offset:64512
    v_rcp_f32 v244, v244
    v_mfma_f32_32x32x16_bf16 v[180:195], v[80:83], a[108:111], v[180:195]
    v_rcp_f32 v245, v245
    v_mul_f32 v132, v132, v242
    v_mul_f32 v133, v133, v243
    v_mul_f32 v134, v134, v244
    s_waitcnt lgkmcnt(4)
    v_mfma_f32_32x32x16_bf16 v[164:179], v[84:87], a[112:115], v[164:179]
    v_mul_f32 v135, v135, v245
    v_mul_f32 v246, v136, v221
    v_mul_f32 v247, v137, v221
    v_mul_f32 v248, v138, v221
    v_mul_f32 v249, v139, v221
    v_mfma_f32_32x32x16_bf16 v[180:195], v[92:95], a[112:115], v[180:195]
    v_exp_f32 v246, v246
    v_exp_f32 v247, v247
    v_exp_f32 v248, v248
    v_mfma_f32_32x32x16_bf16 v[164:179], v[88:91], a[116:119], v[164:179]
    s_waitcnt vmcnt(16)
    s_barrier
    ds_read_b128 v[52:55], v2 offset:0
    ds_read_b128 v[56:59], v2 offset:1024
    ds_read_b128 v[60:63], v2 offset:2048
    ds_read_b128 v[64:67], v2 offset:3072
    v_mfma_f32_32x32x16_bf16 v[180:195], v[96:99], a[116:119], v[180:195]
    s_add_u32 m0, s22, 16384
    s_add_u32 s31, s28, 32768
    buffer_load_dwordx4 v1, s[4:7], s31 offen offset:0 lds
    v_exp_f32 v249, v249
    s_waitcnt lgkmcnt(4)
    v_mfma_f32_32x32x16_bf16 v[164:179], v[36:39], a[120:123], v[164:179]
    buffer_load_dwordx4 v1, s[4:7], s31 offen offset:1024 lds
    v_mul_f32 v136, v136, v144
    v_mul_f32 v137, v137, v145
    v_mul_f32 v138, v138, v146
    v_mul_f32 v139, v139, v147
    v_fma_f32 v246, v246, v222, v222
    v_mfma_f32_32x32x16_bf16 v[180:195], v[44:47], a[120:123], v[180:195]
    buffer_load_dwordx4 v1, s[4:7], s31 offen offset:2048 lds
    v_fma_f32 v247, v247, v222, v222
    v_fma_f32 v248, v248, v222, v222
    v_fma_f32 v249, v249, v222, v222
    v_rcp_f32 v246, v246
    v_mfma_f32_32x32x16_bf16 v[164:179], v[40:43], a[124:127], v[164:179]
    ds_read_b128 v[68:71], v2 offset:4096
    ds_read_b128 v[72:75], v2 offset:5120
    ds_read_b128 v[76:79], v2 offset:6144
    ds_read_b128 v[80:83], v2 offset:7168
    buffer_load_dwordx4 v1, s[4:7], s31 offen offset:3072 lds
    v_mfma_f32_32x32x16_bf16 v[180:195], v[48:51], a[124:127], v[180:195]
    s_add_u32 m0, s22, 32768
    s_add_u32 s31, s28, 49152
    buffer_load_dwordx4 v1, s[4:7], s31 offen offset:0 lds
    v_rcp_f32 v247, v247
    s_waitcnt lgkmcnt(4)
    v_mfma_f32_32x32x16_bf16 v[164:179], v[52:55], a[128:131], v[164:179]
    buffer_load_dwordx4 v1, s[4:7], s31 offen offset:1024 lds
    v_rcp_f32 v248, v248
    v_rcp_f32 v249, v249
    v_mul_f32 v136, v136, v246
    v_mfma_f32_32x32x16_bf16 v[180:195], v[60:63], a[128:131], v[180:195]
    buffer_load_dwordx4 v1, s[4:7], s31 offen offset:2048 lds
    v_mul_f32 v137, v137, v247
    v_mul_f32 v138, v138, v248
    v_mul_f32 v139, v139, v249
    v_cvt_pk_bf16_f32 v140, v132, v133
    v_cvt_pk_bf16_f32 v141, v134, v135
    v_mfma_f32_32x32x16_bf16 v[164:179], v[56:59], a[132:135], v[164:179]
    ds_read_b128 v[84:87], v2 offset:8192
    ds_read_b128 v[88:91], v2 offset:9216
    ds_read_b128 v[92:95], v2 offset:10240
    ds_read_b128 v[96:99], v2 offset:11264
    buffer_load_dwordx4 v1, s[4:7], s31 offen offset:3072 lds
    v_cvt_pk_bf16_f32 v142, v136, v137
    v_mfma_f32_32x32x16_bf16 v[180:195], v[64:67], a[132:135], v[180:195]
    v_cvt_pk_bf16_f32 v143, v138, v139
    s_add_u32 s33, s63, 16384
    buffer_store_dwordx4 v[140:143], v10, s[4:7], s33 offen sc1
    ds_read_b128 v[226:229], v250 offset:17280
    ds_read_b128 v[230:233], v250 offset:17312
    s_waitcnt lgkmcnt(6)
    v_mfma_f32_32x32x16_bf16 v[164:179], v[68:71], a[136:139], v[164:179]
    ds_read_b128 v[234:237], v250 offset:17344
    ds_read_b128 v[238:241], v250 offset:17376
    s_waitcnt lgkmcnt(0)
    v_fmac_f32 v148, v220, v226
    v_fmac_f32 v156, v220, v234
    v_fmac_f32 v149, v220, v227
    v_fmac_f32 v157, v220, v235
    v_mfma_f32_32x32x16_bf16 v[180:195], v[76:79], a[136:139], v[180:195]
    v_fmac_f32 v150, v220, v228
    v_fmac_f32 v158, v220, v236
    v_fmac_f32 v151, v220, v229
    v_fmac_f32 v159, v220, v237
    v_fmac_f32 v152, v220, v230
    v_fmac_f32 v160, v220, v238
    v_mfma_f32_32x32x16_bf16 v[164:179], v[72:75], a[140:143], v[164:179]
    ds_read_b128 v[36:39], v2 offset:12288
    ds_read_b128 v[40:43], v2 offset:13312
    ds_read_b128 v[44:47], v2 offset:14336
    ds_read_b128 v[48:51], v2 offset:15360
    v_fmac_f32 v153, v220, v231
    v_fmac_f32 v161, v220, v239
    v_mfma_f32_32x32x16_bf16 v[180:195], v[80:83], a[140:143], v[180:195]
    v_fmac_f32 v154, v220, v232
    v_fmac_f32 v162, v220, v240
    v_fmac_f32 v155, v220, v233
    v_fmac_f32 v163, v220, v241
    v_mul_f32 v242, v148, v221
    v_mfma_f32_32x32x16_bf16 v[164:179], v[84:87], a[144:147], v[164:179]
    v_mul_f32 v243, v149, v221
    v_mul_f32 v244, v150, v221
    v_mul_f32 v245, v151, v221
    v_exp_f32 v242, v242
    s_mul_i32 s88, s18, 3
    v_mfma_f32_32x32x16_bf16 v[180:195], v[92:95], a[144:147], v[180:195]
    v_exp_f32 v243, v243
    v_exp_f32 v244, v244
    v_exp_f32 v245, v245
    v_mfma_f32_32x32x16_bf16 v[164:179], v[88:91], a[148:151], v[164:179]
    ds_read_b128 v[52:55], v2 offset:16384
    ds_read_b128 v[56:59], v2 offset:17408
    v_mul_f32 v148, v148, v156
    v_mul_f32 v149, v149, v157
    v_mul_f32 v150, v150, v158
    v_mul_f32 v151, v151, v159
    v_mfma_f32_32x32x16_bf16 v[180:195], v[96:99], a[148:151], v[180:195]
    v_fma_f32 v242, v242, v222, v222
    v_fma_f32 v243, v243, v222, v222
    v_fma_f32 v244, v244, v222, v222
    v_fma_f32 v245, v245, v222, v222
    s_add_u32 s88, s88, 2
    s_waitcnt lgkmcnt(2)
    v_mfma_f32_32x32x16_bf16 v[164:179], v[36:39], a[152:155], v[164:179]
    ds_read_b128 v[60:63], v2 offset:18432
    ds_read_b128 v[64:67], v2 offset:19456
    v_rcp_f32 v242, v242
    v_rcp_f32 v243, v243
    v_mfma_f32_32x32x16_bf16 v[180:195], v[44:47], a[152:155], v[180:195]
    v_rcp_f32 v244, v244
    v_rcp_f32 v245, v245
    v_mul_f32 v148, v148, v242
    v_mul_f32 v149, v149, v243
    v_mfma_f32_32x32x16_bf16 v[164:179], v[40:43], a[156:159], v[164:179]
    ds_read_b128 v[68:71], v2 offset:20480
    ds_read_b128 v[72:75], v2 offset:21504
    v_mul_f32 v150, v150, v244
    v_mul_f32 v151, v151, v245
    v_mul_f32 v246, v152, v221
    v_mul_f32 v247, v153, v221
    v_mfma_f32_32x32x16_bf16 v[180:195], v[48:51], a[156:159], v[180:195]
    v_mul_f32 v248, v154, v221
    v_mul_f32 v249, v155, v221
    v_exp_f32 v246, v246
    s_lshr_b32 s89, s88, 3
    s_waitcnt lgkmcnt(4)
    v_mfma_f32_32x32x16_bf16 v[196:211], v[52:55], a[0:3], 0
    ds_read_b128 v[76:79], v2 offset:22528
    ds_read_b128 v[80:83], v2 offset:23552
    v_exp_f32 v247, v247
    v_exp_f32 v248, v248
    v_mfma_f32_32x32x16_bf16 v[196:211], v[56:59], a[4:7], v[196:211]
    v_exp_f32 v249, v249
    v_mul_f32 v152, v152, v160
    v_mul_f32 v153, v153, v161
    v_mul_f32 v154, v154, v162
    s_waitcnt lgkmcnt(4)
    v_mfma_f32_32x32x16_bf16 v[196:211], v[60:63], a[8:11], v[196:211]
    ds_read_b128 v[84:87], v2 offset:24576
    ds_read_b128 v[88:91], v2 offset:25600
    v_mul_f32 v155, v155, v163
    v_fma_f32 v246, v246, v222, v222
    v_fma_f32 v247, v247, v222, v222
    v_fma_f32 v248, v248, v222, v222
    v_mfma_f32_32x32x16_bf16 v[196:211], v[64:67], a[12:15], v[196:211]
    v_fma_f32 v249, v249, v222, v222
    v_rcp_f32 v246, v246
    v_rcp_f32 v247, v247
    s_waitcnt lgkmcnt(4)
    v_mfma_f32_32x32x16_bf16 v[196:211], v[68:71], a[16:19], v[196:211]
    ds_read_b128 v[92:95], v2 offset:26624
    ds_read_b128 v[96:99], v2 offset:27648
    v_rcp_f32 v248, v248
    v_rcp_f32 v249, v249
    v_mfma_f32_32x32x16_bf16 v[196:211], v[72:75], a[20:23], v[196:211]
    v_mul_f32 v152, v152, v246
    v_mul_f32 v153, v153, v247
    v_mul_f32 v154, v154, v248
    v_mul_f32 v155, v155, v249
    v_cvt_pk_bf16_f32 v156, v148, v149
    s_waitcnt lgkmcnt(4)
    v_mfma_f32_32x32x16_bf16 v[196:211], v[76:79], a[24:27], v[196:211]
    ds_read_b128 v[36:39], v2 offset:28672
    ds_read_b128 v[40:43], v2 offset:29696
    v_cvt_pk_bf16_f32 v157, v150, v151
    v_cvt_pk_bf16_f32 v158, v152, v153
    v_cvt_pk_bf16_f32 v159, v154, v155
    s_add_u32 s33, s63, 16896
    v_mfma_f32_32x32x16_bf16 v[196:211], v[80:83], a[28:31], v[196:211]
    buffer_store_dwordx4 v[156:159], v10, s[4:7], s33 offen sc1
    ds_read_b128 v[226:229], v250 offset:17408
    ds_read_b128 v[230:233], v250 offset:17440
    ds_read_b128 v[234:237], v250 offset:17472
    ds_read_b128 v[238:241], v250 offset:17504
    s_waitcnt lgkmcnt(8)
    v_mfma_f32_32x32x16_bf16 v[196:211], v[84:87], a[32:35], v[196:211]
    ds_read_b128 v[44:47], v2 offset:30720
    ds_read_b128 v[48:51], v2 offset:31744
    s_waitcnt lgkmcnt(2)
    v_fmac_f32 v164, v220, v226
    v_fmac_f32 v172, v220, v234
    v_fmac_f32 v165, v220, v227
    v_fmac_f32 v173, v220, v235
    v_mfma_f32_32x32x16_bf16 v[196:211], v[88:91], a[36:39], v[196:211]
    v_fmac_f32 v166, v220, v228
    v_fmac_f32 v174, v220, v236
    v_fmac_f32 v167, v220, v229
    v_fmac_f32 v175, v220, v237
    v_fmac_f32 v168, v220, v230
    v_mfma_f32_32x32x16_bf16 v[196:211], v[92:95], a[40:43], v[196:211]
    s_waitcnt vmcnt(20)
    s_barrier
    ds_read_b128 v[52:55], v2 offset:32768
    ds_read_b128 v[56:59], v2 offset:33792
    v_fmac_f32 v176, v220, v238
    v_fmac_f32 v169, v220, v231
    v_mfma_f32_32x32x16_bf16 v[196:211], v[96:99], a[44:47], v[196:211]
    s_add_u32 m0, s22, 49152
    s_add_u32 s31, s28, 65536
    buffer_load_dwordx4 v1, s[4:7], s31 offen offset:0 lds
    v_fmac_f32 v177, v220, v239
    v_fmac_f32 v170, v220, v232
    v_mfma_f32_32x32x16_bf16 v[196:211], v[36:39], a[48:51], v[196:211]
    ds_read_b128 v[60:63], v2 offset:34816
    ds_read_b128 v[64:67], v2 offset:35840
    buffer_load_dwordx4 v1, s[4:7], s31 offen offset:1024 lds
    v_fmac_f32 v178, v220, v240
    v_fmac_f32 v171, v220, v233
    v_fmac_f32 v179, v220, v241
    v_mfma_f32_32x32x16_bf16 v[196:211], v[40:43], a[52:55], v[196:211]
    buffer_load_dwordx4 v1, s[4:7], s31 offen offset:2048 lds
    v_mul_f32 v242, v164, v221
    v_mul_f32 v243, v165, v221
    v_mul_f32 v244, v166, v221
    v_mul_f32 v245, v167, v221
    s_waitcnt lgkmcnt(4)
    v_mfma_f32_32x32x16_bf16 v[196:211], v[44:47], a[56:59], v[196:211]
    ds_read_b128 v[68:71], v2 offset:36864
    ds_read_b128 v[72:75], v2 offset:37888
    buffer_load_dwordx4 v1, s[4:7], s31 offen offset:3072 lds
    v_exp_f32 v242, v242
    s_add_u32 s89, s89, 48
    v_mfma_f32_32x32x16_bf16 v[196:211], v[48:51], a[60:63], v[196:211]
    s_add_u32 m0, s22, 65536
    s_add_u32 s31, s28, 81920
    buffer_load_dwordx4 v1, s[4:7], s31 offen offset:0 lds
    v_exp_f32 v243, v243
    s_waitcnt lgkmcnt(4)
    v_mfma_f32_32x32x16_bf16 v[196:211], v[52:55], a[64:67], v[196:211]
    ds_read_b128 v[76:79], v2 offset:38912
    ds_read_b128 v[80:83], v2 offset:39936
    buffer_load_dwordx4 v1, s[4:7], s31 offen offset:1024 lds
    v_exp_f32 v244, v244
    s_lshl_b32 s89, s89, 10
    v_mfma_f32_32x32x16_bf16 v[196:211], v[56:59], a[68:71], v[196:211]
    buffer_load_dwordx4 v1, s[4:7], s31 offen offset:2048 lds
    v_exp_f32 v245, v245
    v_mul_f32 v164, v164, v172
    v_mul_f32 v165, v165, v173
    s_waitcnt lgkmcnt(4)
    v_mfma_f32_32x32x16_bf16 v[196:211], v[60:63], a[72:75], v[196:211]
    ds_read_b128 v[84:87], v2 offset:40960
    ds_read_b128 v[88:91], v2 offset:41984
    buffer_load_dwordx4 v1, s[4:7], s31 offen offset:3072 lds
    v_mul_f32 v166, v166, v174
    v_mul_f32 v167, v167, v175
    v_fma_f32 v242, v242, v222, v222
    v_mfma_f32_32x32x16_bf16 v[196:211], v[64:67], a[76:79], v[196:211]
    v_fma_f32 v243, v243, v222, v222
    v_fma_f32 v244, v244, v222, v222
    v_fma_f32 v245, v245, v222, v222
    v_rcp_f32 v242, v242
    s_waitcnt lgkmcnt(4)
    v_mfma_f32_32x32x16_bf16 v[196:211], v[68:71], a[80:83], v[196:211]
    ds_read_b128 v[92:95], v2 offset:43008
    ds_read_b128 v[96:99], v2 offset:44032
    v_rcp_f32 v243, v243
    v_rcp_f32 v244, v244
    v_mfma_f32_32x32x16_bf16 v[196:211], v[72:75], a[84:87], v[196:211]
    v_rcp_f32 v245, v245
    v_mul_f32 v164, v164, v242
    v_mul_f32 v165, v165, v243
    v_mul_f32 v166, v166, v244
    s_waitcnt lgkmcnt(4)
    v_mfma_f32_32x32x16_bf16 v[196:211], v[76:79], a[88:91], v[196:211]
    ds_read_b128 v[36:39], v2 offset:45056
    ds_read_b128 v[40:43], v2 offset:46080
    v_mul_f32 v167, v167, v245
    v_mul_f32 v246, v168, v221
    v_mul_f32 v247, v169, v221
    v_mul_f32 v248, v170, v221
    v_mfma_f32_32x32x16_bf16 v[196:211], v[80:83], a[92:95], v[196:211]
    v_mul_f32 v249, v171, v221
    v_exp_f32 v246, v246
    v_exp_f32 v247, v247
    s_waitcnt lgkmcnt(4)
    v_mfma_f32_32x32x16_bf16 v[196:211], v[84:87], a[96:99], v[196:211]
    ds_read_b128 v[44:47], v2 offset:47104
    ds_read_b128 v[48:51], v2 offset:48128
    v_exp_f32 v248, v248
    v_exp_f32 v249, v249
    v_mfma_f32_32x32x16_bf16 v[196:211], v[88:91], a[100:103], v[196:211]
    v_mul_f32 v168, v168, v176
    v_mul_f32 v169, v169, v177
    v_mul_f32 v170, v170, v178
    v_mul_f32 v171, v171, v179
    v_fma_f32 v246, v246, v222, v222
    s_waitcnt lgkmcnt(4)
    v_mfma_f32_32x32x16_bf16 v[196:211], v[92:95], a[104:107], v[196:211]
    ds_read_b128 v[52:55], v2 offset:49152
    ds_read_b128 v[56:59], v2 offset:50176
    v_fma_f32 v247, v247, v222, v222
    v_fma_f32 v248, v248, v222, v222
    v_fma_f32 v249, v249, v222, v222
    s_add_u32 s90, s62, s89
    v_mfma_f32_32x32x16_bf16 v[196:211], v[96:99], a[108:111], v[196:211]
    v_rcp_f32 v246, v246
    v_rcp_f32 v247, v247
    s_and_b32 s89, s88, 3
    s_waitcnt lgkmcnt(4)
    v_mfma_f32_32x32x16_bf16 v[196:211], v[36:39], a[112:115], v[196:211]
    ds_read_b128 v[60:63], v2 offset:51200
    ds_read_b128 v[64:67], v2 offset:52224
    v_rcp_f32 v248, v248
    v_rcp_f32 v249, v249
    v_mfma_f32_32x32x16_bf16 v[196:211], v[40:43], a[116:119], v[196:211]
    v_mul_f32 v168, v168, v246
    v_mul_f32 v169, v169, v247
    v_mul_f32 v170, v170, v248
    v_mul_f32 v171, v171, v249
    v_cvt_pk_bf16_f32 v172, v164, v165
    s_waitcnt lgkmcnt(4)
    v_mfma_f32_32x32x16_bf16 v[196:211], v[44:47], a[120:123], v[196:211]
    ds_read_b128 v[68:71], v2 offset:53248
    ds_read_b128 v[72:75], v2 offset:54272
    v_cvt_pk_bf16_f32 v173, v166, v167
    v_cvt_pk_bf16_f32 v174, v168, v169
    v_cvt_pk_bf16_f32 v175, v170, v171
    s_add_u32 s33, s63, 32768
    v_mfma_f32_32x32x16_bf16 v[196:211], v[48:51], a[124:127], v[196:211]
    buffer_store_dwordx4 v[172:175], v10, s[4:7], s33 offen sc1
    ds_read_b128 v[226:229], v250 offset:17536
    ds_read_b128 v[230:233], v250 offset:17568
    ds_read_b128 v[234:237], v250 offset:17600
    ds_read_b128 v[238:241], v250 offset:17632
    s_waitcnt lgkmcnt(8)
    v_mfma_f32_32x32x16_bf16 v[196:211], v[52:55], a[128:131], v[196:211]
    ds_read_b128 v[76:79], v2 offset:55296
    ds_read_b128 v[80:83], v2 offset:56320
    s_waitcnt lgkmcnt(2)
    v_fmac_f32 v180, v220, v226
    v_fmac_f32 v188, v220, v234
    v_fmac_f32 v181, v220, v227
    v_fmac_f32 v189, v220, v235
    v_mfma_f32_32x32x16_bf16 v[196:211], v[56:59], a[132:135], v[196:211]
    v_fmac_f32 v182, v220, v228
    v_fmac_f32 v190, v220, v236
    v_fmac_f32 v183, v220, v229
    v_fmac_f32 v191, v220, v237
    v_fmac_f32 v184, v220, v230
    v_mfma_f32_32x32x16_bf16 v[196:211], v[60:63], a[136:139], v[196:211]
    v_fmac_f32 v192, v220, v238
    v_fmac_f32 v185, v220, v231
    v_fmac_f32 v193, v220, v239
    v_fmac_f32 v186, v220, v232
    v_fmac_f32 v194, v220, v240
    v_fmac_f32 v187, v220, v233
    v_mfma_f32_32x32x16_bf16 v[196:211], v[64:67], a[140:143], v[196:211]
    v_fmac_f32 v195, v220, v241
    v_mul_f32 v242, v180, v221
    v_mul_f32 v243, v181, v221
    v_mul_f32 v244, v182, v221
    v_mul_f32 v245, v183, v221
    v_mfma_f32_32x32x16_bf16 v[196:211], v[68:71], a[144:147], v[196:211]
    v_exp_f32 v242, v242
    v_exp_f32 v243, v243
    v_exp_f32 v244, v244
    v_mfma_f32_32x32x16_bf16 v[196:211], v[72:75], a[148:151], v[196:211]
    v_exp_f32 v245, v245
    v_mul_f32 v180, v180, v188
    v_mul_f32 v181, v181, v189
    v_mul_f32 v182, v182, v190
    s_waitcnt lgkmcnt(0)
    v_mfma_f32_32x32x16_bf16 v[196:211], v[76:79], a[152:155], v[196:211]
    v_mul_f32 v183, v183, v191
    v_fma_f32 v242, v242, v222, v222
    v_fma_f32 v243, v243, v222, v222
    v_fma_f32 v244, v244, v222, v222
    v_fma_f32 v245, v245, v222, v222
    s_lshl_b32 s89, s89, 8
    v_mfma_f32_32x32x16_bf16 v[196:211], v[80:83], a[156:159], v[196:211]
    v_rcp_f32 v242, v242
    v_rcp_f32 v243, v243
    v_rcp_f32 v244, v244
    v_rcp_f32 v245, v245
    v_mul_f32 v180, v180, v242
    v_mul_f32 v181, v181, v243
    v_mul_f32 v182, v182, v244
    v_mul_f32 v183, v183, v245
    v_mul_f32 v246, v184, v221
    v_mul_f32 v247, v185, v221
    v_mul_f32 v248, v186, v221
    v_mul_f32 v249, v187, v221
    v_exp_f32 v246, v246
    v_exp_f32 v247, v247
    v_exp_f32 v248, v248
    v_exp_f32 v249, v249
    v_mul_f32 v184, v184, v192
    v_mul_f32 v185, v185, v193
    v_mul_f32 v186, v186, v194
    v_mul_f32 v187, v187, v195
    v_fma_f32 v246, v246, v222, v222
    v_fma_f32 v247, v247, v222, v222
    v_fma_f32 v248, v248, v222, v222
    v_fma_f32 v249, v249, v222, v222
    v_rcp_f32 v246, v246
    v_rcp_f32 v247, v247
    v_rcp_f32 v248, v248
    v_rcp_f32 v249, v249
    v_mul_f32 v184, v184, v246
    v_mul_f32 v185, v185, v247
    v_mul_f32 v186, v186, v248
    v_mul_f32 v187, v187, v249
    v_cvt_pk_bf16_f32 v188, v180, v181
    v_cvt_pk_bf16_f32 v189, v182, v183
    v_cvt_pk_bf16_f32 v190, v184, v185
    v_cvt_pk_bf16_f32 v191, v186, v187
    s_add_u32 s33, s63, 33280
    buffer_store_dwordx4 v[188:191], v10, s[4:7], s33 offen sc1
    s_add_u32 s90, s90, s89
    s_bfe_u32 s89, s88, 0x10002
    s_lshl_b32 s89, s89, 3
    s_add_u32 s90, s90, s89
    ds_read_b128 v[226:229], v250 offset:17664
    ds_read_b128 v[230:233], v250 offset:17696
    ds_read_b128 v[234:237], v250 offset:17728
    ds_read_b128 v[238:241], v250 offset:17760
    s_waitcnt lgkmcnt(0)
    v_fmac_f32 v196, v220, v226
    v_fmac_f32 v204, v220, v234
    v_fmac_f32 v197, v220, v227
    v_fmac_f32 v205, v220, v235
    v_fmac_f32 v198, v220, v228
    v_fmac_f32 v206, v220, v236
    v_fmac_f32 v199, v220, v229
    v_fmac_f32 v207, v220, v237
    v_fmac_f32 v200, v220, v230
    v_fmac_f32 v208, v220, v238
    v_fmac_f32 v201, v220, v231
    v_fmac_f32 v209, v220, v239
    v_fmac_f32 v202, v220, v232
    v_fmac_f32 v210, v220, v240
    v_fmac_f32 v203, v220, v233
    v_fmac_f32 v211, v220, v241
    v_mul_f32 v242, v196, v221
    v_mul_f32 v243, v197, v221
    v_mul_f32 v244, v198, v221
    v_mul_f32 v245, v199, v221
    v_exp_f32 v242, v242
    v_exp_f32 v243, v243
    v_exp_f32 v244, v244
    v_exp_f32 v245, v245
    v_mul_f32 v196, v196, v204
    v_mul_f32 v197, v197, v205
    v_mul_f32 v198, v198, v206
    v_mul_f32 v199, v199, v207
    v_fma_f32 v242, v242, v222, v222
    v_fma_f32 v243, v243, v222, v222
    v_fma_f32 v244, v244, v222, v222
    v_fma_f32 v245, v245, v222, v222
    v_rcp_f32 v242, v242
    v_rcp_f32 v243, v243
    v_rcp_f32 v244, v244
    v_rcp_f32 v245, v245
    v_mul_f32 v196, v196, v242
    v_mul_f32 v197, v197, v243
    v_mul_f32 v198, v198, v244
    v_mul_f32 v199, v199, v245
    v_mul_f32 v246, v200, v221
    v_mul_f32 v247, v201, v221
    v_mul_f32 v248, v202, v221
    v_mul_f32 v249, v203, v221
    v_exp_f32 v246, v246
    v_exp_f32 v247, v247
    v_exp_f32 v248, v248
    v_exp_f32 v249, v249
    v_mul_f32 v200, v200, v208
    v_mul_f32 v201, v201, v209
    v_mul_f32 v202, v202, v210
    v_mul_f32 v203, v203, v211
    v_fma_f32 v246, v246, v222, v222
    v_fma_f32 v247, v247, v222, v222
    v_fma_f32 v248, v248, v222, v222
    v_fma_f32 v249, v249, v222, v222
    v_rcp_f32 v246, v246
    v_rcp_f32 v247, v247
    v_rcp_f32 v248, v248
    v_rcp_f32 v249, v249
    v_mul_f32 v200, v200, v246
    v_mul_f32 v201, v201, v247
    v_mul_f32 v202, v202, v248
    v_mul_f32 v203, v203, v249
    v_cvt_pk_bf16_f32 v204, v196, v197
    v_cvt_pk_bf16_f32 v205, v198, v199
    v_cvt_pk_bf16_f32 v206, v200, v201
    v_cvt_pk_bf16_f32 v207, v202, v203
    buffer_store_dwordx2 v[204:205], v13, s[4:7], s62 offen
    s_mov_b64 exec, s[74:75]
    buffer_store_dwordx2 v[206:207], v10, s[4:7], s90 offen
    s_mov_b64 exec, -1
    s_cmp_lg_u32 s16, 0
    s_cbranch_scc1 Lt6_a
    s_waitcnt vmcnt(0)
    s_branch Lt6_b
Lt6_a:
    s_waitcnt vmcnt(0)
Lt6_b:
    s_barrier
    s_add_u32 s33, s41, 4
    v_mov_b32 v254, s33
    v_mov_b32 v255, 0
    s_mov_b64 exec, s[44:45]
    buffer_store_dword v254, v255, s[4:7], s37 offen
    s_mov_b64 exec, -1
    s_cmp_lg_u32 s16, 0
    s_cbranch_scc1 Lt6_c
    s_add_u32 s33, s41, 4
    s_mov_b32 s47, 0
    v_subrev_u32 v252, 0x20000, v5
Lt6_p:
    buffer_load_dword v253, v252, s[4:7], s38 offen sc1
    s_waitcnt vmcnt(0)
    v_cmp_gt_u32 vcc, s33, v253
    s_add_u32 s47, s47, 1
    s_cmp_gt_u32 s47, 20000
    s_cbranch_scc1 Lt6_p_x
    s_nop 1
    s_cbranch_vccnz Lt6_p
Lt6_p_x:
    s_add_u32 m0, s22, 81920
    s_add_u32 s31, s28, 98304
    buffer_load_dwordx4 v1, s[4:7], s31 offen offset:0 lds
    buffer_load_dwordx4 v1, s[4:7], s31 offen offset:1024 lds
    buffer_load_dwordx4 v1, s[4:7], s31 offen offset:2048 lds
    buffer_load_dwordx4 v1, s[4:7], s31 offen offset:3072 lds
    s_branch Lt6_o
Lt6_c:
    s_add_u32 m0, s22, 81920
    s_add_u32 s31, s28, 98304
    buffer_load_dwordx4 v1, s[4:7], s31 offen offset:0 lds
    buffer_load_dwordx4 v1, s[4:7], s31 offen offset:1024 lds
    buffer_load_dwordx4 v1, s[4:7], s31 offen offset:2048 lds
    buffer_load_dwordx4 v1, s[4:7], s31 offen offset:3072 lds
Lt6_o:
    s_barrier
    s_mul_i32 s32, 0, 7077888
    s_mul_i32 s33, s43, 55296
    s_add_u32 s32, s32, s33
    s_add_u32 s32, s32, 20971520
    ds_read_b128 v[84:87], v3 offset:0
    ds_read_b128 v[88:91], v3 offset:1024
    ds_read_b128 v[92:95], v3 offset:2048
    ds_read_b128 v[96:99], v3 offset:3072
    ds_read_b128 v[36:39], v3 offset:4096
    buffer_load_dwordx4 a[0:3], v1, s[4:7], s32 offen offset:0 sc1
    buffer_load_dwordx4 a[4:7], v1, s[4:7], s32 offen offset:1024 sc1
    buffer_load_dwordx4 a[8:11], v1, s[4:7], s32 offen offset:2048 sc1
    buffer_load_dwordx4 a[12:15], v1, s[4:7], s32 offen offset:3072 sc1
    s_add_u32 s32, s32, 4096
    buffer_load_dwordx4 a[16:19], v1, s[4:7], s32 offen offset:0 sc1
    buffer_load_dwordx4 a[20:23], v1, s[4:7], s32 offen offset:1024 sc1
    buffer_load_dwordx4 a[24:27], v1, s[4:7], s32 offen offset:2048 sc1
    buffer_load_dwordx4 a[28:31], v1, s[4:7], s32 offen offset:3072 sc1
    s_add_u32 s32, s32, 4096
    buffer_load_dwordx4 a[32:35], v1, s[4:7], s32 offen offset:0 sc1
    s_add_u32 m0, s22, 98304
    s_add_u32 s31, s28, 114688
    buffer_load_dwordx4 v1, s[4:7], s31 offen offset:0 lds
    buffer_load_dwordx4 v1, s[4:7], s31 offen offset:1024 lds
    buffer_load_dwordx4 v1, s[4:7], s31 offen offset:2048 lds
    buffer_load_dwordx4 v1, s[4:7], s31 offen offset:3072 lds
    s_waitcnt vmcnt(12) lgkmcnt(0)
    v_mfma_f32_16x16x32_bf16 v[16:19], v[84:87], a[0:3], v[16:19]
    ds_read_b128 v[40:43], v3 offset:5120
    ds_read_b128 v[44:47], v3 offset:6144
    v_mfma_f32_16x16x32_bf16 v[20:23], v[88:91], a[0:3], v[20:23]
    ds_read_b128 v[48:51], v3 offset:7168
    ds_read_b128 v[52:55], v3 offset:8192
    v_mfma_f32_16x16x32_bf16 v[24:27], v[92:95], a[0:3], v[24:27]
    ds_read_b128 v[56:59], v3 offset:9216
    ds_read_b128 v[60:63], v3 offset:10240
    v_mfma_f32_16x16x32_bf16 v[28:31], v[96:99], a[0:3], v[28:31]
    ds_read_b128 v[64:67], v3 offset:11264
    ds_read_b128 v[68:71], v3 offset:12288
    v_mfma_f32_16x16x32_bf16 v[32:35], v[36:39], a[0:3], v[32:35]
    ds_read_b128 v[72:75], v3 offset:13312
    s_waitcnt vmcnt(11) lgkmcnt(4)
    v_mfma_f32_16x16x32_bf16 v[16:19], v[40:43], a[4:7], v[16:19]
    ds_read_b128 v[76:79], v3 offset:14336
    ds_read_b128 v[80:83], v3 offset:15360
    v_mfma_f32_16x16x32_bf16 v[20:23], v[44:47], a[4:7], v[20:23]
    ds_read_b128 v[84:87], v1 offset:0
    ds_read_b128 v[88:91], v1 offset:1024
    v_mfma_f32_16x16x32_bf16 v[24:27], v[48:51], a[4:7], v[24:27]
    ds_read_b128 v[92:95], v1 offset:2048
    buffer_load_dwordx4 a[36:39], v1, s[4:7], s32 offen offset:1024 sc1
    v_mfma_f32_16x16x32_bf16 v[28:31], v[52:55], a[4:7], v[28:31]
    ds_read_b128 v[96:99], v1 offset:3072
    buffer_load_dwordx4 a[40:43], v1, s[4:7], s32 offen offset:2048 sc1
    v_mfma_f32_16x16x32_bf16 v[32:35], v[56:59], a[4:7], v[32:35]
    ds_read_b128 v[36:39], v1 offset:4096
    s_waitcnt vmcnt(12) lgkmcnt(6)
    v_mfma_f32_16x16x32_bf16 v[16:19], v[60:63], a[8:11], v[16:19]
    ds_read_b128 v[40:43], v1 offset:5120
    buffer_load_dwordx4 a[44:47], v1, s[4:7], s32 offen offset:3072 sc1
    v_mfma_f32_16x16x32_bf16 v[20:23], v[64:67], a[8:11], v[20:23]
    ds_read_b128 v[44:47], v1 offset:6144
    s_add_u32 s32, s32, 4096
    buffer_load_dwordx4 a[48:51], v1, s[4:7], s32 offen offset:0 sc1
    v_mfma_f32_16x16x32_bf16 v[24:27], v[68:71], a[8:11], v[24:27]
    ds_read_b128 v[48:51], v1 offset:7168
    buffer_load_dwordx4 a[52:55], v1, s[4:7], s32 offen offset:1024 sc1
    v_mfma_f32_16x16x32_bf16 v[28:31], v[72:75], a[8:11], v[28:31]
    ds_read_b128 v[52:55], v1 offset:8192
    v_mfma_f32_16x16x32_bf16 v[32:35], v[76:79], a[8:11], v[32:35]
    ds_read_b128 v[56:59], v1 offset:9216
    s_waitcnt vmcnt(14) lgkmcnt(6)
    v_mfma_f32_16x16x32_bf16 v[16:19], v[80:83], a[12:15], v[16:19]
    ds_read_b128 v[60:63], v1 offset:10240
    buffer_load_dwordx4 a[56:59], v1, s[4:7], s32 offen offset:2048 sc1
    v_mfma_f32_16x16x32_bf16 v[20:23], v[84:87], a[12:15], v[20:23]
    ds_read_b128 v[64:67], v1 offset:11264
    v_mfma_f32_16x16x32_bf16 v[24:27], v[88:91], a[12:15], v[24:27]
    ds_read_b128 v[68:71], v1 offset:12288
    buffer_load_dwordx4 a[60:63], v1, s[4:7], s32 offen offset:3072 sc1
    v_mfma_f32_16x16x32_bf16 v[28:31], v[92:95], a[12:15], v[28:31]
    ds_read_b128 v[72:75], v1 offset:13312
    v_mfma_f32_16x16x32_bf16 v[32:35], v[96:99], a[12:15], v[32:35]
    ds_read_b128 v[76:79], v1 offset:14336
    s_waitcnt vmcnt(15) lgkmcnt(6)
    v_mfma_f32_16x16x32_bf16 v[16:19], v[36:39], a[16:19], v[16:19]
    ds_read_b128 v[80:83], v1 offset:15360
    s_add_u32 m0, s22, 114688
    s_add_u32 s31, s28, 131072
    buffer_load_dwordx4 v1, s[4:7], s31 offen offset:0 lds
    v_mfma_f32_16x16x32_bf16 v[20:23], v[40:43], a[16:19], v[20:23]
    s_barrier
    ds_read_b128 v[84:87], v1 offset:16384
    v_mfma_f32_16x16x32_bf16 v[24:27], v[44:47], a[16:19], v[24:27]
    ds_read_b128 v[88:91], v1 offset:17408
    buffer_load_dwordx4 v1, s[4:7], s31 offen offset:1024 lds
    v_mfma_f32_16x16x32_bf16 v[28:31], v[48:51], a[16:19], v[28:31]
    ds_read_b128 v[92:95], v1 offset:18432
    v_mfma_f32_16x16x32_bf16 v[32:35], v[52:55], a[16:19], v[32:35]
    ds_read_b128 v[96:99], v1 offset:19456
    s_waitcnt vmcnt(16) lgkmcnt(6)
    v_mfma_f32_16x16x32_bf16 v[16:19], v[56:59], a[20:23], v[16:19]
    ds_read_b128 v[36:39], v1 offset:20480
    buffer_load_dwordx4 v1, s[4:7], s31 offen offset:2048 lds
    v_mfma_f32_16x16x32_bf16 v[20:23], v[60:63], a[20:23], v[20:23]
    ds_read_b128 v[40:43], v1 offset:21504
    v_mfma_f32_16x16x32_bf16 v[24:27], v[64:67], a[20:23], v[24:27]
    ds_read_b128 v[44:47], v1 offset:22528
    v_mfma_f32_16x16x32_bf16 v[28:31], v[68:71], a[20:23], v[28:31]
    ds_read_b128 v[48:51], v1 offset:23552
    buffer_load_dwordx4 v1, s[4:7], s31 offen offset:3072 lds
    v_mfma_f32_16x16x32_bf16 v[32:35], v[72:75], a[20:23], v[32:35]
    ds_read_b128 v[52:55], v1 offset:24576
    s_waitcnt vmcnt(17) lgkmcnt(6)
    v_mfma_f32_16x16x32_bf16 v[16:19], v[76:79], a[24:27], v[16:19]
    ds_read_b128 v[56:59], v1 offset:25600
    v_mfma_f32_16x16x32_bf16 v[20:23], v[80:83], a[24:27], v[20:23]
    ds_read_b128 v[60:63], v1 offset:26624
    s_add_u32 m0, s22, 131072
    s_add_u32 s31, s28, 147456
    buffer_load_dwordx4 v1, s[4:7], s31 offen offset:0 lds
    v_mfma_f32_16x16x32_bf16 v[24:27], v[84:87], a[24:27], v[24:27]
    ds_read_b128 v[64:67], v1 offset:27648
    v_mfma_f32_16x16x32_bf16 v[28:31], v[88:91], a[24:27], v[28:31]
    ds_read_b128 v[68:71], v1 offset:28672
    buffer_load_dwordx4 v1, s[4:7], s31 offen offset:1024 lds
    v_mfma_f32_16x16x32_bf16 v[32:35], v[92:95], a[24:27], v[32:35]
    ds_read_b128 v[72:75], v1 offset:29696
    s_waitcnt vmcnt(18) lgkmcnt(6)
    v_mfma_f32_16x16x32_bf16 v[16:19], v[96:99], a[28:31], v[16:19]
    ds_read_b128 v[76:79], v1 offset:30720
    v_mfma_f32_16x16x32_bf16 v[20:23], v[36:39], a[28:31], v[20:23]
    ds_read_b128 v[80:83], v1 offset:31744
    buffer_load_dwordx4 v1, s[4:7], s31 offen offset:2048 lds
    v_mfma_f32_16x16x32_bf16 v[24:27], v[40:43], a[28:31], v[24:27]
    ds_read_b128 v[84:87], v1 offset:32768
    v_mfma_f32_16x16x32_bf16 v[28:31], v[44:47], a[28:31], v[28:31]
    ds_read_b128 v[88:91], v1 offset:33792
    v_mfma_f32_16x16x32_bf16 v[32:35], v[48:51], a[28:31], v[32:35]
    ds_read_b128 v[92:95], v1 offset:34816
    s_waitcnt vmcnt(18) lgkmcnt(6)
    v_mfma_f32_16x16x32_bf16 v[16:19], v[52:55], a[32:35], v[16:19]
    ds_read_b128 v[96:99], v1 offset:35840
    buffer_load_dwordx4 v1, s[4:7], s31 offen offset:3072 lds
    v_mfma_f32_16x16x32_bf16 v[20:23], v[56:59], a[32:35], v[20:23]
    ds_read_b128 v[36:39], v1 offset:36864
    v_mfma_f32_16x16x32_bf16 v[24:27], v[60:63], a[32:35], v[24:27]
    ds_read_b128 v[40:43], v1 offset:37888
    s_add_u32 s32, s32, 4096
    buffer_load_dwordx4 a[64:67], v1, s[4:7], s32 offen offset:0 sc1
    v_mfma_f32_16x16x32_bf16 v[28:31], v[64:67], a[32:35], v[28:31]
    ds_read_b128 v[44:47], v1 offset:38912
    v_mfma_f32_16x16x32_bf16 v[32:35], v[68:71], a[32:35], v[32:35]
    ds_read_b128 v[48:51], v1 offset:39936
    s_waitcnt vmcnt(15) lgkmcnt(6)
    v_mfma_f32_16x16x32_bf16 v[16:19], v[72:75], a[36:39], v[16:19]
    ds_read_b128 v[52:55], v1 offset:40960
    buffer_load_dwordx4 a[68:71], v1, s[4:7], s32 offen offset:1024 sc1
    v_mfma_f32_16x16x32_bf16 v[20:23], v[76:79], a[36:39], v[20:23]
    ds_read_b128 v[56:59], v1 offset:41984
    v_mfma_f32_16x16x32_bf16 v[24:27], v[80:83], a[36:39], v[24:27]
    ds_read_b128 v[60:63], v1 offset:43008
    buffer_load_dwordx4 a[72:75], v1, s[4:7], s32 offen offset:2048 sc1
    v_mfma_f32_16x16x32_bf16 v[28:31], v[84:87], a[36:39], v[28:31]
    ds_read_b128 v[64:67], v1 offset:44032
    v_mfma_f32_16x16x32_bf16 v[32:35], v[88:91], a[36:39], v[32:35]
    ds_read_b128 v[68:71], v1 offset:45056
    s_waitcnt vmcnt(16) lgkmcnt(6)
    v_mfma_f32_16x16x32_bf16 v[16:19], v[92:95], a[40:43], v[16:19]
    ds_read_b128 v[72:75], v1 offset:46080
    buffer_load_dwordx4 a[76:79], v1, s[4:7], s32 offen offset:3072 sc1
    v_mfma_f32_16x16x32_bf16 v[20:23], v[96:99], a[40:43], v[20:23]
    ds_read_b128 v[76:79], v1 offset:47104
    v_mfma_f32_16x16x32_bf16 v[24:27], v[36:39], a[40:43], v[24:27]
    ds_read_b128 v[80:83], v1 offset:48128
    v_mfma_f32_16x16x32_bf16 v[28:31], v[40:43], a[40:43], v[28:31]
    s_barrier
    ds_read_b128 v[84:87], v1 offset:49152
    v_mfma_f32_16x16x32_bf16 v[32:35], v[44:47], a[40:43], v[32:35]
    ds_read_b128 v[88:91], v1 offset:50176
    s_waitcnt vmcnt(16) lgkmcnt(6)
    v_mfma_f32_16x16x32_bf16 v[16:19], v[48:51], a[44:47], v[16:19]
    ds_read_b128 v[92:95], v1 offset:51200
    s_add_u32 s32, s32, 4096
    buffer_load_dwordx4 a[80:83], v1, s[4:7], s32 offen offset:0 sc1
    v_mfma_f32_16x16x32_bf16 v[20:23], v[52:55], a[44:47], v[20:23]
    ds_read_b128 v[96:99], v1 offset:52224
    buffer_load_dwordx4 a[84:87], v1, s[4:7], s32 offen offset:1024 sc1
    v_mfma_f32_16x16x32_bf16 v[24:27], v[56:59], a[44:47], v[24:27]
    ds_read_b128 v[36:39], v1 offset:53248
    v_mfma_f32_16x16x32_bf16 v[28:31], v[60:63], a[44:47], v[28:31]
    ds_read_b128 v[40:43], v1 offset:54272
    v_mfma_f32_16x16x32_bf16 v[32:35], v[64:67], a[44:47], v[32:35]
    ds_read_b128 v[44:47], v1 offset:55296
    s_waitcnt vmcnt(17) lgkmcnt(6)
    v_mfma_f32_16x16x32_bf16 v[16:19], v[68:71], a[48:51], v[16:19]
    ds_read_b128 v[48:51], v1 offset:56320
    s_add_u32 m0, s22, 0
    s_add_u32 s31, s28, 163840
    buffer_load_dwordx4 v1, s[4:7], s31 offen offset:0 lds
    v_mfma_f32_16x16x32_bf16 v[20:23], v[72:75], a[48:51], v[20:23]
    ds_read_b128 v[52:55], v1 offset:57344
    buffer_load_dwordx4 v1, s[4:7], s31 offen offset:1024 lds
    v_mfma_f32_16x16x32_bf16 v[24:27], v[76:79], a[48:51], v[24:27]
    ds_read_b128 v[56:59], v1 offset:58368
    v_mfma_f32_16x16x32_bf16 v[28:31], v[80:83], a[48:51], v[28:31]
    ds_read_b128 v[60:63], v1 offset:59392
    v_mfma_f32_16x16x32_bf16 v[32:35], v[84:87], a[48:51], v[32:35]
    ds_read_b128 v[64:67], v1 offset:60416
    s_waitcnt vmcnt(18) lgkmcnt(6)
    v_mfma_f32_16x16x32_bf16 v[16:19], v[88:91], a[52:55], v[16:19]
    ds_read_b128 v[68:71], v1 offset:61440
    buffer_load_dwordx4 v1, s[4:7], s31 offen offset:2048 lds
    v_mfma_f32_16x16x32_bf16 v[20:23], v[92:95], a[52:55], v[20:23]
    ds_read_b128 v[72:75], v1 offset:62464
    v_mfma_f32_16x16x32_bf16 v[24:27], v[96:99], a[52:55], v[24:27]
    ds_read_b128 v[76:79], v1 offset:63488
    buffer_load_dwordx4 v1, s[4:7], s31 offen offset:3072 lds
    v_mfma_f32_16x16x32_bf16 v[28:31], v[36:39], a[52:55], v[28:31]
    ds_read_b128 v[80:83], v1 offset:64512
    v_mfma_f32_16x16x32_bf16 v[32:35], v[40:43], a[52:55], v[32:35]
    ds_read_b128 v[84:87], v2 offset:0
    s_waitcnt vmcnt(19) lgkmcnt(6)
    v_mfma_f32_16x16x32_bf16 v[16:19], v[44:47], a[56:59], v[16:19]
    ds_read_b128 v[88:91], v2 offset:1024
    s_add_u32 m0, s22, 16384
    s_add_u32 s31, s28, 180224
    buffer_load_dwordx4 v1, s[4:7], s31 offen offset:0 lds
    v_mfma_f32_16x16x32_bf16 v[20:23], v[48:51], a[56:59], v[20:23]
    ds_read_b128 v[92:95], v2 offset:2048
    v_mfma_f32_16x16x32_bf16 v[24:27], v[52:55], a[56:59], v[24:27]
    ds_read_b128 v[96:99], v2 offset:3072
    v_mfma_f32_16x16x32_bf16 v[28:31], v[56:59], a[56:59], v[28:31]
    ds_read_b128 v[36:39], v2 offset:4096
    buffer_load_dwordx4 v1, s[4:7], s31 offen offset:1024 lds
    v_mfma_f32_16x16x32_bf16 v[32:35], v[60:63], a[56:59], v[32:35]
    ds_read_b128 v[40:43], v2 offset:5120
    s_waitcnt vmcnt(20) lgkmcnt(6)
    v_mfma_f32_16x16x32_bf16 v[16:19], v[64:67], a[60:63], v[16:19]
    ds_read_b128 v[44:47], v2 offset:6144
    buffer_load_dwordx4 v1, s[4:7], s31 offen offset:2048 lds
    v_mfma_f32_16x16x32_bf16 v[20:23], v[68:71], a[60:63], v[20:23]
    ds_read_b128 v[48:51], v2 offset:7168
    v_mfma_f32_16x16x32_bf16 v[24:27], v[72:75], a[60:63], v[24:27]
    ds_read_b128 v[52:55], v2 offset:8192
    v_mfma_f32_16x16x32_bf16 v[28:31], v[76:79], a[60:63], v[28:31]
    ds_read_b128 v[56:59], v2 offset:9216
    buffer_load_dwordx4 v1, s[4:7], s31 offen offset:3072 lds
    v_mfma_f32_16x16x32_bf16 v[32:35], v[80:83], a[60:63], v[32:35]
    ds_read_b128 v[60:63], v2 offset:10240
    buffer_load_dwordx4 a[88:91], v1, s[4:7], s32 offen offset:2048 sc1
    s_waitcnt vmcnt(14) lgkmcnt(6)
    v_mfma_f32_16x16x32_bf16 v[16:19], v[84:87], a[64:67], v[16:19]
    ds_read_b128 v[64:67], v2 offset:11264
    v_mfma_f32_16x16x32_bf16 v[20:23], v[88:91], a[64:67], v[20:23]
    ds_read_b128 v[68:71], v2 offset:12288
    v_mfma_f32_16x16x32_bf16 v[24:27], v[92:95], a[64:67], v[24:27]
    ds_read_b128 v[72:75], v2 offset:13312
    v_mfma_f32_16x16x32_bf16 v[28:31], v[96:99], a[64:67], v[28:31]
    ds_read_b128 v[76:79], v2 offset:14336
    v_mfma_f32_16x16x32_bf16 v[32:35], v[36:39], a[64:67], v[32:35]
    ds_read_b128 v[80:83], v2 offset:15360
    buffer_load_dwordx4 a[92:95], v1, s[4:7], s32 offen offset:3072 sc1
    s_waitcnt vmcnt(14) lgkmcnt(6)
    v_mfma_f32_16x16x32_bf16 v[16:19], v[40:43], a[68:71], v[16:19]
    s_barrier
    ds_read_b128 v[84:87], v2 offset:16384
    v_mfma_f32_16x16x32_bf16 v[20:23], v[44:47], a[68:71], v[20:23]
    ds_read_b128 v[88:91], v2 offset:17408
    v_mfma_f32_16x16x32_bf16 v[24:27], v[48:51], a[68:71], v[24:27]
    ds_read_b128 v[92:95], v2 offset:18432
    s_add_u32 s32, s32, 4096
    buffer_load_dwordx4 a[96:99], v1, s[4:7], s32 offen offset:0 sc1
    v_mfma_f32_16x16x32_bf16 v[28:31], v[52:55], a[68:71], v[28:31]
    ds_read_b128 v[96:99], v2 offset:19456
    v_mfma_f32_16x16x32_bf16 v[32:35], v[56:59], a[68:71], v[32:35]
    ds_read_b128 v[36:39], v2 offset:20480
    s_waitcnt vmcnt(14) lgkmcnt(6)
    v_mfma_f32_16x16x32_bf16 v[16:19], v[60:63], a[72:75], v[16:19]
    ds_read_b128 v[40:43], v2 offset:21504
    buffer_load_dwordx4 a[100:103], v1, s[4:7], s32 offen offset:1024 sc1
    v_mfma_f32_16x16x32_bf16 v[20:23], v[64:67], a[72:75], v[20:23]
    ds_read_b128 v[44:47], v2 offset:22528
    v_mfma_f32_16x16x32_bf16 v[24:27], v[68:71], a[72:75], v[24:27]
    ds_read_b128 v[48:51], v2 offset:23552
    buffer_load_dwordx4 a[104:107], v1, s[4:7], s32 offen offset:2048 sc1
    v_mfma_f32_16x16x32_bf16 v[28:31], v[72:75], a[72:75], v[28:31]
    ds_read_b128 v[52:55], v2 offset:24576
    v_mfma_f32_16x16x32_bf16 v[32:35], v[76:79], a[72:75], v[32:35]
    ds_read_b128 v[56:59], v2 offset:25600
    s_waitcnt vmcnt(15) lgkmcnt(6)
    v_mfma_f32_16x16x32_bf16 v[16:19], v[80:83], a[76:79], v[16:19]
    ds_read_b128 v[60:63], v2 offset:26624
    buffer_load_dwordx4 a[108:111], v1, s[4:7], s32 offen offset:3072 sc1
    v_mfma_f32_16x16x32_bf16 v[20:23], v[84:87], a[76:79], v[20:23]
    ds_read_b128 v[64:67], v2 offset:27648
    v_mfma_f32_16x16x32_bf16 v[24:27], v[88:91], a[76:79], v[24:27]
    ds_read_b128 v[68:71], v2 offset:28672
    v_mfma_f32_16x16x32_bf16 v[28:31], v[92:95], a[76:79], v[28:31]
    ds_read_b128 v[72:75], v2 offset:29696
    s_add_u32 s32, s32, 4096
    buffer_load_dwordx4 a[112:115], v1, s[4:7], s32 offen offset:0 sc1
    v_mfma_f32_16x16x32_bf16 v[32:35], v[96:99], a[76:79], v[32:35]
    ds_read_b128 v[76:79], v2 offset:30720
    s_waitcnt vmcnt(16) lgkmcnt(6)
    v_mfma_f32_16x16x32_bf16 v[16:19], v[36:39], a[80:83], v[16:19]
    ds_read_b128 v[80:83], v2 offset:31744
    v_mfma_f32_16x16x32_bf16 v[20:23], v[40:43], a[80:83], v[20:23]
    ds_read_b128 v[84:87], v2 offset:32768
    s_add_u32 m0, s22, 32768
    s_add_u32 s31, s28, 196608
    buffer_load_dwordx4 v1, s[4:7], s31 offen offset:0 lds
    v_mfma_f32_16x16x32_bf16 v[24:27], v[44:47], a[80:83], v[24:27]
    ds_read_b128 v[88:91], v2 offset:33792
    v_mfma_f32_16x16x32_bf16 v[28:31], v[48:51], a[80:83], v[28:31]
    ds_read_b128 v[92:95], v2 offset:34816
    buffer_load_dwordx4 v1, s[4:7], s31 offen offset:1024 lds
    v_mfma_f32_16x16x32_bf16 v[32:35], v[52:55], a[80:83], v[32:35]
    ds_read_b128 v[96:99], v2 offset:35840
    s_waitcnt vmcnt(17) lgkmcnt(6)
    v_mfma_f32_16x16x32_bf16 v[16:19], v[56:59], a[84:87], v[16:19]
    ds_read_b128 v[36:39], v2 offset:36864
    v_mfma_f32_16x16x32_bf16 v[20:23], v[60:63], a[84:87], v[20:23]
    ds_read_b128 v[40:43], v2 offset:37888
    buffer_load_dwordx4 v1, s[4:7], s31 offen offset:2048 lds
    v_mfma_f32_16x16x32_bf16 v[24:27], v[64:67], a[84:87], v[24:27]
    ds_read_b128 v[44:47], v2 offset:38912
    v_mfma_f32_16x16x32_bf16 v[28:31], v[68:71], a[84:87], v[28:31]
    ds_read_b128 v[48:51], v2 offset:39936
    v_mfma_f32_16x16x32_bf16 v[32:35], v[72:75], a[84:87], v[32:35]
    ds_read_b128 v[52:55], v2 offset:40960
    s_waitcnt vmcnt(9) lgkmcnt(6)
    v_mfma_f32_16x16x32_bf16 v[16:19], v[76:79], a[88:91], v[16:19]
    ds_read_b128 v[56:59], v2 offset:41984
    buffer_load_dwordx4 v1, s[4:7], s31 offen offset:3072 lds
    v_mfma_f32_16x16x32_bf16 v[20:23], v[80:83], a[88:91], v[20:23]
    ds_read_b128 v[60:63], v2 offset:43008
    v_mfma_f32_16x16x32_bf16 v[24:27], v[84:87], a[88:91], v[24:27]
    ds_read_b128 v[64:67], v2 offset:44032
    s_add_u32 m0, s22, 49152
    s_add_u32 s31, s28, 212992
    buffer_load_dwordx4 v1, s[4:7], s31 offen offset:0 lds
    v_mfma_f32_16x16x32_bf16 v[28:31], v[88:91], a[88:91], v[28:31]
    ds_read_b128 v[68:71], v2 offset:45056
    v_mfma_f32_16x16x32_bf16 v[32:35], v[92:95], a[88:91], v[32:35]
    ds_read_b128 v[72:75], v2 offset:46080
    buffer_load_dwordx4 a[116:119], v1, s[4:7], s32 offen offset:1024 sc1
    s_waitcnt vmcnt(11) lgkmcnt(6)
    v_mfma_f32_16x16x32_bf16 v[16:19], v[96:99], a[92:95], v[16:19]
    ds_read_b128 v[76:79], v2 offset:47104
    v_mfma_f32_16x16x32_bf16 v[20:23], v[36:39], a[92:95], v[20:23]
    ds_read_b128 v[80:83], v2 offset:48128
    v_mfma_f32_16x16x32_bf16 v[24:27], v[40:43], a[92:95], v[24:27]
    s_barrier
    ds_read_b128 v[84:87], v2 offset:49152
    v_mfma_f32_16x16x32_bf16 v[28:31], v[44:47], a[92:95], v[28:31]
    ds_read_b128 v[88:91], v2 offset:50176
    buffer_load_dwordx4 v1, s[4:7], s31 offen offset:1024 lds
    v_mfma_f32_16x16x32_bf16 v[32:35], v[48:51], a[92:95], v[32:35]
    ds_read_b128 v[92:95], v2 offset:51200
    buffer_load_dwordx4 a[120:123], v1, s[4:7], s32 offen offset:2048 sc1
    s_waitcnt vmcnt(12) lgkmcnt(6)
    v_mfma_f32_16x16x32_bf16 v[16:19], v[52:55], a[96:99], v[16:19]
    ds_read_b128 v[96:99], v2 offset:52224
    v_mfma_f32_16x16x32_bf16 v[20:23], v[56:59], a[96:99], v[20:23]
    ds_read_b128 v[36:39], v2 offset:53248
    v_mfma_f32_16x16x32_bf16 v[24:27], v[60:63], a[96:99], v[24:27]
    ds_read_b128 v[40:43], v2 offset:54272
    v_mfma_f32_16x16x32_bf16 v[28:31], v[64:67], a[96:99], v[28:31]
    ds_read_b128 v[44:47], v2 offset:55296
    buffer_load_dwordx4 v1, s[4:7], s31 offen offset:2048 lds
    v_mfma_f32_16x16x32_bf16 v[32:35], v[68:71], a[96:99], v[32:35]
    ds_read_b128 v[48:51], v2 offset:56320
    buffer_load_dwordx4 a[124:127], v1, s[4:7], s32 offen offset:3072 sc1
    s_waitcnt vmcnt(13) lgkmcnt(6)
    v_mfma_f32_16x16x32_bf16 v[16:19], v[72:75], a[100:103], v[16:19]
    ds_read_b128 v[52:55], v2 offset:57344
    v_mfma_f32_16x16x32_bf16 v[20:23], v[76:79], a[100:103], v[20:23]
    ds_read_b128 v[56:59], v2 offset:58368
    v_mfma_f32_16x16x32_bf16 v[24:27], v[80:83], a[100:103], v[24:27]
    ds_read_b128 v[60:63], v2 offset:59392
    v_mfma_f32_16x16x32_bf16 v[28:31], v[84:87], a[100:103], v[28:31]
    ds_read_b128 v[64:67], v2 offset:60416
    v_mfma_f32_16x16x32_bf16 v[32:35], v[88:91], a[100:103], v[32:35]
    ds_read_b128 v[68:71], v2 offset:61440
    s_add_u32 s32, s32, 4096
    buffer_load_dwordx4 a[128:131], v1, s[4:7], s32 offen offset:0 sc1
    s_waitcnt vmcnt(13) lgkmcnt(6)
    v_mfma_f32_16x16x32_bf16 v[16:19], v[92:95], a[104:107], v[16:19]
    ds_read_b128 v[72:75], v2 offset:62464
    v_mfma_f32_16x16x32_bf16 v[20:23], v[96:99], a[104:107], v[20:23]
    ds_read_b128 v[76:79], v2 offset:63488
    v_mfma_f32_16x16x32_bf16 v[24:27], v[36:39], a[104:107], v[24:27]
    ds_read_b128 v[80:83], v2 offset:64512
    buffer_load_dwordx4 v1, s[4:7], s31 offen offset:3072 lds
    v_mfma_f32_16x16x32_bf16 v[28:31], v[40:43], a[104:107], v[28:31]
    ds_read_b128 v[84:87], v3 offset:0
    v_mfma_f32_16x16x32_bf16 v[32:35], v[44:47], a[104:107], v[32:35]
    ds_read_b128 v[88:91], v3 offset:1024
    buffer_load_dwordx4 a[132:135], v1, s[4:7], s32 offen offset:1024 sc1
    s_waitcnt vmcnt(14) lgkmcnt(6)
    v_mfma_f32_16x16x32_bf16 v[16:19], v[48:51], a[108:111], v[16:19]
    ds_read_b128 v[92:95], v3 offset:2048
    v_mfma_f32_16x16x32_bf16 v[20:23], v[52:55], a[108:111], v[20:23]
    ds_read_b128 v[96:99], v3 offset:3072
    v_mfma_f32_16x16x32_bf16 v[24:27], v[56:59], a[108:111], v[24:27]
    ds_read_b128 v[36:39], v3 offset:4096
    buffer_load_dwordx4 a[136:139], v1, s[4:7], s32 offen offset:2048 sc1
    v_mfma_f32_16x16x32_bf16 v[28:31], v[60:63], a[108:111], v[28:31]
    ds_read_b128 v[40:43], v3 offset:5120
    v_mfma_f32_16x16x32_bf16 v[32:35], v[64:67], a[108:111], v[32:35]
    ds_read_b128 v[44:47], v3 offset:6144
    s_waitcnt vmcnt(14) lgkmcnt(6)
    v_mfma_f32_16x16x32_bf16 v[16:19], v[68:71], a[112:115], v[16:19]
    ds_read_b128 v[48:51], v3 offset:7168
    s_add_u32 m0, s22, 65536
    s_add_u32 s31, s28, 229376
    buffer_load_dwordx4 v1, s[4:7], s31 offen offset:0 lds
    v_mfma_f32_16x16x32_bf16 v[20:23], v[72:75], a[112:115], v[20:23]
    ds_read_b128 v[52:55], v3 offset:8192
    v_mfma_f32_16x16x32_bf16 v[24:27], v[76:79], a[112:115], v[24:27]
    ds_read_b128 v[56:59], v3 offset:9216
    v_mfma_f32_16x16x32_bf16 v[28:31], v[80:83], a[112:115], v[28:31]
    ds_read_b128 v[60:63], v3 offset:10240
    buffer_load_dwordx4 v1, s[4:7], s31 offen offset:1024 lds
    v_mfma_f32_16x16x32_bf16 v[32:35], v[84:87], a[112:115], v[32:35]
    ds_read_b128 v[64:67], v3 offset:11264
    buffer_load_dwordx4 a[140:143], v1, s[4:7], s32 offen offset:3072 sc1
    s_waitcnt vmcnt(11) lgkmcnt(6)
    v_mfma_f32_16x16x32_bf16 v[16:19], v[88:91], a[116:119], v[16:19]
    ds_read_b128 v[68:71], v3 offset:12288
    v_mfma_f32_16x16x32_bf16 v[20:23], v[92:95], a[116:119], v[20:23]
    ds_read_b128 v[72:75], v3 offset:13312
    v_mfma_f32_16x16x32_bf16 v[24:27], v[96:99], a[116:119], v[24:27]
    ds_read_b128 v[76:79], v3 offset:14336
    v_mfma_f32_16x16x32_bf16 v[28:31], v[36:39], a[116:119], v[28:31]
    ds_read_b128 v[80:83], v3 offset:15360
    buffer_load_dwordx4 v1, s[4:7], s31 offen offset:2048 lds
    v_mfma_f32_16x16x32_bf16 v[32:35], v[40:43], a[116:119], v[32:35]
    s_barrier
    ds_read_b128 v[84:87], v1 offset:0
    s_add_u32 s32, s32, 4096
    buffer_load_dwordx4 a[144:147], v1, s[4:7], s32 offen offset:0 sc1
    s_waitcnt vmcnt(11) lgkmcnt(6)
    v_mfma_f32_16x16x32_bf16 v[16:19], v[44:47], a[120:123], v[16:19]
    ds_read_b128 v[88:91], v1 offset:1024
    v_mfma_f32_16x16x32_bf16 v[20:23], v[48:51], a[120:123], v[20:23]
    ds_read_b128 v[92:95], v1 offset:2048
    v_mfma_f32_16x16x32_bf16 v[24:27], v[52:55], a[120:123], v[24:27]
    ds_read_b128 v[96:99], v1 offset:3072
    v_mfma_f32_16x16x32_bf16 v[28:31], v[56:59], a[120:123], v[28:31]
    ds_read_b128 v[36:39], v1 offset:4096
    v_mfma_f32_16x16x32_bf16 v[32:35], v[60:63], a[120:123], v[32:35]
    ds_read_b128 v[40:43], v1 offset:5120
    buffer_load_dwordx4 a[148:151], v1, s[4:7], s32 offen offset:1024 sc1
    s_waitcnt vmcnt(10) lgkmcnt(6)
    v_mfma_f32_16x16x32_bf16 v[16:19], v[64:67], a[124:127], v[16:19]
    ds_read_b128 v[44:47], v1 offset:6144
    v_mfma_f32_16x16x32_bf16 v[20:23], v[68:71], a[124:127], v[20:23]
    ds_read_b128 v[48:51], v1 offset:7168
    v_mfma_f32_16x16x32_bf16 v[24:27], v[72:75], a[124:127], v[24:27]
    ds_read_b128 v[52:55], v1 offset:8192
    buffer_load_dwordx4 v1, s[4:7], s31 offen offset:3072 lds
    v_mfma_f32_16x16x32_bf16 v[28:31], v[76:79], a[124:127], v[28:31]
    ds_read_b128 v[56:59], v1 offset:9216
    v_mfma_f32_16x16x32_bf16 v[32:35], v[80:83], a[124:127], v[32:35]
    ds_read_b128 v[60:63], v1 offset:10240
    buffer_load_dwordx4 a[152:155], v1, s[4:7], s32 offen offset:2048 sc1
    s_waitcnt vmcnt(11) lgkmcnt(6)
    v_mfma_f32_16x16x32_bf16 v[16:19], v[84:87], a[128:131], v[16:19]
    ds_read_b128 v[64:67], v1 offset:11264
    v_mfma_f32_16x16x32_bf16 v[20:23], v[88:91], a[128:131], v[20:23]
    ds_read_b128 v[68:71], v1 offset:12288
    v_mfma_f32_16x16x32_bf16 v[24:27], v[92:95], a[128:131], v[24:27]
    ds_read_b128 v[72:75], v1 offset:13312
    s_add_u32 m0, s22, 81920
    s_add_u32 s31, s28, 245760
    buffer_load_dwordx4 v1, s[4:7], s31 offen offset:0 lds
    v_mfma_f32_16x16x32_bf16 v[28:31], v[96:99], a[128:131], v[28:31]
    ds_read_b128 v[76:79], v1 offset:14336
    v_mfma_f32_16x16x32_bf16 v[32:35], v[36:39], a[128:131], v[32:35]
    ds_read_b128 v[80:83], v1 offset:15360
    buffer_load_dwordx4 a[156:159], v1, s[4:7], s32 offen offset:3072 sc1
    s_waitcnt vmcnt(11) lgkmcnt(6)
    v_mfma_f32_16x16x32_bf16 v[16:19], v[40:43], a[132:135], v[16:19]
    ds_read_b128 v[84:87], v1 offset:16384
    v_mfma_f32_16x16x32_bf16 v[20:23], v[44:47], a[132:135], v[20:23]
    ds_read_b128 v[88:91], v1 offset:17408
    v_mfma_f32_16x16x32_bf16 v[24:27], v[48:51], a[132:135], v[24:27]
    ds_read_b128 v[92:95], v1 offset:18432
    v_mfma_f32_16x16x32_bf16 v[28:31], v[52:55], a[132:135], v[28:31]
    ds_read_b128 v[96:99], v1 offset:19456
    buffer_load_dwordx4 v1, s[4:7], s31 offen offset:1024 lds
    v_mfma_f32_16x16x32_bf16 v[32:35], v[56:59], a[132:135], v[32:35]
    ds_read_b128 v[36:39], v1 offset:20480
    s_add_u32 s32, s32, 4096
    buffer_load_dwordx4 a[160:163], v1, s[4:7], s32 offen offset:0 sc1
    s_waitcnt vmcnt(12) lgkmcnt(6)
    v_mfma_f32_16x16x32_bf16 v[16:19], v[60:63], a[136:139], v[16:19]
    ds_read_b128 v[40:43], v1 offset:21504
    v_mfma_f32_16x16x32_bf16 v[20:23], v[64:67], a[136:139], v[20:23]
    ds_read_b128 v[44:47], v1 offset:22528
    v_mfma_f32_16x16x32_bf16 v[24:27], v[68:71], a[136:139], v[24:27]
    ds_read_b128 v[48:51], v1 offset:23552
    v_mfma_f32_16x16x32_bf16 v[28:31], v[72:75], a[136:139], v[28:31]
    ds_read_b128 v[52:55], v1 offset:24576
    v_mfma_f32_16x16x32_bf16 v[32:35], v[76:79], a[136:139], v[32:35]
    ds_read_b128 v[56:59], v1 offset:25600
    buffer_load_dwordx4 a[164:167], v1, s[4:7], s32 offen offset:1024 sc1
    s_waitcnt vmcnt(10) lgkmcnt(6)
    v_mfma_f32_16x16x32_bf16 v[16:19], v[80:83], a[140:143], v[16:19]
    ds_read_b128 v[60:63], v1 offset:26624
    v_mfma_f32_16x16x32_bf16 v[20:23], v[84:87], a[140:143], v[20:23]
    ds_read_b128 v[64:67], v1 offset:27648
    buffer_load_dwordx4 v1, s[4:7], s31 offen offset:2048 lds
    v_mfma_f32_16x16x32_bf16 v[24:27], v[88:91], a[140:143], v[24:27]
    ds_read_b128 v[68:71], v1 offset:28672
    v_mfma_f32_16x16x32_bf16 v[28:31], v[92:95], a[140:143], v[28:31]
    ds_read_b128 v[72:75], v1 offset:29696
    v_mfma_f32_16x16x32_bf16 v[32:35], v[96:99], a[140:143], v[32:35]
    ds_read_b128 v[76:79], v1 offset:30720
    buffer_load_dwordx4 a[168:171], v1, s[4:7], s32 offen offset:2048 sc1
    s_waitcnt vmcnt(10) lgkmcnt(6)
    v_mfma_f32_16x16x32_bf16 v[16:19], v[36:39], a[144:147], v[16:19]
    ds_read_b128 v[80:83], v1 offset:31744
    v_mfma_f32_16x16x32_bf16 v[20:23], v[40:43], a[144:147], v[20:23]
    s_barrier
    ds_read_b128 v[84:87], v1 offset:32768
    v_mfma_f32_16x16x32_bf16 v[24:27], v[44:47], a[144:147], v[24:27]
    ds_read_b128 v[88:91], v1 offset:33792
    buffer_load_dwordx4 v1, s[4:7], s31 offen offset:3072 lds
    v_mfma_f32_16x16x32_bf16 v[28:31], v[48:51], a[144:147], v[28:31]
    ds_read_b128 v[92:95], v1 offset:34816
    v_mfma_f32_16x16x32_bf16 v[32:35], v[52:55], a[144:147], v[32:35]
    ds_read_b128 v[96:99], v1 offset:35840
    buffer_load_dwordx4 a[172:175], v1, s[4:7], s32 offen offset:3072 sc1
    s_waitcnt vmcnt(11) lgkmcnt(6)
    v_mfma_f32_16x16x32_bf16 v[16:19], v[56:59], a[148:151], v[16:19]
    ds_read_b128 v[36:39], v1 offset:36864
    v_mfma_f32_16x16x32_bf16 v[20:23], v[60:63], a[148:151], v[20:23]
    ds_read_b128 v[40:43], v1 offset:37888
    v_mfma_f32_16x16x32_bf16 v[24:27], v[64:67], a[148:151], v[24:27]
    ds_read_b128 v[44:47], v1 offset:38912
    v_mfma_f32_16x16x32_bf16 v[28:31], v[68:71], a[148:151], v[28:31]
    ds_read_b128 v[48:51], v1 offset:39936
    s_add_u32 m0, s22, 98304
    s_add_u32 s31, s28, 262144
    buffer_load_dwordx4 v1, s[4:7], s31 offen offset:0 lds
    v_mfma_f32_16x16x32_bf16 v[32:35], v[72:75], a[148:151], v[32:35]
    ds_read_b128 v[52:55], v1 offset:40960
    s_add_u32 s32, s32, 4096
    buffer_load_dwordx4 a[176:179], v1, s[4:7], s32 offen offset:0 sc1
    s_waitcnt vmcnt(11) lgkmcnt(6)
    v_mfma_f32_16x16x32_bf16 v[16:19], v[76:79], a[152:155], v[16:19]
    ds_read_b128 v[56:59], v1 offset:41984
    v_mfma_f32_16x16x32_bf16 v[20:23], v[80:83], a[152:155], v[20:23]
    ds_read_b128 v[60:63], v1 offset:43008
    v_mfma_f32_16x16x32_bf16 v[24:27], v[84:87], a[152:155], v[24:27]
    ds_read_b128 v[64:67], v1 offset:44032
    v_mfma_f32_16x16x32_bf16 v[28:31], v[88:91], a[152:155], v[28:31]
    ds_read_b128 v[68:71], v1 offset:45056
    buffer_load_dwordx4 v1, s[4:7], s31 offen offset:1024 lds
    v_mfma_f32_16x16x32_bf16 v[32:35], v[92:95], a[152:155], v[32:35]
    ds_read_b128 v[72:75], v1 offset:46080
    buffer_load_dwordx4 a[180:183], v1, s[4:7], s32 offen offset:1024 sc1
    s_waitcnt vmcnt(11) lgkmcnt(6)
    v_mfma_f32_16x16x32_bf16 v[16:19], v[96:99], a[156:159], v[16:19]
    ds_read_b128 v[76:79], v1 offset:47104
    v_mfma_f32_16x16x32_bf16 v[20:23], v[36:39], a[156:159], v[20:23]
    ds_read_b128 v[80:83], v1 offset:48128
    v_mfma_f32_16x16x32_bf16 v[24:27], v[40:43], a[156:159], v[24:27]
    ds_read_b128 v[84:87], v1 offset:49152
    v_mfma_f32_16x16x32_bf16 v[28:31], v[44:47], a[156:159], v[28:31]
    ds_read_b128 v[88:91], v1 offset:50176
    v_mfma_f32_16x16x32_bf16 v[32:35], v[48:51], a[156:159], v[32:35]
    ds_read_b128 v[92:95], v1 offset:51200
    buffer_load_dwordx4 a[184:187], v1, s[4:7], s32 offen offset:2048 sc1
    s_waitcnt vmcnt(10) lgkmcnt(6)
    v_mfma_f32_16x16x32_bf16 v[16:19], v[52:55], a[160:163], v[16:19]
    ds_read_b128 v[96:99], v1 offset:52224
    v_mfma_f32_16x16x32_bf16 v[20:23], v[56:59], a[160:163], v[20:23]
    ds_read_b128 v[36:39], v1 offset:53248
    v_mfma_f32_16x16x32_bf16 v[24:27], v[60:63], a[160:163], v[24:27]
    ds_read_b128 v[40:43], v1 offset:54272
    buffer_load_dwordx4 v1, s[4:7], s31 offen offset:2048 lds
    v_mfma_f32_16x16x32_bf16 v[28:31], v[64:67], a[160:163], v[28:31]
    ds_read_b128 v[44:47], v1 offset:55296
    v_mfma_f32_16x16x32_bf16 v[32:35], v[68:71], a[160:163], v[32:35]
    ds_read_b128 v[48:51], v1 offset:56320
    buffer_load_dwordx4 a[188:191], v1, s[4:7], s32 offen offset:3072 sc1
    s_waitcnt vmcnt(11) lgkmcnt(6)
    v_mfma_f32_16x16x32_bf16 v[16:19], v[72:75], a[164:167], v[16:19]
    ds_read_b128 v[52:55], v1 offset:57344
    v_mfma_f32_16x16x32_bf16 v[20:23], v[76:79], a[164:167], v[20:23]
    ds_read_b128 v[56:59], v1 offset:58368
    v_mfma_f32_16x16x32_bf16 v[24:27], v[80:83], a[164:167], v[24:27]
    ds_read_b128 v[60:63], v1 offset:59392
    buffer_load_dwordx4 v1, s[4:7], s31 offen offset:3072 lds
    v_mfma_f32_16x16x32_bf16 v[28:31], v[84:87], a[164:167], v[28:31]
    ds_read_b128 v[64:67], v1 offset:60416
    v_mfma_f32_16x16x32_bf16 v[32:35], v[88:91], a[164:167], v[32:35]
    ds_read_b128 v[68:71], v1 offset:61440
    s_add_u32 s32, s32, 4096
    buffer_load_dwordx4 a[192:195], v1, s[4:7], s32 offen offset:0 sc1
    s_waitcnt vmcnt(11) lgkmcnt(6)
    v_mfma_f32_16x16x32_bf16 v[16:19], v[92:95], a[168:171], v[16:19]
    ds_read_b128 v[72:75], v1 offset:62464
    v_mfma_f32_16x16x32_bf16 v[20:23], v[96:99], a[168:171], v[20:23]
    ds_read_b128 v[76:79], v1 offset:63488
    v_mfma_f32_16x16x32_bf16 v[24:27], v[36:39], a[168:171], v[24:27]
    ds_read_b128 v[80:83], v1 offset:64512
    v_mfma_f32_16x16x32_bf16 v[28:31], v[40:43], a[168:171], v[28:31]
    s_waitcnt vmcnt(10)
    s_barrier
    ds_read_b128 v[84:87], v2 offset:0
    v_mfma_f32_16x16x32_bf16 v[32:35], v[44:47], a[168:171], v[32:35]
    ds_read_b128 v[88:91], v2 offset:1024
    buffer_load_dwordx4 a[196:199], v1, s[4:7], s32 offen offset:1024 sc1
    s_waitcnt vmcnt(10) lgkmcnt(6)
    v_mfma_f32_16x16x32_bf16 v[16:19], v[48:51], a[172:175], v[16:19]
    ds_read_b128 v[92:95], v2 offset:2048
    v_mfma_f32_16x16x32_bf16 v[20:23], v[52:55], a[172:175], v[20:23]
    ds_read_b128 v[96:99], v2 offset:3072
    buffer_load_dwordx4 a[200:203], v1, s[4:7], s32 offen offset:2048 sc1
    v_mfma_f32_16x16x32_bf16 v[24:27], v[56:59], a[172:175], v[24:27]
    ds_read_b128 v[36:39], v2 offset:4096
    v_mfma_f32_16x16x32_bf16 v[28:31], v[60:63], a[172:175], v[28:31]
    ds_read_b128 v[40:43], v2 offset:5120
    buffer_load_dwordx4 a[204:207], v1, s[4:7], s32 offen offset:3072 sc1
    v_mfma_f32_16x16x32_bf16 v[32:35], v[64:67], a[172:175], v[32:35]
    ds_read_b128 v[44:47], v2 offset:6144
    s_waitcnt vmcnt(10) lgkmcnt(6)
    v_mfma_f32_16x16x32_bf16 v[16:19], v[68:71], a[176:179], v[16:19]
    ds_read_b128 v[48:51], v2 offset:7168
    v_mfma_f32_16x16x32_bf16 v[20:23], v[72:75], a[176:179], v[20:23]
    ds_read_b128 v[52:55], v2 offset:8192
    s_add_u32 s32, s32, 4096
    buffer_load_dwordx4 a[208:211], v1, s[4:7], s32 offen offset:0 sc1
    v_mfma_f32_16x16x32_bf16 v[24:27], v[76:79], a[176:179], v[24:27]
    ds_read_b128 v[56:59], v2 offset:9216
    v_mfma_f32_16x16x32_bf16 v[28:31], v[80:83], a[176:179], v[28:31]
    ds_read_b128 v[60:63], v2 offset:10240
    v_mfma_f32_16x16x32_bf16 v[32:35], v[84:87], a[176:179], v[32:35]
    ds_read_b128 v[64:67], v2 offset:11264
    s_waitcnt vmcnt(9) lgkmcnt(6)
    v_mfma_f32_16x16x32_bf16 v[16:19], v[88:91], a[180:183], v[16:19]
    ds_read_b128 v[68:71], v2 offset:12288
    buffer_load_dwordx4 a[212:215], v1, s[4:7], s32 offen offset:1024 sc1
    v_mfma_f32_16x16x32_bf16 v[20:23], v[92:95], a[180:183], v[20:23]
    ds_read_b128 v[72:75], v2 offset:13312
    v_mfma_f32_16x16x32_bf16 v[24:27], v[96:99], a[180:183], v[24:27]
    ds_read_b128 v[76:79], v2 offset:14336
    s_add_u32 m0, s22, 0
    s_add_u32 s31, s25, 0
    buffer_load_dwordx4 v1, s[12:15], s31 offen offset:0 lds
    v_mfma_f32_16x16x32_bf16 v[28:31], v[36:39], a[180:183], v[28:31]
    ds_read_b128 v[80:83], v2 offset:15360
    v_mfma_f32_16x16x32_bf16 v[32:35], v[40:43], a[180:183], v[32:35]
    ds_read_b128 v[84:87], v2 offset:16384
    s_waitcnt vmcnt(10) lgkmcnt(6)
    v_mfma_f32_16x16x32_bf16 v[16:19], v[44:47], a[184:187], v[16:19]
    ds_read_b128 v[88:91], v2 offset:17408
    buffer_load_dwordx4 v1, s[12:15], s31 offen offset:1024 lds
    v_mfma_f32_16x16x32_bf16 v[20:23], v[48:51], a[184:187], v[20:23]
    ds_read_b128 v[92:95], v2 offset:18432
    v_mfma_f32_16x16x32_bf16 v[24:27], v[52:55], a[184:187], v[24:27]
    ds_read_b128 v[96:99], v2 offset:19456
    buffer_load_dwordx4 v1, s[12:15], s31 offen offset:2048 lds
    v_mfma_f32_16x16x32_bf16 v[28:31], v[56:59], a[184:187], v[28:31]
    ds_read_b128 v[36:39], v2 offset:20480
    v_mfma_f32_16x16x32_bf16 v[32:35], v[60:63], a[184:187], v[32:35]
    ds_read_b128 v[40:43], v2 offset:21504
    s_waitcnt vmcnt(10) lgkmcnt(6)
    v_mfma_f32_16x16x32_bf16 v[16:19], v[64:67], a[188:191], v[16:19]
    ds_read_b128 v[44:47], v2 offset:22528
    buffer_load_dwordx4 v1, s[12:15], s31 offen offset:3072 lds
    v_mfma_f32_16x16x32_bf16 v[20:23], v[68:71], a[188:191], v[20:23]
    ds_read_b128 v[48:51], v2 offset:23552
    v_mfma_f32_16x16x32_bf16 v[24:27], v[72:75], a[188:191], v[24:27]
    ds_read_b128 v[52:55], v2 offset:24576
    v_mfma_f32_16x16x32_bf16 v[28:31], v[76:79], a[188:191], v[28:31]
    ds_read_b128 v[56:59], v2 offset:25600
    s_add_u32 m0, s22, 16384
    s_add_u32 s31, s25, 16384
    buffer_load_dwordx4 v1, s[12:15], s31 offen offset:0 lds
    v_mfma_f32_16x16x32_bf16 v[32:35], v[80:83], a[188:191], v[32:35]
    ds_read_b128 v[60:63], v2 offset:26624
    s_waitcnt vmcnt(10) lgkmcnt(6)
    v_mfma_f32_16x16x32_bf16 v[16:19], v[84:87], a[192:195], v[16:19]
    ds_read_b128 v[64:67], v2 offset:27648
    v_mfma_f32_16x16x32_bf16 v[20:23], v[88:91], a[192:195], v[20:23]
    ds_read_b128 v[68:71], v2 offset:28672
    buffer_load_dwordx4 v1, s[12:15], s31 offen offset:1024 lds
    v_mfma_f32_16x16x32_bf16 v[24:27], v[92:95], a[192:195], v[24:27]
    ds_read_b128 v[72:75], v2 offset:29696
    v_mfma_f32_16x16x32_bf16 v[28:31], v[96:99], a[192:195], v[28:31]
    ds_read_b128 v[76:79], v2 offset:30720
    v_mfma_f32_16x16x32_bf16 v[32:35], v[36:39], a[192:195], v[32:35]
    ds_read_b128 v[80:83], v2 offset:31744
    s_waitcnt vmcnt(10) lgkmcnt(6)
    v_mfma_f32_16x16x32_bf16 v[16:19], v[40:43], a[196:199], v[16:19]
    s_barrier
    ds_read_b128 v[84:87], v2 offset:32768
    v_mfma_f32_16x16x32_bf16 v[20:23], v[44:47], a[196:199], v[20:23]
    ds_read_b128 v[88:91], v2 offset:33792
    buffer_load_dwordx4 v1, s[12:15], s31 offen offset:2048 lds
    v_mfma_f32_16x16x32_bf16 v[24:27], v[48:51], a[196:199], v[24:27]
    ds_read_b128 v[92:95], v2 offset:34816
    buffer_load_dwordx4 v1, s[12:15], s31 offen offset:3072 lds
    v_mfma_f32_16x16x32_bf16 v[28:31], v[52:55], a[196:199], v[28:31]
    ds_read_b128 v[96:99], v2 offset:35840
    v_mfma_f32_16x16x32_bf16 v[32:35], v[56:59], a[196:199], v[32:35]
    ds_read_b128 v[36:39], v2 offset:36864
    s_waitcnt vmcnt(11) lgkmcnt(6)
    v_mfma_f32_16x16x32_bf16 v[16:19], v[60:63], a[200:203], v[16:19]
    ds_read_b128 v[40:43], v2 offset:37888
    s_add_u32 m0, s22, 32768
    s_add_u32 s31, s25, 32768
    buffer_load_dwordx4 v1, s[12:15], s31 offen offset:0 lds
    v_mfma_f32_16x16x32_bf16 v[20:23], v[64:67], a[200:203], v[20:23]
    ds_read_b128 v[44:47], v2 offset:38912
    v_mfma_f32_16x16x32_bf16 v[24:27], v[68:71], a[200:203], v[24:27]
    ds_read_b128 v[48:51], v2 offset:39936
    buffer_load_dwordx4 v1, s[12:15], s31 offen offset:1024 lds
    v_mfma_f32_16x16x32_bf16 v[28:31], v[72:75], a[200:203], v[28:31]
    ds_read_b128 v[52:55], v2 offset:40960
    v_mfma_f32_16x16x32_bf16 v[32:35], v[76:79], a[200:203], v[32:35]
    ds_read_b128 v[56:59], v2 offset:41984
    s_waitcnt vmcnt(12) lgkmcnt(6)
    v_mfma_f32_16x16x32_bf16 v[16:19], v[80:83], a[204:207], v[16:19]
    ds_read_b128 v[60:63], v2 offset:43008
    buffer_load_dwordx4 v1, s[12:15], s31 offen offset:2048 lds
    v_mfma_f32_16x16x32_bf16 v[20:23], v[84:87], a[204:207], v[20:23]
    ds_read_b128 v[64:67], v2 offset:44032
    v_mfma_f32_16x16x32_bf16 v[24:27], v[88:91], a[204:207], v[24:27]
    ds_read_b128 v[68:71], v2 offset:45056
    v_mfma_f32_16x16x32_bf16 v[28:31], v[92:95], a[204:207], v[28:31]
    ds_read_b128 v[72:75], v2 offset:46080
    buffer_load_dwordx4 v1, s[12:15], s31 offen offset:3072 lds
    v_mfma_f32_16x16x32_bf16 v[32:35], v[96:99], a[204:207], v[32:35]
    s_waitcnt vmcnt(13) lgkmcnt(5)
    v_mfma_f32_16x16x32_bf16 v[16:19], v[36:39], a[208:211], v[16:19]
    s_add_u32 m0, s22, 49152
    s_add_u32 s31, s25, 49152
    buffer_load_dwordx4 v1, s[12:15], s31 offen offset:0 lds
    v_mfma_f32_16x16x32_bf16 v[20:23], v[40:43], a[208:211], v[20:23]
    v_mfma_f32_16x16x32_bf16 v[24:27], v[44:47], a[208:211], v[24:27]
    v_mfma_f32_16x16x32_bf16 v[28:31], v[48:51], a[208:211], v[28:31]
    buffer_load_dwordx4 v1, s[12:15], s31 offen offset:1024 lds
    v_mfma_f32_16x16x32_bf16 v[32:35], v[52:55], a[208:211], v[32:35]
    s_waitcnt vmcnt(14) lgkmcnt(0)
    v_mfma_f32_16x16x32_bf16 v[16:19], v[56:59], a[212:215], v[16:19]
    v_mfma_f32_16x16x32_bf16 v[20:23], v[60:63], a[212:215], v[20:23]
    buffer_load_dwordx4 v1, s[12:15], s31 offen offset:2048 lds
    v_mfma_f32_16x16x32_bf16 v[24:27], v[64:67], a[212:215], v[24:27]
    v_mfma_f32_16x16x32_bf16 v[28:31], v[68:71], a[212:215], v[28:31]
    v_mfma_f32_16x16x32_bf16 v[32:35], v[72:75], a[212:215], v[32:35]
    buffer_load_dwordx4 v1, s[12:15], s31 offen offset:3072 lds
    s_nop 1
    v_cvt_pk_bf16_f32 v212, v16, v17
    v_cvt_pk_bf16_f32 v213, v18, v19
    v_cvt_pk_bf16_f32 v214, v20, v21
    v_cvt_pk_bf16_f32 v215, v22, v23
    v_cvt_pk_bf16_f32 v216, v24, v25
    v_cvt_pk_bf16_f32 v217, v26, v27
    v_cvt_pk_bf16_f32 v218, v28, v29
    v_cvt_pk_bf16_f32 v219, v30, v31
    v_cvt_pk_bf16_f32 v220, v32, v33
    v_cvt_pk_bf16_f32 v221, v34, v35
    s_cmp_eq_u32 s21, 1
    s_cbranch_scc1 Lfin7
    s_mov_b32 s60, 1
    s_mul_i32 s62, s60, 2621440
    s_mul_i32 s33, s43, 20480
    s_add_u32 s62, s62, s33
    s_add_u32 s62, s62, 4194304
    s_lshr_b32 s33, s20, 1
    s_mul_i32 s33, s33, 5
    s_lshl_b32 s34, s64, 1
    s_add_u32 s34, s34, s33
    s_lshl_b32 s34, s34, 10
    s_add_u32 s34, s34, s62
    buffer_store_dwordx4 v[212:215], v1, s[4:7], s34 offen
    buffer_store_dwordx4 v[216:219], v1, s[4:7], s34 offen offset:1024
    s_add_u32 s33, s33, 4
    s_lshl_b32 s33, s33, 10
    s_add_u32 s33, s33, s62
    s_lshl_b32 s34, s64, 3
    s_add_u32 s33, s33, s34
    buffer_store_dwordx2 v[220:221], v1, s[4:7], s33 offen
    v_add_f32 v224, v16, v17
    v_mul_f32 v225, v16, v16
    v_fmac_f32 v225, v17, v17
    v_add_f32 v226, v18, v19
    v_mul_f32 v227, v18, v18
    v_fmac_f32 v227, v19, v19
    v_add_f32 v224, v224, v20
    v_fmac_f32 v225, v20, v20
    v_add_f32 v226, v226, v21
    v_fmac_f32 v227, v21, v21
    v_add_f32 v224, v224, v22
    v_fmac_f32 v225, v22, v22
    v_add_f32 v226, v226, v23
    v_fmac_f32 v227, v23, v23
    v_add_f32 v224, v224, v24
    v_fmac_f32 v225, v24, v24
    v_add_f32 v226, v226, v25
    v_fmac_f32 v227, v25, v25
    v_add_f32 v224, v224, v26
    v_fmac_f32 v225, v26, v26
    v_add_f32 v226, v226, v27
    v_fmac_f32 v227, v27, v27
    v_add_f32 v224, v224, v28
    v_fmac_f32 v225, v28, v28
    v_add_f32 v226, v226, v29
    v_fmac_f32 v227, v29, v29
    v_add_f32 v224, v224, v30
    v_fmac_f32 v225, v30, v30
    v_add_f32 v226, v226, v31
    v_fmac_f32 v227, v31, v31
    v_add_f32 v224, v224, v32
    v_fmac_f32 v225, v32, v32
    v_add_f32 v226, v226, v33
    v_fmac_f32 v227, v33, v33
    v_add_f32 v224, v224, v34
    v_fmac_f32 v225, v34, v34
    v_add_f32 v226, v226, v35
    v_fmac_f32 v227, v35, v35
    v_add_f32 v224, v224, v226
    v_add_f32 v225, v225, v227
    v_mov_b32 v226, v224
    v_mov_b32 v227, v225
    s_nop 0
    v_permlane32_swap_b32 v224, v226
    v_permlane32_swap_b32 v225, v227
    v_add_f32 v224, v224, v226
    v_add_f32 v225, v225, v227
    v_mov_b32 v226, v224
    v_mov_b32 v227, v225
    s_nop 0
    v_permlane16_swap_b32 v224, v226
    v_permlane16_swap_b32 v225, v227
    v_add_f32 v224, v224, v226
    v_add_f32 v225, v225, v227
    s_mul_i32 s62, s60, 131072
    s_lshl_b32 s33, s43, 10
    s_add_u32 s62, s62, s33
    s_lshl_b32 s33, s20, 7
    s_add_u32 s62, s62, s33
    s_add_u32 s62, s62, 393216
    s_mov_b64 exec, s[48:49]
    buffer_store_dwordx2 v[224:225], v12, s[4:7], s62 offen
    s_mov_b64 exec, -1
    s_branch Lfin7_x
Lfin7:
    s_mul_i32 s62, s43, 20480
    s_mul_i32 s33, s20, 160
    s_add_u32 s62, s62, s33
    buffer_store_dwordx2 v[212:213], v15, s[8:11], s62 offen offset:0
    buffer_store_dwordx2 v[214:215], v15, s[8:11], s62 offen offset:32
    buffer_store_dwordx2 v[216:217], v15, s[8:11], s62 offen offset:64
    buffer_store_dwordx2 v[218:219], v15, s[8:11], s62 offen offset:96
    buffer_store_dwordx2 v[220:221], v15, s[8:11], s62 offen offset:128
    s_waitcnt vmcnt(0)
    s_endpgm
Lfin7_x:
    s_cmp_lg_u32 s16, 0
    s_cbranch_scc1 Lt8_a
    s_waitcnt vmcnt(0)
    s_branch Lt8_b
Lt8_a:
    s_waitcnt vmcnt(0)
Lt8_b:
    s_barrier
    s_add_u32 s33, s41, 5
    v_mov_b32 v254, s33
    v_mov_b32 v255, 0
    s_mov_b64 exec, s[44:45]
    buffer_store_dword v254, v255, s[4:7], s37 offen
    s_mov_b64 exec, -1
    s_cmp_lg_u32 s16, 0
    s_cbranch_scc1 Lt8_c
    s_add_u32 s33, s41, 5
    s_mov_b32 s47, 0
    v_subrev_u32 v252, 0x20000, v5
Lt8_p:
    buffer_load_dword v253, v252, s[4:7], s38 offen sc1
    s_waitcnt vmcnt(0)
    v_cmp_gt_u32 vcc, s33, v253
    s_add_u32 s47, s47, 1
    s_cmp_gt_u32 s47, 20000
    s_cbranch_scc1 Lt8_p_x
    s_nop 1
    s_cbranch_vccnz Lt8_p
Lt8_p_x:
    s_add_u32 m0, s22, 65536
    s_add_u32 s31, s25, 65536
    buffer_load_dwordx4 v1, s[12:15], s31 offen offset:0 lds
    buffer_load_dwordx4 v1, s[12:15], s31 offen offset:1024 lds
    buffer_load_dwordx4 v1, s[12:15], s31 offen offset:2048 lds
    buffer_load_dwordx4 v1, s[12:15], s31 offen offset:3072 lds
    s_branch Lt8_o
Lt8_c:
    s_add_u32 m0, s22, 65536
    s_add_u32 s31, s25, 65536
    buffer_load_dwordx4 v1, s[12:15], s31 offen offset:0 lds
    buffer_load_dwordx4 v1, s[12:15], s31 offen offset:1024 lds
    buffer_load_dwordx4 v1, s[12:15], s31 offen offset:2048 lds
    buffer_load_dwordx4 v1, s[12:15], s31 offen offset:3072 lds
Lt8_o:
    s_barrier
    s_add_u32 s21, s21, 1
    s_add_u32 s41, s41, 5
    s_branch Lm_layerF
Lm_layerS:
    s_cmp_eq_u32 s21, 1
    s_cselect_b32 s14, 0, 50331648
    s_mul_i32 s32, s60, 2621440
    s_mul_i32 s33, s42, 20480
    s_add_u32 s32, s32, s33
    s_add_u32 s32, s32, 4194304
    s_mul_i32 s62, s60, 131072
    s_lshl_b32 s63, s42, 10
    s_add_u32 s62, s62, s63
    s_add_u32 s62, s62, 393216
    buffer_load_dwordx2 v[212:213], v12, s[4:7], s62 offen offset:0 sc1
    buffer_load_dwordx2 v[214:215], v12, s[4:7], s62 offen offset:128 sc1
    buffer_load_dwordx2 v[216:217], v12, s[4:7], s62 offen offset:1024 sc1
    buffer_load_dwordx2 v[218:219], v12, s[4:7], s62 offen offset:1152 sc1
    s_waitcnt vmcnt(16)
    s_barrier
    ds_read_b128 v[36:39], v1 offset:0
    ds_read_b128 v[40:43], v1 offset:1024
    ds_read_b128 v[44:47], v1 offset:2048
    ds_read_b128 v[48:51], v1 offset:3072
    ds_read_b128 v[52:55], v1 offset:4096
    buffer_load_dwordx4 a[0:3], v1, s[4:7], s32 offen offset:0 sc1
    buffer_load_dwordx4 a[80:83], v4, s[4:7], s32 offen offset:0 sc1
    buffer_load_dwordx4 a[4:7], v1, s[4:7], s32 offen offset:1024 sc1
    buffer_load_dwordx4 a[84:87], v4, s[4:7], s32 offen offset:1024 sc1
    buffer_load_dwordx4 a[8:11], v1, s[4:7], s32 offen offset:2048 sc1
    buffer_load_dwordx4 a[88:91], v4, s[4:7], s32 offen offset:2048 sc1
    buffer_load_dwordx4 a[12:15], v1, s[4:7], s32 offen offset:3072 sc1
    buffer_load_dwordx4 a[92:95], v4, s[4:7], s32 offen offset:3072 sc1
    s_add_u32 s32, s32, 4096
    buffer_load_dwordx4 a[16:19], v1, s[4:7], s32 offen offset:0 sc1
    buffer_load_dwordx4 a[96:99], v4, s[4:7], s32 offen offset:0 sc1
    s_waitcnt vmcnt(8) lgkmcnt(0)
    v_mfma_f32_16x16x32_bf16 v[100:103], a[0:3], v[36:39], 0
    ds_read_b128 v[56:59], v1 offset:5120
    ds_read_b128 v[60:63], v1 offset:6144
    v_mfma_f32_16x16x32_bf16 v[104:107], a[80:83], v[36:39], 0
    ds_read_b128 v[64:67], v1 offset:7168
    ds_read_b128 v[68:71], v1 offset:8192
    v_mfma_f32_16x16x32_bf16 v[108:111], a[0:3], v[40:43], 0
    ds_read_b128 v[72:75], v1 offset:9216
    buffer_load_dwordx4 a[20:23], v1, s[4:7], s32 offen offset:1024 sc1
    v_mfma_f32_16x16x32_bf16 v[112:115], a[80:83], v[40:43], 0
    v_mfma_f32_16x16x32_bf16 v[116:119], a[0:3], v[44:47], 0
    v_mfma_f32_16x16x32_bf16 v[120:123], a[80:83], v[44:47], 0
    buffer_load_dwordx4 a[100:103], v4, s[4:7], s32 offen offset:1024 sc1
    v_mfma_f32_16x16x32_bf16 v[124:127], a[0:3], v[48:51], 0
    v_mfma_f32_16x16x32_bf16 v[128:131], a[80:83], v[48:51], 0
    v_mfma_f32_16x16x32_bf16 v[132:135], a[0:3], v[52:55], 0
    v_mfma_f32_16x16x32_bf16 v[136:139], a[80:83], v[52:55], 0
    ds_read_b128 v[76:79], v1 offset:10240
    s_waitcnt vmcnt(8) lgkmcnt(1)
    v_mfma_f32_16x16x32_bf16 v[100:103], a[4:7], v[56:59], v[100:103]
    ds_read_b128 v[80:83], v1 offset:11264
    ds_read_b128 v[84:87], v1 offset:12288
    v_mfma_f32_16x16x32_bf16 v[104:107], a[84:87], v[56:59], v[104:107]
    ds_read_b128 v[88:91], v1 offset:13312
    ds_read_b128 v[92:95], v1 offset:14336
    v_mfma_f32_16x16x32_bf16 v[108:111], a[4:7], v[60:63], v[108:111]
    buffer_load_dwordx4 a[24:27], v1, s[4:7], s32 offen offset:2048 sc1
    v_mfma_f32_16x16x32_bf16 v[112:115], a[84:87], v[60:63], v[112:115]
    buffer_load_dwordx4 a[104:107], v4, s[4:7], s32 offen offset:2048 sc1
    v_mfma_f32_16x16x32_bf16 v[116:119], a[4:7], v[64:67], v[116:119]
    v_mfma_f32_16x16x32_bf16 v[120:123], a[84:87], v[64:67], v[120:123]
    v_mfma_f32_16x16x32_bf16 v[124:127], a[4:7], v[68:71], v[124:127]
    v_mfma_f32_16x16x32_bf16 v[128:131], a[84:87], v[68:71], v[128:131]
    buffer_load_dwordx4 a[28:31], v1, s[4:7], s32 offen offset:3072 sc1
    v_mfma_f32_16x16x32_bf16 v[132:135], a[4:7], v[72:75], v[132:135]
    v_mfma_f32_16x16x32_bf16 v[136:139], a[84:87], v[72:75], v[136:139]
    ds_read_b128 v[96:99], v1 offset:15360
    s_waitcnt vmcnt(9) lgkmcnt(1)
    v_mfma_f32_16x16x32_bf16 v[100:103], a[8:11], v[76:79], v[100:103]
    ds_read_b128 v[36:39], v1 offset:16384
    ds_read_b128 v[40:43], v1 offset:17408
    v_mfma_f32_16x16x32_bf16 v[104:107], a[88:91], v[76:79], v[104:107]
    ds_read_b128 v[44:47], v1 offset:18432
    ds_read_b128 v[48:51], v1 offset:19456
    v_mfma_f32_16x16x32_bf16 v[108:111], a[8:11], v[80:83], v[108:111]
    buffer_load_dwordx4 a[108:111], v4, s[4:7], s32 offen offset:3072 sc1
    v_mfma_f32_16x16x32_bf16 v[112:115], a[88:91], v[80:83], v[112:115]
    v_mfma_f32_16x16x32_bf16 v[116:119], a[8:11], v[84:87], v[116:119]
    s_add_u32 m0, s22, 81920
    s_add_u32 s31, s25, 81920
    buffer_load_dwordx4 v1, s[4:7], s31 offen offset:0 lds
    v_mfma_f32_16x16x32_bf16 v[120:123], a[88:91], v[84:87], v[120:123]
    v_mfma_f32_16x16x32_bf16 v[124:127], a[8:11], v[88:91], v[124:127]
    v_mfma_f32_16x16x32_bf16 v[128:131], a[88:91], v[88:91], v[128:131]
    v_mfma_f32_16x16x32_bf16 v[132:135], a[8:11], v[92:95], v[132:135]
    buffer_load_dwordx4 v1, s[4:7], s31 offen offset:1024 lds
    v_mfma_f32_16x16x32_bf16 v[136:139], a[88:91], v[92:95], v[136:139]
    ds_read_b128 v[52:55], v1 offset:20480
    s_waitcnt vmcnt(10) lgkmcnt(1)
    v_mfma_f32_16x16x32_bf16 v[100:103], a[12:15], v[96:99], v[100:103]
    ds_read_b128 v[56:59], v1 offset:21504
    ds_read_b128 v[60:63], v1 offset:22528
    v_mfma_f32_16x16x32_bf16 v[104:107], a[92:95], v[96:99], v[104:107]
    ds_read_b128 v[64:67], v1 offset:23552
    ds_read_b128 v[68:71], v1 offset:24576
    v_mfma_f32_16x16x32_bf16 v[108:111], a[12:15], v[36:39], v[108:111]
    buffer_load_dwordx4 v1, s[4:7], s31 offen offset:2048 lds
    v_mfma_f32_16x16x32_bf16 v[112:115], a[92:95], v[36:39], v[112:115]
    v_mfma_f32_16x16x32_bf16 v[116:119], a[12:15], v[40:43], v[116:119]
    v_mfma_f32_16x16x32_bf16 v[120:123], a[92:95], v[40:43], v[120:123]
    v_mfma_f32_16x16x32_bf16 v[124:127], a[12:15], v[44:47], v[124:127]
    buffer_load_dwordx4 v1, s[4:7], s31 offen offset:3072 lds
    v_mfma_f32_16x16x32_bf16 v[128:131], a[92:95], v[44:47], v[128:131]
    v_mfma_f32_16x16x32_bf16 v[132:135], a[12:15], v[48:51], v[132:135]
    v_mfma_f32_16x16x32_bf16 v[136:139], a[92:95], v[48:51], v[136:139]
    ds_read_b128 v[72:75], v1 offset:25600
    s_waitcnt vmcnt(10) lgkmcnt(1)
    v_mfma_f32_16x16x32_bf16 v[100:103], a[16:19], v[52:55], v[100:103]
    ds_read_b128 v[76:79], v1 offset:26624
    ds_read_b128 v[80:83], v1 offset:27648
    v_mfma_f32_16x16x32_bf16 v[104:107], a[96:99], v[52:55], v[104:107]
    ds_read_b128 v[84:87], v1 offset:28672
    ds_read_b128 v[88:91], v1 offset:29696
    v_mfma_f32_16x16x32_bf16 v[108:111], a[16:19], v[56:59], v[108:111]
    s_add_u32 s32, s32, 4096
    buffer_load_dwordx4 a[32:35], v1, s[4:7], s32 offen offset:0 sc1
    v_mfma_f32_16x16x32_bf16 v[112:115], a[96:99], v[56:59], v[112:115]
    buffer_load_dwordx4 a[112:115], v4, s[4:7], s32 offen offset:0 sc1
    v_add_f32 v212, v212, v214
    v_mfma_f32_16x16x32_bf16 v[116:119], a[16:19], v[60:63], v[116:119]
    v_add_f32 v213, v213, v215
    v_mov_b32 v224, v212
    v_mfma_f32_16x16x32_bf16 v[120:123], a[96:99], v[60:63], v[120:123]
    v_mov_b32 v225, v213
    v_permlane32_swap_b32 v212, v224
    v_mfma_f32_16x16x32_bf16 v[124:127], a[16:19], v[64:67], v[124:127]
    v_permlane32_swap_b32 v213, v225
    v_add_f32 v212, v212, v224
    v_mfma_f32_16x16x32_bf16 v[128:131], a[96:99], v[64:67], v[128:131]
    buffer_load_dwordx4 a[36:39], v1, s[4:7], s32 offen offset:1024 sc1
    v_add_f32 v213, v213, v225
    v_mfma_f32_16x16x32_bf16 v[132:135], a[16:19], v[68:71], v[132:135]
    v_mov_b32 v224, v212
    v_mov_b32 v225, v213
    v_mfma_f32_16x16x32_bf16 v[136:139], a[96:99], v[68:71], v[136:139]
    ds_read_b128 v[92:95], v1 offset:30720
    s_waitcnt vmcnt(11) lgkmcnt(1)
    v_mfma_f32_16x16x32_bf16 v[100:103], a[20:23], v[72:75], v[100:103]
    ds_read_b128 v[96:99], v1 offset:31744
    s_barrier
    ds_read_b128 v[36:39], v1 offset:32768
    v_mfma_f32_16x16x32_bf16 v[104:107], a[100:103], v[72:75], v[104:107]
    ds_read_b128 v[40:43], v1 offset:33792
    ds_read_b128 v[44:47], v1 offset:34816
    v_mfma_f32_16x16x32_bf16 v[108:111], a[20:23], v[76:79], v[108:111]
    buffer_load_dwordx4 a[116:119], v4, s[4:7], s32 offen offset:1024 sc1
    v_permlane16_swap_b32 v212, v224
    v_mfma_f32_16x16x32_bf16 v[112:115], a[100:103], v[76:79], v[112:115]
    v_permlane16_swap_b32 v213, v225
    v_add_f32 v212, v212, v224
    v_mfma_f32_16x16x32_bf16 v[116:119], a[20:23], v[80:83], v[116:119]
    v_add_f32 v213, v213, v225
    v_mul_f32 v220, 0xbacccccd, v212
    v_mfma_f32_16x16x32_bf16 v[120:123], a[100:103], v[80:83], v[120:123]
    buffer_load_dwordx4 a[40:43], v1, s[4:7], s32 offen offset:2048 sc1
    v_mul_f32 v213, 0x3acccccd, v213
    v_mfma_f32_16x16x32_bf16 v[124:127], a[20:23], v[84:87], v[124:127]
    v_fma_f32 v213, -v220, v220, v213
    v_max_f32 v213, 0, v213
    v_mfma_f32_16x16x32_bf16 v[128:131], a[100:103], v[84:87], v[128:131]
    v_add_f32 v213, 0x3727c5ac, v213
    v_mfma_f32_16x16x32_bf16 v[132:135], a[20:23], v[88:91], v[132:135]
    buffer_load_dwordx4 a[120:123], v4, s[4:7], s32 offen offset:2048 sc1
    v_mfma_f32_16x16x32_bf16 v[136:139], a[100:103], v[88:91], v[136:139]
    ds_read_b128 v[48:51], v1 offset:35840
    s_waitcnt vmcnt(12) lgkmcnt(1)
    v_mfma_f32_16x16x32_bf16 v[100:103], a[24:27], v[92:95], v[100:103]
    ds_read_b128 v[52:55], v1 offset:36864
    ds_read_b128 v[56:59], v1 offset:37888
    v_mfma_f32_16x16x32_bf16 v[104:107], a[104:107], v[92:95], v[104:107]
    ds_read_b128 v[60:63], v1 offset:38912
    ds_read_b128 v[64:67], v1 offset:39936
    v_mfma_f32_16x16x32_bf16 v[108:111], a[24:27], v[96:99], v[108:111]
    buffer_load_dwordx4 a[44:47], v1, s[4:7], s32 offen offset:3072 sc1
    v_mfma_f32_16x16x32_bf16 v[112:115], a[104:107], v[96:99], v[112:115]
    v_rsq_f32 v221, v213
    v_mfma_f32_16x16x32_bf16 v[116:119], a[24:27], v[36:39], v[116:119]
    v_add_f32 v216, v216, v218
    v_add_f32 v217, v217, v219
    v_mfma_f32_16x16x32_bf16 v[120:123], a[104:107], v[36:39], v[120:123]
    v_mov_b32 v224, v216
    v_mov_b32 v225, v217
    v_mfma_f32_16x16x32_bf16 v[124:127], a[24:27], v[40:43], v[124:127]
    buffer_load_dwordx4 a[124:127], v4, s[4:7], s32 offen offset:3072 sc1
    v_permlane32_swap_b32 v216, v224
    v_mfma_f32_16x16x32_bf16 v[128:131], a[104:107], v[40:43], v[128:131]
    v_permlane32_swap_b32 v217, v225
    v_add_f32 v216, v216, v224
    v_mfma_f32_16x16x32_bf16 v[132:135], a[24:27], v[44:47], v[132:135]
    v_add_f32 v217, v217, v225
    v_mov_b32 v224, v216
    v_mfma_f32_16x16x32_bf16 v[136:139], a[104:107], v[44:47], v[136:139]
    ds_read_b128 v[68:71], v1 offset:40960
    s_waitcnt vmcnt(12) lgkmcnt(1)
    v_mfma_f32_16x16x32_bf16 v[100:103], a[28:31], v[48:51], v[100:103]
    ds_read_b128 v[72:75], v1 offset:41984
    ds_read_b128 v[76:79], v1 offset:43008
    v_mfma_f32_16x16x32_bf16 v[104:107], a[108:111], v[48:51], v[104:107]
    ds_read_b128 v[80:83], v1 offset:44032
    ds_read_b128 v[84:87], v1 offset:45056
    v_mfma_f32_16x16x32_bf16 v[108:111], a[28:31], v[52:55], v[108:111]
    s_add_u32 s32, s32, 4096
    buffer_load_dwordx4 a[48:51], v1, s[4:7], s32 offen offset:0 sc1
    v_mfma_f32_16x16x32_bf16 v[112:115], a[108:111], v[52:55], v[112:115]
    v_mov_b32 v225, v217
    v_permlane16_swap_b32 v216, v224
    v_mfma_f32_16x16x32_bf16 v[116:119], a[28:31], v[56:59], v[116:119]
    buffer_load_dwordx4 a[128:131], v4, s[4:7], s32 offen offset:0 sc1
    v_permlane16_swap_b32 v217, v225
    v_mfma_f32_16x16x32_bf16 v[120:123], a[108:111], v[56:59], v[120:123]
    v_add_f32 v216, v216, v224
    v_add_f32 v217, v217, v225
    v_mfma_f32_16x16x32_bf16 v[124:127], a[28:31], v[60:63], v[124:127]
    v_mul_f32 v222, 0xbacccccd, v216
    v_mul_f32 v217, 0x3acccccd, v217
    v_mfma_f32_16x16x32_bf16 v[128:131], a[108:111], v[60:63], v[128:131]
    buffer_load_dwordx4 a[52:55], v1, s[4:7], s32 offen offset:1024 sc1
    v_fma_f32 v217, -v222, v222, v217
    v_mfma_f32_16x16x32_bf16 v[132:135], a[28:31], v[64:67], v[132:135]
    v_max_f32 v217, 0, v217
    v_add_f32 v217, 0x3727c5ac, v217
    v_mfma_f32_16x16x32_bf16 v[136:139], a[108:111], v[64:67], v[136:139]
    ds_read_b128 v[88:91], v1 offset:46080
    s_waitcnt vmcnt(9) lgkmcnt(1)
    v_mfma_f32_16x16x32_bf16 v[100:103], a[32:35], v[68:71], v[100:103]
    ds_read_b128 v[92:95], v1 offset:47104
    ds_read_b128 v[96:99], v1 offset:48128
    v_mfma_f32_16x16x32_bf16 v[104:107], a[112:115], v[68:71], v[104:107]
    ds_read_b128 v[36:39], v1 offset:49152
    ds_read_b128 v[40:43], v1 offset:50176
    v_mfma_f32_16x16x32_bf16 v[108:111], a[32:35], v[72:75], v[108:111]
    buffer_load_dwordx4 a[132:135], v4, s[4:7], s32 offen offset:1024 sc1
    v_mfma_f32_16x16x32_bf16 v[112:115], a[112:115], v[72:75], v[112:115]
    v_rsq_f32 v223, v217
    v_mfma_f32_16x16x32_bf16 v[116:119], a[32:35], v[76:79], v[116:119]
    ds_write_b32 v6, v220 offset:17920
    ds_write_b32 v6, v221 offset:17984
    v_mfma_f32_16x16x32_bf16 v[120:123], a[112:115], v[76:79], v[120:123]
    s_add_u32 m0, s22, 98304
    s_add_u32 s31, s25, 98304
    buffer_load_dwordx4 v1, s[4:7], s31 offen offset:0 lds
    v_mfma_f32_16x16x32_bf16 v[124:127], a[32:35], v[80:83], v[124:127]
    ds_write_b32 v6, v222 offset:18048
    ds_write_b32 v6, v223 offset:18112
    v_mfma_f32_16x16x32_bf16 v[128:131], a[112:115], v[80:83], v[128:131]
    s_waitcnt lgkmcnt(0)
    ds_read_b128 v[226:229], v8 offset:17920
    ds_read_b128 v[230:233], v8 offset:17984
    v_mfma_f32_16x16x32_bf16 v[132:135], a[32:35], v[84:87], v[132:135]
    ds_read_b128 v[234:237], v8 offset:18048
    ds_read_b128 v[238:241], v8 offset:18112
    v_mfma_f32_16x16x32_bf16 v[136:139], a[112:115], v[84:87], v[136:139]
    ds_read_b128 v[44:47], v1 offset:51200
    s_waitcnt vmcnt(9)
    v_mfma_f32_16x16x32_bf16 v[100:103], a[36:39], v[88:91], v[100:103]
    ds_read_b128 v[48:51], v1 offset:52224
    ds_read_b128 v[52:55], v1 offset:53248
    v_mfma_f32_16x16x32_bf16 v[104:107], a[116:119], v[88:91], v[104:107]
    ds_read_b128 v[56:59], v1 offset:54272
    ds_read_b128 v[60:63], v1 offset:55296
    v_mfma_f32_16x16x32_bf16 v[108:111], a[36:39], v[92:95], v[108:111]
    buffer_load_dwordx4 v1, s[4:7], s31 offen offset:1024 lds
    s_waitcnt lgkmcnt(5)
    v_mul_f32 v242, 0x3fb8aa3b, v230
    v_mfma_f32_16x16x32_bf16 v[112:115], a[116:119], v[92:95], v[112:115]
    buffer_load_dwordx4 v1, s[4:7], s31 offen offset:2048 lds
    v_mul_f32 v243, 0x3fb8aa3b, v231
    v_mfma_f32_16x16x32_bf16 v[116:119], a[36:39], v[96:99], v[116:119]
    v_mul_f32 v244, 0x3fb8aa3b, v232
    v_mul_f32 v245, 0x3fb8aa3b, v233
    v_mfma_f32_16x16x32_bf16 v[120:123], a[116:119], v[96:99], v[120:123]
    v_mul_f32 v246, 0x3fb8aa3b, v238
    v_mul_f32 v247, 0x3fb8aa3b, v239
    v_mfma_f32_16x16x32_bf16 v[124:127], a[36:39], v[36:39], v[124:127]
    buffer_load_dwordx4 v1, s[4:7], s31 offen offset:3072 lds
    v_mul_f32 v248, 0x3fb8aa3b, v240
    v_mfma_f32_16x16x32_bf16 v[128:131], a[116:119], v[36:39], v[128:131]
    v_mul_f32 v249, 0x3fb8aa3b, v241
    v_mfma_f32_16x16x32_bf16 v[132:135], a[36:39], v[40:43], v[132:135]
    v_mfma_f32_16x16x32_bf16 v[136:139], a[116:119], v[40:43], v[136:139]
    ds_read_b128 v[64:67], v1 offset:56320
    s_waitcnt vmcnt(10) lgkmcnt(1)
    v_mfma_f32_16x16x32_bf16 v[100:103], a[40:43], v[44:47], v[100:103]
    ds_read_b128 v[68:71], v1 offset:57344
    ds_read_b128 v[72:75], v1 offset:58368
    v_mfma_f32_16x16x32_bf16 v[104:107], a[120:123], v[44:47], v[104:107]
    ds_read_b128 v[76:79], v1 offset:59392
    ds_read_b128 v[80:83], v1 offset:60416
    v_mfma_f32_16x16x32_bf16 v[108:111], a[40:43], v[48:51], v[108:111]
    buffer_load_dwordx4 a[56:59], v1, s[4:7], s32 offen offset:2048 sc1
    v_mfma_f32_16x16x32_bf16 v[112:115], a[120:123], v[48:51], v[112:115]
    v_mfma_f32_16x16x32_bf16 v[116:119], a[40:43], v[52:55], v[116:119]
    buffer_load_dwordx4 a[136:139], v4, s[4:7], s32 offen offset:2048 sc1
    v_mfma_f32_16x16x32_bf16 v[120:123], a[120:123], v[52:55], v[120:123]
    v_mfma_f32_16x16x32_bf16 v[124:127], a[40:43], v[56:59], v[124:127]
    v_mfma_f32_16x16x32_bf16 v[128:131], a[120:123], v[56:59], v[128:131]
    v_mfma_f32_16x16x32_bf16 v[132:135], a[40:43], v[60:63], v[132:135]
    buffer_load_dwordx4 a[60:63], v1, s[4:7], s32 offen offset:3072 sc1
    v_mfma_f32_16x16x32_bf16 v[136:139], a[120:123], v[60:63], v[136:139]
    ds_read_b128 v[84:87], v1 offset:61440
    s_waitcnt vmcnt(11) lgkmcnt(1)
    v_mfma_f32_16x16x32_bf16 v[100:103], a[44:47], v[64:67], v[100:103]
    ds_read_b128 v[88:91], v1 offset:62464
    ds_read_b128 v[92:95], v1 offset:63488
    v_mfma_f32_16x16x32_bf16 v[104:107], a[124:127], v[64:67], v[104:107]
    ds_read_b128 v[96:99], v1 offset:64512
    s_barrier
    ds_read_b128 v[36:39], v2 offset:0
    v_mfma_f32_16x16x32_bf16 v[108:111], a[44:47], v[68:71], v[108:111]
    buffer_load_dwordx4 a[140:143], v4, s[4:7], s32 offen offset:3072 sc1
    v_mfma_f32_16x16x32_bf16 v[112:115], a[124:127], v[68:71], v[112:115]
    v_mfma_f32_16x16x32_bf16 v[116:119], a[44:47], v[72:75], v[116:119]
    v_mfma_f32_16x16x32_bf16 v[120:123], a[124:127], v[72:75], v[120:123]
    s_add_u32 s32, s32, 4096
    buffer_load_dwordx4 a[64:67], v1, s[4:7], s32 offen offset:0 sc1
    v_mfma_f32_16x16x32_bf16 v[124:127], a[44:47], v[76:79], v[124:127]
    v_mfma_f32_16x16x32_bf16 v[128:131], a[124:127], v[76:79], v[128:131]
    v_mfma_f32_16x16x32_bf16 v[132:135], a[44:47], v[80:83], v[132:135]
    v_mfma_f32_16x16x32_bf16 v[136:139], a[124:127], v[80:83], v[136:139]
    ds_read_b128 v[40:43], v2 offset:1024
    s_waitcnt vmcnt(11) lgkmcnt(1)
    v_mfma_f32_16x16x32_bf16 v[100:103], a[48:51], v[84:87], v[100:103]
    ds_read_b128 v[44:47], v2 offset:2048
    ds_read_b128 v[48:51], v2 offset:3072
    v_mfma_f32_16x16x32_bf16 v[104:107], a[128:131], v[84:87], v[104:107]
    ds_read_b128 v[52:55], v2 offset:4096
    ds_read_b128 v[56:59], v2 offset:5120
    v_mfma_f32_16x16x32_bf16 v[108:111], a[48:51], v[88:91], v[108:111]
    buffer_load_dwordx4 a[144:147], v4, s[4:7], s32 offen offset:0 sc1
    v_mfma_f32_16x16x32_bf16 v[112:115], a[128:131], v[88:91], v[112:115]
    buffer_load_dwordx4 a[68:71], v1, s[4:7], s32 offen offset:1024 sc1
    v_mfma_f32_16x16x32_bf16 v[116:119], a[48:51], v[92:95], v[116:119]
    v_mfma_f32_16x16x32_bf16 v[120:123], a[128:131], v[92:95], v[120:123]
    v_mfma_f32_16x16x32_bf16 v[124:127], a[48:51], v[96:99], v[124:127]
    v_mfma_f32_16x16x32_bf16 v[128:131], a[128:131], v[96:99], v[128:131]
    buffer_load_dwordx4 a[148:151], v4, s[4:7], s32 offen offset:1024 sc1
    v_mfma_f32_16x16x32_bf16 v[132:135], a[48:51], v[36:39], v[132:135]
    v_mfma_f32_16x16x32_bf16 v[136:139], a[128:131], v[36:39], v[136:139]
    ds_read_b128 v[60:63], v2 offset:6144
    s_waitcnt vmcnt(12) lgkmcnt(1)
    v_mfma_f32_16x16x32_bf16 v[100:103], a[52:55], v[40:43], v[100:103]
    ds_read_b128 v[64:67], v2 offset:7168
    ds_read_b128 v[68:71], v2 offset:8192
    v_mfma_f32_16x16x32_bf16 v[104:107], a[132:135], v[40:43], v[104:107]
    ds_read_b128 v[72:75], v2 offset:9216
    ds_read_b128 v[76:79], v2 offset:10240
    v_mfma_f32_16x16x32_bf16 v[108:111], a[52:55], v[44:47], v[108:111]
    buffer_load_dwordx4 a[72:75], v1, s[4:7], s32 offen offset:2048 sc1
    v_mfma_f32_16x16x32_bf16 v[112:115], a[132:135], v[44:47], v[112:115]
    v_mfma_f32_16x16x32_bf16 v[116:119], a[52:55], v[48:51], v[116:119]
    v_mfma_f32_16x16x32_bf16 v[120:123], a[132:135], v[48:51], v[120:123]
    buffer_load_dwordx4 a[152:155], v4, s[4:7], s32 offen offset:2048 sc1
    v_mfma_f32_16x16x32_bf16 v[124:127], a[52:55], v[52:55], v[124:127]
    v_mfma_f32_16x16x32_bf16 v[128:131], a[132:135], v[52:55], v[128:131]
    v_mfma_f32_16x16x32_bf16 v[132:135], a[52:55], v[56:59], v[132:135]
    buffer_load_dwordx4 a[76:79], v1, s[4:7], s32 offen offset:3072 sc1
    v_mfma_f32_16x16x32_bf16 v[136:139], a[132:135], v[56:59], v[136:139]
    ds_read_b128 v[80:83], v2 offset:11264
    s_waitcnt vmcnt(9) lgkmcnt(1)
    v_mfma_f32_16x16x32_bf16 v[100:103], a[56:59], v[60:63], v[100:103]
    ds_read_b128 v[84:87], v2 offset:12288
    ds_read_b128 v[88:91], v2 offset:13312
    v_mfma_f32_16x16x32_bf16 v[104:107], a[136:139], v[60:63], v[104:107]
    ds_read_b128 v[92:95], v2 offset:14336
    ds_read_b128 v[96:99], v2 offset:15360
    v_mfma_f32_16x16x32_bf16 v[108:111], a[56:59], v[64:67], v[108:111]
    buffer_load_dwordx4 a[156:159], v4, s[4:7], s32 offen offset:3072 sc1
    v_mfma_f32_16x16x32_bf16 v[112:115], a[136:139], v[64:67], v[112:115]
    v_mfma_f32_16x16x32_bf16 v[116:119], a[56:59], v[68:71], v[116:119]
    v_mfma_f32_16x16x32_bf16 v[120:123], a[136:139], v[68:71], v[120:123]
    v_mfma_f32_16x16x32_bf16 v[124:127], a[56:59], v[72:75], v[124:127]
    s_add_u32 m0, s22, 114688
    s_add_u32 s31, s25, 114688
    buffer_load_dwordx4 v1, s[4:7], s31 offen offset:0 lds
    v_mfma_f32_16x16x32_bf16 v[128:131], a[136:139], v[72:75], v[128:131]
    v_mfma_f32_16x16x32_bf16 v[132:135], a[56:59], v[76:79], v[132:135]
    v_mfma_f32_16x16x32_bf16 v[136:139], a[136:139], v[76:79], v[136:139]
    ds_read_b128 v[36:39], v2 offset:16384
    s_waitcnt vmcnt(9) lgkmcnt(1)
    v_mfma_f32_16x16x32_bf16 v[100:103], a[60:63], v[80:83], v[100:103]
    ds_read_b128 v[40:43], v2 offset:17408
    ds_read_b128 v[44:47], v2 offset:18432
    v_mfma_f32_16x16x32_bf16 v[104:107], a[140:143], v[80:83], v[104:107]
    ds_read_b128 v[48:51], v2 offset:19456
    ds_read_b128 v[52:55], v2 offset:20480
    v_mfma_f32_16x16x32_bf16 v[108:111], a[60:63], v[84:87], v[108:111]
    buffer_load_dwordx4 v1, s[4:7], s31 offen offset:1024 lds
    v_mfma_f32_16x16x32_bf16 v[112:115], a[140:143], v[84:87], v[112:115]
    v_mfma_f32_16x16x32_bf16 v[116:119], a[60:63], v[88:91], v[116:119]
    buffer_load_dwordx4 v1, s[4:7], s31 offen offset:2048 lds
    v_mfma_f32_16x16x32_bf16 v[120:123], a[140:143], v[88:91], v[120:123]
    v_mfma_f32_16x16x32_bf16 v[124:127], a[60:63], v[92:95], v[124:127]
    v_mfma_f32_16x16x32_bf16 v[128:131], a[140:143], v[92:95], v[128:131]
    buffer_load_dwordx4 v1, s[4:7], s31 offen offset:3072 lds
    v_mfma_f32_16x16x32_bf16 v[132:135], a[60:63], v[96:99], v[132:135]
    v_mfma_f32_16x16x32_bf16 v[136:139], a[140:143], v[96:99], v[136:139]
    ds_read_b128 v[56:59], v2 offset:21504
    s_waitcnt vmcnt(10) lgkmcnt(1)
    v_mfma_f32_16x16x32_bf16 v[100:103], a[64:67], v[36:39], v[100:103]
    ds_read_b128 v[60:63], v2 offset:22528
    ds_read_b128 v[64:67], v2 offset:23552
    v_mfma_f32_16x16x32_bf16 v[104:107], a[144:147], v[36:39], v[104:107]
    ds_read_b128 v[68:71], v2 offset:24576
    ds_read_b128 v[72:75], v2 offset:25600
    v_mfma_f32_16x16x32_bf16 v[108:111], a[64:67], v[40:43], v[108:111]
    s_add_u32 m0, s22, 131072
    s_add_u32 s31, s25, 131072
    buffer_load_dwordx4 v1, s[4:7], s31 offen offset:0 lds
    v_mfma_f32_16x16x32_bf16 v[112:115], a[144:147], v[40:43], v[112:115]
    v_mfma_f32_16x16x32_bf16 v[116:119], a[64:67], v[44:47], v[116:119]
    v_mfma_f32_16x16x32_bf16 v[120:123], a[144:147], v[44:47], v[120:123]
    buffer_load_dwordx4 v1, s[4:7], s31 offen offset:1024 lds
    v_mfma_f32_16x16x32_bf16 v[124:127], a[64:67], v[48:51], v[124:127]
    v_mfma_f32_16x16x32_bf16 v[128:131], a[144:147], v[48:51], v[128:131]
    v_mfma_f32_16x16x32_bf16 v[132:135], a[64:67], v[52:55], v[132:135]
    v_mfma_f32_16x16x32_bf16 v[136:139], a[144:147], v[52:55], v[136:139]
    ds_read_b128 v[76:79], v2 offset:26624
    s_waitcnt vmcnt(10) lgkmcnt(1)
    v_mfma_f32_16x16x32_bf16 v[100:103], a[68:71], v[56:59], v[100:103]
    ds_read_b128 v[80:83], v2 offset:27648
    ds_read_b128 v[84:87], v2 offset:28672
    v_mfma_f32_16x16x32_bf16 v[104:107], a[148:151], v[56:59], v[104:107]
    ds_read_b128 v[88:91], v2 offset:29696
    ds_read_b128 v[92:95], v2 offset:30720
    v_mfma_f32_16x16x32_bf16 v[108:111], a[68:71], v[60:63], v[108:111]
    buffer_load_dwordx4 v1, s[4:7], s31 offen offset:2048 lds
    v_mfma_f32_16x16x32_bf16 v[112:115], a[148:151], v[60:63], v[112:115]
    buffer_load_dwordx4 v1, s[4:7], s31 offen offset:3072 lds
    v_mfma_f32_16x16x32_bf16 v[116:119], a[68:71], v[64:67], v[116:119]
    v_mfma_f32_16x16x32_bf16 v[120:123], a[148:151], v[64:67], v[120:123]
    v_mfma_f32_16x16x32_bf16 v[124:127], a[68:71], v[68:71], v[124:127]
    v_mfma_f32_16x16x32_bf16 v[128:131], a[148:151], v[68:71], v[128:131]
    v_mfma_f32_16x16x32_bf16 v[132:135], a[68:71], v[72:75], v[132:135]
    v_mfma_f32_16x16x32_bf16 v[136:139], a[148:151], v[72:75], v[136:139]
    ds_read_b128 v[96:99], v2 offset:31744
    s_waitcnt vmcnt(10) lgkmcnt(1)
    v_mfma_f32_16x16x32_bf16 v[100:103], a[72:75], v[76:79], v[100:103]
    s_barrier
    ds_read_b128 v[36:39], v2 offset:32768
    v_mfma_f32_16x16x32_bf16 v[104:107], a[152:155], v[76:79], v[104:107]
    ds_read_b128 v[40:43], v2 offset:33792
    ds_read_b128 v[44:47], v2 offset:34816
    v_mfma_f32_16x16x32_bf16 v[108:111], a[72:75], v[80:83], v[108:111]
    ds_read_b128 v[48:51], v2 offset:35840
    v_mfma_f32_16x16x32_bf16 v[112:115], a[152:155], v[80:83], v[112:115]
    v_mfma_f32_16x16x32_bf16 v[116:119], a[72:75], v[84:87], v[116:119]
    v_mfma_f32_16x16x32_bf16 v[120:123], a[152:155], v[84:87], v[120:123]
    v_mfma_f32_16x16x32_bf16 v[124:127], a[72:75], v[88:91], v[124:127]
    v_mfma_f32_16x16x32_bf16 v[128:131], a[152:155], v[88:91], v[128:131]
    v_mfma_f32_16x16x32_bf16 v[132:135], a[72:75], v[92:95], v[132:135]
    v_mfma_f32_16x16x32_bf16 v[136:139], a[152:155], v[92:95], v[136:139]
    s_waitcnt vmcnt(8) lgkmcnt(0)
    v_mfma_f32_16x16x32_bf16 v[100:103], a[76:79], v[96:99], v[100:103]
    v_mfma_f32_16x16x32_bf16 v[104:107], a[156:159], v[96:99], v[104:107]
    v_mfma_f32_16x16x32_bf16 v[108:111], a[76:79], v[36:39], v[108:111]
    v_mfma_f32_16x16x32_bf16 v[112:115], a[156:159], v[36:39], v[112:115]
    v_mfma_f32_16x16x32_bf16 v[116:119], a[76:79], v[40:43], v[116:119]
    v_mfma_f32_16x16x32_bf16 v[120:123], a[156:159], v[40:43], v[120:123]
    v_mfma_f32_16x16x32_bf16 v[124:127], a[76:79], v[44:47], v[124:127]
    v_mfma_f32_16x16x32_bf16 v[128:131], a[156:159], v[44:47], v[128:131]
    v_mfma_f32_16x16x32_bf16 v[132:135], a[76:79], v[48:51], v[132:135]
    v_mfma_f32_16x16x32_bf16 v[136:139], a[156:159], v[48:51], v[136:139]
Lk1_nocsS:
    s_waitcnt lgkmcnt(0)
    ds_read_b32 v140, v5 offset:16384
    ds_read_b32 v141, v5 offset:16448
    ds_read_b32 v142, v5 offset:16512
    ds_read_b32 v143, v5 offset:16576
    ds_read_b32 v144, v5 offset:16640
    s_mul_i32 s62, s21, 1048576
    s_lshl_b32 s63, s18, 16
    s_add_u32 s62, s62, s63
    s_add_u32 s62, s62, 1048576
    s_add_u32 s62, s62, s23
    s_lshl_b32 s63, s17, 12
    s_add_u32 s63, s63, s62
    v_add_u32 v254, s23, v2
    v_add_u32 v255, s22, v2
    ds_read_b128 v[52:55], v2 offset:36864
    ds_read_b128 v[56:59], v2 offset:37888
    ds_read_b128 v[60:63], v2 offset:38912
    s_waitcnt lgkmcnt(3)
    v_fmac_f32 v100, v226, v140
    s_add_u32 m0, s22, 0
    s_add_u32 s31, s25, 147456
    buffer_load_dwordx4 v1, s[4:7], s31 offen offset:0 lds
    s_waitcnt lgkmcnt(0)
    v_mfma_f32_16x16x32_bf16 v[188:191], v[52:55], a[0:3], 0
    ds_read_b128 v[64:67], v2 offset:39936
    ds_read_b128 v[68:71], v2 offset:40960
    v_fmac_f32 v101, v227, v140
    v_fmac_f32 v102, v228, v140
    v_fmac_f32 v103, v229, v140
    buffer_load_dwordx4 v1, s[4:7], s31 offen offset:1024 lds
    v_mfma_f32_16x16x32_bf16 v[192:195], v[52:55], a[80:83], 0
    ds_read_b128 v[72:75], v2 offset:41984
    ds_read_b128 v[76:79], v2 offset:43008
    v_mul_f32 v180, v100, v242
    v_mul_f32 v181, v101, v243
    v_mul_f32 v182, v102, v244
    v_mfma_f32_16x16x32_bf16 v[196:199], v[56:59], a[0:3], 0
    ds_read_b128 v[80:83], v2 offset:44032
    ds_read_b128 v[84:87], v2 offset:45056
    v_mul_f32 v183, v103, v245
    v_exp_f32 v180, v180 clamp
    buffer_load_dwordx4 v1, s[4:7], s31 offen offset:2048 lds
    v_mfma_f32_16x16x32_bf16 v[200:203], v[56:59], a[80:83], 0
    v_exp_f32 v181, v181 clamp
    v_exp_f32 v182, v182 clamp
    v_mfma_f32_16x16x32_bf16 v[204:207], v[60:63], a[0:3], 0
    v_exp_f32 v183, v183 clamp
    v_max_f32 v100, 0, v100
    v_max_f32 v101, 0, v101
    v_max_f32 v102, 0, v102
    v_mfma_f32_16x16x32_bf16 v[208:211], v[60:63], a[80:83], 0
    v_max_f32 v103, 0, v103
    v_add_f32 v180, 0x358637bd, v180
    v_add_f32 v181, 0x358637bd, v181
    v_add_f32 v182, 0x358637bd, v182
    s_waitcnt lgkmcnt(3)
    v_mfma_f32_16x16x32_bf16 v[188:191], v[64:67], a[4:7], v[188:191]
    v_add_f32 v183, 0x358637bd, v183
    v_fma_f32 v100, v100, v230, v180
    v_fma_f32 v101, v101, v231, v181
    v_fma_f32 v102, v102, v232, v182
    v_fma_f32 v103, v103, v233, v183
    buffer_load_dwordx4 v1, s[4:7], s31 offen offset:3072 lds
    v_mfma_f32_16x16x32_bf16 v[192:195], v[64:67], a[84:87], v[192:195]
    ds_read_b128 v[88:91], v2 offset:46080
    ds_read_b128 v[92:95], v2 offset:47104
    v_fmac_f32 v104, v234, v140
    v_fmac_f32 v105, v235, v140
    v_fmac_f32 v106, v236, v140
    v_mfma_f32_16x16x32_bf16 v[196:199], v[68:71], a[4:7], v[196:199]
    ds_read_b128 v[96:99], v2 offset:48128
    v_fmac_f32 v107, v237, v140
    v_mul_f32 v184, v104, v246
    v_mul_f32 v185, v105, v247
    v_mul_f32 v186, v106, v248
    v_mfma_f32_16x16x32_bf16 v[200:203], v[68:71], a[84:87], v[200:203]
    v_mul_f32 v187, v107, v249
    v_exp_f32 v184, v184 clamp
    v_exp_f32 v185, v185 clamp
    s_add_u32 m0, s22, 16384
    s_add_u32 s31, s26, 0
    buffer_load_dwordx4 v1, s[4:7], s31 offen offset:0 lds
    v_mfma_f32_16x16x32_bf16 v[204:207], v[72:75], a[4:7], v[204:207]
    v_exp_f32 v186, v186 clamp
    v_exp_f32 v187, v187 clamp
    v_max_f32 v104, 0, v104
    v_mfma_f32_16x16x32_bf16 v[208:211], v[72:75], a[84:87], v[208:211]
    v_max_f32 v105, 0, v105
    v_max_f32 v106, 0, v106
    v_max_f32 v107, 0, v107
    v_add_f32 v184, 0x358637bd, v184
    s_waitcnt lgkmcnt(3)
    v_mfma_f32_16x16x32_bf16 v[188:191], v[76:79], a[8:11], v[188:191]
    v_add_f32 v185, 0x358637bd, v185
    v_add_f32 v186, 0x358637bd, v186
    v_add_f32 v187, 0x358637bd, v187
    v_fma_f32 v104, v104, v238, v184
    v_fma_f32 v105, v105, v239, v185
    v_mfma_f32_16x16x32_bf16 v[192:195], v[76:79], a[88:91], v[192:195]
    s_waitcnt vmcnt(5)
    s_barrier
    ds_read_b128 v[36:39], v2 offset:49152
    v_fma_f32 v106, v106, v240, v186
    v_fma_f32 v107, v107, v241, v187
    buffer_load_dwordx4 v1, s[4:7], s31 offen offset:1024 lds
    v_mfma_f32_16x16x32_bf16 v[196:199], v[80:83], a[8:11], v[196:199]
    ds_read_b128 v[40:43], v2 offset:50176
    ds_read_b128 v[44:47], v2 offset:51200
    v_fmac_f32 v108, v226, v141
    v_fmac_f32 v109, v227, v141
    v_fmac_f32 v110, v228, v141
    v_mfma_f32_16x16x32_bf16 v[200:203], v[80:83], a[88:91], v[200:203]
    v_fmac_f32 v111, v229, v141
    v_mul_f32 v180, v108, v242
    v_mul_f32 v181, v109, v243
    v_mul_f32 v182, v110, v244
    v_mul_f32 v183, v111, v245
    v_mfma_f32_16x16x32_bf16 v[204:207], v[84:87], a[8:11], v[204:207]
    v_exp_f32 v180, v180 clamp
    v_exp_f32 v181, v181 clamp
    buffer_load_dwordx4 v1, s[4:7], s31 offen offset:2048 lds
    v_mfma_f32_16x16x32_bf16 v[208:211], v[84:87], a[88:91], v[208:211]
    v_exp_f32 v182, v182 clamp
    v_exp_f32 v183, v183 clamp
    s_waitcnt lgkmcnt(3)
    v_mfma_f32_16x16x32_bf16 v[188:191], v[88:91], a[12:15], v[188:191]
    v_max_f32 v108, 0, v108
    v_max_f32 v109, 0, v109
    v_max_f32 v110, 0, v110
    v_max_f32 v111, 0, v111
    v_add_f32 v180, 0x358637bd, v180
    v_mfma_f32_16x16x32_bf16 v[192:195], v[88:91], a[92:95], v[192:195]
    ds_read_b128 v[48:51], v2 offset:52224
    ds_read_b128 v[52:55], v2 offset:53248
    v_add_f32 v181, 0x358637bd, v181
    v_add_f32 v182, 0x358637bd, v182
    v_add_f32 v183, 0x358637bd, v183
    v_mfma_f32_16x16x32_bf16 v[196:199], v[92:95], a[12:15], v[196:199]
    ds_read_b128 v[56:59], v2 offset:54272
    v_fma_f32 v108, v108, v230, v180
    v_fma_f32 v109, v109, v231, v181
    v_fma_f32 v110, v110, v232, v182
    v_fma_f32 v111, v111, v233, v183
    buffer_load_dwordx4 v1, s[4:7], s31 offen offset:3072 lds
    v_mfma_f32_16x16x32_bf16 v[200:203], v[92:95], a[92:95], v[200:203]
    v_fmac_f32 v112, v234, v141
    v_fmac_f32 v113, v235, v141
    v_fmac_f32 v114, v236, v141
    v_fmac_f32 v115, v237, v141
    v_mul_f32 v184, v112, v246
    v_mfma_f32_16x16x32_bf16 v[204:207], v[96:99], a[12:15], v[204:207]
    v_mul_f32 v185, v113, v247
    v_mul_f32 v186, v114, v248
    v_mul_f32 v187, v115, v249
    v_exp_f32 v184, v184 clamp
    v_mfma_f32_16x16x32_bf16 v[208:211], v[96:99], a[92:95], v[208:211]
    v_exp_f32 v185, v185 clamp
    v_exp_f32 v186, v186 clamp
    s_add_u32 m0, s22, 32768
    s_add_u32 s31, s26, 16384
    buffer_load_dwordx4 v1, s[4:7], s31 offen offset:0 lds
    s_waitcnt lgkmcnt(3)
    v_mfma_f32_16x16x32_bf16 v[188:191], v[36:39], a[16:19], v[188:191]
    v_exp_f32 v187, v187 clamp
    v_max_f32 v112, 0, v112
    v_max_f32 v113, 0, v113
    v_max_f32 v114, 0, v114
    v_mfma_f32_16x16x32_bf16 v[192:195], v[36:39], a[96:99], v[192:195]
    ds_read_b128 v[60:63], v2 offset:55296
    ds_read_b128 v[64:67], v2 offset:56320
    v_max_f32 v115, 0, v115
    v_add_f32 v184, 0x358637bd, v184
    v_add_f32 v185, 0x358637bd, v185
    v_mfma_f32_16x16x32_bf16 v[196:199], v[40:43], a[16:19], v[196:199]
    ds_read_b128 v[68:71], v2 offset:57344
    v_add_f32 v186, 0x358637bd, v186
    v_add_f32 v187, 0x358637bd, v187
    v_fma_f32 v112, v112, v238, v184
    v_fma_f32 v113, v113, v239, v185
    v_mfma_f32_16x16x32_bf16 v[200:203], v[40:43], a[96:99], v[200:203]
    v_fma_f32 v114, v114, v240, v186
    v_fma_f32 v115, v115, v241, v187
    v_fmac_f32 v132, v226, v144
    v_fmac_f32 v133, v227, v144
    v_fmac_f32 v134, v228, v144
    buffer_load_dwordx4 v1, s[4:7], s31 offen offset:1024 lds
    v_mfma_f32_16x16x32_bf16 v[204:207], v[44:47], a[16:19], v[204:207]
    v_fmac_f32 v135, v229, v144
    v_mul_f32 v172, v132, v230
    v_mul_f32 v173, v133, v231
    v_mul_f32 v174, v134, v232
    v_mul_f32 v175, v135, v233
    v_mfma_f32_16x16x32_bf16 v[208:211], v[44:47], a[96:99], v[208:211]
    v_mul_f32 v180, v132, v242
    v_mul_f32 v181, v133, v243
    v_mul_f32 v182, v134, v244
    v_mul_f32 v183, v135, v245
    s_waitcnt lgkmcnt(3)
    v_mfma_f32_16x16x32_bf16 v[188:191], v[48:51], a[20:23], v[188:191]
    v_exp_f32 v180, v180 clamp
    v_exp_f32 v181, v181 clamp
    buffer_load_dwordx4 v1, s[4:7], s31 offen offset:2048 lds
    v_mfma_f32_16x16x32_bf16 v[192:195], v[48:51], a[100:103], v[192:195]
    ds_read_b128 v[72:75], v2 offset:58368
    ds_read_b128 v[76:79], v2 offset:59392
    v_exp_f32 v182, v182 clamp
    v_mfma_f32_16x16x32_bf16 v[196:199], v[52:55], a[20:23], v[196:199]
    ds_read_b128 v[80:83], v2 offset:60416
    v_exp_f32 v183, v183 clamp
    v_max_f32 v132, 0, v132
    v_max_f32 v133, 0, v133
    v_mfma_f32_16x16x32_bf16 v[200:203], v[52:55], a[100:103], v[200:203]
    v_max_f32 v134, 0, v134
    v_max_f32 v135, 0, v135
    v_add_f32 v180, 0x358637bd, v180
    v_add_f32 v181, 0x358637bd, v181
    v_add_f32 v182, 0x358637bd, v182
    v_mfma_f32_16x16x32_bf16 v[204:207], v[56:59], a[20:23], v[204:207]
    v_add_f32 v183, 0x358637bd, v183
    v_fma_f32 v132, v132, v230, v180
    v_fma_f32 v133, v133, v231, v181
    v_fma_f32 v134, v134, v232, v182
    v_fma_f32 v135, v135, v233, v183
    buffer_load_dwordx4 v1, s[4:7], s31 offen offset:3072 lds
    v_mfma_f32_16x16x32_bf16 v[208:211], v[56:59], a[100:103], v[208:211]
    v_fmac_f32 v136, v234, v144
    v_fmac_f32 v137, v235, v144
    v_fmac_f32 v138, v236, v144
    v_fmac_f32 v139, v237, v144
    s_waitcnt lgkmcnt(3)
    v_mfma_f32_16x16x32_bf16 v[188:191], v[60:63], a[24:27], v[188:191]
    v_mul_f32 v176, v136, v238
    v_mul_f32 v177, v137, v239
    v_mul_f32 v178, v138, v240
    v_mul_f32 v179, v139, v241
    v_mul_f32 v184, v136, v246
    v_mfma_f32_16x16x32_bf16 v[192:195], v[60:63], a[104:107], v[192:195]
    ds_read_b128 v[84:87], v2 offset:61440
    ds_read_b128 v[88:91], v2 offset:62464
    v_mul_f32 v185, v137, v247
    v_mul_f32 v186, v138, v248
    v_mul_f32 v187, v139, v249
    s_add_u32 m0, s22, 49152
    s_add_u32 s31, s26, 32768
    buffer_load_dwordx4 v1, s[4:7], s31 offen offset:0 lds
    v_mfma_f32_16x16x32_bf16 v[196:199], v[64:67], a[24:27], v[196:199]
    ds_read_b128 v[92:95], v2 offset:63488
    v_exp_f32 v184, v184 clamp
    v_exp_f32 v185, v185 clamp
    v_mfma_f32_16x16x32_bf16 v[200:203], v[64:67], a[104:107], v[200:203]
    v_exp_f32 v186, v186 clamp
    v_exp_f32 v187, v187 clamp
    v_max_f32 v136, 0, v136
    v_mfma_f32_16x16x32_bf16 v[204:207], v[68:71], a[24:27], v[204:207]
    v_max_f32 v137, 0, v137
    v_max_f32 v138, 0, v138
    v_max_f32 v139, 0, v139
    v_add_f32 v184, 0x358637bd, v184
    v_add_f32 v185, 0x358637bd, v185
    v_mfma_f32_16x16x32_bf16 v[208:211], v[68:71], a[104:107], v[208:211]
    v_add_f32 v186, 0x358637bd, v186
    v_add_f32 v187, 0x358637bd, v187
    v_fma_f32 v136, v136, v238, v184
    v_fma_f32 v137, v137, v239, v185
    buffer_load_dwordx4 v1, s[4:7], s31 offen offset:1024 lds
    s_waitcnt lgkmcnt(3)
    v_mfma_f32_16x16x32_bf16 v[188:191], v[72:75], a[28:31], v[188:191]
    v_fma_f32 v138, v138, v240, v186
    v_fma_f32 v139, v139, v241, v187
    v_fmac_f32 v116, v226, v142
    v_fmac_f32 v117, v227, v142
    v_fmac_f32 v118, v228, v142
    v_mfma_f32_16x16x32_bf16 v[192:195], v[72:75], a[108:111], v[192:195]
    ds_read_b128 v[96:99], v2 offset:64512
    ds_read_b128 v[36:39], v3 offset:0
    v_fmac_f32 v119, v229, v142
    v_mul_f32 v116, v116, v230
    v_mul_f32 v117, v117, v231
    v_mfma_f32_16x16x32_bf16 v[196:199], v[76:79], a[28:31], v[196:199]
    ds_read_b128 v[40:43], v3 offset:1024
    v_mul_f32 v118, v118, v232
    v_mul_f32 v119, v119, v233
    v_fmac_f32 v120, v234, v142
    v_fmac_f32 v121, v235, v142
    buffer_load_dwordx4 v1, s[4:7], s31 offen offset:2048 lds
    v_mfma_f32_16x16x32_bf16 v[200:203], v[76:79], a[108:111], v[200:203]
    v_fmac_f32 v122, v236, v142
    v_fmac_f32 v123, v237, v142
    v_mul_f32 v120, v120, v238
    v_mul_f32 v121, v121, v239
    v_mul_f32 v122, v122, v240
    v_mfma_f32_16x16x32_bf16 v[204:207], v[80:83], a[28:31], v[204:207]
    v_mul_f32 v123, v123, v241
    v_fmac_f32 v124, v226, v143
    v_fmac_f32 v125, v227, v143
    v_fmac_f32 v126, v228, v143
    v_fmac_f32 v127, v229, v143
    v_mfma_f32_16x16x32_bf16 v[208:211], v[80:83], a[108:111], v[208:211]
    v_mul_f32 v124, v124, v230
    v_mul_f32 v125, v125, v231
    v_mul_f32 v126, v126, v232
    v_mul_f32 v127, v127, v233
    s_waitcnt lgkmcnt(3)
    v_mfma_f32_16x16x32_bf16 v[188:191], v[84:87], a[32:35], v[188:191]
    v_fmac_f32 v128, v234, v143
    v_fmac_f32 v129, v235, v143
    v_fmac_f32 v130, v236, v143
    v_fmac_f32 v131, v237, v143
    v_mul_f32 v128, v128, v238
    buffer_load_dwordx4 v1, s[4:7], s31 offen offset:3072 lds
    v_mfma_f32_16x16x32_bf16 v[192:195], v[84:87], a[112:115], v[192:195]
    ds_read_b128 v[44:47], v3 offset:2048
    ds_read_b128 v[48:51], v3 offset:3072
    v_mul_f32 v129, v129, v239
    v_mul_f32 v130, v130, v240
    v_mul_f32 v131, v131, v241
    v_mfma_f32_16x16x32_bf16 v[196:199], v[88:91], a[32:35], v[196:199]
    ds_read_b128 v[52:55], v3 offset:4096
    v_cndmask_b32 v172, v172, 1.0, s[68:69]
    v_cndmask_b32 v173, v173, 1.0, s[68:69]
    v_cndmask_b32 v174, v174, 1.0, s[68:69]
    v_cndmask_b32 v175, v175, 1.0, s[68:69]
    v_mfma_f32_16x16x32_bf16 v[200:203], v[88:91], a[112:115], v[200:203]
    v_cndmask_b32 v176, v176, 1.0, s[68:69]
    v_cndmask_b32 v177, v177, 1.0, s[68:69]
    v_cndmask_b32 v178, v178, 1.0, s[68:69]
    v_cndmask_b32 v179, v179, 1.0, s[68:69]
    v_cvt_pk_bf16_f32 v148, v100, v101
    s_add_u32 m0, s22, 65536
    s_add_u32 s31, s26, 49152
    buffer_load_dwordx4 v1, s[4:7], s31 offen offset:0 lds
    v_mfma_f32_16x16x32_bf16 v[204:207], v[92:95], a[32:35], v[204:207]
    v_cvt_pk_bf16_f32 v149, v102, v103
    v_cvt_pk_bf16_f32 v150, v104, v105
    v_cvt_pk_bf16_f32 v151, v106, v107
    v_cvt_pk_bf16_f32 v152, v108, v109
    v_cvt_pk_bf16_f32 v153, v110, v111
    v_mfma_f32_16x16x32_bf16 v[208:211], v[92:95], a[112:115], v[208:211]
    v_cvt_pk_bf16_f32 v154, v112, v113
    v_cvt_pk_bf16_f32 v155, v114, v115
    v_cvt_pk_bf16_f32 v164, v132, v133
    v_cvt_pk_bf16_f32 v165, v134, v135
    s_waitcnt lgkmcnt(3)
    v_mfma_f32_16x16x32_bf16 v[188:191], v[96:99], a[36:39], v[188:191]
    v_cvt_pk_bf16_f32 v166, v136, v137
    v_cvt_pk_bf16_f32 v167, v138, v139
    v_cvt_pk_bf16_f32 v156, v116, v117
    v_cvt_pk_bf16_f32 v157, v118, v119
    v_cvt_pk_bf16_f32 v158, v120, v121
    v_mfma_f32_16x16x32_bf16 v[192:195], v[96:99], a[116:119], v[192:195]
    ds_read_b128 v[56:59], v3 offset:5120
    ds_read_b128 v[60:63], v3 offset:6144
    v_cvt_pk_bf16_f32 v159, v122, v123
    v_cvt_pk_bf16_f32 v160, v124, v125
    v_cvt_pk_bf16_f32 v161, v126, v127
    buffer_load_dwordx4 v1, s[4:7], s31 offen offset:1024 lds
    v_mfma_f32_16x16x32_bf16 v[196:199], v[36:39], a[36:39], v[196:199]
    ds_read_b128 v[64:67], v3 offset:7168
    v_cvt_pk_bf16_f32 v162, v128, v129
    v_cvt_pk_bf16_f32 v163, v130, v131
    v_cvt_pk_bf16_f32 v168, v172, v173
    v_cvt_pk_bf16_f32 v169, v174, v175
    v_mfma_f32_16x16x32_bf16 v[200:203], v[36:39], a[116:119], v[200:203]
    v_cvt_pk_bf16_f32 v170, v176, v177
    v_cvt_pk_bf16_f32 v171, v178, v179
    v_mfma_f32_16x16x32_bf16 v[204:207], v[40:43], a[36:39], v[204:207]
    v_mfma_f32_16x16x32_bf16 v[100:103], v[148:151], v[156:159], 0
    v_mfma_f32_16x16x32_bf16 v[104:107], v[152:155], v[160:163], 0
    buffer_load_dwordx4 v1, s[4:7], s31 offen offset:2048 lds
    v_mfma_f32_16x16x32_bf16 v[208:211], v[40:43], a[116:119], v[208:211]
    v_mfma_f32_16x16x32_bf16 v[108:111], v[164:167], v[156:159], 0
    v_mfma_f32_16x16x32_bf16 v[112:115], v[164:167], v[160:163], 0
    s_waitcnt lgkmcnt(3)
    v_mfma_f32_16x16x32_bf16 v[188:191], v[44:47], a[40:43], v[188:191]
    v_mfma_f32_16x16x32_bf16 v[116:119], v[148:151], v[168:171], 0
    v_mfma_f32_16x16x32_bf16 v[120:123], v[152:155], v[168:171], 0
    v_mfma_f32_16x16x32_bf16 v[192:195], v[44:47], a[120:123], v[192:195]
    ds_read_b128 v[68:71], v3 offset:8192
    ds_read_b128 v[72:75], v3 offset:9216
    v_mfma_f32_16x16x32_bf16 v[124:127], v[164:167], v[168:171], 0
    v_mfma_f32_16x16x32_bf16 v[196:199], v[48:51], a[40:43], v[196:199]
    ds_read_b128 v[76:79], v3 offset:10240
    buffer_load_dwordx4 v1, s[4:7], s31 offen offset:3072 lds
    v_mfma_f32_16x16x32_bf16 v[200:203], v[48:51], a[120:123], v[200:203]
    ds_write_b128 v254, v[100:103] offset:16384
    ds_write_b128 v254, v[104:107] offset:20480
    v_cndmask_b32 v116, v116, v120, s[66:67]
    v_cndmask_b32 v117, v117, v121, s[66:67]
    v_cndmask_b32 v118, v118, v122, s[66:67]
    v_mfma_f32_16x16x32_bf16 v[204:207], v[52:55], a[40:43], v[204:207]
    v_cndmask_b32 v119, v119, v123, s[66:67]
    v_cndmask_b32 v108, v108, v112, s[50:51]
    v_cndmask_b32 v109, v109, v113, s[50:51]
    v_cndmask_b32 v110, v110, v114, s[50:51]
    v_cndmask_b32 v111, v111, v115, s[50:51]
    v_mfma_f32_16x16x32_bf16 v[208:211], v[52:55], a[120:123], v[208:211]
    ds_write_b128 v254, v[116:119] offset:24576
    v_permlane32_swap_b32 v108, v124
    v_permlane32_swap_b32 v109, v125
    v_permlane32_swap_b32 v110, v126
    s_waitcnt lgkmcnt(6)
    v_mfma_f32_16x16x32_bf16 v[188:191], v[56:59], a[44:47], v[188:191]
    v_permlane32_swap_b32 v111, v127
    v_mfma_f32_16x16x32_bf16 v[192:195], v[56:59], a[124:127], v[192:195]
    ds_read_b128 v[80:83], v3 offset:11264
    ds_read_b128 v[84:87], v3 offset:12288
    ds_write_b128 v254, v[108:111] offset:28672
    v_mfma_f32_16x16x32_bf16 v[196:199], v[60:63], a[44:47], v[196:199]
    ds_read_b128 v[88:91], v3 offset:13312
    v_mfma_f32_16x16x32_bf16 v[200:203], v[60:63], a[124:127], v[200:203]
    v_mfma_f32_16x16x32_bf16 v[204:207], v[64:67], a[44:47], v[204:207]
    s_waitcnt vmcnt(16) lgkmcnt(1)
    s_barrier
    ds_read_b128 v[100:103], v255 offset:16384
    ds_read_b128 v[104:107], v255 offset:17408
    ds_read_b128 v[108:111], v255 offset:18432
    ds_read_b128 v[112:115], v255 offset:19456
    v_mfma_f32_16x16x32_bf16 v[208:211], v[64:67], a[124:127], v[208:211]
    v_mfma_f32_16x16x32_bf16 v[188:191], v[68:71], a[48:51], v[188:191]
    v_mfma_f32_16x16x32_bf16 v[192:195], v[68:71], a[128:131], v[192:195]
    ds_read_b128 v[92:95], v3 offset:14336
    ds_read_b128 v[96:99], v3 offset:15360
    v_mfma_f32_16x16x32_bf16 v[196:199], v[72:75], a[48:51], v[196:199]
    v_lshrrev_b32 v254, 1, v1
    s_waitcnt lgkmcnt(4)
    v_add_f32 v100, v100, v104
    v_add_f32 v101, v101, v105
    v_add_f32 v102, v102, v106
    v_mfma_f32_16x16x32_bf16 v[200:203], v[72:75], a[128:131], v[200:203]
    v_add_f32 v103, v103, v107
    s_waitcnt lgkmcnt(2)
    v_add_f32 v108, v108, v112
    v_add_f32 v109, v109, v113
    v_add_f32 v110, v110, v114
    v_mfma_f32_16x16x32_bf16 v[204:207], v[76:79], a[48:51], v[204:207]
    v_add_f32 v111, v111, v115
    v_add_f32 v100, v100, v108
    v_add_f32 v101, v101, v109
    v_add_f32 v102, v102, v110
    v_mfma_f32_16x16x32_bf16 v[208:211], v[76:79], a[128:131], v[208:211]
    v_add_f32 v103, v103, v111
    v_cvt_pk_bf16_f32 v100, v100, v101
    v_cvt_pk_bf16_f32 v101, v102, v103
    v_mfma_f32_16x16x32_bf16 v[188:191], v[80:83], a[52:55], v[188:191]
    buffer_store_dwordx2 v[100:101], v254, s[4:7], s63 offen sc1
    ds_read_b128 v[36:39], v1 offset:0
    v_mfma_f32_16x16x32_bf16 v[192:195], v[80:83], a[132:135], v[192:195]
    ds_read_b128 v[40:43], v1 offset:1024
    ds_read_b128 v[44:47], v1 offset:2048
    s_add_u32 m0, s22, 81920
    s_add_u32 s31, s26, 65536
    buffer_load_dwordx4 v1, s[4:7], s31 offen offset:0 lds
    v_mfma_f32_16x16x32_bf16 v[196:199], v[84:87], a[52:55], v[196:199]
    ds_read_b128 v[48:51], v1 offset:3072
    buffer_load_dwordx4 v1, s[4:7], s31 offen offset:1024 lds
    v_mfma_f32_16x16x32_bf16 v[200:203], v[84:87], a[132:135], v[200:203]
    ds_read_b128 v[140:143], v7 offset:16704
    ds_read_b128 v[144:147], v7 offset:16768
    v_mfma_f32_16x16x32_bf16 v[204:207], v[88:91], a[52:55], v[204:207]
    buffer_load_dwordx4 v1, s[4:7], s31 offen offset:2048 lds
    ds_read_b128 v[148:151], v7 offset:16832
    v_mfma_f32_16x16x32_bf16 v[208:211], v[88:91], a[132:135], v[208:211]
    v_mul_f32 v152, 0x3fb8aa3b, v221
    s_waitcnt lgkmcnt(6)
    v_mfma_f32_16x16x32_bf16 v[188:191], v[92:95], a[56:59], v[188:191]
    v_mul_f32 v153, 0x3fb8aa3b, v223
    v_mfma_f32_16x16x32_bf16 v[192:195], v[92:95], a[136:139], v[192:195]
    ds_read_b128 v[52:55], v1 offset:4096
    ds_read_b128 v[56:59], v1 offset:5120
    v_mfma_f32_16x16x32_bf16 v[196:199], v[96:99], a[56:59], v[196:199]
    ds_read_b128 v[60:63], v1 offset:6144
    buffer_load_dwordx4 v1, s[4:7], s31 offen offset:3072 lds
    v_mfma_f32_16x16x32_bf16 v[200:203], v[96:99], a[136:139], v[200:203]
    v_mfma_f32_16x16x32_bf16 v[204:207], v[36:39], a[56:59], v[204:207]
    v_mfma_f32_16x16x32_bf16 v[208:211], v[36:39], a[136:139], v[208:211]
    s_waitcnt lgkmcnt(6)
    v_mfma_f32_16x16x32_bf16 v[188:191], v[40:43], a[60:63], v[188:191]
    v_mfma_f32_16x16x32_bf16 v[192:195], v[40:43], a[140:143], v[192:195]
    ds_read_b128 v[64:67], v1 offset:7168
    ds_read_b128 v[68:71], v1 offset:8192
    v_mfma_f32_16x16x32_bf16 v[196:199], v[44:47], a[60:63], v[196:199]
    ds_read_b128 v[72:75], v1 offset:9216
    v_mfma_f32_16x16x32_bf16 v[200:203], v[44:47], a[140:143], v[200:203]
    v_mfma_f32_16x16x32_bf16 v[204:207], v[48:51], a[60:63], v[204:207]
    v_mfma_f32_16x16x32_bf16 v[208:211], v[48:51], a[140:143], v[208:211]
    s_waitcnt lgkmcnt(3)
    v_mfma_f32_16x16x32_bf16 v[188:191], v[52:55], a[64:67], v[188:191]
    v_mfma_f32_16x16x32_bf16 v[192:195], v[52:55], a[144:147], v[192:195]
    ds_read_b128 v[76:79], v1 offset:10240
    ds_read_b128 v[80:83], v1 offset:11264
    v_mfma_f32_16x16x32_bf16 v[196:199], v[56:59], a[64:67], v[196:199]
    ds_read_b128 v[84:87], v1 offset:12288
    v_mfma_f32_16x16x32_bf16 v[200:203], v[56:59], a[144:147], v[200:203]
    v_mfma_f32_16x16x32_bf16 v[204:207], v[60:63], a[64:67], v[204:207]
    v_mfma_f32_16x16x32_bf16 v[208:211], v[60:63], a[144:147], v[208:211]
    s_waitcnt lgkmcnt(3)
    v_mfma_f32_16x16x32_bf16 v[188:191], v[64:67], a[68:71], v[188:191]
    v_mfma_f32_16x16x32_bf16 v[192:195], v[64:67], a[148:151], v[192:195]
    ds_read_b128 v[88:91], v1 offset:13312
    ds_read_b128 v[92:95], v1 offset:14336
    v_mfma_f32_16x16x32_bf16 v[196:199], v[68:71], a[68:71], v[196:199]
    ds_read_b128 v[96:99], v1 offset:15360
    v_mfma_f32_16x16x32_bf16 v[200:203], v[68:71], a[148:151], v[200:203]
    v_mfma_f32_16x16x32_bf16 v[204:207], v[72:75], a[68:71], v[204:207]
    v_mfma_f32_16x16x32_bf16 v[208:211], v[72:75], a[148:151], v[208:211]
    s_waitcnt lgkmcnt(3)
    v_mfma_f32_16x16x32_bf16 v[188:191], v[76:79], a[72:75], v[188:191]
    v_mfma_f32_16x16x32_bf16 v[192:195], v[76:79], a[152:155], v[192:195]
    v_mfma_f32_16x16x32_bf16 v[196:199], v[80:83], a[72:75], v[196:199]
    v_mfma_f32_16x16x32_bf16 v[200:203], v[80:83], a[152:155], v[200:203]
    v_mfma_f32_16x16x32_bf16 v[204:207], v[84:87], a[72:75], v[204:207]
    v_mfma_f32_16x16x32_bf16 v[208:211], v[84:87], a[152:155], v[208:211]
    s_waitcnt lgkmcnt(0)
    v_mfma_f32_16x16x32_bf16 v[188:191], v[88:91], a[76:79], v[188:191]
    v_mfma_f32_16x16x32_bf16 v[192:195], v[88:91], a[156:159], v[192:195]
    v_mfma_f32_16x16x32_bf16 v[196:199], v[92:95], a[76:79], v[196:199]
    v_mfma_f32_16x16x32_bf16 v[200:203], v[92:95], a[156:159], v[200:203]
    v_mfma_f32_16x16x32_bf16 v[204:207], v[96:99], a[76:79], v[204:207]
    v_mfma_f32_16x16x32_bf16 v[208:211], v[96:99], a[156:159], v[208:211]
    v_and_b32 v254, 0x200, v1
    v_lshlrev_b32 v254, 3, v254
    v_and_b32 v255, 0x1f0, v1
    v_add_u32 v255, v255, v254
    s_add_u32 s63, s62, 0
    buffer_load_dwordx4 v[36:39], v255, s[4:7], s63 offen
    v_fmac_f32 v188, v220, v140
    v_fmac_f32 v189, v220, v141
    v_fmac_f32 v190, v220, v142
    v_fmac_f32 v191, v220, v143
    v_mul_f32 v180, v188, v152
    v_mul_f32 v181, v189, v152
    s_add_u32 s63, s62, 8192
    buffer_load_dwordx4 v[40:43], v255, s[4:7], s63 offen
    v_mul_f32 v182, v190, v152
    v_mul_f32 v183, v191, v152
    v_exp_f32 v180, v180 clamp
    v_exp_f32 v181, v181 clamp
    v_exp_f32 v182, v182 clamp
    v_exp_f32 v183, v183 clamp
    s_add_u32 s63, s62, 16384
    buffer_load_dwordx4 v[44:47], v255, s[4:7], s63 offen
    v_max_f32 v188, 0, v188
    v_max_f32 v189, 0, v189
    v_max_f32 v190, 0, v190
    v_max_f32 v191, 0, v191
    v_add_f32 v180, 0x358637bd, v180
    v_add_f32 v181, 0x358637bd, v181
    s_add_u32 s63, s62, 24576
    buffer_load_dwordx4 v[48:51], v255, s[4:7], s63 offen
    v_add_f32 v182, 0x358637bd, v182
    v_add_f32 v183, 0x358637bd, v183
    v_fma_f32 v188, v188, v221, v180
    v_fma_f32 v189, v189, v221, v181
    v_fma_f32 v190, v190, v221, v182
    v_fma_f32 v191, v191, v221, v183
    s_add_u32 s63, s62, 32768
    buffer_load_dwordx4 v[52:55], v255, s[4:7], s63 offen
    v_fmac_f32 v192, v222, v140
    v_fmac_f32 v193, v222, v141
    v_fmac_f32 v194, v222, v142
    v_fmac_f32 v195, v222, v143
    v_mul_f32 v184, v192, v153
    v_mul_f32 v185, v193, v153
    s_add_u32 s63, s62, 40960
    buffer_load_dwordx4 v[56:59], v255, s[4:7], s63 offen
    v_mul_f32 v186, v194, v153
    v_mul_f32 v187, v195, v153
    v_exp_f32 v184, v184 clamp
    v_exp_f32 v185, v185 clamp
    v_exp_f32 v186, v186 clamp
    v_exp_f32 v187, v187 clamp
    s_add_u32 s63, s62, 49152
    buffer_load_dwordx4 v[60:63], v255, s[4:7], s63 offen
    v_max_f32 v192, 0, v192
    v_max_f32 v193, 0, v193
    v_max_f32 v194, 0, v194
    v_max_f32 v195, 0, v195
    v_add_f32 v184, 0x358637bd, v184
    v_add_f32 v185, 0x358637bd, v185
    s_add_u32 s63, s62, 57344
    buffer_load_dwordx4 v[64:67], v255, s[4:7], s63 offen
    v_add_f32 v186, 0x358637bd, v186
    v_add_f32 v187, 0x358637bd, v187
    v_fma_f32 v192, v192, v223, v184
    v_fma_f32 v193, v193, v223, v185
    v_fma_f32 v194, v194, v223, v186
    v_fma_f32 v195, v195, v223, v187
    v_fmac_f32 v196, v220, v144
    v_fmac_f32 v197, v220, v145
    v_fmac_f32 v198, v220, v146
    v_fmac_f32 v199, v220, v147
    v_mul_f32 v180, v196, v152
    v_mul_f32 v181, v197, v152
    v_mul_f32 v182, v198, v152
    v_mul_f32 v183, v199, v152
    v_exp_f32 v180, v180 clamp
    v_exp_f32 v181, v181 clamp
    v_exp_f32 v182, v182 clamp
    v_exp_f32 v183, v183 clamp
    v_max_f32 v196, 0, v196
    v_max_f32 v197, 0, v197
    v_max_f32 v198, 0, v198
    v_max_f32 v199, 0, v199
    v_add_f32 v180, 0x358637bd, v180
    v_add_f32 v181, 0x358637bd, v181
    v_add_f32 v182, 0x358637bd, v182
    v_add_f32 v183, 0x358637bd, v183
    v_fma_f32 v196, v196, v221, v180
    v_fma_f32 v197, v197, v221, v181
    v_fma_f32 v198, v198, v221, v182
    v_fma_f32 v199, v199, v221, v183
    v_fmac_f32 v200, v222, v144
    v_fmac_f32 v201, v222, v145
    v_fmac_f32 v202, v222, v146
    v_fmac_f32 v203, v222, v147
    v_mul_f32 v184, v200, v153
    v_mul_f32 v185, v201, v153
    v_mul_f32 v186, v202, v153
    v_mul_f32 v187, v203, v153
    v_exp_f32 v184, v184 clamp
    v_exp_f32 v185, v185 clamp
    v_exp_f32 v186, v186 clamp
    v_exp_f32 v187, v187 clamp
    v_max_f32 v200, 0, v200
    v_max_f32 v201, 0, v201
    v_max_f32 v202, 0, v202
    v_max_f32 v203, 0, v203
    v_add_f32 v184, 0x358637bd, v184
    v_add_f32 v185, 0x358637bd, v185
    v_add_f32 v186, 0x358637bd, v186
    v_add_f32 v187, 0x358637bd, v187
    v_fma_f32 v200, v200, v223, v184
    v_fma_f32 v201, v201, v223, v185
    v_fma_f32 v202, v202, v223, v186
    v_fma_f32 v203, v203, v223, v187
    v_fmac_f32 v204, v220, v148
    v_fmac_f32 v205, v220, v149
    v_fmac_f32 v206, v220, v150
    v_fmac_f32 v207, v220, v151
    v_mul_f32 v180, v204, v152
    v_mul_f32 v181, v205, v152
    v_mul_f32 v182, v206, v152
    v_mul_f32 v183, v207, v152
    v_exp_f32 v180, v180 clamp
    v_exp_f32 v181, v181 clamp
    v_exp_f32 v182, v182 clamp
    v_exp_f32 v183, v183 clamp
    v_max_f32 v204, 0, v204
    v_max_f32 v205, 0, v205
    v_max_f32 v206, 0, v206
    v_max_f32 v207, 0, v207
    v_add_f32 v180, 0x358637bd, v180
    v_add_f32 v181, 0x358637bd, v181
    v_add_f32 v182, 0x358637bd, v182
    v_add_f32 v183, 0x358637bd, v183
    v_fma_f32 v204, v204, v221, v180
    v_fma_f32 v205, v205, v221, v181
    v_fma_f32 v206, v206, v221, v182
    v_fma_f32 v207, v207, v221, v183
    v_fmac_f32 v208, v222, v148
    v_fmac_f32 v209, v222, v149
    v_fmac_f32 v210, v222, v150
    v_fmac_f32 v211, v222, v151
    v_mul_f32 v184, v208, v153
    v_mul_f32 v185, v209, v153
    v_mul_f32 v186, v210, v153
    v_mul_f32 v187, v211, v153
    v_exp_f32 v184, v184 clamp
    v_exp_f32 v185, v185 clamp
    v_exp_f32 v186, v186 clamp
    v_exp_f32 v187, v187 clamp
    v_max_f32 v208, 0, v208
    v_max_f32 v209, 0, v209
    v_max_f32 v210, 0, v210
    v_max_f32 v211, 0, v211
    v_add_f32 v184, 0x358637bd, v184
    v_add_f32 v185, 0x358637bd, v185
    v_add_f32 v186, 0x358637bd, v186
    v_add_f32 v187, 0x358637bd, v187
    v_fma_f32 v208, v208, v223, v184
    v_fma_f32 v209, v209, v223, v185
    v_fma_f32 v210, v210, v223, v186
    v_fma_f32 v211, v211, v223, v187
    v_cvt_pk_bf16_f32 v156, v188, v189
    v_cvt_pk_bf16_f32 v157, v190, v191
    v_cvt_pk_bf16_f32 v158, v204, v205
    v_cvt_pk_bf16_f32 v159, v206, v207
    v_cvt_pk_bf16_f32 v160, v196, v197
    v_cvt_pk_bf16_f32 v161, v198, v199
    v_mov_b32 v162, v158
    v_mov_b32 v163, v159
    v_cvt_pk_bf16_f32 v164, v192, v193
    v_cvt_pk_bf16_f32 v165, v194, v195
    v_cvt_pk_bf16_f32 v166, v208, v209
    v_cvt_pk_bf16_f32 v167, v210, v211
    v_cvt_pk_bf16_f32 v168, v200, v201
    v_cvt_pk_bf16_f32 v169, v202, v203
    v_mov_b32 v170, v166
    v_mov_b32 v171, v167
    s_mov_b32 s47, 0
    s_mov_b32 s88, 0x3f80
    s_mov_b32 s89, 0x3f800000
    s_waitcnt vmcnt(7)
Lkv9_s:
    v_mov_b32 v68, 0
    v_mov_b32 v69, 0
    v_mov_b32 v70, 0
    v_mov_b32 v71, 0
    v_mov_b32 v72, 0
    v_mov_b32 v73, 0
    v_mov_b32 v74, 0
    v_mov_b32 v75, 0
    v_dot2c_f32_bf16 v68, s88, v36
    v_dot2c_f32_bf16 v69, s89, v36
    v_dot2c_f32_bf16 v70, s88, v37
    v_dot2c_f32_bf16 v71, s89, v37
    v_dot2c_f32_bf16 v72, s88, v38
    v_dot2c_f32_bf16 v73, s89, v38
    v_dot2c_f32_bf16 v74, s88, v39
    v_dot2c_f32_bf16 v75, s89, v39
    s_waitcnt vmcnt(6)
    v_dot2c_f32_bf16 v68, s88, v40
    v_dot2c_f32_bf16 v69, s89, v40
    v_dot2c_f32_bf16 v70, s88, v41
    v_dot2c_f32_bf16 v71, s89, v41
    v_dot2c_f32_bf16 v72, s88, v42
    v_dot2c_f32_bf16 v73, s89, v42
    v_dot2c_f32_bf16 v74, s88, v43
    v_dot2c_f32_bf16 v75, s89, v43
    s_waitcnt vmcnt(5)
    v_dot2c_f32_bf16 v68, s88, v44
    v_dot2c_f32_bf16 v69, s89, v44
    v_dot2c_f32_bf16 v70, s88, v45
    v_dot2c_f32_bf16 v71, s89, v45
    v_dot2c_f32_bf16 v72, s88, v46
    v_dot2c_f32_bf16 v73, s89, v46
    v_dot2c_f32_bf16 v74, s88, v47
    v_dot2c_f32_bf16 v75, s89, v47
    s_waitcnt vmcnt(4)
    v_dot2c_f32_bf16 v68, s88, v48
    v_dot2c_f32_bf16 v69, s89, v48
    v_dot2c_f32_bf16 v70, s88, v49
    v_dot2c_f32_bf16 v71, s89, v49
    v_dot2c_f32_bf16 v72, s88, v50
    v_dot2c_f32_bf16 v73, s89, v50
    v_dot2c_f32_bf16 v74, s88, v51
    v_dot2c_f32_bf16 v75, s89, v51
    s_waitcnt vmcnt(3)
    v_dot2c_f32_bf16 v68, s88, v52
    v_dot2c_f32_bf16 v69, s89, v52
    v_dot2c_f32_bf16 v70, s88, v53
    v_dot2c_f32_bf16 v71, s89, v53
    v_dot2c_f32_bf16 v72, s88, v54
    v_dot2c_f32_bf16 v73, s89, v54
    v_dot2c_f32_bf16 v74, s88, v55
    v_dot2c_f32_bf16 v75, s89, v55
    s_waitcnt vmcnt(2)
    v_dot2c_f32_bf16 v68, s88, v56
    v_dot2c_f32_bf16 v69, s89, v56
    v_dot2c_f32_bf16 v70, s88, v57
    v_dot2c_f32_bf16 v71, s89, v57
    v_dot2c_f32_bf16 v72, s88, v58
    v_dot2c_f32_bf16 v73, s89, v58
    v_dot2c_f32_bf16 v74, s88, v59
    v_dot2c_f32_bf16 v75, s89, v59
    s_waitcnt vmcnt(1)
    v_dot2c_f32_bf16 v68, s88, v60
    v_dot2c_f32_bf16 v69, s89, v60
    v_dot2c_f32_bf16 v70, s88, v61
    v_dot2c_f32_bf16 v71, s89, v61
    v_dot2c_f32_bf16 v72, s88, v62
    v_dot2c_f32_bf16 v73, s89, v62
    v_dot2c_f32_bf16 v74, s88, v63
    v_dot2c_f32_bf16 v75, s89, v63
    s_waitcnt vmcnt(0)
    v_dot2c_f32_bf16 v68, s88, v64
    v_dot2c_f32_bf16 v69, s89, v64
    v_dot2c_f32_bf16 v70, s88, v65
    v_dot2c_f32_bf16 v71, s89, v65
    v_dot2c_f32_bf16 v72, s88, v66
    v_dot2c_f32_bf16 v73, s89, v66
    v_dot2c_f32_bf16 v74, s88, v67
    v_dot2c_f32_bf16 v75, s89, v67
    v_cmp_u_f32 vcc, v68, v70
    s_nop 0
    v_cmp_u_f32 s[34:35], v72, v74
    s_nop 3
    s_or_b64 vcc, vcc, s[34:35]
    s_cbranch_vccz Lkv9_o
    s_add_u32 s47, s47, 1
    s_cmp_gt_u32 s47, 20000
    s_cbranch_scc1 Lkv9_o
    s_add_u32 s63, s62, 0
    buffer_load_dwordx4 v[36:39], v255, s[4:7], s63 offen sc1
    s_add_u32 s63, s62, 8192
    buffer_load_dwordx4 v[40:43], v255, s[4:7], s63 offen sc1
    s_add_u32 s63, s62, 16384
    buffer_load_dwordx4 v[44:47], v255, s[4:7], s63 offen sc1
    s_add_u32 s63, s62, 24576
    buffer_load_dwordx4 v[48:51], v255, s[4:7], s63 offen sc1
    s_add_u32 s63, s62, 32768
    buffer_load_dwordx4 v[52:55], v255, s[4:7], s63 offen sc1
    s_add_u32 s63, s62, 40960
    buffer_load_dwordx4 v[56:59], v255, s[4:7], s63 offen sc1
    s_add_u32 s63, s62, 49152
    buffer_load_dwordx4 v[60:63], v255, s[4:7], s63 offen sc1
    s_add_u32 s63, s62, 57344
    buffer_load_dwordx4 v[64:67], v255, s[4:7], s63 offen sc1
    s_waitcnt vmcnt(0)
    s_branch Lkv9_s
Lkv9_o:
    v_permlane32_swap_b32 v68, v72
    v_permlane32_swap_b32 v69, v73
    v_permlane32_swap_b32 v70, v74
    v_permlane32_swap_b32 v71, v75
    v_add_f32 v68, v68, v72
    v_add_f32 v69, v69, v73
    v_add_f32 v70, v70, v74
    v_add_f32 v71, v71, v75
    v_cvt_pk_bf16_f32 v36, v68, v69
    v_cvt_pk_bf16_f32 v37, v70, v71
    v_and_b32 v254, 0x1f0, v1
    v_lshrrev_b32 v255, 6, v1
    v_and_b32 v255, 8, v255
    v_add_u32 v254, v254, v255
    s_lshl_b32 s33, s16, 9
    s_add_u32 s33, s33, 0x20000
    v_add_u32 v254, s33, v254
    ds_write_b64 v254, v[36:37] offset:24576
    s_waitcnt lgkmcnt(0)
    s_barrier
    s_add_u32 m0, s22, 98304
    s_add_u32 s31, s26, 81920
    buffer_load_dwordx4 v1, s[4:7], s31 offen offset:0 lds
    buffer_load_dwordx4 v1, s[4:7], s31 offen offset:1024 lds
    buffer_load_dwordx4 v1, s[4:7], s31 offen offset:2048 lds
    buffer_load_dwordx4 v1, s[4:7], s31 offen offset:3072 lds
    s_add_u32 m0, s23, 114688
    s_add_u32 s31, s29, 98304
    buffer_load_dwordx4 v1, s[4:7], s31 offen offset:0 lds
    s_add_u32 m0, s22, 131072
    s_add_u32 s31, s27, 0
    buffer_load_dwordx4 v1, s[4:7], s31 offen offset:0 lds
    buffer_load_dwordx4 v1, s[4:7], s31 offen offset:1024 lds
    buffer_load_dwordx4 v1, s[4:7], s31 offen offset:2048 lds
    buffer_load_dwordx4 v1, s[4:7], s31 offen offset:3072 lds
    s_add_u32 m0, s22, 0
    s_add_u32 s31, s27, 16384
    buffer_load_dwordx4 v1, s[4:7], s31 offen offset:0 lds
    buffer_load_dwordx4 v1, s[4:7], s31 offen offset:1024 lds
    buffer_load_dwordx4 v1, s[4:7], s31 offen offset:2048 lds
    buffer_load_dwordx4 v1, s[4:7], s31 offen offset:3072 lds
    ds_read_b64 v[176:177], v11 offset:24576
    ds_read_b64 v[178:179], v11 offset:25088
    ds_read_b64 v[180:181], v11 offset:25600
    ds_read_b64 v[182:183], v11 offset:26112
    v_xor_b32 v254, 256, v11
    ds_read_b64 v[184:185], v254 offset:26112
    v_lshlrev_b32 v254, 3, v7
    v_and_b32 v254, 0x3ff, v254
    v_add_u32 v254, 0x20000, v254
    ds_read_b64 v[186:187], v254 offset:25600
    ds_read_b64 v[188:189], v254 offset:25632
    v_mov_b32 v255, 0x20000
    ds_read_b64 v[190:191], v255 offset:26368
    ds_read_b64 v[192:193], v255 offset:26528
    s_waitcnt lgkmcnt(0)
    v_mov_b32 v196, v176
    v_mov_b32 v197, v177
    v_cndmask_b32 v198, 0, v182, s[48:49]
    v_cndmask_b32 v199, 0, v183, s[48:49]
    v_mov_b32 v200, v178
    v_mov_b32 v201, v179
    v_cndmask_b32 v202, 0, v182, s[50:51]
    v_cndmask_b32 v203, 0, v183, s[50:51]
    v_cndmask_b32 v204, 0, v180, s[52:53]
    v_cndmask_b32 v205, 0, v181, s[52:53]
    v_cndmask_b32 v206, 0, v184, s[56:57]
    v_cndmask_b32 v207, 0, v185, s[56:57]
    v_cndmask_b32 v208, 0, v180, s[54:55]
    v_cndmask_b32 v209, 0, v181, s[54:55]
    v_cndmask_b32 v210, 0, v184, s[58:59]
    v_cndmask_b32 v211, 0, v185, s[58:59]
    v_mov_b32 v212, v186
    v_mov_b32 v213, v187
    v_cndmask_b32 v214, 0, v190, s[48:49]
    v_cndmask_b32 v215, 0, v191, s[48:49]
    v_mov_b32 v216, v188
    v_mov_b32 v217, v189
    v_cndmask_b32 v218, 0, v192, s[50:51]
    v_cndmask_b32 v219, 0, v193, s[50:51]
    v_mfma_f32_16x16x32_bf16 v[112:115], v[212:215], v[156:159], 0
    s_nop 0
    v_mfma_f32_16x16x32_bf16 v[116:119], v[216:219], v[160:163], 0
    v_mfma_f32_16x16x32_bf16 v[100:103], v[196:199], v[156:159], 0
    v_mfma_f32_16x16x32_bf16 v[104:107], v[200:203], v[160:163], 0
    v_mfma_f32_16x16x32_bf16 v[108:111], v[204:207], v[156:159], 0
    v_mfma_f32_16x16x32_bf16 v[108:111], v[208:211], v[160:163], v[108:111]
    v_mfma_f32_16x16x32_bf16 v[132:135], v[212:215], v[164:167], 0
    v_mfma_f32_16x16x32_bf16 v[136:139], v[216:219], v[168:171], 0
    v_mfma_f32_16x16x32_bf16 v[120:123], v[196:199], v[164:167], 0
    v_mfma_f32_16x16x32_bf16 v[124:127], v[200:203], v[168:171], 0
    v_mfma_f32_16x16x32_bf16 v[128:131], v[204:207], v[164:167], 0
    v_mfma_f32_16x16x32_bf16 v[128:131], v[208:211], v[168:171], v[128:131]
    s_mul_i32 s62, s21, 2621440
    s_mul_i32 s63, s42, 20480
    s_add_u32 s62, s62, s63
    s_add_u32 s62, s62, 14680064
    s_lshl_b32 s63, s18, 10
    s_add_u32 s63, s63, s62
    v_add_f32 v112, 0x358637bd, v112
    v_add_f32 v116, 0x358637bd, v116
    v_rcp_f32 v112, v112
    v_rcp_f32 v116, v116
    s_nop 0
    v_cndmask_b32 v113, v112, v116, s[72:73]
    v_mul_f32 v100, v100, v112
    v_mul_f32 v104, v104, v116
    v_mul_f32 v108, v108, v113
    v_mul_f32 v101, v101, v112
    v_mul_f32 v105, v105, v116
    v_mul_f32 v109, v109, v113
    v_mul_f32 v102, v102, v112
    v_mul_f32 v106, v106, v116
    v_mul_f32 v110, v110, v113
    v_mul_f32 v103, v103, v112
    v_mul_f32 v107, v107, v116
    v_mul_f32 v111, v111, v113
    v_cvt_pk_bf16_f32 v100, v100, v101
    v_cvt_pk_bf16_f32 v101, v102, v103
    v_cvt_pk_bf16_f32 v102, v104, v105
    v_cvt_pk_bf16_f32 v103, v106, v107
    v_cvt_pk_bf16_f32 v108, v108, v109
    v_cvt_pk_bf16_f32 v109, v110, v111
    buffer_store_dwordx4 v[100:103], v1, s[4:7], s63 offen sc1
    s_mov_b64 exec, s[70:71]
    buffer_store_dwordx2 v[108:109], v14, s[4:7], s62 offen sc1
    s_mov_b64 exec, -1
    v_add_f32 v132, 0x358637bd, v132
    v_add_f32 v136, 0x358637bd, v136
    v_rcp_f32 v132, v132
    v_rcp_f32 v136, v136
    s_nop 0
    v_cndmask_b32 v133, v132, v136, s[72:73]
    v_mul_f32 v120, v120, v132
    v_mul_f32 v124, v124, v136
    v_mul_f32 v128, v128, v133
    v_mul_f32 v121, v121, v132
    v_mul_f32 v125, v125, v136
    v_mul_f32 v129, v129, v133
    v_mul_f32 v122, v122, v132
    v_mul_f32 v126, v126, v136
    v_mul_f32 v130, v130, v133
    v_mul_f32 v123, v123, v132
    v_mul_f32 v127, v127, v136
    v_mul_f32 v131, v131, v133
    v_cvt_pk_bf16_f32 v120, v120, v121
    v_cvt_pk_bf16_f32 v121, v122, v123
    v_cvt_pk_bf16_f32 v122, v124, v125
    v_cvt_pk_bf16_f32 v123, v126, v127
    v_cvt_pk_bf16_f32 v128, v128, v129
    v_cvt_pk_bf16_f32 v129, v130, v131
    buffer_store_dwordx4 v[120:123], v4, s[4:7], s63 offen sc1
    s_add_u32 s62, s62, 20480
    s_mov_b64 exec, s[70:71]
    buffer_store_dwordx2 v[128:129], v14, s[4:7], s62 offen sc1
    s_mov_b64 exec, -1
    s_waitcnt vmcnt(0)
    s_barrier
    s_add_u32 s33, s41, 1
    v_mov_b32 v254, s33
    v_mov_b32 v255, 0
    s_mov_b64 exec, s[44:45]
    buffer_store_dword v254, v255, s[4:7], s37 offen sc1
    s_mov_b64 exec, -1
    s_cmp_lg_u32 s16, 0
    s_cbranch_scc1 Lt10_o
    s_add_u32 s33, s41, 1
    s_mov_b32 s47, 0
    v_subrev_u32 v252, 0x20000, v5
Lt10_p:
    buffer_load_dword v253, v252, s[4:7], s38 offen sc1
    s_waitcnt vmcnt(0)
    v_cmp_gt_u32 vcc, s33, v253
    s_add_u32 s47, s47, 1
    s_cmp_gt_u32 s47, 20000
    s_cbranch_scc1 Lt10_p_x
    s_nop 1
    s_cbranch_vccnz Lt10_p
Lt10_p_x:
Lt10_o:
    s_barrier
    s_mul_i32 s32, s21, 2621440
    s_mul_i32 s33, s43, 20480
    s_add_u32 s32, s32, s33
    s_add_u32 s32, s32, 14680064
    ds_read_b128 v[36:39], v1 offset:16384
    ds_read_b128 v[40:43], v1 offset:17408
    ds_read_b128 v[44:47], v1 offset:18432
    ds_read_b128 v[48:51], v1 offset:19456
    ds_read_b128 v[52:55], v1 offset:20480
    buffer_load_dwordx4 a[0:3], v1, s[4:7], s32 offen offset:0 sc1
    buffer_load_dwordx4 a[4:7], v1, s[4:7], s32 offen offset:1024 sc1
    buffer_load_dwordx4 a[8:11], v1, s[4:7], s32 offen offset:2048 sc1
    buffer_load_dwordx4 a[12:15], v1, s[4:7], s32 offen offset:3072 sc1
    s_add_u32 s32, s32, 4096
    buffer_load_dwordx4 a[16:19], v1, s[4:7], s32 offen offset:0 sc1
    buffer_load_dwordx4 a[20:23], v1, s[4:7], s32 offen offset:1024 sc1
    buffer_load_dwordx4 a[24:27], v1, s[4:7], s32 offen offset:2048 sc1
    buffer_load_dwordx4 a[28:31], v1, s[4:7], s32 offen offset:3072 sc1
    s_add_u32 s32, s32, 4096
    buffer_load_dwordx4 a[32:35], v1, s[4:7], s32 offen offset:0 sc1
    buffer_load_dwordx4 a[36:39], v1, s[4:7], s32 offen offset:1024 sc1
    buffer_load_dwordx4 a[40:43], v1, s[4:7], s32 offen offset:2048 sc1
    s_waitcnt vmcnt(10) lgkmcnt(0)
    v_mfma_f32_16x16x32_bf16 v[16:19], v[36:39], a[0:3], v[16:19]
    ds_read_b128 v[56:59], v1 offset:21504
    ds_read_b128 v[60:63], v1 offset:22528
    v_mfma_f32_16x16x32_bf16 v[20:23], v[40:43], a[0:3], v[20:23]
    ds_read_b128 v[64:67], v1 offset:23552
    ds_read_b128 v[68:71], v1 offset:24576
    v_mfma_f32_16x16x32_bf16 v[24:27], v[44:47], a[0:3], v[24:27]
    ds_read_b128 v[72:75], v1 offset:25600
    ds_read_b128 v[76:79], v1 offset:26624
    v_mfma_f32_16x16x32_bf16 v[28:31], v[48:51], a[0:3], v[28:31]
    ds_read_b128 v[80:83], v1 offset:27648
    ds_read_b128 v[84:87], v1 offset:28672
    v_mfma_f32_16x16x32_bf16 v[32:35], v[52:55], a[0:3], v[32:35]
    ds_read_b128 v[88:91], v1 offset:29696
    s_waitcnt vmcnt(9) lgkmcnt(4)
    v_mfma_f32_16x16x32_bf16 v[16:19], v[56:59], a[4:7], v[16:19]
    ds_read_b128 v[92:95], v1 offset:30720
    ds_read_b128 v[96:99], v1 offset:31744
    v_mfma_f32_16x16x32_bf16 v[20:23], v[60:63], a[4:7], v[20:23]
    ds_read_b128 v[36:39], v1 offset:32768
    ds_read_b128 v[40:43], v1 offset:33792
    v_mfma_f32_16x16x32_bf16 v[24:27], v[64:67], a[4:7], v[24:27]
    ds_read_b128 v[44:47], v1 offset:34816
    buffer_load_dwordx4 a[44:47], v1, s[4:7], s32 offen offset:3072 sc1
    v_mfma_f32_16x16x32_bf16 v[28:31], v[68:71], a[4:7], v[28:31]
    ds_read_b128 v[48:51], v1 offset:35840
    s_add_u32 s32, s32, 4096
    buffer_load_dwordx4 a[48:51], v1, s[4:7], s32 offen offset:0 sc1
    v_mfma_f32_16x16x32_bf16 v[32:35], v[72:75], a[4:7], v[32:35]
    ds_read_b128 v[52:55], v1 offset:36864
    s_waitcnt vmcnt(10) lgkmcnt(6)
    v_mfma_f32_16x16x32_bf16 v[16:19], v[76:79], a[8:11], v[16:19]
    ds_read_b128 v[56:59], v1 offset:37888
    buffer_load_dwordx4 a[52:55], v1, s[4:7], s32 offen offset:1024 sc1
    v_mfma_f32_16x16x32_bf16 v[20:23], v[80:83], a[8:11], v[20:23]
    ds_read_b128 v[60:63], v1 offset:38912
    v_mfma_f32_16x16x32_bf16 v[24:27], v[84:87], a[8:11], v[24:27]
    ds_read_b128 v[64:67], v1 offset:39936
    buffer_load_dwordx4 a[56:59], v1, s[4:7], s32 offen offset:2048 sc1
    v_mfma_f32_16x16x32_bf16 v[28:31], v[88:91], a[8:11], v[28:31]
    ds_read_b128 v[68:71], v1 offset:40960
    v_mfma_f32_16x16x32_bf16 v[32:35], v[92:95], a[8:11], v[32:35]
    ds_read_b128 v[72:75], v1 offset:41984
    s_waitcnt vmcnt(11) lgkmcnt(6)
    v_mfma_f32_16x16x32_bf16 v[16:19], v[96:99], a[12:15], v[16:19]
    ds_read_b128 v[76:79], v1 offset:43008
    v_mfma_f32_16x16x32_bf16 v[20:23], v[36:39], a[12:15], v[20:23]
    ds_read_b128 v[80:83], v1 offset:44032
    buffer_load_dwordx4 a[60:63], v1, s[4:7], s32 offen offset:3072 sc1
    v_mfma_f32_16x16x32_bf16 v[24:27], v[40:43], a[12:15], v[24:27]
    ds_read_b128 v[84:87], v1 offset:45056
    v_mfma_f32_16x16x32_bf16 v[28:31], v[44:47], a[12:15], v[28:31]
    ds_read_b128 v[88:91], v1 offset:46080
    v_mfma_f32_16x16x32_bf16 v[32:35], v[48:51], a[12:15], v[32:35]
    ds_read_b128 v[92:95], v1 offset:47104
    s_waitcnt vmcnt(11) lgkmcnt(6)
    v_mfma_f32_16x16x32_bf16 v[16:19], v[52:55], a[16:19], v[16:19]
    ds_read_b128 v[96:99], v1 offset:48128
    s_add_u32 s32, s32, 4096
    buffer_load_dwordx4 a[64:67], v1, s[4:7], s32 offen offset:0 sc1
    v_mfma_f32_16x16x32_bf16 v[20:23], v[56:59], a[16:19], v[20:23]
    ds_read_b128 v[36:39], v1 offset:49152
    v_mfma_f32_16x16x32_bf16 v[24:27], v[60:63], a[16:19], v[24:27]
    ds_read_b128 v[40:43], v1 offset:50176
    v_mfma_f32_16x16x32_bf16 v[28:31], v[64:67], a[16:19], v[28:31]
    ds_read_b128 v[44:47], v1 offset:51200
    buffer_load_dwordx4 a[68:71], v1, s[4:7], s32 offen offset:1024 sc1
    v_mfma_f32_16x16x32_bf16 v[32:35], v[68:71], a[16:19], v[32:35]
    ds_read_b128 v[48:51], v1 offset:52224
    s_waitcnt vmcnt(12) lgkmcnt(6)
    v_mfma_f32_16x16x32_bf16 v[16:19], v[72:75], a[20:23], v[16:19]
    ds_read_b128 v[52:55], v1 offset:53248
    v_mfma_f32_16x16x32_bf16 v[20:23], v[76:79], a[20:23], v[20:23]
    ds_read_b128 v[56:59], v1 offset:54272
    buffer_load_dwordx4 a[72:75], v1, s[4:7], s32 offen offset:2048 sc1
    v_mfma_f32_16x16x32_bf16 v[24:27], v[80:83], a[20:23], v[24:27]
    ds_read_b128 v[60:63], v1 offset:55296
    v_mfma_f32_16x16x32_bf16 v[28:31], v[84:87], a[20:23], v[28:31]
    ds_read_b128 v[64:67], v1 offset:56320
    v_mfma_f32_16x16x32_bf16 v[32:35], v[88:91], a[20:23], v[32:35]
    ds_read_b128 v[68:71], v1 offset:57344
    s_waitcnt vmcnt(12) lgkmcnt(6)
    v_mfma_f32_16x16x32_bf16 v[16:19], v[92:95], a[24:27], v[16:19]
    ds_read_b128 v[72:75], v1 offset:58368
    buffer_load_dwordx4 a[76:79], v1, s[4:7], s32 offen offset:3072 sc1
    v_mfma_f32_16x16x32_bf16 v[20:23], v[96:99], a[24:27], v[20:23]
    ds_read_b128 v[76:79], v1 offset:59392
    v_mfma_f32_16x16x32_bf16 v[24:27], v[36:39], a[24:27], v[24:27]
    ds_read_b128 v[80:83], v1 offset:60416
    v_mfma_f32_16x16x32_bf16 v[28:31], v[40:43], a[24:27], v[28:31]
    ds_read_b128 v[84:87], v1 offset:61440
    v_mfma_f32_16x16x32_bf16 v[32:35], v[44:47], a[24:27], v[32:35]
    ds_read_b128 v[88:91], v1 offset:62464
    s_waitcnt vmcnt(12) lgkmcnt(6)
    v_mfma_f32_16x16x32_bf16 v[16:19], v[48:51], a[28:31], v[16:19]
    ds_read_b128 v[92:95], v1 offset:63488
    v_mfma_f32_16x16x32_bf16 v[20:23], v[52:55], a[28:31], v[20:23]
    ds_read_b128 v[96:99], v1 offset:64512
    v_mfma_f32_16x16x32_bf16 v[24:27], v[56:59], a[28:31], v[24:27]
    s_barrier
    ds_read_b128 v[36:39], v2 offset:0
    v_mfma_f32_16x16x32_bf16 v[28:31], v[60:63], a[28:31], v[28:31]
    ds_read_b128 v[40:43], v2 offset:1024
    s_add_u32 m0, s22, 16384
    s_add_u32 s31, s27, 32768
    buffer_load_dwordx4 v1, s[4:7], s31 offen offset:0 lds
    v_mfma_f32_16x16x32_bf16 v[32:35], v[64:67], a[28:31], v[32:35]
    ds_read_b128 v[44:47], v2 offset:2048
    s_waitcnt vmcnt(12) lgkmcnt(6)
    v_mfma_f32_16x16x32_bf16 v[16:19], v[68:71], a[32:35], v[16:19]
    ds_read_b128 v[48:51], v2 offset:3072
    buffer_load_dwordx4 v1, s[4:7], s31 offen offset:1024 lds
    v_mfma_f32_16x16x32_bf16 v[20:23], v[72:75], a[32:35], v[20:23]
    ds_read_b128 v[52:55], v2 offset:4096
    buffer_load_dwordx4 v1, s[4:7], s31 offen offset:2048 lds
    v_mfma_f32_16x16x32_bf16 v[24:27], v[76:79], a[32:35], v[24:27]
    ds_read_b128 v[56:59], v2 offset:5120
    v_mfma_f32_16x16x32_bf16 v[28:31], v[80:83], a[32:35], v[28:31]
    ds_read_b128 v[60:63], v2 offset:6144
    v_mfma_f32_16x16x32_bf16 v[32:35], v[84:87], a[32:35], v[32:35]
    ds_read_b128 v[64:67], v2 offset:7168
    s_waitcnt vmcnt(13) lgkmcnt(6)
    v_mfma_f32_16x16x32_bf16 v[16:19], v[88:91], a[36:39], v[16:19]
    ds_read_b128 v[68:71], v2 offset:8192
    buffer_load_dwordx4 v1, s[4:7], s31 offen offset:3072 lds
    v_mfma_f32_16x16x32_bf16 v[20:23], v[92:95], a[36:39], v[20:23]
    ds_read_b128 v[72:75], v2 offset:9216
    v_mfma_f32_16x16x32_bf16 v[24:27], v[96:99], a[36:39], v[24:27]
    ds_read_b128 v[76:79], v2 offset:10240
    s_add_u32 m0, s22, 32768
    s_add_u32 s31, s27, 49152
    buffer_load_dwordx4 v1, s[4:7], s31 offen offset:0 lds
    v_mfma_f32_16x16x32_bf16 v[28:31], v[36:39], a[36:39], v[28:31]
    ds_read_b128 v[80:83], v2 offset:11264
    v_mfma_f32_16x16x32_bf16 v[32:35], v[40:43], a[36:39], v[32:35]
    ds_read_b128 v[84:87], v2 offset:12288
    s_waitcnt vmcnt(14) lgkmcnt(6)
    v_mfma_f32_16x16x32_bf16 v[16:19], v[44:47], a[40:43], v[16:19]
    ds_read_b128 v[88:91], v2 offset:13312
    v_mfma_f32_16x16x32_bf16 v[20:23], v[48:51], a[40:43], v[20:23]
    ds_read_b128 v[92:95], v2 offset:14336
    buffer_load_dwordx4 v1, s[4:7], s31 offen offset:1024 lds
    v_mfma_f32_16x16x32_bf16 v[24:27], v[52:55], a[40:43], v[24:27]
    ds_read_b128 v[96:99], v2 offset:15360
    v_mfma_f32_16x16x32_bf16 v[28:31], v[56:59], a[40:43], v[28:31]
    s_barrier
    ds_read_b128 v[36:39], v2 offset:16384
    v_mfma_f32_16x16x32_bf16 v[32:35], v[60:63], a[40:43], v[32:35]
    ds_read_b128 v[40:43], v2 offset:17408
    s_waitcnt vmcnt(14) lgkmcnt(6)
    v_mfma_f32_16x16x32_bf16 v[16:19], v[64:67], a[44:47], v[16:19]
    ds_read_b128 v[44:47], v2 offset:18432
    buffer_load_dwordx4 v1, s[4:7], s31 offen offset:2048 lds
    v_mfma_f32_16x16x32_bf16 v[20:23], v[68:71], a[44:47], v[20:23]
    ds_read_b128 v[48:51], v2 offset:19456
    v_mfma_f32_16x16x32_bf16 v[24:27], v[72:75], a[44:47], v[24:27]
    ds_read_b128 v[52:55], v2 offset:20480
    v_mfma_f32_16x16x32_bf16 v[28:31], v[76:79], a[44:47], v[28:31]
    ds_read_b128 v[56:59], v2 offset:21504
    buffer_load_dwordx4 v1, s[4:7], s31 offen offset:3072 lds
    v_mfma_f32_16x16x32_bf16 v[32:35], v[80:83], a[44:47], v[32:35]
    ds_read_b128 v[60:63], v2 offset:22528
    s_waitcnt vmcnt(15) lgkmcnt(6)
    v_mfma_f32_16x16x32_bf16 v[16:19], v[84:87], a[48:51], v[16:19]
    ds_read_b128 v[64:67], v2 offset:23552
    v_mfma_f32_16x16x32_bf16 v[20:23], v[88:91], a[48:51], v[20:23]
    ds_read_b128 v[68:71], v2 offset:24576
    s_add_u32 m0, s22, 49152
    s_add_u32 s31, s27, 65536
    buffer_load_dwordx4 v1, s[4:7], s31 offen offset:0 lds
    v_mfma_f32_16x16x32_bf16 v[24:27], v[92:95], a[48:51], v[24:27]
    ds_read_b128 v[72:75], v2 offset:25600
    v_mfma_f32_16x16x32_bf16 v[28:31], v[96:99], a[48:51], v[28:31]
    ds_read_b128 v[76:79], v2 offset:26624
    v_mfma_f32_16x16x32_bf16 v[32:35], v[36:39], a[48:51], v[32:35]
    ds_read_b128 v[80:83], v2 offset:27648
    s_waitcnt vmcnt(15) lgkmcnt(6)
    v_mfma_f32_16x16x32_bf16 v[16:19], v[40:43], a[52:55], v[16:19]
    ds_read_b128 v[84:87], v2 offset:28672
    buffer_load_dwordx4 v1, s[4:7], s31 offen offset:1024 lds
    v_mfma_f32_16x16x32_bf16 v[20:23], v[44:47], a[52:55], v[20:23]
    ds_read_b128 v[88:91], v2 offset:29696
    v_mfma_f32_16x16x32_bf16 v[24:27], v[48:51], a[52:55], v[24:27]
    ds_read_b128 v[92:95], v2 offset:30720
    v_mfma_f32_16x16x32_bf16 v[28:31], v[52:55], a[52:55], v[28:31]
    ds_read_b128 v[96:99], v2 offset:31744
    buffer_load_dwordx4 v1, s[4:7], s31 offen offset:2048 lds
    v_mfma_f32_16x16x32_bf16 v[32:35], v[56:59], a[52:55], v[32:35]
    ds_read_b128 v[36:39], v2 offset:32768
    s_waitcnt vmcnt(16) lgkmcnt(6)
    v_mfma_f32_16x16x32_bf16 v[16:19], v[60:63], a[56:59], v[16:19]
    ds_read_b128 v[40:43], v2 offset:33792
    v_mfma_f32_16x16x32_bf16 v[20:23], v[64:67], a[56:59], v[20:23]
    ds_read_b128 v[44:47], v2 offset:34816
    v_mfma_f32_16x16x32_bf16 v[24:27], v[68:71], a[56:59], v[24:27]
    ds_read_b128 v[48:51], v2 offset:35840
    v_mfma_f32_16x16x32_bf16 v[28:31], v[72:75], a[56:59], v[28:31]
    ds_read_b128 v[52:55], v2 offset:36864
    v_mfma_f32_16x16x32_bf16 v[32:35], v[76:79], a[56:59], v[32:35]
    ds_read_b128 v[56:59], v2 offset:37888
    s_waitcnt vmcnt(15) lgkmcnt(6)
    v_mfma_f32_16x16x32_bf16 v[16:19], v[80:83], a[60:63], v[16:19]
    ds_read_b128 v[60:63], v2 offset:38912
    v_mfma_f32_16x16x32_bf16 v[20:23], v[84:87], a[60:63], v[20:23]
    ds_read_b128 v[64:67], v2 offset:39936
    v_mfma_f32_16x16x32_bf16 v[24:27], v[88:91], a[60:63], v[24:27]
    ds_read_b128 v[68:71], v2 offset:40960
    v_mfma_f32_16x16x32_bf16 v[28:31], v[92:95], a[60:63], v[28:31]
    ds_read_b128 v[72:75], v2 offset:41984
    v_mfma_f32_16x16x32_bf16 v[32:35], v[96:99], a[60:63], v[32:35]
    ds_read_b128 v[76:79], v2 offset:43008
    s_waitcnt vmcnt(14) lgkmcnt(6)
    v_mfma_f32_16x16x32_bf16 v[16:19], v[36:39], a[64:67], v[16:19]
    ds_read_b128 v[80:83], v2 offset:44032
    v_mfma_f32_16x16x32_bf16 v[20:23], v[40:43], a[64:67], v[20:23]
    ds_read_b128 v[84:87], v2 offset:45056
    v_mfma_f32_16x16x32_bf16 v[24:27], v[44:47], a[64:67], v[24:27]
    ds_read_b128 v[88:91], v2 offset:46080
    v_mfma_f32_16x16x32_bf16 v[28:31], v[48:51], a[64:67], v[28:31]
    ds_read_b128 v[92:95], v2 offset:47104
    v_mfma_f32_16x16x32_bf16 v[32:35], v[52:55], a[64:67], v[32:35]
    ds_read_b128 v[96:99], v2 offset:48128
    s_waitcnt vmcnt(13) lgkmcnt(6)
    v_mfma_f32_16x16x32_bf16 v[16:19], v[56:59], a[68:71], v[16:19]
    ds_read_b128 v[36:39], v2 offset:49152
    v_mfma_f32_16x16x32_bf16 v[20:23], v[60:63], a[68:71], v[20:23]
    ds_read_b128 v[40:43], v2 offset:50176
    v_mfma_f32_16x16x32_bf16 v[24:27], v[64:67], a[68:71], v[24:27]
    ds_read_b128 v[44:47], v2 offset:51200
    v_mfma_f32_16x16x32_bf16 v[28:31], v[68:71], a[68:71], v[28:31]
    ds_read_b128 v[48:51], v2 offset:52224
    v_mfma_f32_16x16x32_bf16 v[32:35], v[72:75], a[68:71], v[32:35]
    s_waitcnt vmcnt(12) lgkmcnt(5)
    v_mfma_f32_16x16x32_bf16 v[16:19], v[76:79], a[72:75], v[16:19]
    v_mfma_f32_16x16x32_bf16 v[20:23], v[80:83], a[72:75], v[20:23]
    v_mfma_f32_16x16x32_bf16 v[24:27], v[84:87], a[72:75], v[24:27]
    v_mfma_f32_16x16x32_bf16 v[28:31], v[88:91], a[72:75], v[28:31]
    v_mfma_f32_16x16x32_bf16 v[32:35], v[92:95], a[72:75], v[32:35]
    s_waitcnt vmcnt(11) lgkmcnt(0)
    v_mfma_f32_16x16x32_bf16 v[16:19], v[96:99], a[76:79], v[16:19]
    v_mfma_f32_16x16x32_bf16 v[20:23], v[36:39], a[76:79], v[20:23]
    v_mfma_f32_16x16x32_bf16 v[24:27], v[40:43], a[76:79], v[24:27]
    v_mfma_f32_16x16x32_bf16 v[28:31], v[44:47], a[76:79], v[28:31]
    v_mfma_f32_16x16x32_bf16 v[32:35], v[48:51], a[76:79], v[32:35]
    s_nop 3
    v_cvt_pk_bf16_f32 v212, v16, v17
    v_cvt_pk_bf16_f32 v213, v18, v19
    v_cvt_pk_bf16_f32 v214, v20, v21
    v_cvt_pk_bf16_f32 v215, v22, v23
    v_cvt_pk_bf16_f32 v216, v24, v25
    v_cvt_pk_bf16_f32 v217, v26, v27
    v_cvt_pk_bf16_f32 v218, v28, v29
    v_cvt_pk_bf16_f32 v219, v30, v31
    v_cvt_pk_bf16_f32 v220, v32, v33
    v_cvt_pk_bf16_f32 v221, v34, v35
    s_add_u32 s60, s60, 1
    s_mul_i32 s62, s60, 2621440
    s_mul_i32 s33, s43, 20480
    s_add_u32 s62, s62, s33
    s_add_u32 s62, s62, 4194304
    s_lshr_b32 s33, s20, 1
    s_mul_i32 s33, s33, 5
    s_lshl_b32 s34, s64, 1
    s_add_u32 s34, s34, s33
    s_lshl_b32 s34, s34, 10
    s_add_u32 s34, s34, s62
    buffer_store_dwordx4 v[212:215], v1, s[4:7], s34 offen sc1
    buffer_store_dwordx4 v[216:219], v1, s[4:7], s34 offen offset:1024 sc1
    s_add_u32 s33, s33, 4
    s_lshl_b32 s33, s33, 10
    s_add_u32 s33, s33, s62
    s_lshl_b32 s34, s64, 3
    s_add_u32 s33, s33, s34
    buffer_store_dwordx2 v[220:221], v1, s[4:7], s33 offen sc1
    v_add_f32 v224, v16, v17
    v_mul_f32 v225, v16, v16
    v_fmac_f32 v225, v17, v17
    v_add_f32 v226, v18, v19
    v_mul_f32 v227, v18, v18
    v_fmac_f32 v227, v19, v19
    v_add_f32 v224, v224, v20
    v_fmac_f32 v225, v20, v20
    v_add_f32 v226, v226, v21
    v_fmac_f32 v227, v21, v21
    v_add_f32 v224, v224, v22
    v_fmac_f32 v225, v22, v22
    v_add_f32 v226, v226, v23
    v_fmac_f32 v227, v23, v23
    v_add_f32 v224, v224, v24
    v_fmac_f32 v225, v24, v24
    v_add_f32 v226, v226, v25
    v_fmac_f32 v227, v25, v25
    v_add_f32 v224, v224, v26
    v_fmac_f32 v225, v26, v26
    v_add_f32 v226, v226, v27
    v_fmac_f32 v227, v27, v27
    v_add_f32 v224, v224, v28
    v_fmac_f32 v225, v28, v28
    v_add_f32 v226, v226, v29
    v_fmac_f32 v227, v29, v29
    v_add_f32 v224, v224, v30
    v_fmac_f32 v225, v30, v30
    v_add_f32 v226, v226, v31
    v_fmac_f32 v227, v31, v31
    v_add_f32 v224, v224, v32
    v_fmac_f32 v225, v32, v32
    v_add_f32 v226, v226, v33
    v_fmac_f32 v227, v33, v33
    v_add_f32 v224, v224, v34
    v_fmac_f32 v225, v34, v34
    v_add_f32 v226, v226, v35
    v_fmac_f32 v227, v35, v35
    v_add_f32 v224, v224, v226
    v_add_f32 v225, v225, v227
    v_mov_b32 v226, v224
    v_mov_b32 v227, v225
    s_nop 0
    v_permlane32_swap_b32 v224, v226
    v_permlane32_swap_b32 v225, v227
    v_add_f32 v224, v224, v226
    v_add_f32 v225, v225, v227
    v_mov_b32 v226, v224
    v_mov_b32 v227, v225
    s_nop 0
    v_permlane16_swap_b32 v224, v226
    v_permlane16_swap_b32 v225, v227
    v_add_f32 v224, v224, v226
    v_add_f32 v225, v225, v227
    s_mul_i32 s62, s60, 131072
    s_lshl_b32 s33, s43, 10
    s_add_u32 s62, s62, s33
    s_lshl_b32 s33, s20, 7
    s_add_u32 s62, s62, s33
    s_add_u32 s62, s62, 393216
    s_mov_b64 exec, s[48:49]
    buffer_store_dwordx2 v[224:225], v12, s[4:7], s62 offen sc1
    s_mov_b64 exec, -1
    s_cmp_lg_u32 s16, 0
    s_cbranch_scc1 Lt12_a
    s_waitcnt vmcnt(0)
    s_branch Lt12_b
Lt12_a:
    s_waitcnt vmcnt(0)
Lt12_b:
    s_barrier
    s_add_u32 s33, s41, 2
    v_mov_b32 v254, s33
    v_mov_b32 v255, 0
    s_mov_b64 exec, s[44:45]
    buffer_store_dword v254, v255, s[4:7], s37 offen sc1
    s_mov_b64 exec, -1
    s_cmp_lg_u32 s16, 0
    s_cbranch_scc1 Lt12_c
    s_add_u32 s33, s41, 2
    s_mov_b32 s47, 0
    v_subrev_u32 v252, 0x20000, v5
Lt12_p:
    buffer_load_dword v253, v252, s[4:7], s38 offen sc1
    s_waitcnt vmcnt(0)
    v_cmp_gt_u32 vcc, s33, v253
    s_add_u32 s47, s47, 1
    s_cmp_gt_u32 s47, 20000
    s_cbranch_scc1 Lt12_p_x
    s_nop 1
    s_cbranch_vccnz Lt12_p
Lt12_p_x:
    s_branch Lt12_o
Lt12_c:
Lt12_o:
    s_barrier
    s_mul_i32 s32, s60, 2621440
    s_mul_i32 s33, s42, 20480
    s_add_u32 s32, s32, s33
    s_add_u32 s32, s32, 4194304
    ds_read_b128 v[52:55], v3 offset:0
    ds_read_b128 v[56:59], v3 offset:1024
    ds_read_b128 v[60:63], v3 offset:2048
    ds_read_b128 v[64:67], v3 offset:3072
    ds_read_b128 v[68:71], v3 offset:4096
    buffer_load_dwordx4 a[0:3], v9, s[4:7], s32 offen offset:0 sc1
    buffer_load_dwordx4 a[4:7], v9, s[4:7], s32 offen offset:512 sc1
    buffer_load_dwordx4 a[8:11], v9, s[4:7], s32 offen offset:1024 sc1
    buffer_load_dwordx4 a[12:15], v9, s[4:7], s32 offen offset:1536 sc1
    buffer_load_dwordx4 v1, s[4:7], s31 offen offset:3072 lds
    s_add_u32 m0, s22, 65536
    s_add_u32 s31, s27, 81920
    buffer_load_dwordx4 v1, s[4:7], s31 offen offset:0 lds
    buffer_load_dwordx4 v1, s[4:7], s31 offen offset:1024 lds
    buffer_load_dwordx4 v1, s[4:7], s31 offen offset:2048 lds
    buffer_load_dwordx4 v1, s[4:7], s31 offen offset:3072 lds
    buffer_load_dwordx4 a[16:19], v9, s[4:7], s32 offen offset:2048 sc1
    s_waitcnt vmcnt(8) lgkmcnt(1)
    v_mfma_f32_32x32x16_bf16 v[100:115], v[52:55], a[0:3], 0
    ds_read_b128 v[72:75], v3 offset:5120
    ds_read_b128 v[76:79], v3 offset:6144
    ds_read_b128 v[80:83], v3 offset:7168
    buffer_load_dwordx4 a[20:23], v9, s[4:7], s32 offen offset:2560 sc1
    v_mfma_f32_32x32x16_bf16 v[116:131], v[60:63], a[0:3], 0
    v_and_b32 v223, 0xf0, v1
    v_lshrrev_b32 v223, 1, v223
    v_and_b32 v220, 0x200, v1
    v_add_u32 v223, v223, v220
    v_and_b32 v220, 0x100, v1
    v_lshlrev_b32 v220, 2, v220
    v_mfma_f32_32x32x16_bf16 v[100:115], v[56:59], a[4:7], v[100:115]
    ds_read_b128 v[84:87], v3 offset:8192
    ds_read_b128 v[88:91], v3 offset:9216
    ds_read_b128 v[92:95], v3 offset:10240
    ds_read_b128 v[96:99], v3 offset:11264
    s_add_u32 m0, s22, 81920
    s_add_u32 s31, s27, 98304
    buffer_load_dwordx4 v1, s[4:7], s31 offen offset:0 lds
    v_mfma_f32_32x32x16_bf16 v[116:131], v[64:67], a[4:7], v[116:131]
    v_add_u32 v223, v223, v220
    s_mul_i32 s62, s60, 131072
    s_lshl_b32 s63, s42, 10
    s_add_u32 s62, s62, s63
    s_add_u32 s62, s62, 393216
    s_waitcnt lgkmcnt(4)
    v_mfma_f32_32x32x16_bf16 v[132:147], v[68:71], a[0:3], 0
    buffer_load_dwordx4 v1, s[4:7], s31 offen offset:1024 lds
    buffer_load_dwordx2 v[212:213], v223, s[4:7], s62 offen offset:0 sc1
    buffer_load_dwordx2 v[214:215], v223, s[4:7], s62 offen offset:128 sc1
    buffer_load_dwordx2 v[216:217], v223, s[4:7], s62 offen offset:256 sc1
    buffer_load_dwordx2 v[218:219], v223, s[4:7], s62 offen offset:384 sc1
    v_mfma_f32_32x32x16_bf16 v[148:163], v[76:79], a[0:3], 0
    v_mfma_f32_32x32x16_bf16 v[132:147], v[72:75], a[4:7], v[132:147]
    ds_read_b128 v[36:39], v3 offset:12288
    ds_read_b128 v[40:43], v3 offset:13312
    ds_read_b128 v[44:47], v3 offset:14336
    ds_read_b128 v[48:51], v3 offset:15360
    buffer_load_dwordx4 v1, s[4:7], s31 offen offset:2048 lds
    v_mfma_f32_32x32x16_bf16 v[148:163], v[80:83], a[4:7], v[148:163]
    s_waitcnt lgkmcnt(4)
    v_mfma_f32_32x32x16_bf16 v[164:179], v[84:87], a[0:3], 0
    buffer_load_dwordx4 v1, s[4:7], s31 offen offset:3072 lds
    v_mfma_f32_32x32x16_bf16 v[180:195], v[92:95], a[0:3], 0
    v_mfma_f32_32x32x16_bf16 v[164:179], v[88:91], a[4:7], v[164:179]
    ds_read_b128 v[52:55], v1 offset:0
    ds_read_b128 v[56:59], v1 offset:1024
    ds_read_b128 v[60:63], v1 offset:2048
    ds_read_b128 v[64:67], v1 offset:3072
    s_add_u32 m0, s22, 98304
    s_add_u32 s31, s27, 114688
    buffer_load_dwordx4 v1, s[4:7], s31 offen offset:0 lds
    v_mfma_f32_32x32x16_bf16 v[180:195], v[96:99], a[4:7], v[180:195]
    s_waitcnt vmcnt(16) lgkmcnt(4)
    v_mfma_f32_32x32x16_bf16 v[100:115], v[36:39], a[8:11], v[100:115]
    buffer_load_dwordx4 v1, s[4:7], s31 offen offset:1024 lds
    v_mfma_f32_32x32x16_bf16 v[116:131], v[44:47], a[8:11], v[116:131]
    v_mfma_f32_32x32x16_bf16 v[100:115], v[40:43], a[12:15], v[100:115]
    ds_read_b128 v[68:71], v1 offset:4096
    ds_read_b128 v[72:75], v1 offset:5120
    ds_read_b128 v[76:79], v1 offset:6144
    ds_read_b128 v[80:83], v1 offset:7168
    buffer_load_dwordx4 v1, s[4:7], s31 offen offset:2048 lds
    v_mfma_f32_32x32x16_bf16 v[116:131], v[48:51], a[12:15], v[116:131]
    s_waitcnt lgkmcnt(4)
    v_mfma_f32_32x32x16_bf16 v[132:147], v[52:55], a[8:11], v[132:147]
    buffer_load_dwordx4 v1, s[4:7], s31 offen offset:3072 lds
    v_mfma_f32_32x32x16_bf16 v[148:163], v[60:63], a[8:11], v[148:163]
    v_mfma_f32_32x32x16_bf16 v[132:147], v[56:59], a[12:15], v[132:147]
    ds_read_b128 v[84:87], v1 offset:8192
    ds_read_b128 v[88:91], v1 offset:9216
    ds_read_b128 v[92:95], v1 offset:10240
    ds_read_b128 v[96:99], v1 offset:11264
    buffer_load_dwordx4 a[24:27], v9, s[4:7], s32 offen offset:3072 sc1
    v_mfma_f32_32x32x16_bf16 v[148:163], v[64:67], a[12:15], v[148:163]
    buffer_load_dwordx4 a[28:31], v9, s[4:7], s32 offen offset:3584 sc1
    s_waitcnt lgkmcnt(4)
    v_mfma_f32_32x32x16_bf16 v[164:179], v[68:71], a[8:11], v[164:179]
    v_mfma_f32_32x32x16_bf16 v[180:195], v[76:79], a[8:11], v[180:195]
    s_add_u32 s32, s32, 4096
    buffer_load_dwordx4 a[32:35], v9, s[4:7], s32 offen offset:0 sc1
    v_mfma_f32_32x32x16_bf16 v[164:179], v[72:75], a[12:15], v[164:179]
    ds_read_b128 v[36:39], v1 offset:12288
    ds_read_b128 v[40:43], v1 offset:13312
    ds_read_b128 v[44:47], v1 offset:14336
    ds_read_b128 v[48:51], v1 offset:15360
    v_mfma_f32_32x32x16_bf16 v[180:195], v[80:83], a[12:15], v[180:195]
    buffer_load_dwordx4 a[36:39], v9, s[4:7], s32 offen offset:512 sc1
    s_waitcnt vmcnt(16) lgkmcnt(4)
    v_mfma_f32_32x32x16_bf16 v[100:115], v[84:87], a[16:19], v[100:115]
    v_mfma_f32_32x32x16_bf16 v[116:131], v[92:95], a[16:19], v[116:131]
    buffer_load_dwordx4 a[40:43], v9, s[4:7], s32 offen offset:1024 sc1
    v_mfma_f32_32x32x16_bf16 v[100:115], v[88:91], a[20:23], v[100:115]
    s_barrier
    ds_read_b128 v[52:55], v1 offset:16384
    ds_read_b128 v[56:59], v1 offset:17408
    ds_read_b128 v[60:63], v1 offset:18432
    ds_read_b128 v[64:67], v1 offset:19456
    v_mfma_f32_32x32x16_bf16 v[116:131], v[96:99], a[20:23], v[116:131]
    buffer_load_dwordx4 a[44:47], v9, s[4:7], s32 offen offset:1536 sc1
    s_waitcnt lgkmcnt(4)
    v_mfma_f32_32x32x16_bf16 v[132:147], v[36:39], a[16:19], v[132:147]
    v_mfma_f32_32x32x16_bf16 v[148:163], v[44:47], a[16:19], v[148:163]
    s_add_u32 m0, s22, 114688
    s_add_u32 s31, s27, 131072
    buffer_load_dwordx4 v1, s[4:7], s31 offen offset:0 lds
    s_waitcnt vmcnt(13)
    v_add_f32 v212, v212, v214
    v_add_f32 v213, v213, v215
    v_add_f32 v216, v216, v218
    v_mfma_f32_32x32x16_bf16 v[132:147], v[40:43], a[20:23], v[132:147]
    ds_read_b128 v[68:71], v1 offset:20480
    ds_read_b128 v[72:75], v1 offset:21504
    ds_read_b128 v[76:79], v1 offset:22528
    ds_read_b128 v[80:83], v1 offset:23552
    v_add_f32 v217, v217, v219
    v_add_f32 v212, v212, v216
    v_mfma_f32_32x32x16_bf16 v[148:163], v[48:51], a[20:23], v[148:163]
    buffer_load_dwordx4 v1, s[4:7], s31 offen offset:1024 lds
    v_add_f32 v213, v213, v217
    v_mov_b32 v214, v212
    v_mov_b32 v215, v213
    s_nop 0
    v_permlane32_swap_b32 v212, v214
    s_waitcnt lgkmcnt(4)
    v_mfma_f32_32x32x16_bf16 v[164:179], v[52:55], a[16:19], v[164:179]
    v_permlane32_swap_b32 v213, v215
    v_add_f32 v212, v212, v214
    v_add_f32 v213, v213, v215
    v_mul_f32 v220, 0xbacccccd, v212
    v_mul_f32 v222, 0x3acccccd, v213
    v_fma_f32 v222, -v220, v220, v222
    v_mfma_f32_32x32x16_bf16 v[180:195], v[60:63], a[16:19], v[180:195]
    buffer_load_dwordx4 v1, s[4:7], s31 offen offset:2048 lds
    v_max_f32 v222, 0, v222
    v_add_f32 v222, 0x3727c5ac, v222
    v_rsq_f32 v221, v222
    s_nop 0
    v_mul_f32 v221, 0xbfb8aa3b, v221
    v_mfma_f32_32x32x16_bf16 v[164:179], v[56:59], a[20:23], v[164:179]
    ds_read_b128 v[84:87], v1 offset:24576
    ds_read_b128 v[88:91], v1 offset:25600
    ds_read_b128 v[92:95], v1 offset:26624
    ds_read_b128 v[96:99], v1 offset:27648
    v_mfma_f32_32x32x16_bf16 v[180:195], v[64:67], a[20:23], v[180:195]
    buffer_load_dwordx4 v1, s[4:7], s31 offen offset:3072 lds
    s_waitcnt vmcnt(8) lgkmcnt(4)
    v_mfma_f32_32x32x16_bf16 v[100:115], v[68:71], a[24:27], v[100:115]
    v_mfma_f32_32x32x16_bf16 v[116:131], v[76:79], a[24:27], v[116:131]
    s_add_u32 m0, s22, 131072
    s_add_u32 s31, s27, 147456
    buffer_load_dwordx4 v1, s[4:7], s31 offen offset:0 lds
    v_mfma_f32_32x32x16_bf16 v[100:115], v[72:75], a[28:31], v[100:115]
    ds_read_b128 v[36:39], v1 offset:28672
    ds_read_b128 v[40:43], v1 offset:29696
    ds_read_b128 v[44:47], v1 offset:30720
    ds_read_b128 v[48:51], v1 offset:31744
    buffer_load_dwordx4 v1, s[4:7], s31 offen offset:1024 lds
    v_mfma_f32_32x32x16_bf16 v[116:131], v[80:83], a[28:31], v[116:131]
    s_waitcnt lgkmcnt(4)
    v_mfma_f32_32x32x16_bf16 v[132:147], v[84:87], a[24:27], v[132:147]
    buffer_load_dwordx4 v1, s[4:7], s31 offen offset:2048 lds
    v_mfma_f32_32x32x16_bf16 v[148:163], v[92:95], a[24:27], v[148:163]
    v_mfma_f32_32x32x16_bf16 v[132:147], v[88:91], a[28:31], v[132:147]
    ds_read_b128 v[52:55], v1 offset:32768
    ds_read_b128 v[56:59], v1 offset:33792
    ds_read_b128 v[60:63], v1 offset:34816
    ds_read_b128 v[64:67], v1 offset:35840
    buffer_load_dwordx4 v1, s[4:7], s31 offen offset:3072 lds
    v_mfma_f32_32x32x16_bf16 v[148:163], v[96:99], a[28:31], v[148:163]
    s_waitcnt lgkmcnt(4)
    v_mfma_f32_32x32x16_bf16 v[164:179], v[36:39], a[24:27], v[164:179]
    buffer_load_dwordx4 a[48:51], v9, s[4:7], s32 offen offset:2048 sc1
    v_mfma_f32_32x32x16_bf16 v[180:195], v[44:47], a[24:27], v[180:195]
    v_mfma_f32_32x32x16_bf16 v[164:179], v[40:43], a[28:31], v[164:179]
    ds_read_b128 v[68:71], v1 offset:36864
    ds_read_b128 v[72:75], v1 offset:37888
    ds_read_b128 v[76:79], v1 offset:38912
    ds_read_b128 v[80:83], v1 offset:39936
    buffer_load_dwordx4 a[52:55], v9, s[4:7], s32 offen offset:2560 sc1
    v_mfma_f32_32x32x16_bf16 v[180:195], v[48:51], a[28:31], v[180:195]
    s_waitcnt vmcnt(12) lgkmcnt(4)
    v_mfma_f32_32x32x16_bf16 v[100:115], v[52:55], a[32:35], v[100:115]
    buffer_load_dwordx4 a[56:59], v9, s[4:7], s32 offen offset:3072 sc1
    v_mfma_f32_32x32x16_bf16 v[116:131], v[60:63], a[32:35], v[116:131]
    s_mul_i32 s62, s21, 7077888
    s_mul_i32 s63, s42, 55296
    s_add_u32 s62, s62, s63
    s_add_u32 s62, s62, 20971520
    s_lshl_b32 s63, s18, 10
    s_add_u32 s63, s63, s62
    v_mfma_f32_32x32x16_bf16 v[100:115], v[56:59], a[36:39], v[100:115]
    ds_read_b128 v[84:87], v1 offset:40960
    ds_read_b128 v[88:91], v1 offset:41984
    ds_read_b128 v[92:95], v1 offset:43008
    ds_read_b128 v[96:99], v1 offset:44032
    buffer_load_dwordx4 a[60:63], v9, s[4:7], s32 offen offset:3584 sc1
    v_mfma_f32_32x32x16_bf16 v[116:131], v[64:67], a[36:39], v[116:131]
    s_waitcnt lgkmcnt(4)
    v_mfma_f32_32x32x16_bf16 v[132:147], v[68:71], a[32:35], v[132:147]
    s_add_u32 s32, s32, 4096
    buffer_load_dwordx4 a[64:67], v9, s[4:7], s32 offen offset:0 sc1
    v_mfma_f32_32x32x16_bf16 v[148:163], v[76:79], a[32:35], v[148:163]
    v_mfma_f32_32x32x16_bf16 v[132:147], v[72:75], a[36:39], v[132:147]
    ds_read_b128 v[36:39], v1 offset:45056
    ds_read_b128 v[40:43], v1 offset:46080
    ds_read_b128 v[44:47], v1 offset:47104
    ds_read_b128 v[48:51], v1 offset:48128
    buffer_load_dwordx4 a[68:71], v9, s[4:7], s32 offen offset:512 sc1
    v_mfma_f32_32x32x16_bf16 v[148:163], v[80:83], a[36:39], v[148:163]
    s_waitcnt lgkmcnt(4)
    v_mfma_f32_32x32x16_bf16 v[164:179], v[84:87], a[32:35], v[164:179]
    buffer_load_dwordx4 a[72:75], v9, s[4:7], s32 offen offset:1024 sc1
    v_mfma_f32_32x32x16_bf16 v[180:195], v[92:95], a[32:35], v[180:195]
    buffer_load_dwordx4 a[76:79], v9, s[4:7], s32 offen offset:1536 sc1
    v_mfma_f32_32x32x16_bf16 v[164:179], v[88:91], a[36:39], v[164:179]
    s_barrier
    ds_read_b128 v[52:55], v1 offset:49152
    ds_read_b128 v[56:59], v1 offset:50176
    ds_read_b128 v[60:63], v1 offset:51200
    ds_read_b128 v[64:67], v1 offset:52224
    v_mfma_f32_32x32x16_bf16 v[180:195], v[96:99], a[36:39], v[180:195]
    s_add_u32 m0, s22, 0
    s_add_u32 s31, s27, 163840
    buffer_load_dwordx4 v1, s[4:7], s31 offen offset:0 lds
    s_waitcnt vmcnt(17) lgkmcnt(4)
    v_mfma_f32_32x32x16_bf16 v[100:115], v[36:39], a[40:43], v[100:115]
    v_mfma_f32_32x32x16_bf16 v[116:131], v[44:47], a[40:43], v[116:131]
    buffer_load_dwordx4 v1, s[4:7], s31 offen offset:1024 lds
    v_mfma_f32_32x32x16_bf16 v[100:115], v[40:43], a[44:47], v[100:115]
    ds_read_b128 v[68:71], v1 offset:53248
    ds_read_b128 v[72:75], v1 offset:54272
    ds_read_b128 v[76:79], v1 offset:55296
    ds_read_b128 v[80:83], v1 offset:56320
    v_mfma_f32_32x32x16_bf16 v[116:131], v[48:51], a[44:47], v[116:131]
    buffer_load_dwordx4 v1, s[4:7], s31 offen offset:2048 lds
    s_waitcnt lgkmcnt(4)
    v_mfma_f32_32x32x16_bf16 v[132:147], v[52:55], a[40:43], v[132:147]
    v_mfma_f32_32x32x16_bf16 v[148:163], v[60:63], a[40:43], v[148:163]
    buffer_load_dwordx4 v1, s[4:7], s31 offen offset:3072 lds
    v_mfma_f32_32x32x16_bf16 v[132:147], v[56:59], a[44:47], v[132:147]
    ds_read_b128 v[84:87], v1 offset:57344
    ds_read_b128 v[88:91], v1 offset:58368
    ds_read_b128 v[92:95], v1 offset:59392
    ds_read_b128 v[96:99], v1 offset:60416
    v_mfma_f32_32x32x16_bf16 v[148:163], v[64:67], a[44:47], v[148:163]
    s_add_u32 m0, s22, 16384
    s_add_u32 s31, s27, 180224
    buffer_load_dwordx4 v1, s[4:7], s31 offen offset:0 lds
    s_waitcnt lgkmcnt(4)
    v_mfma_f32_32x32x16_bf16 v[164:179], v[68:71], a[40:43], v[164:179]
    v_mfma_f32_32x32x16_bf16 v[180:195], v[76:79], a[40:43], v[180:195]
    buffer_load_dwordx4 v1, s[4:7], s31 offen offset:1024 lds
    v_mfma_f32_32x32x16_bf16 v[164:179], v[72:75], a[44:47], v[164:179]
    ds_read_b128 v[36:39], v1 offset:61440
    ds_read_b128 v[40:43], v1 offset:62464
    ds_read_b128 v[44:47], v1 offset:63488
    ds_read_b128 v[48:51], v1 offset:64512
    v_mfma_f32_32x32x16_bf16 v[180:195], v[80:83], a[44:47], v[180:195]
    buffer_load_dwordx4 v1, s[4:7], s31 offen offset:2048 lds
    s_waitcnt vmcnt(13) lgkmcnt(4)
    v_mfma_f32_32x32x16_bf16 v[100:115], v[84:87], a[48:51], v[100:115]
    v_mfma_f32_32x32x16_bf16 v[116:131], v[92:95], a[48:51], v[116:131]
    buffer_load_dwordx4 v1, s[4:7], s31 offen offset:3072 lds
    v_mfma_f32_32x32x16_bf16 v[100:115], v[88:91], a[52:55], v[100:115]
    ds_read_b128 v[52:55], v2 offset:0
    ds_read_b128 v[56:59], v2 offset:1024
    ds_read_b128 v[60:63], v2 offset:2048
    ds_read_b128 v[64:67], v2 offset:3072
    v_mfma_f32_32x32x16_bf16 v[116:131], v[96:99], a[52:55], v[116:131]
    buffer_load_dwordx4 a[80:83], v9, s[4:7], s32 offen offset:2048 sc1
    s_waitcnt lgkmcnt(4)
    v_mfma_f32_32x32x16_bf16 v[132:147], v[36:39], a[48:51], v[132:147]
    v_mfma_f32_32x32x16_bf16 v[148:163], v[44:47], a[48:51], v[148:163]
    buffer_load_dwordx4 a[84:87], v9, s[4:7], s32 offen offset:2560 sc1
    v_mfma_f32_32x32x16_bf16 v[132:147], v[40:43], a[52:55], v[132:147]
    ds_read_b128 v[68:71], v2 offset:4096
    ds_read_b128 v[72:75], v2 offset:5120
    ds_read_b128 v[76:79], v2 offset:6144
    ds_read_b128 v[80:83], v2 offset:7168
    buffer_load_dwordx4 a[88:91], v9, s[4:7], s32 offen offset:3072 sc1
    v_mfma_f32_32x32x16_bf16 v[148:163], v[48:51], a[52:55], v[148:163]
    s_waitcnt lgkmcnt(4)
    v_mfma_f32_32x32x16_bf16 v[164:179], v[52:55], a[48:51], v[164:179]
    buffer_load_dwordx4 a[92:95], v9, s[4:7], s32 offen offset:3584 sc1
    v_mfma_f32_32x32x16_bf16 v[180:195], v[60:63], a[48:51], v[180:195]
    v_mfma_f32_32x32x16_bf16 v[164:179], v[56:59], a[52:55], v[164:179]
    ds_read_b128 v[84:87], v2 offset:8192
    ds_read_b128 v[88:91], v2 offset:9216
    ds_read_b128 v[92:95], v2 offset:10240
    ds_read_b128 v[96:99], v2 offset:11264
    s_add_u32 s32, s32, 4096
    buffer_load_dwordx4 a[96:99], v9, s[4:7], s32 offen offset:0 sc1
    v_mfma_f32_32x32x16_bf16 v[180:195], v[64:67], a[52:55], v[180:195]
    s_waitcnt vmcnt(17) lgkmcnt(4)
    v_mfma_f32_32x32x16_bf16 v[100:115], v[68:71], a[56:59], v[100:115]
    buffer_load_dwordx4 a[100:103], v9, s[4:7], s32 offen offset:512 sc1
    v_mfma_f32_32x32x16_bf16 v[116:131], v[76:79], a[56:59], v[116:131]
    v_mfma_f32_32x32x16_bf16 v[100:115], v[72:75], a[60:63], v[100:115]
    ds_read_b128 v[36:39], v2 offset:12288
    ds_read_b128 v[40:43], v2 offset:13312
    ds_read_b128 v[44:47], v2 offset:14336
    ds_read_b128 v[48:51], v2 offset:15360
    buffer_load_dwordx4 a[104:107], v9, s[4:7], s32 offen offset:1024 sc1
    v_mfma_f32_32x32x16_bf16 v[116:131], v[80:83], a[60:63], v[116:131]
    s_waitcnt lgkmcnt(4)
    v_mfma_f32_32x32x16_bf16 v[132:147], v[84:87], a[56:59], v[132:147]
    buffer_load_dwordx4 a[108:111], v9, s[4:7], s32 offen offset:1536 sc1
    v_mfma_f32_32x32x16_bf16 v[148:163], v[92:95], a[56:59], v[148:163]
    v_mfma_f32_32x32x16_bf16 v[132:147], v[88:91], a[60:63], v[132:147]
    s_barrier
    ds_read_b128 v[52:55], v2 offset:16384
    ds_read_b128 v[56:59], v2 offset:17408
    ds_read_b128 v[60:63], v2 offset:18432
    ds_read_b128 v[64:67], v2 offset:19456
    v_mfma_f32_32x32x16_bf16 v[148:163], v[96:99], a[60:63], v[148:163]
    s_add_u32 m0, s22, 32768
    s_add_u32 s31, s27, 196608
    buffer_load_dwordx4 v1, s[4:7], s31 offen offset:0 lds
    s_waitcnt lgkmcnt(4)
    v_mfma_f32_32x32x16_bf16 v[164:179], v[36:39], a[56:59], v[164:179]
    buffer_load_dwordx4 v1, s[4:7], s31 offen offset:1024 lds
    v_mfma_f32_32x32x16_bf16 v[180:195], v[44:47], a[56:59], v[180:195]
    v_mfma_f32_32x32x16_bf16 v[164:179], v[40:43], a[60:63], v[164:179]
    ds_read_b128 v[68:71], v2 offset:20480
    ds_read_b128 v[72:75], v2 offset:21504
    ds_read_b128 v[76:79], v2 offset:22528
    ds_read_b128 v[80:83], v2 offset:23552
    buffer_load_dwordx4 v1, s[4:7], s31 offen offset:2048 lds
    v_mfma_f32_32x32x16_bf16 v[180:195], v[48:51], a[60:63], v[180:195]
    s_waitcnt vmcnt(21) lgkmcnt(4)
    v_mfma_f32_32x32x16_bf16 v[100:115], v[52:55], a[64:67], v[100:115]
    buffer_load_dwordx4 v1, s[4:7], s31 offen offset:3072 lds
    v_mfma_f32_32x32x16_bf16 v[116:131], v[60:63], a[64:67], v[116:131]
    s_add_u32 m0, s22, 49152
    s_add_u32 s31, s27, 212992
    buffer_load_dwordx4 v1, s[4:7], s31 offen offset:0 lds
    v_mfma_f32_32x32x16_bf16 v[100:115], v[56:59], a[68:71], v[100:115]
    ds_read_b128 v[84:87], v2 offset:24576
    ds_read_b128 v[88:91], v2 offset:25600
    ds_read_b128 v[92:95], v2 offset:26624
    ds_read_b128 v[96:99], v2 offset:27648
    v_mfma_f32_32x32x16_bf16 v[116:131], v[64:67], a[68:71], v[116:131]
    buffer_load_dwordx4 v1, s[4:7], s31 offen offset:1024 lds
    s_waitcnt lgkmcnt(4)
    v_mfma_f32_32x32x16_bf16 v[132:147], v[68:71], a[64:67], v[132:147]
    v_mfma_f32_32x32x16_bf16 v[148:163], v[76:79], a[64:67], v[148:163]
    buffer_load_dwordx4 v1, s[4:7], s31 offen offset:2048 lds
    v_mfma_f32_32x32x16_bf16 v[132:147], v[72:75], a[68:71], v[132:147]
    ds_read_b128 v[36:39], v2 offset:28672
    ds_read_b128 v[40:43], v2 offset:29696
    ds_read_b128 v[44:47], v2 offset:30720
    ds_read_b128 v[48:51], v2 offset:31744
    v_mfma_f32_32x32x16_bf16 v[148:163], v[80:83], a[68:71], v[148:163]
    buffer_load_dwordx4 v1, s[4:7], s31 offen offset:3072 lds
    s_waitcnt lgkmcnt(4)
    v_mfma_f32_32x32x16_bf16 v[164:179], v[84:87], a[64:67], v[164:179]
    v_mfma_f32_32x32x16_bf16 v[180:195], v[92:95], a[64:67], v[180:195]
    buffer_load_dwordx4 a[112:115], v9, s[4:7], s32 offen offset:2048 sc1
    v_mfma_f32_32x32x16_bf16 v[164:179], v[88:91], a[68:71], v[164:179]
    ds_read_b128 v[52:55], v2 offset:32768
    ds_read_b128 v[56:59], v2 offset:33792
    ds_read_b128 v[60:63], v2 offset:34816
    ds_read_b128 v[64:67], v2 offset:35840
    v_mfma_f32_32x32x16_bf16 v[180:195], v[96:99], a[68:71], v[180:195]
    buffer_load_dwordx4 a[116:119], v9, s[4:7], s32 offen offset:2560 sc1
    s_waitcnt vmcnt(26) lgkmcnt(4)
    v_mfma_f32_32x32x16_bf16 v[100:115], v[36:39], a[72:75], v[100:115]
    v_mfma_f32_32x32x16_bf16 v[116:131], v[44:47], a[72:75], v[116:131]
    buffer_load_dwordx4 a[120:123], v9, s[4:7], s32 offen offset:3072 sc1
    v_mfma_f32_32x32x16_bf16 v[100:115], v[40:43], a[76:79], v[100:115]
    ds_read_b128 v[68:71], v2 offset:36864
    ds_read_b128 v[72:75], v2 offset:37888
    ds_read_b128 v[76:79], v2 offset:38912
    ds_read_b128 v[80:83], v2 offset:39936
    v_mfma_f32_32x32x16_bf16 v[116:131], v[48:51], a[76:79], v[116:131]
    buffer_load_dwordx4 a[124:127], v9, s[4:7], s32 offen offset:3584 sc1
    s_waitcnt lgkmcnt(4)
    v_mfma_f32_32x32x16_bf16 v[132:147], v[52:55], a[72:75], v[132:147]
    v_mfma_f32_32x32x16_bf16 v[148:163], v[60:63], a[72:75], v[148:163]
    s_add_u32 s32, s32, 4096
    buffer_load_dwordx4 a[128:131], v9, s[4:7], s32 offen offset:0 sc1
    v_mfma_f32_32x32x16_bf16 v[132:147], v[56:59], a[76:79], v[132:147]
    ds_read_b128 v[84:87], v2 offset:40960
    ds_read_b128 v[88:91], v2 offset:41984
    ds_read_b128 v[92:95], v2 offset:43008
    ds_read_b128 v[96:99], v2 offset:44032
    v_mfma_f32_32x32x16_bf16 v[148:163], v[64:67], a[76:79], v[148:163]
    buffer_load_dwordx4 a[132:135], v9, s[4:7], s32 offen offset:512 sc1
    s_waitcnt lgkmcnt(4)
    v_mfma_f32_32x32x16_bf16 v[164:179], v[68:71], a[72:75], v[164:179]
    buffer_load_dwordx4 a[136:139], v9, s[4:7], s32 offen offset:1024 sc1
    v_mfma_f32_32x32x16_bf16 v[180:195], v[76:79], a[72:75], v[180:195]
    v_mfma_f32_32x32x16_bf16 v[164:179], v[72:75], a[76:79], v[164:179]
    ds_read_b128 v[36:39], v2 offset:45056
    ds_read_b128 v[40:43], v2 offset:46080
    ds_read_b128 v[44:47], v2 offset:47104
    ds_read_b128 v[48:51], v2 offset:48128
    buffer_load_dwordx4 a[140:143], v9, s[4:7], s32 offen offset:1536 sc1
    v_mfma_f32_32x32x16_bf16 v[180:195], v[80:83], a[76:79], v[180:195]
    s_waitcnt vmcnt(22) lgkmcnt(4)
    v_mfma_f32_32x32x16_bf16 v[100:115], v[84:87], a[80:83], v[100:115]
    buffer_load_dwordx4 a[144:147], v9, s[4:7], s32 offen offset:2048 sc1
    v_mfma_f32_32x32x16_bf16 v[116:131], v[92:95], a[80:83], v[116:131]
    v_mfma_f32_32x32x16_bf16 v[100:115], v[88:91], a[84:87], v[100:115]
    s_barrier
    ds_read_b128 v[52:55], v2 offset:49152
    ds_read_b128 v[56:59], v2 offset:50176
    ds_read_b128 v[60:63], v2 offset:51200
    ds_read_b128 v[64:67], v2 offset:52224
    v_mfma_f32_32x32x16_bf16 v[116:131], v[96:99], a[84:87], v[116:131]
    buffer_load_dwordx4 a[148:151], v9, s[4:7], s32 offen offset:2560 sc1
    s_waitcnt vmcnt(22) lgkmcnt(4)
    v_mfma_f32_32x32x16_bf16 v[100:115], v[36:39], a[88:91], v[100:115]
    buffer_load_dwordx4 a[152:155], v9, s[4:7], s32 offen offset:3072 sc1
    v_mfma_f32_32x32x16_bf16 v[116:131], v[44:47], a[88:91], v[116:131]
    v_mfma_f32_32x32x16_bf16 v[100:115], v[40:43], a[92:95], v[100:115]
    ds_read_b128 v[68:71], v2 offset:53248
    ds_read_b128 v[72:75], v2 offset:54272
    ds_read_b128 v[76:79], v2 offset:55296
    ds_read_b128 v[80:83], v2 offset:56320
    buffer_load_dwordx4 a[156:159], v9, s[4:7], s32 offen offset:3584 sc1
    v_mfma_f32_32x32x16_bf16 v[116:131], v[48:51], a[92:95], v[116:131]
    s_waitcnt vmcnt(22) lgkmcnt(4)
    v_mfma_f32_32x32x16_bf16 v[100:115], v[52:55], a[96:99], v[100:115]
    s_add_u32 m0, s22, 65536
    s_add_u32 s31, s27, 229376
    buffer_load_dwordx4 v1, s[4:7], s31 offen offset:0 lds
    v_mfma_f32_32x32x16_bf16 v[116:131], v[60:63], a[96:99], v[116:131]
    v_mfma_f32_32x32x16_bf16 v[100:115], v[56:59], a[100:103], v[100:115]
    ds_read_b128 v[84:87], v2 offset:57344
    ds_read_b128 v[88:91], v2 offset:58368
    ds_read_b128 v[92:95], v2 offset:59392
    ds_read_b128 v[96:99], v2 offset:60416
    buffer_load_dwordx4 v1, s[4:7], s31 offen offset:1024 lds
    v_mfma_f32_32x32x16_bf16 v[116:131], v[64:67], a[100:103], v[116:131]
    s_waitcnt vmcnt(22) lgkmcnt(4)
    v_mfma_f32_32x32x16_bf16 v[100:115], v[68:71], a[104:107], v[100:115]
    buffer_load_dwordx4 v1, s[4:7], s31 offen offset:2048 lds
    v_mfma_f32_32x32x16_bf16 v[116:131], v[76:79], a[104:107], v[116:131]
    v_mfma_f32_32x32x16_bf16 v[100:115], v[72:75], a[108:111], v[100:115]
    ds_read_b128 v[36:39], v2 offset:61440
    ds_read_b128 v[40:43], v2 offset:62464
    ds_read_b128 v[44:47], v2 offset:63488
    ds_read_b128 v[48:51], v2 offset:64512
    buffer_load_dwordx4 v1, s[4:7], s31 offen offset:3072 lds
    v_mfma_f32_32x32x16_bf16 v[116:131], v[80:83], a[108:111], v[116:131]
    s_add_u32 m0, s22, 81920
    s_add_u32 s31, s27, 245760
    buffer_load_dwordx4 v1, s[4:7], s31 offen offset:0 lds
    s_waitcnt vmcnt(15) lgkmcnt(4)
    v_mfma_f32_32x32x16_bf16 v[100:115], v[84:87], a[112:115], v[100:115]
    v_mfma_f32_32x32x16_bf16 v[116:131], v[92:95], a[112:115], v[116:131]
    buffer_load_dwordx4 v1, s[4:7], s31 offen offset:1024 lds
    v_mfma_f32_32x32x16_bf16 v[100:115], v[88:91], a[116:119], v[100:115]
    ds_read_b128 v[52:55], v3 offset:0
    ds_read_b128 v[56:59], v3 offset:1024
    ds_read_b128 v[60:63], v3 offset:2048
    ds_read_b128 v[64:67], v3 offset:3072
    v_mfma_f32_32x32x16_bf16 v[116:131], v[96:99], a[116:119], v[116:131]
    buffer_load_dwordx4 v1, s[4:7], s31 offen offset:2048 lds
    s_waitcnt vmcnt(15) lgkmcnt(4)
    v_mfma_f32_32x32x16_bf16 v[100:115], v[36:39], a[120:123], v[100:115]
    v_mfma_f32_32x32x16_bf16 v[116:131], v[44:47], a[120:123], v[116:131]
    buffer_load_dwordx4 v1, s[4:7], s31 offen offset:3072 lds
    v_mfma_f32_32x32x16_bf16 v[100:115], v[40:43], a[124:127], v[100:115]
    ds_read_b128 v[68:71], v3 offset:4096
    ds_read_b128 v[72:75], v3 offset:5120
    ds_read_b128 v[76:79], v3 offset:6144
    ds_read_b128 v[80:83], v3 offset:7168
    v_mfma_f32_32x32x16_bf16 v[116:131], v[48:51], a[124:127], v[116:131]
    s_waitcnt vmcnt(14) lgkmcnt(4)
    v_mfma_f32_32x32x16_bf16 v[100:115], v[52:55], a[128:131], v[100:115]
    v_mfma_f32_32x32x16_bf16 v[116:131], v[60:63], a[128:131], v[116:131]
    v_mfma_f32_32x32x16_bf16 v[100:115], v[56:59], a[132:135], v[100:115]
    ds_read_b128 v[84:87], v3 offset:8192
    ds_read_b128 v[88:91], v3 offset:9216
    ds_read_b128 v[92:95], v3 offset:10240
    ds_read_b128 v[96:99], v3 offset:11264
    v_mfma_f32_32x32x16_bf16 v[116:131], v[64:67], a[132:135], v[116:131]
    s_waitcnt vmcnt(12) lgkmcnt(4)
    v_mfma_f32_32x32x16_bf16 v[100:115], v[68:71], a[136:139], v[100:115]
    v_mfma_f32_32x32x16_bf16 v[116:131], v[76:79], a[136:139], v[116:131]
    v_mfma_f32_32x32x16_bf16 v[100:115], v[72:75], a[140:143], v[100:115]
    ds_read_b128 v[36:39], v3 offset:12288
    ds_read_b128 v[40:43], v3 offset:13312
    ds_read_b128 v[44:47], v3 offset:14336
    ds_read_b128 v[48:51], v3 offset:15360
    v_mfma_f32_32x32x16_bf16 v[116:131], v[80:83], a[140:143], v[116:131]
    s_waitcnt vmcnt(10) lgkmcnt(4)
    v_mfma_f32_32x32x16_bf16 v[100:115], v[84:87], a[144:147], v[100:115]
    v_mfma_f32_32x32x16_bf16 v[116:131], v[92:95], a[144:147], v[116:131]
    v_mfma_f32_32x32x16_bf16 v[100:115], v[88:91], a[148:151], v[100:115]
    s_barrier
    ds_read_b128 v[52:55], v1 offset:0
    ds_read_b128 v[56:59], v1 offset:1024
    ds_read_b128 v[60:63], v1 offset:2048
    ds_read_b128 v[64:67], v1 offset:3072
    v_mfma_f32_32x32x16_bf16 v[116:131], v[96:99], a[148:151], v[116:131]
    s_add_u32 m0, s22, 98304
    s_add_u32 s31, s27, 262144
    buffer_load_dwordx4 v1, s[4:7], s31 offen offset:0 lds
    s_waitcnt vmcnt(9) lgkmcnt(4)
    v_mfma_f32_32x32x16_bf16 v[100:115], v[36:39], a[152:155], v[100:115]
    buffer_load_dwordx4 v1, s[4:7], s31 offen offset:1024 lds
    v_mfma_f32_32x32x16_bf16 v[116:131], v[44:47], a[152:155], v[116:131]
    buffer_load_dwordx4 v1, s[4:7], s31 offen offset:2048 lds
    v_mfma_f32_32x32x16_bf16 v[100:115], v[40:43], a[156:159], v[100:115]
    ds_read_b128 v[68:71], v1 offset:4096
    ds_read_b128 v[72:75], v1 offset:5120
    ds_read_b128 v[76:79], v1 offset:6144
    ds_read_b128 v[80:83], v1 offset:7168
    buffer_load_dwordx4 v1, s[4:7], s31 offen offset:3072 lds
    v_mfma_f32_32x32x16_bf16 v[116:131], v[48:51], a[156:159], v[116:131]
    s_add_u32 m0, s24, 114688
    s_add_u32 s31, s30, 278528
    buffer_load_dwordx4 v1, s[4:7], s31 offen offset:0 lds
    s_waitcnt lgkmcnt(4)
    v_mfma_f32_32x32x16_bf16 v[132:147], v[52:55], a[80:83], v[132:147]
    buffer_load_dwordx4 v1, s[4:7], s31 offen offset:1024 lds
    v_mfma_f32_32x32x16_bf16 v[148:163], v[60:63], a[80:83], v[148:163]
    v_mfma_f32_32x32x16_bf16 v[132:147], v[56:59], a[84:87], v[132:147]
    ds_read_b128 v[84:87], v1 offset:8192
    ds_read_b128 v[88:91], v1 offset:9216
    ds_read_b128 v[92:95], v1 offset:10240
    ds_read_b128 v[96:99], v1 offset:11264
    ds_read_b128 v[226:229], v250 offset:16896
    ds_read_b128 v[230:233], v250 offset:16928
    v_mfma_f32_32x32x16_bf16 v[148:163], v[64:67], a[84:87], v[148:163]
    ds_read_b128 v[234:237], v250 offset:16960
    ds_read_b128 v[238:241], v250 offset:16992
    s_waitcnt lgkmcnt(0)
    v_fmac_f32 v100, v220, v226
    v_fmac_f32 v108, v220, v234
    v_fmac_f32 v101, v220, v227
    v_mfma_f32_32x32x16_bf16 v[132:147], v[68:71], a[88:91], v[132:147]
    v_fmac_f32 v109, v220, v235
    v_fmac_f32 v102, v220, v228
    v_fmac_f32 v110, v220, v236
    v_fmac_f32 v103, v220, v229
    v_fmac_f32 v111, v220, v237
    v_fmac_f32 v104, v220, v230
    v_mfma_f32_32x32x16_bf16 v[148:163], v[76:79], a[88:91], v[148:163]
    v_fmac_f32 v112, v220, v238
    v_fmac_f32 v105, v220, v231
    v_fmac_f32 v113, v220, v239
    v_fmac_f32 v106, v220, v232
    v_fmac_f32 v114, v220, v240
    v_fmac_f32 v107, v220, v233
    v_mfma_f32_32x32x16_bf16 v[132:147], v[72:75], a[92:95], v[132:147]
    ds_read_b128 v[36:39], v1 offset:12288
    ds_read_b128 v[40:43], v1 offset:13312
    ds_read_b128 v[44:47], v1 offset:14336
    ds_read_b128 v[48:51], v1 offset:15360
    v_fmac_f32 v115, v220, v241
    v_mul_f32 v242, v100, v221
    v_mfma_f32_32x32x16_bf16 v[148:163], v[80:83], a[92:95], v[148:163]
    v_mul_f32 v243, v101, v221
    v_mul_f32 v244, v102, v221
    v_mul_f32 v245, v103, v221
    v_exp_f32 v242, v242
    v_mfma_f32_32x32x16_bf16 v[132:147], v[84:87], a[96:99], v[132:147]
    v_exp_f32 v243, v243
    v_exp_f32 v244, v244
    v_exp_f32 v245, v245
    v_mfma_f32_32x32x16_bf16 v[148:163], v[92:95], a[96:99], v[148:163]
    v_mul_f32 v100, v100, v108
    v_mul_f32 v101, v101, v109
    v_mul_f32 v102, v102, v110
    v_mul_f32 v103, v103, v111
    v_fma_f32 v242, v242, v222, v222
    v_fma_f32 v243, v243, v222, v222
    v_mfma_f32_32x32x16_bf16 v[132:147], v[88:91], a[100:103], v[132:147]
    ds_read_b128 v[52:55], v1 offset:16384
    ds_read_b128 v[56:59], v1 offset:17408
    ds_read_b128 v[60:63], v1 offset:18432
    ds_read_b128 v[64:67], v1 offset:19456
    v_fma_f32 v244, v244, v222, v222
    v_fma_f32 v245, v245, v222, v222
    v_mfma_f32_32x32x16_bf16 v[148:163], v[96:99], a[100:103], v[148:163]
    v_rcp_f32 v242, v242
    v_rcp_f32 v243, v243
    s_waitcnt lgkmcnt(4)
    v_mfma_f32_32x32x16_bf16 v[132:147], v[36:39], a[104:107], v[132:147]
    v_rcp_f32 v244, v244
    v_rcp_f32 v245, v245
    v_mul_f32 v100, v100, v242
    v_mul_f32 v101, v101, v243
    v_mfma_f32_32x32x16_bf16 v[148:163], v[44:47], a[104:107], v[148:163]
    v_mul_f32 v102, v102, v244
    v_mul_f32 v103, v103, v245
    v_mul_f32 v246, v104, v221
    v_mul_f32 v247, v105, v221
    v_mul_f32 v248, v106, v221
    v_mul_f32 v249, v107, v221
    v_mfma_f32_32x32x16_bf16 v[132:147], v[40:43], a[108:111], v[132:147]
    ds_read_b128 v[68:71], v1 offset:20480
    ds_read_b128 v[72:75], v1 offset:21504
    ds_read_b128 v[76:79], v1 offset:22528
    ds_read_b128 v[80:83], v1 offset:23552
    v_exp_f32 v246, v246
    v_mfma_f32_32x32x16_bf16 v[148:163], v[48:51], a[108:111], v[148:163]
    v_exp_f32 v247, v247
    v_exp_f32 v248, v248
    s_waitcnt lgkmcnt(4)
    v_mfma_f32_32x32x16_bf16 v[132:147], v[52:55], a[112:115], v[132:147]
    v_exp_f32 v249, v249
    v_mul_f32 v104, v104, v112
    v_mul_f32 v105, v105, v113
    v_mul_f32 v106, v106, v114
    v_mul_f32 v107, v107, v115
    v_mfma_f32_32x32x16_bf16 v[148:163], v[60:63], a[112:115], v[148:163]
    v_fma_f32 v246, v246, v222, v222
    v_fma_f32 v247, v247, v222, v222
    v_fma_f32 v248, v248, v222, v222
    v_fma_f32 v249, v249, v222, v222
    v_rcp_f32 v246, v246
    v_mfma_f32_32x32x16_bf16 v[132:147], v[56:59], a[116:119], v[132:147]
    ds_read_b128 v[84:87], v1 offset:24576
    ds_read_b128 v[88:91], v1 offset:25600
    ds_read_b128 v[92:95], v1 offset:26624
    ds_read_b128 v[96:99], v1 offset:27648
    v_rcp_f32 v247, v247
    v_mfma_f32_32x32x16_bf16 v[148:163], v[64:67], a[116:119], v[148:163]
    v_rcp_f32 v248, v248
    v_rcp_f32 v249, v249
    v_mul_f32 v104, v104, v246
    s_waitcnt lgkmcnt(4)
    v_mfma_f32_32x32x16_bf16 v[132:147], v[68:71], a[120:123], v[132:147]
    v_mul_f32 v105, v105, v247
    v_mul_f32 v106, v106, v248
    v_mul_f32 v107, v107, v249
    v_cvt_pk_bf16_f32 v108, v100, v101
    v_cvt_pk_bf16_f32 v109, v102, v103
    v_cvt_pk_bf16_f32 v110, v104, v105
    v_mfma_f32_32x32x16_bf16 v[148:163], v[76:79], a[120:123], v[148:163]
    v_cvt_pk_bf16_f32 v111, v106, v107
    s_add_u32 s33, s63, 0
    buffer_store_dwordx4 v[108:111], v10, s[4:7], s33 offen sc1
    ds_read_b128 v[226:229], v250 offset:17024
    ds_read_b128 v[230:233], v250 offset:17056
    ds_read_b128 v[234:237], v250 offset:17088
    v_mfma_f32_32x32x16_bf16 v[132:147], v[72:75], a[124:127], v[132:147]
    ds_read_b128 v[36:39], v1 offset:28672
    ds_read_b128 v[40:43], v1 offset:29696
    ds_read_b128 v[44:47], v1 offset:30720
    ds_read_b128 v[48:51], v1 offset:31744
    ds_read_b128 v[238:241], v250 offset:17120
    s_waitcnt lgkmcnt(0)
    v_fmac_f32 v116, v220, v226
    v_mfma_f32_32x32x16_bf16 v[148:163], v[80:83], a[124:127], v[148:163]
    v_fmac_f32 v124, v220, v234
    v_fmac_f32 v117, v220, v227
    v_fmac_f32 v125, v220, v235
    v_fmac_f32 v118, v220, v228
    v_fmac_f32 v126, v220, v236
    v_mfma_f32_32x32x16_bf16 v[132:147], v[84:87], a[128:131], v[132:147]
    v_fmac_f32 v119, v220, v229
    v_fmac_f32 v127, v220, v237
    v_fmac_f32 v120, v220, v230
    v_fmac_f32 v128, v220, v238
    v_fmac_f32 v121, v220, v231
    v_fmac_f32 v129, v220, v239
    v_mfma_f32_32x32x16_bf16 v[148:163], v[92:95], a[128:131], v[148:163]
    v_fmac_f32 v122, v220, v232
    v_fmac_f32 v130, v220, v240
    v_fmac_f32 v123, v220, v233
    v_fmac_f32 v131, v220, v241
    v_mul_f32 v242, v116, v221
    v_mul_f32 v243, v117, v221
    v_mfma_f32_32x32x16_bf16 v[132:147], v[88:91], a[132:135], v[132:147]
    s_barrier
    ds_read_b128 v[52:55], v1 offset:32768
    ds_read_b128 v[56:59], v1 offset:33792
    ds_read_b128 v[60:63], v1 offset:34816
    ds_read_b128 v[64:67], v1 offset:35840
    v_mfma_f32_32x32x16_bf16 v[148:163], v[96:99], a[132:135], v[148:163]
    s_add_u32 m0, s22, 131072
    s_add_u32 s31, s28, 0
    buffer_load_dwordx4 v1, s[4:7], s31 offen offset:0 lds
    v_mul_f32 v244, v118, v221
    v_mul_f32 v245, v119, v221
    v_mfma_f32_32x32x16_bf16 v[132:147], v[36:39], a[136:139], v[132:147]
    buffer_load_dwordx4 v1, s[4:7], s31 offen offset:1024 lds
    v_exp_f32 v242, v242
    v_exp_f32 v243, v243
    v_mfma_f32_32x32x16_bf16 v[148:163], v[44:47], a[136:139], v[148:163]
    buffer_load_dwordx4 v1, s[4:7], s31 offen offset:2048 lds
    v_exp_f32 v244, v244
    v_exp_f32 v245, v245
    v_mul_f32 v116, v116, v124
    v_mfma_f32_32x32x16_bf16 v[132:147], v[40:43], a[140:143], v[132:147]
    ds_read_b128 v[68:71], v1 offset:36864
    ds_read_b128 v[72:75], v1 offset:37888
    ds_read_b128 v[76:79], v1 offset:38912
    ds_read_b128 v[80:83], v1 offset:39936
    buffer_load_dwordx4 v1, s[4:7], s31 offen offset:3072 lds
    v_mul_f32 v117, v117, v125
    v_mfma_f32_32x32x16_bf16 v[148:163], v[48:51], a[140:143], v[148:163]
    s_add_u32 m0, s22, 0
    s_add_u32 s31, s28, 16384
    buffer_load_dwordx4 v1, s[4:7], s31 offen offset:0 lds
    v_mul_f32 v118, v118, v126
    v_mul_f32 v119, v119, v127
    s_waitcnt lgkmcnt(4)
    v_mfma_f32_32x32x16_bf16 v[132:147], v[52:55], a[144:147], v[132:147]
    buffer_load_dwordx4 v1, s[4:7], s31 offen offset:1024 lds
    v_fma_f32 v242, v242, v222, v222
    v_fma_f32 v243, v243, v222, v222
    v_fma_f32 v244, v244, v222, v222
    v_fma_f32 v245, v245, v222, v222
    v_mfma_f32_32x32x16_bf16 v[148:163], v[60:63], a[144:147], v[148:163]
    buffer_load_dwordx4 v1, s[4:7], s31 offen offset:2048 lds
    v_rcp_f32 v242, v242
    v_rcp_f32 v243, v243
    v_mfma_f32_32x32x16_bf16 v[132:147], v[56:59], a[148:151], v[132:147]
    ds_read_b128 v[84:87], v1 offset:40960
    ds_read_b128 v[88:91], v1 offset:41984
    ds_read_b128 v[92:95], v1 offset:43008
    ds_read_b128 v[96:99], v1 offset:44032
    buffer_load_dwordx4 v1, s[4:7], s31 offen offset:3072 lds
    v_mfma_f32_32x32x16_bf16 v[148:163], v[64:67], a[148:151], v[148:163]
    v_rcp_f32 v244, v244
    v_rcp_f32 v245, v245
    v_mul_f32 v116, v116, v242
    s_waitcnt lgkmcnt(4)
    v_mfma_f32_32x32x16_bf16 v[132:147], v[68:71], a[152:155], v[132:147]
    v_mul_f32 v117, v117, v243
    v_mul_f32 v118, v118, v244
    v_mul_f32 v119, v119, v245
    v_mul_f32 v246, v120, v221
    v_mul_f32 v247, v121, v221
    v_mul_f32 v248, v122, v221
    v_mfma_f32_32x32x16_bf16 v[148:163], v[76:79], a[152:155], v[148:163]
    v_mul_f32 v249, v123, v221
    v_exp_f32 v246, v246
    v_exp_f32 v247, v247
    v_mfma_f32_32x32x16_bf16 v[132:147], v[72:75], a[156:159], v[132:147]
    ds_read_b128 v[36:39], v1 offset:45056
    ds_read_b128 v[40:43], v1 offset:46080
    ds_read_b128 v[44:47], v1 offset:47104
    ds_read_b128 v[48:51], v1 offset:48128
    v_exp_f32 v248, v248
    v_mfma_f32_32x32x16_bf16 v[148:163], v[80:83], a[156:159], v[148:163]
    v_exp_f32 v249, v249
    v_mul_f32 v120, v120, v128
    v_mul_f32 v121, v121, v129
    v_mul_f32 v122, v122, v130
    s_waitcnt lgkmcnt(4)
    v_mfma_f32_32x32x16_bf16 v[164:179], v[84:87], a[80:83], v[164:179]
    v_mul_f32 v123, v123, v131
    v_fma_f32 v246, v246, v222, v222
    v_fma_f32 v247, v247, v222, v222
    v_fma_f32 v248, v248, v222, v222
    v_fma_f32 v249, v249, v222, v222
    v_mfma_f32_32x32x16_bf16 v[180:195], v[92:95], a[80:83], v[180:195]
    v_rcp_f32 v246, v246
    v_rcp_f32 v247, v247
    v_rcp_f32 v248, v248
    v_mfma_f32_32x32x16_bf16 v[164:179], v[88:91], a[84:87], v[164:179]
    ds_read_b128 v[52:55], v1 offset:49152
    ds_read_b128 v[56:59], v1 offset:50176
    ds_read_b128 v[60:63], v1 offset:51200
    ds_read_b128 v[64:67], v1 offset:52224
    v_rcp_f32 v249, v249
    v_mfma_f32_32x32x16_bf16 v[180:195], v[96:99], a[84:87], v[180:195]
    v_mul_f32 v120, v120, v246
    v_mul_f32 v121, v121, v247
    v_mul_f32 v122, v122, v248
    v_mul_f32 v123, v123, v249
    v_cvt_pk_bf16_f32 v124, v116, v117
    s_waitcnt lgkmcnt(4)
    v_mfma_f32_32x32x16_bf16 v[164:179], v[36:39], a[88:91], v[164:179]
    v_cvt_pk_bf16_f32 v125, v118, v119
    v_cvt_pk_bf16_f32 v126, v120, v121
    v_cvt_pk_bf16_f32 v127, v122, v123
    s_add_u32 s33, s63, 512
    buffer_store_dwordx4 v[124:127], v10, s[4:7], s33 offen sc1
    ds_read_b128 v[226:229], v250 offset:17152
    v_mfma_f32_32x32x16_bf16 v[180:195], v[44:47], a[88:91], v[180:195]
    ds_read_b128 v[230:233], v250 offset:17184
    ds_read_b128 v[234:237], v250 offset:17216
    ds_read_b128 v[238:241], v250 offset:17248
    s_waitcnt lgkmcnt(0)
    v_fmac_f32 v132, v220, v226
    v_fmac_f32 v140, v220, v234
    v_fmac_f32 v133, v220, v227
    v_mfma_f32_32x32x16_bf16 v[164:179], v[40:43], a[92:95], v[164:179]
    ds_read_b128 v[68:71], v1 offset:53248
    ds_read_b128 v[72:75], v1 offset:54272
    ds_read_b128 v[76:79], v1 offset:55296
    ds_read_b128 v[80:83], v1 offset:56320
    v_fmac_f32 v141, v220, v235
    v_fmac_f32 v134, v220, v228
    v_mfma_f32_32x32x16_bf16 v[180:195], v[48:51], a[92:95], v[180:195]
    v_fmac_f32 v142, v220, v236
    v_fmac_f32 v135, v220, v229
    v_fmac_f32 v143, v220, v237
    v_fmac_f32 v136, v220, v230
    v_fmac_f32 v144, v220, v238
    v_mfma_f32_32x32x16_bf16 v[164:179], v[52:55], a[96:99], v[164:179]
    v_fmac_f32 v137, v220, v231
    v_fmac_f32 v145, v220, v239
    v_fmac_f32 v138, v220, v232
    v_fmac_f32 v146, v220, v240
    v_fmac_f32 v139, v220, v233
    v_fmac_f32 v147, v220, v241
    v_mfma_f32_32x32x16_bf16 v[180:195], v[60:63], a[96:99], v[180:195]
    v_mul_f32 v242, v132, v221
    v_mul_f32 v243, v133, v221
    v_mul_f32 v244, v134, v221
    v_mul_f32 v245, v135, v221
    v_exp_f32 v242, v242
    v_mfma_f32_32x32x16_bf16 v[164:179], v[56:59], a[100:103], v[164:179]
    ds_read_b128 v[84:87], v1 offset:57344
    ds_read_b128 v[88:91], v1 offset:58368
    ds_read_b128 v[92:95], v1 offset:59392
    ds_read_b128 v[96:99], v1 offset:60416
    v_exp_f32 v243, v243
    v_mfma_f32_32x32x16_bf16 v[180:195], v[64:67], a[100:103], v[180:195]
    v_exp_f32 v244, v244
    v_exp_f32 v245, v245
    v_mul_f32 v132, v132, v140
    s_waitcnt lgkmcnt(4)
    v_mfma_f32_32x32x16_bf16 v[164:179], v[68:71], a[104:107], v[164:179]
    v_mul_f32 v133, v133, v141
    v_mul_f32 v134, v134, v142
    v_mul_f32 v135, v135, v143
    v_fma_f32 v242, v242, v222, v222
    v_fma_f32 v243, v243, v222, v222
    v_fma_f32 v244, v244, v222, v222
    v_mfma_f32_32x32x16_bf16 v[180:195], v[76:79], a[104:107], v[180:195]
    v_fma_f32 v245, v245, v222, v222
    v_rcp_f32 v242, v242
    v_rcp_f32 v243, v243
    v_mfma_f32_32x32x16_bf16 v[164:179], v[72:75], a[108:111], v[164:179]
    ds_read_b128 v[36:39], v1 offset:61440
    ds_read_b128 v[40:43], v1 offset:62464
    ds_read_b128 v[44:47], v1 offset:63488
    ds_read_b128 v[48:51], v1 offset:64512
    v_rcp_f32 v244, v244
    v_mfma_f32_32x32x16_bf16 v[180:195], v[80:83], a[108:111], v[180:195]
    v_rcp_f32 v245, v245
    v_mul_f32 v132, v132, v242
    v_mul_f32 v133, v133, v243
    v_mul_f32 v134, v134, v244
    s_waitcnt lgkmcnt(4)
    v_mfma_f32_32x32x16_bf16 v[164:179], v[84:87], a[112:115], v[164:179]
    v_mul_f32 v135, v135, v245
    v_mul_f32 v246, v136, v221
    v_mul_f32 v247, v137, v221
    v_mul_f32 v248, v138, v221
    v_mul_f32 v249, v139, v221
    v_mfma_f32_32x32x16_bf16 v[180:195], v[92:95], a[112:115], v[180:195]
    v_exp_f32 v246, v246
    v_exp_f32 v247, v247
    v_exp_f32 v248, v248
    v_mfma_f32_32x32x16_bf16 v[164:179], v[88:91], a[116:119], v[164:179]
    s_waitcnt vmcnt(16)
    s_barrier
    ds_read_b128 v[52:55], v2 offset:0
    ds_read_b128 v[56:59], v2 offset:1024
    ds_read_b128 v[60:63], v2 offset:2048
    ds_read_b128 v[64:67], v2 offset:3072
    v_mfma_f32_32x32x16_bf16 v[180:195], v[96:99], a[116:119], v[180:195]
    s_add_u32 m0, s22, 16384
    s_add_u32 s31, s28, 32768
    buffer_load_dwordx4 v1, s[4:7], s31 offen offset:0 lds
    v_exp_f32 v249, v249
    s_waitcnt lgkmcnt(4)
    v_mfma_f32_32x32x16_bf16 v[164:179], v[36:39], a[120:123], v[164:179]
    buffer_load_dwordx4 v1, s[4:7], s31 offen offset:1024 lds
    v_mul_f32 v136, v136, v144
    v_mul_f32 v137, v137, v145
    v_mul_f32 v138, v138, v146
    v_mul_f32 v139, v139, v147
    v_fma_f32 v246, v246, v222, v222
    v_mfma_f32_32x32x16_bf16 v[180:195], v[44:47], a[120:123], v[180:195]
    buffer_load_dwordx4 v1, s[4:7], s31 offen offset:2048 lds
    v_fma_f32 v247, v247, v222, v222
    v_fma_f32 v248, v248, v222, v222
    v_fma_f32 v249, v249, v222, v222
    v_rcp_f32 v246, v246
    v_mfma_f32_32x32x16_bf16 v[164:179], v[40:43], a[124:127], v[164:179]
    ds_read_b128 v[68:71], v2 offset:4096
    ds_read_b128 v[72:75], v2 offset:5120
    ds_read_b128 v[76:79], v2 offset:6144
    ds_read_b128 v[80:83], v2 offset:7168
    buffer_load_dwordx4 v1, s[4:7], s31 offen offset:3072 lds
    v_mfma_f32_32x32x16_bf16 v[180:195], v[48:51], a[124:127], v[180:195]
    s_add_u32 m0, s22, 32768
    s_add_u32 s31, s28, 49152
    buffer_load_dwordx4 v1, s[4:7], s31 offen offset:0 lds
    v_rcp_f32 v247, v247
    s_waitcnt lgkmcnt(4)
    v_mfma_f32_32x32x16_bf16 v[164:179], v[52:55], a[128:131], v[164:179]
    buffer_load_dwordx4 v1, s[4:7], s31 offen offset:1024 lds
    v_rcp_f32 v248, v248
    v_rcp_f32 v249, v249
    v_mul_f32 v136, v136, v246
    v_mfma_f32_32x32x16_bf16 v[180:195], v[60:63], a[128:131], v[180:195]
    buffer_load_dwordx4 v1, s[4:7], s31 offen offset:2048 lds
    v_mul_f32 v137, v137, v247
    v_mul_f32 v138, v138, v248
    v_mul_f32 v139, v139, v249
    v_cvt_pk_bf16_f32 v140, v132, v133
    v_cvt_pk_bf16_f32 v141, v134, v135
    v_mfma_f32_32x32x16_bf16 v[164:179], v[56:59], a[132:135], v[164:179]
    ds_read_b128 v[84:87], v2 offset:8192
    ds_read_b128 v[88:91], v2 offset:9216
    ds_read_b128 v[92:95], v2 offset:10240
    ds_read_b128 v[96:99], v2 offset:11264
    buffer_load_dwordx4 v1, s[4:7], s31 offen offset:3072 lds
    v_cvt_pk_bf16_f32 v142, v136, v137
    v_mfma_f32_32x32x16_bf16 v[180:195], v[64:67], a[132:135], v[180:195]
    v_cvt_pk_bf16_f32 v143, v138, v139
    s_add_u32 s33, s63, 16384
    buffer_store_dwordx4 v[140:143], v10, s[4:7], s33 offen sc1
    ds_read_b128 v[226:229], v250 offset:17280
    ds_read_b128 v[230:233], v250 offset:17312
    s_waitcnt lgkmcnt(6)
    v_mfma_f32_32x32x16_bf16 v[164:179], v[68:71], a[136:139], v[164:179]
    ds_read_b128 v[234:237], v250 offset:17344
    ds_read_b128 v[238:241], v250 offset:17376
    s_waitcnt lgkmcnt(0)
    v_fmac_f32 v148, v220, v226
    v_fmac_f32 v156, v220, v234
    v_fmac_f32 v149, v220, v227
    v_fmac_f32 v157, v220, v235
    v_mfma_f32_32x32x16_bf16 v[180:195], v[76:79], a[136:139], v[180:195]
    v_fmac_f32 v150, v220, v228
    v_fmac_f32 v158, v220, v236
    v_fmac_f32 v151, v220, v229
    v_fmac_f32 v159, v220, v237
    v_fmac_f32 v152, v220, v230
    v_fmac_f32 v160, v220, v238
    v_mfma_f32_32x32x16_bf16 v[164:179], v[72:75], a[140:143], v[164:179]
    ds_read_b128 v[36:39], v2 offset:12288
    ds_read_b128 v[40:43], v2 offset:13312
    ds_read_b128 v[44:47], v2 offset:14336
    ds_read_b128 v[48:51], v2 offset:15360
    v_fmac_f32 v153, v220, v231
    v_fmac_f32 v161, v220, v239
    v_mfma_f32_32x32x16_bf16 v[180:195], v[80:83], a[140:143], v[180:195]
    v_fmac_f32 v154, v220, v232
    v_fmac_f32 v162, v220, v240
    v_fmac_f32 v155, v220, v233
    v_fmac_f32 v163, v220, v241
    v_mul_f32 v242, v148, v221
    v_mfma_f32_32x32x16_bf16 v[164:179], v[84:87], a[144:147], v[164:179]
    v_mul_f32 v243, v149, v221
    v_mul_f32 v244, v150, v221
    v_mul_f32 v245, v151, v221
    v_exp_f32 v242, v242
    s_mul_i32 s88, s18, 3
    v_mfma_f32_32x32x16_bf16 v[180:195], v[92:95], a[144:147], v[180:195]
    v_exp_f32 v243, v243
    v_exp_f32 v244, v244
    v_exp_f32 v245, v245
    v_mfma_f32_32x32x16_bf16 v[164:179], v[88:91], a[148:151], v[164:179]
    ds_read_b128 v[52:55], v2 offset:16384
    ds_read_b128 v[56:59], v2 offset:17408
    v_mul_f32 v148, v148, v156
    v_mul_f32 v149, v149, v157
    v_mul_f32 v150, v150, v158
    v_mul_f32 v151, v151, v159
    v_mfma_f32_32x32x16_bf16 v[180:195], v[96:99], a[148:151], v[180:195]
    v_fma_f32 v242, v242, v222, v222
    v_fma_f32 v243, v243, v222, v222
    v_fma_f32 v244, v244, v222, v222
    v_fma_f32 v245, v245, v222, v222
    s_add_u32 s88, s88, 2
    s_waitcnt lgkmcnt(2)
    v_mfma_f32_32x32x16_bf16 v[164:179], v[36:39], a[152:155], v[164:179]
    ds_read_b128 v[60:63], v2 offset:18432
    ds_read_b128 v[64:67], v2 offset:19456
    v_rcp_f32 v242, v242
    v_rcp_f32 v243, v243
    v_mfma_f32_32x32x16_bf16 v[180:195], v[44:47], a[152:155], v[180:195]
    v_rcp_f32 v244, v244
    v_rcp_f32 v245, v245
    v_mul_f32 v148, v148, v242
    v_mul_f32 v149, v149, v243
    v_mfma_f32_32x32x16_bf16 v[164:179], v[40:43], a[156:159], v[164:179]
    ds_read_b128 v[68:71], v2 offset:20480
    ds_read_b128 v[72:75], v2 offset:21504
    v_mul_f32 v150, v150, v244
    v_mul_f32 v151, v151, v245
    v_mul_f32 v246, v152, v221
    v_mul_f32 v247, v153, v221
    v_mfma_f32_32x32x16_bf16 v[180:195], v[48:51], a[156:159], v[180:195]
    v_mul_f32 v248, v154, v221
    v_mul_f32 v249, v155, v221
    v_exp_f32 v246, v246
    s_lshr_b32 s89, s88, 3
    s_waitcnt lgkmcnt(4)
    v_mfma_f32_32x32x16_bf16 v[196:211], v[52:55], a[0:3], 0
    ds_read_b128 v[76:79], v2 offset:22528
    ds_read_b128 v[80:83], v2 offset:23552
    v_exp_f32 v247, v247
    v_exp_f32 v248, v248
    v_mfma_f32_32x32x16_bf16 v[196:211], v[56:59], a[4:7], v[196:211]
    v_exp_f32 v249, v249
    v_mul_f32 v152, v152, v160
    v_mul_f32 v153, v153, v161
    v_mul_f32 v154, v154, v162
    s_waitcnt lgkmcnt(4)
    v_mfma_f32_32x32x16_bf16 v[196:211], v[60:63], a[8:11], v[196:211]
    ds_read_b128 v[84:87], v2 offset:24576
    ds_read_b128 v[88:91], v2 offset:25600
    v_mul_f32 v155, v155, v163
    v_fma_f32 v246, v246, v222, v222
    v_fma_f32 v247, v247, v222, v222
    v_fma_f32 v248, v248, v222, v222
    v_mfma_f32_32x32x16_bf16 v[196:211], v[64:67], a[12:15], v[196:211]
    v_fma_f32 v249, v249, v222, v222
    v_rcp_f32 v246, v246
    v_rcp_f32 v247, v247
    s_waitcnt lgkmcnt(4)
    v_mfma_f32_32x32x16_bf16 v[196:211], v[68:71], a[16:19], v[196:211]
    ds_read_b128 v[92:95], v2 offset:26624
    ds_read_b128 v[96:99], v2 offset:27648
    v_rcp_f32 v248, v248
    v_rcp_f32 v249, v249
    v_mfma_f32_32x32x16_bf16 v[196:211], v[72:75], a[20:23], v[196:211]
    v_mul_f32 v152, v152, v246
    v_mul_f32 v153, v153, v247
    v_mul_f32 v154, v154, v248
    v_mul_f32 v155, v155, v249
    v_cvt_pk_bf16_f32 v156, v148, v149
    s_waitcnt lgkmcnt(4)
    v_mfma_f32_32x32x16_bf16 v[196:211], v[76:79], a[24:27], v[196:211]
    ds_read_b128 v[36:39], v2 offset:28672
    ds_read_b128 v[40:43], v2 offset:29696
    v_cvt_pk_bf16_f32 v157, v150, v151
    v_cvt_pk_bf16_f32 v158, v152, v153
    v_cvt_pk_bf16_f32 v159, v154, v155
    s_add_u32 s33, s63, 16896
    v_mfma_f32_32x32x16_bf16 v[196:211], v[80:83], a[28:31], v[196:211]
    buffer_store_dwordx4 v[156:159], v10, s[4:7], s33 offen sc1
    ds_read_b128 v[226:229], v250 offset:17408
    ds_read_b128 v[230:233], v250 offset:17440
    ds_read_b128 v[234:237], v250 offset:17472
    ds_read_b128 v[238:241], v250 offset:17504
    s_waitcnt lgkmcnt(8)
    v_mfma_f32_32x32x16_bf16 v[196:211], v[84:87], a[32:35], v[196:211]
    ds_read_b128 v[44:47], v2 offset:30720
    ds_read_b128 v[48:51], v2 offset:31744
    s_waitcnt lgkmcnt(2)
    v_fmac_f32 v164, v220, v226
    v_fmac_f32 v172, v220, v234
    v_fmac_f32 v165, v220, v227
    v_fmac_f32 v173, v220, v235
    v_mfma_f32_32x32x16_bf16 v[196:211], v[88:91], a[36:39], v[196:211]
    v_fmac_f32 v166, v220, v228
    v_fmac_f32 v174, v220, v236
    v_fmac_f32 v167, v220, v229
    v_fmac_f32 v175, v220, v237
    v_fmac_f32 v168, v220, v230
    v_mfma_f32_32x32x16_bf16 v[196:211], v[92:95], a[40:43], v[196:211]
    s_waitcnt vmcnt(20)
    s_barrier
    ds_read_b128 v[52:55], v2 offset:32768
    ds_read_b128 v[56:59], v2 offset:33792
    v_fmac_f32 v176, v220, v238
    v_fmac_f32 v169, v220, v231
    v_mfma_f32_32x32x16_bf16 v[196:211], v[96:99], a[44:47], v[196:211]
    s_add_u32 m0, s22, 49152
    s_add_u32 s31, s28, 65536
    buffer_load_dwordx4 v1, s[4:7], s31 offen offset:0 lds
    v_fmac_f32 v177, v220, v239
    v_fmac_f32 v170, v220, v232
    v_mfma_f32_32x32x16_bf16 v[196:211], v[36:39], a[48:51], v[196:211]
    ds_read_b128 v[60:63], v2 offset:34816
    ds_read_b128 v[64:67], v2 offset:35840
    buffer_load_dwordx4 v1, s[4:7], s31 offen offset:1024 lds
    v_fmac_f32 v178, v220, v240
    v_fmac_f32 v171, v220, v233
    v_fmac_f32 v179, v220, v241
    v_mfma_f32_32x32x16_bf16 v[196:211], v[40:43], a[52:55], v[196:211]
    buffer_load_dwordx4 v1, s[4:7], s31 offen offset:2048 lds
    v_mul_f32 v242, v164, v221
    v_mul_f32 v243, v165, v221
    v_mul_f32 v244, v166, v221
    v_mul_f32 v245, v167, v221
    s_waitcnt lgkmcnt(4)
    v_mfma_f32_32x32x16_bf16 v[196:211], v[44:47], a[56:59], v[196:211]
    ds_read_b128 v[68:71], v2 offset:36864
    ds_read_b128 v[72:75], v2 offset:37888
    buffer_load_dwordx4 v1, s[4:7], s31 offen offset:3072 lds
    v_exp_f32 v242, v242
    s_add_u32 s89, s89, 48
    v_mfma_f32_32x32x16_bf16 v[196:211], v[48:51], a[60:63], v[196:211]
    s_add_u32 m0, s22, 65536
    s_add_u32 s31, s28, 81920
    buffer_load_dwordx4 v1, s[4:7], s31 offen offset:0 lds
    v_exp_f32 v243, v243
    s_waitcnt lgkmcnt(4)
    v_mfma_f32_32x32x16_bf16 v[196:211], v[52:55], a[64:67], v[196:211]
    ds_read_b128 v[76:79], v2 offset:38912
    ds_read_b128 v[80:83], v2 offset:39936
    buffer_load_dwordx4 v1, s[4:7], s31 offen offset:1024 lds
    v_exp_f32 v244, v244
    s_lshl_b32 s89, s89, 10
    v_mfma_f32_32x32x16_bf16 v[196:211], v[56:59], a[68:71], v[196:211]
    buffer_load_dwordx4 v1, s[4:7], s31 offen offset:2048 lds
    v_exp_f32 v245, v245
    v_mul_f32 v164, v164, v172
    v_mul_f32 v165, v165, v173
    s_waitcnt lgkmcnt(4)
    v_mfma_f32_32x32x16_bf16 v[196:211], v[60:63], a[72:75], v[196:211]
    ds_read_b128 v[84:87], v2 offset:40960
    ds_read_b128 v[88:91], v2 offset:41984
    buffer_load_dwordx4 v1, s[4:7], s31 offen offset:3072 lds
    v_mul_f32 v166, v166, v174
    v_mul_f32 v167, v167, v175
    v_fma_f32 v242, v242, v222, v222
    v_mfma_f32_32x32x16_bf16 v[196:211], v[64:67], a[76:79], v[196:211]
    v_fma_f32 v243, v243, v222, v222
    v_fma_f32 v244, v244, v222, v222
    v_fma_f32 v245, v245, v222, v222
    v_rcp_f32 v242, v242
    s_waitcnt lgkmcnt(4)
    v_mfma_f32_32x32x16_bf16 v[196:211], v[68:71], a[80:83], v[196:211]
    ds_read_b128 v[92:95], v2 offset:43008
    ds_read_b128 v[96:99], v2 offset:44032
    v_rcp_f32 v243, v243
    v_rcp_f32 v244, v244
    v_mfma_f32_32x32x16_bf16 v[196:211], v[72:75], a[84:87], v[196:211]
    v_rcp_f32 v245, v245
    v_mul_f32 v164, v164, v242
    v_mul_f32 v165, v165, v243
    v_mul_f32 v166, v166, v244
    s_waitcnt lgkmcnt(4)
    v_mfma_f32_32x32x16_bf16 v[196:211], v[76:79], a[88:91], v[196:211]
    ds_read_b128 v[36:39], v2 offset:45056
    ds_read_b128 v[40:43], v2 offset:46080
    v_mul_f32 v167, v167, v245
    v_mul_f32 v246, v168, v221
    v_mul_f32 v247, v169, v221
    v_mul_f32 v248, v170, v221
    v_mfma_f32_32x32x16_bf16 v[196:211], v[80:83], a[92:95], v[196:211]
    v_mul_f32 v249, v171, v221
    v_exp_f32 v246, v246
    v_exp_f32 v247, v247
    s_waitcnt lgkmcnt(4)
    v_mfma_f32_32x32x16_bf16 v[196:211], v[84:87], a[96:99], v[196:211]
    ds_read_b128 v[44:47], v2 offset:47104
    ds_read_b128 v[48:51], v2 offset:48128
    v_exp_f32 v248, v248
    v_exp_f32 v249, v249
    v_mfma_f32_32x32x16_bf16 v[196:211], v[88:91], a[100:103], v[196:211]
    v_mul_f32 v168, v168, v176
    v_mul_f32 v169, v169, v177
    v_mul_f32 v170, v170, v178
    v_mul_f32 v171, v171, v179
    v_fma_f32 v246, v246, v222, v222
    s_waitcnt lgkmcnt(4)
    v_mfma_f32_32x32x16_bf16 v[196:211], v[92:95], a[104:107], v[196:211]
    ds_read_b128 v[52:55], v2 offset:49152
    ds_read_b128 v[56:59], v2 offset:50176
    v_fma_f32 v247, v247, v222, v222
    v_fma_f32 v248, v248, v222, v222
    v_fma_f32 v249, v249, v222, v222
    s_add_u32 s90, s62, s89
    v_mfma_f32_32x32x16_bf16 v[196:211], v[96:99], a[108:111], v[196:211]
    v_rcp_f32 v246, v246
    v_rcp_f32 v247, v247
    s_and_b32 s89, s88, 3
    s_waitcnt lgkmcnt(4)
    v_mfma_f32_32x32x16_bf16 v[196:211], v[36:39], a[112:115], v[196:211]
    ds_read_b128 v[60:63], v2 offset:51200
    ds_read_b128 v[64:67], v2 offset:52224
    v_rcp_f32 v248, v248
    v_rcp_f32 v249, v249
    v_mfma_f32_32x32x16_bf16 v[196:211], v[40:43], a[116:119], v[196:211]
    v_mul_f32 v168, v168, v246
    v_mul_f32 v169, v169, v247
    v_mul_f32 v170, v170, v248
    v_mul_f32 v171, v171, v249
    v_cvt_pk_bf16_f32 v172, v164, v165
    s_waitcnt lgkmcnt(4)
    v_mfma_f32_32x32x16_bf16 v[196:211], v[44:47], a[120:123], v[196:211]
    ds_read_b128 v[68:71], v2 offset:53248
    ds_read_b128 v[72:75], v2 offset:54272
    v_cvt_pk_bf16_f32 v173, v166, v167
    v_cvt_pk_bf16_f32 v174, v168, v169
    v_cvt_pk_bf16_f32 v175, v170, v171
    s_add_u32 s33, s63, 32768
    v_mfma_f32_32x32x16_bf16 v[196:211], v[48:51], a[124:127], v[196:211]
    buffer_store_dwordx4 v[172:175], v10, s[4:7], s33 offen sc1
    ds_read_b128 v[226:229], v250 offset:17536
    ds_read_b128 v[230:233], v250 offset:17568
    ds_read_b128 v[234:237], v250 offset:17600
    ds_read_b128 v[238:241], v250 offset:17632
    s_waitcnt lgkmcnt(8)
    v_mfma_f32_32x32x16_bf16 v[196:211], v[52:55], a[128:131], v[196:211]
    ds_read_b128 v[76:79], v2 offset:55296
    ds_read_b128 v[80:83], v2 offset:56320
    s_waitcnt lgkmcnt(2)
    v_fmac_f32 v180, v220, v226
    v_fmac_f32 v188, v220, v234
    v_fmac_f32 v181, v220, v227
    v_fmac_f32 v189, v220, v235
    v_mfma_f32_32x32x16_bf16 v[196:211], v[56:59], a[132:135], v[196:211]
    v_fmac_f32 v182, v220, v228
    v_fmac_f32 v190, v220, v236
    v_fmac_f32 v183, v220, v229
    v_fmac_f32 v191, v220, v237
    v_fmac_f32 v184, v220, v230
    v_mfma_f32_32x32x16_bf16 v[196:211], v[60:63], a[136:139], v[196:211]
    v_fmac_f32 v192, v220, v238
    v_fmac_f32 v185, v220, v231
    v_fmac_f32 v193, v220, v239
    v_fmac_f32 v186, v220, v232
    v_fmac_f32 v194, v220, v240
    v_fmac_f32 v187, v220, v233
    v_mfma_f32_32x32x16_bf16 v[196:211], v[64:67], a[140:143], v[196:211]
    v_fmac_f32 v195, v220, v241
    v_mul_f32 v242, v180, v221
    v_mul_f32 v243, v181, v221
    v_mul_f32 v244, v182, v221
    v_mul_f32 v245, v183, v221
    v_mfma_f32_32x32x16_bf16 v[196:211], v[68:71], a[144:147], v[196:211]
    v_exp_f32 v242, v242
    v_exp_f32 v243, v243
    v_exp_f32 v244, v244
    v_mfma_f32_32x32x16_bf16 v[196:211], v[72:75], a[148:151], v[196:211]
    v_exp_f32 v245, v245
    v_mul_f32 v180, v180, v188
    v_mul_f32 v181, v181, v189
    v_mul_f32 v182, v182, v190
    s_waitcnt lgkmcnt(0)
    v_mfma_f32_32x32x16_bf16 v[196:211], v[76:79], a[152:155], v[196:211]
    v_mul_f32 v183, v183, v191
    v_fma_f32 v242, v242, v222, v222
    v_fma_f32 v243, v243, v222, v222
    v_fma_f32 v244, v244, v222, v222
    v_fma_f32 v245, v245, v222, v222
    s_lshl_b32 s89, s89, 8
    v_mfma_f32_32x32x16_bf16 v[196:211], v[80:83], a[156:159], v[196:211]
    v_rcp_f32 v242, v242
    v_rcp_f32 v243, v243
    v_rcp_f32 v244, v244
    v_rcp_f32 v245, v245
    v_mul_f32 v180, v180, v242
    v_mul_f32 v181, v181, v243
    v_mul_f32 v182, v182, v244
    v_mul_f32 v183, v183, v245
    v_mul_f32 v246, v184, v221
    v_mul_f32 v247, v185, v221
    v_mul_f32 v248, v186, v221
    v_mul_f32 v249, v187, v221
    v_exp_f32 v246, v246
    v_exp_f32 v247, v247
    v_exp_f32 v248, v248
    v_exp_f32 v249, v249
    v_mul_f32 v184, v184, v192
    v_mul_f32 v185, v185, v193
    v_mul_f32 v186, v186, v194
    v_mul_f32 v187, v187, v195
    v_fma_f32 v246, v246, v222, v222
    v_fma_f32 v247, v247, v222, v222
    v_fma_f32 v248, v248, v222, v222
    v_fma_f32 v249, v249, v222, v222
    v_rcp_f32 v246, v246
    v_rcp_f32 v247, v247
    v_rcp_f32 v248, v248
    v_rcp_f32 v249, v249
    v_mul_f32 v184, v184, v246
    v_mul_f32 v185, v185, v247
    v_mul_f32 v186, v186, v248
    v_mul_f32 v187, v187, v249
    v_cvt_pk_bf16_f32 v188, v180, v181
    v_cvt_pk_bf16_f32 v189, v182, v183
    v_cvt_pk_bf16_f32 v190, v184, v185
    v_cvt_pk_bf16_f32 v191, v186, v187
    s_add_u32 s33, s63, 33280
    buffer_store_dwordx4 v[188:191], v10, s[4:7], s33 offen sc1
    s_add_u32 s90, s90, s89
    s_bfe_u32 s89, s88, 0x10002
    s_lshl_b32 s89, s89, 3
    s_add_u32 s90, s90, s89
    ds_read_b128 v[226:229], v250 offset:17664
    ds_read_b128 v[230:233], v250 offset:17696
    ds_read_b128 v[234:237], v250 offset:17728
    ds_read_b128 v[238:241], v250 offset:17760
    s_waitcnt lgkmcnt(0)
    v_fmac_f32 v196, v220, v226
    v_fmac_f32 v204, v220, v234
    v_fmac_f32 v197, v220, v227
    v_fmac_f32 v205, v220, v235
    v_fmac_f32 v198, v220, v228
    v_fmac_f32 v206, v220, v236
    v_fmac_f32 v199, v220, v229
    v_fmac_f32 v207, v220, v237
    v_fmac_f32 v200, v220, v230
    v_fmac_f32 v208, v220, v238
    v_fmac_f32 v201, v220, v231
    v_fmac_f32 v209, v220, v239
    v_fmac_f32 v202, v220, v232
    v_fmac_f32 v210, v220, v240
    v_fmac_f32 v203, v220, v233
    v_fmac_f32 v211, v220, v241
    v_mul_f32 v242, v196, v221
    v_mul_f32 v243, v197, v221
    v_mul_f32 v244, v198, v221
    v_mul_f32 v245, v199, v221
    v_exp_f32 v242, v242
    v_exp_f32 v243, v243
    v_exp_f32 v244, v244
    v_exp_f32 v245, v245
    v_mul_f32 v196, v196, v204
    v_mul_f32 v197, v197, v205
    v_mul_f32 v198, v198, v206
    v_mul_f32 v199, v199, v207
    v_fma_f32 v242, v242, v222, v222
    v_fma_f32 v243, v243, v222, v222
    v_fma_f32 v244, v244, v222, v222
    v_fma_f32 v245, v245, v222, v222
    v_rcp_f32 v242, v242
    v_rcp_f32 v243, v243
    v_rcp_f32 v244, v244
    v_rcp_f32 v245, v245
    v_mul_f32 v196, v196, v242
    v_mul_f32 v197, v197, v243
    v_mul_f32 v198, v198, v244
    v_mul_f32 v199, v199, v245
    v_mul_f32 v246, v200, v221
    v_mul_f32 v247, v201, v221
    v_mul_f32 v248, v202, v221
    v_mul_f32 v249, v203, v221
    v_exp_f32 v246, v246
    v_exp_f32 v247, v247
    v_exp_f32 v248, v248
    v_exp_f32 v249, v249
    v_mul_f32 v200, v200, v208
    v_mul_f32 v201, v201, v209
    v_mul_f32 v202, v202, v210
    v_mul_f32 v203, v203, v211
    v_fma_f32 v246, v246, v222, v222
    v_fma_f32 v247, v247, v222, v222
    v_fma_f32 v248, v248, v222, v222
    v_fma_f32 v249, v249, v222, v222
    v_rcp_f32 v246, v246
    v_rcp_f32 v247, v247
    v_rcp_f32 v248, v248
    v_rcp_f32 v249, v249
    v_mul_f32 v200, v200, v246
    v_mul_f32 v201, v201, v247
    v_mul_f32 v202, v202, v248
    v_mul_f32 v203, v203, v249
    v_cvt_pk_bf16_f32 v204, v196, v197
    v_cvt_pk_bf16_f32 v205, v198, v199
    v_cvt_pk_bf16_f32 v206, v200, v201
    v_cvt_pk_bf16_f32 v207, v202, v203
    buffer_store_dwordx2 v[204:205], v13, s[4:7], s62 offen sc1
    s_mov_b64 exec, s[74:75]
    buffer_store_dwordx2 v[206:207], v10, s[4:7], s90 offen sc1
    s_mov_b64 exec, -1
    s_cmp_lg_u32 s16, 0
    s_cbranch_scc1 Lt13_a
    s_waitcnt vmcnt(0)
    s_branch Lt13_b
Lt13_a:
    s_waitcnt vmcnt(0)
Lt13_b:
    s_barrier
    s_add_u32 s33, s41, 4
    v_mov_b32 v254, s33
    v_mov_b32 v255, 0
    s_mov_b64 exec, s[44:45]
    buffer_store_dword v254, v255, s[4:7], s37 offen sc1
    s_mov_b64 exec, -1
    s_cmp_lg_u32 s16, 0
    s_cbranch_scc1 Lt13_c
    s_add_u32 s33, s41, 4
    s_mov_b32 s47, 0
    v_subrev_u32 v252, 0x20000, v5
Lt13_p:
    buffer_load_dword v253, v252, s[4:7], s38 offen sc1
    s_waitcnt vmcnt(0)
    v_cmp_gt_u32 vcc, s33, v253
    s_add_u32 s47, s47, 1
    s_cmp_gt_u32 s47, 20000
    s_cbranch_scc1 Lt13_p_x
    s_nop 1
    s_cbranch_vccnz Lt13_p
Lt13_p_x:
    s_add_u32 m0, s22, 81920
    s_add_u32 s31, s28, 98304
    buffer_load_dwordx4 v1, s[4:7], s31 offen offset:0 lds
    buffer_load_dwordx4 v1, s[4:7], s31 offen offset:1024 lds
    buffer_load_dwordx4 v1, s[4:7], s31 offen offset:2048 lds
    buffer_load_dwordx4 v1, s[4:7], s31 offen offset:3072 lds
    s_branch Lt13_o
Lt13_c:
    s_add_u32 m0, s22, 81920
    s_add_u32 s31, s28, 98304
    buffer_load_dwordx4 v1, s[4:7], s31 offen offset:0 lds
    buffer_load_dwordx4 v1, s[4:7], s31 offen offset:1024 lds
    buffer_load_dwordx4 v1, s[4:7], s31 offen offset:2048 lds
    buffer_load_dwordx4 v1, s[4:7], s31 offen offset:3072 lds
Lt13_o:
    s_barrier
    s_mul_i32 s32, s21, 7077888
    s_mul_i32 s33, s43, 55296
    s_add_u32 s32, s32, s33
    s_add_u32 s32, s32, 20971520
    ds_read_b128 v[84:87], v3 offset:0
    ds_read_b128 v[88:91], v3 offset:1024
    ds_read_b128 v[92:95], v3 offset:2048
    ds_read_b128 v[96:99], v3 offset:3072
    ds_read_b128 v[36:39], v3 offset:4096
    buffer_load_dwordx4 a[0:3], v1, s[4:7], s32 offen offset:0 sc1
    buffer_load_dwordx4 a[4:7], v1, s[4:7], s32 offen offset:1024 sc1
    buffer_load_dwordx4 a[8:11], v1, s[4:7], s32 offen offset:2048 sc1
    buffer_load_dwordx4 a[12:15], v1, s[4:7], s32 offen offset:3072 sc1
    s_add_u32 s32, s32, 4096
    buffer_load_dwordx4 a[16:19], v1, s[4:7], s32 offen offset:0 sc1
    buffer_load_dwordx4 a[20:23], v1, s[4:7], s32 offen offset:1024 sc1
    buffer_load_dwordx4 a[24:27], v1, s[4:7], s32 offen offset:2048 sc1
    buffer_load_dwordx4 a[28:31], v1, s[4:7], s32 offen offset:3072 sc1
    s_add_u32 s32, s32, 4096
    buffer_load_dwordx4 a[32:35], v1, s[4:7], s32 offen offset:0 sc1
    s_add_u32 m0, s22, 98304
    s_add_u32 s31, s28, 114688
    buffer_load_dwordx4 v1, s[4:7], s31 offen offset:0 lds
    buffer_load_dwordx4 v1, s[4:7], s31 offen offset:1024 lds
    buffer_load_dwordx4 v1, s[4:7], s31 offen offset:2048 lds
    buffer_load_dwordx4 v1, s[4:7], s31 offen offset:3072 lds
    s_waitcnt vmcnt(12) lgkmcnt(0)
    v_mfma_f32_16x16x32_bf16 v[16:19], v[84:87], a[0:3], v[16:19]
    ds_read_b128 v[40:43], v3 offset:5120
    ds_read_b128 v[44:47], v3 offset:6144
    v_mfma_f32_16x16x32_bf16 v[20:23], v[88:91], a[0:3], v[20:23]
    ds_read_b128 v[48:51], v3 offset:7168
    ds_read_b128 v[52:55], v3 offset:8192
    v_mfma_f32_16x16x32_bf16 v[24:27], v[92:95], a[0:3], v[24:27]
    ds_read_b128 v[56:59], v3 offset:9216
    ds_read_b128 v[60:63], v3 offset:10240
    v_mfma_f32_16x16x32_bf16 v[28:31], v[96:99], a[0:3], v[28:31]
    ds_read_b128 v[64:67], v3 offset:11264
    ds_read_b128 v[68:71], v3 offset:12288
    v_mfma_f32_16x16x32_bf16 v[32:35], v[36:39], a[0:3], v[32:35]
    ds_read_b128 v[72:75], v3 offset:13312
    s_waitcnt vmcnt(11) lgkmcnt(4)
    v_mfma_f32_16x16x32_bf16 v[16:19], v[40:43], a[4:7], v[16:19]
    ds_read_b128 v[76:79], v3 offset:14336
    ds_read_b128 v[80:83], v3 offset:15360
    v_mfma_f32_16x16x32_bf16 v[20:23], v[44:47], a[4:7], v[20:23]
    ds_read_b128 v[84:87], v1 offset:0
    ds_read_b128 v[88:91], v1 offset:1024
    v_mfma_f32_16x16x32_bf16 v[24:27], v[48:51], a[4:7], v[24:27]
    ds_read_b128 v[92:95], v1 offset:2048
    buffer_load_dwordx4 a[36:39], v1, s[4:7], s32 offen offset:1024 sc1
    v_mfma_f32_16x16x32_bf16 v[28:31], v[52:55], a[4:7], v[28:31]
    ds_read_b128 v[96:99], v1 offset:3072
    buffer_load_dwordx4 a[40:43], v1, s[4:7], s32 offen offset:2048 sc1
    v_mfma_f32_16x16x32_bf16 v[32:35], v[56:59], a[4:7], v[32:35]
    ds_read_b128 v[36:39], v1 offset:4096
    s_waitcnt vmcnt(12) lgkmcnt(6)
    v_mfma_f32_16x16x32_bf16 v[16:19], v[60:63], a[8:11], v[16:19]
    ds_read_b128 v[40:43], v1 offset:5120
    buffer_load_dwordx4 a[44:47], v1, s[4:7], s32 offen offset:3072 sc1
    v_mfma_f32_16x16x32_bf16 v[20:23], v[64:67], a[8:11], v[20:23]
    ds_read_b128 v[44:47], v1 offset:6144
    s_add_u32 s32, s32, 4096
    buffer_load_dwordx4 a[48:51], v1, s[4:7], s32 offen offset:0 sc1
    v_mfma_f32_16x16x32_bf16 v[24:27], v[68:71], a[8:11], v[24:27]
    ds_read_b128 v[48:51], v1 offset:7168
    buffer_load_dwordx4 a[52:55], v1, s[4:7], s32 offen offset:1024 sc1
    v_mfma_f32_16x16x32_bf16 v[28:31], v[72:75], a[8:11], v[28:31]
    ds_read_b128 v[52:55], v1 offset:8192
    v_mfma_f32_16x16x32_bf16 v[32:35], v[76:79], a[8:11], v[32:35]
    ds_read_b128 v[56:59], v1 offset:9216
    s_waitcnt vmcnt(14) lgkmcnt(6)
    v_mfma_f32_16x16x32_bf16 v[16:19], v[80:83], a[12:15], v[16:19]
    ds_read_b128 v[60:63], v1 offset:10240
    buffer_load_dwordx4 a[56:59], v1, s[4:7], s32 offen offset:2048 sc1
    v_mfma_f32_16x16x32_bf16 v[20:23], v[84:87], a[12:15], v[20:23]
    ds_read_b128 v[64:67], v1 offset:11264
    v_mfma_f32_16x16x32_bf16 v[24:27], v[88:91], a[12:15], v[24:27]
    ds_read_b128 v[68:71], v1 offset:12288
    buffer_load_dwordx4 a[60:63], v1, s[4:7], s32 offen offset:3072 sc1
    v_mfma_f32_16x16x32_bf16 v[28:31], v[92:95], a[12:15], v[28:31]
    ds_read_b128 v[72:75], v1 offset:13312
    v_mfma_f32_16x16x32_bf16 v[32:35], v[96:99], a[12:15], v[32:35]
    ds_read_b128 v[76:79], v1 offset:14336
    s_waitcnt vmcnt(15) lgkmcnt(6)
    v_mfma_f32_16x16x32_bf16 v[16:19], v[36:39], a[16:19], v[16:19]
    ds_read_b128 v[80:83], v1 offset:15360
    s_add_u32 m0, s22, 114688
    s_add_u32 s31, s28, 131072
    buffer_load_dwordx4 v1, s[4:7], s31 offen offset:0 lds
    v_mfma_f32_16x16x32_bf16 v[20:23], v[40:43], a[16:19], v[20:23]
    s_barrier
    ds_read_b128 v[84:87], v1 offset:16384
    v_mfma_f32_16x16x32_bf16 v[24:27], v[44:47], a[16:19], v[24:27]
    ds_read_b128 v[88:91], v1 offset:17408
    buffer_load_dwordx4 v1, s[4:7], s31 offen offset:1024 lds
    v_mfma_f32_16x16x32_bf16 v[28:31], v[48:51], a[16:19], v[28:31]
    ds_read_b128 v[92:95], v1 offset:18432
    v_mfma_f32_16x16x32_bf16 v[32:35], v[52:55], a[16:19], v[32:35]
    ds_read_b128 v[96:99], v1 offset:19456
    s_waitcnt vmcnt(16) lgkmcnt(6)
    v_mfma_f32_16x16x32_bf16 v[16:19], v[56:59], a[20:23], v[16:19]
    ds_read_b128 v[36:39], v1 offset:20480
    buffer_load_dwordx4 v1, s[4:7], s31 offen offset:2048 lds
    v_mfma_f32_16x16x32_bf16 v[20:23], v[60:63], a[20:23], v[20:23]
    ds_read_b128 v[40:43], v1 offset:21504
    v_mfma_f32_16x16x32_bf16 v[24:27], v[64:67], a[20:23], v[24:27]
    ds_read_b128 v[44:47], v1 offset:22528
    v_mfma_f32_16x16x32_bf16 v[28:31], v[68:71], a[20:23], v[28:31]
    ds_read_b128 v[48:51], v1 offset:23552
    buffer_load_dwordx4 v1, s[4:7], s31 offen offset:3072 lds
    v_mfma_f32_16x16x32_bf16 v[32:35], v[72:75], a[20:23], v[32:35]
    ds_read_b128 v[52:55], v1 offset:24576
    s_waitcnt vmcnt(17) lgkmcnt(6)
    v_mfma_f32_16x16x32_bf16 v[16:19], v[76:79], a[24:27], v[16:19]
    ds_read_b128 v[56:59], v1 offset:25600
    v_mfma_f32_16x16x32_bf16 v[20:23], v[80:83], a[24:27], v[20:23]
    ds_read_b128 v[60:63], v1 offset:26624
    s_add_u32 m0, s22, 131072
    s_add_u32 s31, s28, 147456
    buffer_load_dwordx4 v1, s[4:7], s31 offen offset:0 lds
    v_mfma_f32_16x16x32_bf16 v[24:27], v[84:87], a[24:27], v[24:27]
    ds_read_b128 v[64:67], v1 offset:27648
    v_mfma_f32_16x16x32_bf16 v[28:31], v[88:91], a[24:27], v[28:31]
    ds_read_b128 v[68:71], v1 offset:28672
    buffer_load_dwordx4 v1, s[4:7], s31 offen offset:1024 lds
    v_mfma_f32_16x16x32_bf16 v[32:35], v[92:95], a[24:27], v[32:35]
    ds_read_b128 v[72:75], v1 offset:29696
    s_waitcnt vmcnt(18) lgkmcnt(6)
    v_mfma_f32_16x16x32_bf16 v[16:19], v[96:99], a[28:31], v[16:19]
    ds_read_b128 v[76:79], v1 offset:30720
    v_mfma_f32_16x16x32_bf16 v[20:23], v[36:39], a[28:31], v[20:23]
    ds_read_b128 v[80:83], v1 offset:31744
    buffer_load_dwordx4 v1, s[4:7], s31 offen offset:2048 lds
    v_mfma_f32_16x16x32_bf16 v[24:27], v[40:43], a[28:31], v[24:27]
    ds_read_b128 v[84:87], v1 offset:32768
    v_mfma_f32_16x16x32_bf16 v[28:31], v[44:47], a[28:31], v[28:31]
    ds_read_b128 v[88:91], v1 offset:33792
    v_mfma_f32_16x16x32_bf16 v[32:35], v[48:51], a[28:31], v[32:35]
    ds_read_b128 v[92:95], v1 offset:34816
    s_waitcnt vmcnt(18) lgkmcnt(6)
    v_mfma_f32_16x16x32_bf16 v[16:19], v[52:55], a[32:35], v[16:19]
    ds_read_b128 v[96:99], v1 offset:35840
    buffer_load_dwordx4 v1, s[4:7], s31 offen offset:3072 lds
    v_mfma_f32_16x16x32_bf16 v[20:23], v[56:59], a[32:35], v[20:23]
    ds_read_b128 v[36:39], v1 offset:36864
    v_mfma_f32_16x16x32_bf16 v[24:27], v[60:63], a[32:35], v[24:27]
    ds_read_b128 v[40:43], v1 offset:37888
    s_add_u32 s32, s32, 4096
    buffer_load_dwordx4 a[64:67], v1, s[4:7], s32 offen offset:0 sc1
    v_mfma_f32_16x16x32_bf16 v[28:31], v[64:67], a[32:35], v[28:31]
    ds_read_b128 v[44:47], v1 offset:38912
    v_mfma_f32_16x16x32_bf16 v[32:35], v[68:71], a[32:35], v[32:35]
    ds_read_b128 v[48:51], v1 offset:39936
    s_waitcnt vmcnt(15) lgkmcnt(6)
    v_mfma_f32_16x16x32_bf16 v[16:19], v[72:75], a[36:39], v[16:19]
    ds_read_b128 v[52:55], v1 offset:40960
    buffer_load_dwordx4 a[68:71], v1, s[4:7], s32 offen offset:1024 sc1
    v_mfma_f32_16x16x32_bf16 v[20:23], v[76:79], a[36:39], v[20:23]
    ds_read_b128 v[56:59], v1 offset:41984
    v_mfma_f32_16x16x32_bf16 v[24:27], v[80:83], a[36:39], v[24:27]
    ds_read_b128 v[60:63], v1 offset:43008
    buffer_load_dwordx4 a[72:75], v1, s[4:7], s32 offen offset:2048 sc1
    v_mfma_f32_16x16x32_bf16 v[28:31], v[84:87], a[36:39], v[28:31]
    ds_read_b128 v[64:67], v1 offset:44032
    v_mfma_f32_16x16x32_bf16 v[32:35], v[88:91], a[36:39], v[32:35]
    ds_read_b128 v[68:71], v1 offset:45056
    s_waitcnt vmcnt(16) lgkmcnt(6)
    v_mfma_f32_16x16x32_bf16 v[16:19], v[92:95], a[40:43], v[16:19]
    ds_read_b128 v[72:75], v1 offset:46080
    buffer_load_dwordx4 a[76:79], v1, s[4:7], s32 offen offset:3072 sc1
    v_mfma_f32_16x16x32_bf16 v[20:23], v[96:99], a[40:43], v[20:23]
    ds_read_b128 v[76:79], v1 offset:47104
    v_mfma_f32_16x16x32_bf16 v[24:27], v[36:39], a[40:43], v[24:27]
    ds_read_b128 v[80:83], v1 offset:48128
    v_mfma_f32_16x16x32_bf16 v[28:31], v[40:43], a[40:43], v[28:31]
    s_barrier
    ds_read_b128 v[84:87], v1 offset:49152
    v_mfma_f32_16x16x32_bf16 v[32:35], v[44:47], a[40:43], v[32:35]
    ds_read_b128 v[88:91], v1 offset:50176
    s_waitcnt vmcnt(16) lgkmcnt(6)
    v_mfma_f32_16x16x32_bf16 v[16:19], v[48:51], a[44:47], v[16:19]
    ds_read_b128 v[92:95], v1 offset:51200
    s_add_u32 s32, s32, 4096
    buffer_load_dwordx4 a[80:83], v1, s[4:7], s32 offen offset:0 sc1
    v_mfma_f32_16x16x32_bf16 v[20:23], v[52:55], a[44:47], v[20:23]
    ds_read_b128 v[96:99], v1 offset:52224
    buffer_load_dwordx4 a[84:87], v1, s[4:7], s32 offen offset:1024 sc1
    v_mfma_f32_16x16x32_bf16 v[24:27], v[56:59], a[44:47], v[24:27]
    ds_read_b128 v[36:39], v1 offset:53248
    v_mfma_f32_16x16x32_bf16 v[28:31], v[60:63], a[44:47], v[28:31]
    ds_read_b128 v[40:43], v1 offset:54272
    v_mfma_f32_16x16x32_bf16 v[32:35], v[64:67], a[44:47], v[32:35]
    ds_read_b128 v[44:47], v1 offset:55296
    s_waitcnt vmcnt(17) lgkmcnt(6)
    v_mfma_f32_16x16x32_bf16 v[16:19], v[68:71], a[48:51], v[16:19]
    ds_read_b128 v[48:51], v1 offset:56320
    s_add_u32 m0, s22, 0
    s_add_u32 s31, s28, 163840
    buffer_load_dwordx4 v1, s[4:7], s31 offen offset:0 lds
    v_mfma_f32_16x16x32_bf16 v[20:23], v[72:75], a[48:51], v[20:23]
    ds_read_b128 v[52:55], v1 offset:57344
    buffer_load_dwordx4 v1, s[4:7], s31 offen offset:1024 lds
    v_mfma_f32_16x16x32_bf16 v[24:27], v[76:79], a[48:51], v[24:27]
    ds_read_b128 v[56:59], v1 offset:58368
    v_mfma_f32_16x16x32_bf16 v[28:31], v[80:83], a[48:51], v[28:31]
    ds_read_b128 v[60:63], v1 offset:59392
    v_mfma_f32_16x16x32_bf16 v[32:35], v[84:87], a[48:51], v[32:35]
    ds_read_b128 v[64:67], v1 offset:60416
    s_waitcnt vmcnt(18) lgkmcnt(6)
    v_mfma_f32_16x16x32_bf16 v[16:19], v[88:91], a[52:55], v[16:19]
    ds_read_b128 v[68:71], v1 offset:61440
    buffer_load_dwordx4 v1, s[4:7], s31 offen offset:2048 lds
    v_mfma_f32_16x16x32_bf16 v[20:23], v[92:95], a[52:55], v[20:23]
    ds_read_b128 v[72:75], v1 offset:62464
    v_mfma_f32_16x16x32_bf16 v[24:27], v[96:99], a[52:55], v[24:27]
    ds_read_b128 v[76:79], v1 offset:63488
    buffer_load_dwordx4 v1, s[4:7], s31 offen offset:3072 lds
    v_mfma_f32_16x16x32_bf16 v[28:31], v[36:39], a[52:55], v[28:31]
    ds_read_b128 v[80:83], v1 offset:64512
    v_mfma_f32_16x16x32_bf16 v[32:35], v[40:43], a[52:55], v[32:35]
    ds_read_b128 v[84:87], v2 offset:0
    s_waitcnt vmcnt(19) lgkmcnt(6)
    v_mfma_f32_16x16x32_bf16 v[16:19], v[44:47], a[56:59], v[16:19]
    ds_read_b128 v[88:91], v2 offset:1024
    s_add_u32 m0, s22, 16384
    s_add_u32 s31, s28, 180224
    buffer_load_dwordx4 v1, s[4:7], s31 offen offset:0 lds
    v_mfma_f32_16x16x32_bf16 v[20:23], v[48:51], a[56:59], v[20:23]
    ds_read_b128 v[92:95], v2 offset:2048
    v_mfma_f32_16x16x32_bf16 v[24:27], v[52:55], a[56:59], v[24:27]
    ds_read_b128 v[96:99], v2 offset:3072
    v_mfma_f32_16x16x32_bf16 v[28:31], v[56:59], a[56:59], v[28:31]
    ds_read_b128 v[36:39], v2 offset:4096
    buffer_load_dwordx4 v1, s[4:7], s31 offen offset:1024 lds
    v_mfma_f32_16x16x32_bf16 v[32:35], v[60:63], a[56:59], v[32:35]
    ds_read_b128 v[40:43], v2 offset:5120
    s_waitcnt vmcnt(20) lgkmcnt(6)
    v_mfma_f32_16x16x32_bf16 v[16:19], v[64:67], a[60:63], v[16:19]
    ds_read_b128 v[44:47], v2 offset:6144
    buffer_load_dwordx4 v1, s[4:7], s31 offen offset:2048 lds
    v_mfma_f32_16x16x32_bf16 v[20:23], v[68:71], a[60:63], v[20:23]
    ds_read_b128 v[48:51], v2 offset:7168
    v_mfma_f32_16x16x32_bf16 v[24:27], v[72:75], a[60:63], v[24:27]
    ds_read_b128 v[52:55], v2 offset:8192
    v_mfma_f32_16x16x32_bf16 v[28:31], v[76:79], a[60:63], v[28:31]
    ds_read_b128 v[56:59], v2 offset:9216
    buffer_load_dwordx4 v1, s[4:7], s31 offen offset:3072 lds
    v_mfma_f32_16x16x32_bf16 v[32:35], v[80:83], a[60:63], v[32:35]
    ds_read_b128 v[60:63], v2 offset:10240
    buffer_load_dwordx4 a[88:91], v1, s[4:7], s32 offen offset:2048 sc1
    s_waitcnt vmcnt(14) lgkmcnt(6)
    v_mfma_f32_16x16x32_bf16 v[16:19], v[84:87], a[64:67], v[16:19]
    ds_read_b128 v[64:67], v2 offset:11264
    v_mfma_f32_16x16x32_bf16 v[20:23], v[88:91], a[64:67], v[20:23]
    ds_read_b128 v[68:71], v2 offset:12288
    v_mfma_f32_16x16x32_bf16 v[24:27], v[92:95], a[64:67], v[24:27]
    ds_read_b128 v[72:75], v2 offset:13312
    v_mfma_f32_16x16x32_bf16 v[28:31], v[96:99], a[64:67], v[28:31]
    ds_read_b128 v[76:79], v2 offset:14336
    v_mfma_f32_16x16x32_bf16 v[32:35], v[36:39], a[64:67], v[32:35]
    ds_read_b128 v[80:83], v2 offset:15360
    buffer_load_dwordx4 a[92:95], v1, s[4:7], s32 offen offset:3072 sc1
    s_waitcnt vmcnt(14) lgkmcnt(6)
    v_mfma_f32_16x16x32_bf16 v[16:19], v[40:43], a[68:71], v[16:19]
    s_barrier
    ds_read_b128 v[84:87], v2 offset:16384
    v_mfma_f32_16x16x32_bf16 v[20:23], v[44:47], a[68:71], v[20:23]
    ds_read_b128 v[88:91], v2 offset:17408
    v_mfma_f32_16x16x32_bf16 v[24:27], v[48:51], a[68:71], v[24:27]
    ds_read_b128 v[92:95], v2 offset:18432
    s_add_u32 s32, s32, 4096
    buffer_load_dwordx4 a[96:99], v1, s[4:7], s32 offen offset:0 sc1
    v_mfma_f32_16x16x32_bf16 v[28:31], v[52:55], a[68:71], v[28:31]
    ds_read_b128 v[96:99], v2 offset:19456
    v_mfma_f32_16x16x32_bf16 v[32:35], v[56:59], a[68:71], v[32:35]
    ds_read_b128 v[36:39], v2 offset:20480
    s_waitcnt vmcnt(14) lgkmcnt(6)
    v_mfma_f32_16x16x32_bf16 v[16:19], v[60:63], a[72:75], v[16:19]
    ds_read_b128 v[40:43], v2 offset:21504
    buffer_load_dwordx4 a[100:103], v1, s[4:7], s32 offen offset:1024 sc1
    v_mfma_f32_16x16x32_bf16 v[20:23], v[64:67], a[72:75], v[20:23]
    ds_read_b128 v[44:47], v2 offset:22528
    v_mfma_f32_16x16x32_bf16 v[24:27], v[68:71], a[72:75], v[24:27]
    ds_read_b128 v[48:51], v2 offset:23552
    buffer_load_dwordx4 a[104:107], v1, s[4:7], s32 offen offset:2048 sc1
    v_mfma_f32_16x16x32_bf16 v[28:31], v[72:75], a[72:75], v[28:31]
    ds_read_b128 v[52:55], v2 offset:24576
    v_mfma_f32_16x16x32_bf16 v[32:35], v[76:79], a[72:75], v[32:35]
    ds_read_b128 v[56:59], v2 offset:25600
    s_waitcnt vmcnt(15) lgkmcnt(6)
    v_mfma_f32_16x16x32_bf16 v[16:19], v[80:83], a[76:79], v[16:19]
    ds_read_b128 v[60:63], v2 offset:26624
    buffer_load_dwordx4 a[108:111], v1, s[4:7], s32 offen offset:3072 sc1
    v_mfma_f32_16x16x32_bf16 v[20:23], v[84:87], a[76:79], v[20:23]
    ds_read_b128 v[64:67], v2 offset:27648
    v_mfma_f32_16x16x32_bf16 v[24:27], v[88:91], a[76:79], v[24:27]
    ds_read_b128 v[68:71], v2 offset:28672
    v_mfma_f32_16x16x32_bf16 v[28:31], v[92:95], a[76:79], v[28:31]
    ds_read_b128 v[72:75], v2 offset:29696
    s_add_u32 s32, s32, 4096
    buffer_load_dwordx4 a[112:115], v1, s[4:7], s32 offen offset:0 sc1
    v_mfma_f32_16x16x32_bf16 v[32:35], v[96:99], a[76:79], v[32:35]
    ds_read_b128 v[76:79], v2 offset:30720
    s_waitcnt vmcnt(16) lgkmcnt(6)
    v_mfma_f32_16x16x32_bf16 v[16:19], v[36:39], a[80:83], v[16:19]
    ds_read_b128 v[80:83], v2 offset:31744
    v_mfma_f32_16x16x32_bf16 v[20:23], v[40:43], a[80:83], v[20:23]
    ds_read_b128 v[84:87], v2 offset:32768
    s_add_u32 m0, s22, 32768
    s_add_u32 s31, s28, 196608
    buffer_load_dwordx4 v1, s[4:7], s31 offen offset:0 lds
    v_mfma_f32_16x16x32_bf16 v[24:27], v[44:47], a[80:83], v[24:27]
    ds_read_b128 v[88:91], v2 offset:33792
    v_mfma_f32_16x16x32_bf16 v[28:31], v[48:51], a[80:83], v[28:31]
    ds_read_b128 v[92:95], v2 offset:34816
    buffer_load_dwordx4 v1, s[4:7], s31 offen offset:1024 lds
    v_mfma_f32_16x16x32_bf16 v[32:35], v[52:55], a[80:83], v[32:35]
    ds_read_b128 v[96:99], v2 offset:35840
    s_waitcnt vmcnt(17) lgkmcnt(6)
    v_mfma_f32_16x16x32_bf16 v[16:19], v[56:59], a[84:87], v[16:19]
    ds_read_b128 v[36:39], v2 offset:36864
    v_mfma_f32_16x16x32_bf16 v[20:23], v[60:63], a[84:87], v[20:23]
    ds_read_b128 v[40:43], v2 offset:37888
    buffer_load_dwordx4 v1, s[4:7], s31 offen offset:2048 lds
    v_mfma_f32_16x16x32_bf16 v[24:27], v[64:67], a[84:87], v[24:27]
    ds_read_b128 v[44:47], v2 offset:38912
    v_mfma_f32_16x16x32_bf16 v[28:31], v[68:71], a[84:87], v[28:31]
    ds_read_b128 v[48:51], v2 offset:39936
    v_mfma_f32_16x16x32_bf16 v[32:35], v[72:75], a[84:87], v[32:35]
    ds_read_b128 v[52:55], v2 offset:40960
    s_waitcnt vmcnt(9) lgkmcnt(6)
    v_mfma_f32_16x16x32_bf16 v[16:19], v[76:79], a[88:91], v[16:19]
    ds_read_b128 v[56:59], v2 offset:41984
    buffer_load_dwordx4 v1, s[4:7], s31 offen offset:3072 lds
    v_mfma_f32_16x16x32_bf16 v[20:23], v[80:83], a[88:91], v[20:23]
    ds_read_b128 v[60:63], v2 offset:43008
    v_mfma_f32_16x16x32_bf16 v[24:27], v[84:87], a[88:91], v[24:27]
    ds_read_b128 v[64:67], v2 offset:44032
    s_add_u32 m0, s22, 49152
    s_add_u32 s31, s28, 212992
    buffer_load_dwordx4 v1, s[4:7], s31 offen offset:0 lds
    v_mfma_f32_16x16x32_bf16 v[28:31], v[88:91], a[88:91], v[28:31]
    ds_read_b128 v[68:71], v2 offset:45056
    v_mfma_f32_16x16x32_bf16 v[32:35], v[92:95], a[88:91], v[32:35]
    ds_read_b128 v[72:75], v2 offset:46080
    buffer_load_dwordx4 a[116:119], v1, s[4:7], s32 offen offset:1024 sc1
    s_waitcnt vmcnt(11) lgkmcnt(6)
    v_mfma_f32_16x16x32_bf16 v[16:19], v[96:99], a[92:95], v[16:19]
    ds_read_b128 v[76:79], v2 offset:47104
    v_mfma_f32_16x16x32_bf16 v[20:23], v[36:39], a[92:95], v[20:23]
    ds_read_b128 v[80:83], v2 offset:48128
    v_mfma_f32_16x16x32_bf16 v[24:27], v[40:43], a[92:95], v[24:27]
    s_barrier
    ds_read_b128 v[84:87], v2 offset:49152
    v_mfma_f32_16x16x32_bf16 v[28:31], v[44:47], a[92:95], v[28:31]
    ds_read_b128 v[88:91], v2 offset:50176
    buffer_load_dwordx4 v1, s[4:7], s31 offen offset:1024 lds
    v_mfma_f32_16x16x32_bf16 v[32:35], v[48:51], a[92:95], v[32:35]
    ds_read_b128 v[92:95], v2 offset:51200
    buffer_load_dwordx4 a[120:123], v1, s[4:7], s32 offen offset:2048 sc1
    s_waitcnt vmcnt(12) lgkmcnt(6)
    v_mfma_f32_16x16x32_bf16 v[16:19], v[52:55], a[96:99], v[16:19]
    ds_read_b128 v[96:99], v2 offset:52224
    v_mfma_f32_16x16x32_bf16 v[20:23], v[56:59], a[96:99], v[20:23]
    ds_read_b128 v[36:39], v2 offset:53248
    v_mfma_f32_16x16x32_bf16 v[24:27], v[60:63], a[96:99], v[24:27]
    ds_read_b128 v[40:43], v2 offset:54272
    v_mfma_f32_16x16x32_bf16 v[28:31], v[64:67], a[96:99], v[28:31]
    ds_read_b128 v[44:47], v2 offset:55296
    buffer_load_dwordx4 v1, s[4:7], s31 offen offset:2048 lds
    v_mfma_f32_16x16x32_bf16 v[32:35], v[68:71], a[96:99], v[32:35]
    ds_read_b128 v[48:51], v2 offset:56320
    buffer_load_dwordx4 a[124:127], v1, s[4:7], s32 offen offset:3072 sc1
    s_waitcnt vmcnt(13) lgkmcnt(6)
    v_mfma_f32_16x16x32_bf16 v[16:19], v[72:75], a[100:103], v[16:19]
    ds_read_b128 v[52:55], v2 offset:57344
    v_mfma_f32_16x16x32_bf16 v[20:23], v[76:79], a[100:103], v[20:23]
    ds_read_b128 v[56:59], v2 offset:58368
    v_mfma_f32_16x16x32_bf16 v[24:27], v[80:83], a[100:103], v[24:27]
    ds_read_b128 v[60:63], v2 offset:59392
    v_mfma_f32_16x16x32_bf16 v[28:31], v[84:87], a[100:103], v[28:31]
    ds_read_b128 v[64:67], v2 offset:60416
    v_mfma_f32_16x16x32_bf16 v[32:35], v[88:91], a[100:103], v[32:35]
    ds_read_b128 v[68:71], v2 offset:61440
    s_add_u32 s32, s32, 4096
    buffer_load_dwordx4 a[128:131], v1, s[4:7], s32 offen offset:0 sc1
    s_waitcnt vmcnt(13) lgkmcnt(6)
    v_mfma_f32_16x16x32_bf16 v[16:19], v[92:95], a[104:107], v[16:19]
    ds_read_b128 v[72:75], v2 offset:62464
    v_mfma_f32_16x16x32_bf16 v[20:23], v[96:99], a[104:107], v[20:23]
    ds_read_b128 v[76:79], v2 offset:63488
    v_mfma_f32_16x16x32_bf16 v[24:27], v[36:39], a[104:107], v[24:27]
    ds_read_b128 v[80:83], v2 offset:64512
    buffer_load_dwordx4 v1, s[4:7], s31 offen offset:3072 lds
    v_mfma_f32_16x16x32_bf16 v[28:31], v[40:43], a[104:107], v[28:31]
    ds_read_b128 v[84:87], v3 offset:0
    v_mfma_f32_16x16x32_bf16 v[32:35], v[44:47], a[104:107], v[32:35]
    ds_read_b128 v[88:91], v3 offset:1024
    buffer_load_dwordx4 a[132:135], v1, s[4:7], s32 offen offset:1024 sc1
    s_waitcnt vmcnt(14) lgkmcnt(6)
    v_mfma_f32_16x16x32_bf16 v[16:19], v[48:51], a[108:111], v[16:19]
    ds_read_b128 v[92:95], v3 offset:2048
    v_mfma_f32_16x16x32_bf16 v[20:23], v[52:55], a[108:111], v[20:23]
    ds_read_b128 v[96:99], v3 offset:3072
    v_mfma_f32_16x16x32_bf16 v[24:27], v[56:59], a[108:111], v[24:27]
    ds_read_b128 v[36:39], v3 offset:4096
    buffer_load_dwordx4 a[136:139], v1, s[4:7], s32 offen offset:2048 sc1
    v_mfma_f32_16x16x32_bf16 v[28:31], v[60:63], a[108:111], v[28:31]
    ds_read_b128 v[40:43], v3 offset:5120
    v_mfma_f32_16x16x32_bf16 v[32:35], v[64:67], a[108:111], v[32:35]
    ds_read_b128 v[44:47], v3 offset:6144
    s_waitcnt vmcnt(14) lgkmcnt(6)
    v_mfma_f32_16x16x32_bf16 v[16:19], v[68:71], a[112:115], v[16:19]
    ds_read_b128 v[48:51], v3 offset:7168
    s_add_u32 m0, s22, 65536
    s_add_u32 s31, s28, 229376
    buffer_load_dwordx4 v1, s[4:7], s31 offen offset:0 lds
    v_mfma_f32_16x16x32_bf16 v[20:23], v[72:75], a[112:115], v[20:23]
    ds_read_b128 v[52:55], v3 offset:8192
    v_mfma_f32_16x16x32_bf16 v[24:27], v[76:79], a[112:115], v[24:27]
    ds_read_b128 v[56:59], v3 offset:9216
    v_mfma_f32_16x16x32_bf16 v[28:31], v[80:83], a[112:115], v[28:31]
    ds_read_b128 v[60:63], v3 offset:10240
    buffer_load_dwordx4 v1, s[4:7], s31 offen offset:1024 lds
    v_mfma_f32_16x16x32_bf16 v[32:35], v[84:87], a[112:115], v[32:35]
    ds_read_b128 v[64:67], v3 offset:11264
    buffer_load_dwordx4 a[140:143], v1, s[4:7], s32 offen offset:3072 sc1
    s_waitcnt vmcnt(11) lgkmcnt(6)
    v_mfma_f32_16x16x32_bf16 v[16:19], v[88:91], a[116:119], v[16:19]
    ds_read_b128 v[68:71], v3 offset:12288
    v_mfma_f32_16x16x32_bf16 v[20:23], v[92:95], a[116:119], v[20:23]
    ds_read_b128 v[72:75], v3 offset:13312
    v_mfma_f32_16x16x32_bf16 v[24:27], v[96:99], a[116:119], v[24:27]
    ds_read_b128 v[76:79], v3 offset:14336
    v_mfma_f32_16x16x32_bf16 v[28:31], v[36:39], a[116:119], v[28:31]
    ds_read_b128 v[80:83], v3 offset:15360
    buffer_load_dwordx4 v1, s[4:7], s31 offen offset:2048 lds
    v_mfma_f32_16x16x32_bf16 v[32:35], v[40:43], a[116:119], v[32:35]
    s_barrier
    ds_read_b128 v[84:87], v1 offset:0
    s_add_u32 s32, s32, 4096
    buffer_load_dwordx4 a[144:147], v1, s[4:7], s32 offen offset:0 sc1
    s_waitcnt vmcnt(11) lgkmcnt(6)
    v_mfma_f32_16x16x32_bf16 v[16:19], v[44:47], a[120:123], v[16:19]
    ds_read_b128 v[88:91], v1 offset:1024
    v_mfma_f32_16x16x32_bf16 v[20:23], v[48:51], a[120:123], v[20:23]
    ds_read_b128 v[92:95], v1 offset:2048
    v_mfma_f32_16x16x32_bf16 v[24:27], v[52:55], a[120:123], v[24:27]
    ds_read_b128 v[96:99], v1 offset:3072
    v_mfma_f32_16x16x32_bf16 v[28:31], v[56:59], a[120:123], v[28:31]
    ds_read_b128 v[36:39], v1 offset:4096
    v_mfma_f32_16x16x32_bf16 v[32:35], v[60:63], a[120:123], v[32:35]
    ds_read_b128 v[40:43], v1 offset:5120
    buffer_load_dwordx4 a[148:151], v1, s[4:7], s32 offen offset:1024 sc1
    s_waitcnt vmcnt(10) lgkmcnt(6)
    v_mfma_f32_16x16x32_bf16 v[16:19], v[64:67], a[124:127], v[16:19]
    ds_read_b128 v[44:47], v1 offset:6144
    v_mfma_f32_16x16x32_bf16 v[20:23], v[68:71], a[124:127], v[20:23]
    ds_read_b128 v[48:51], v1 offset:7168
    v_mfma_f32_16x16x32_bf16 v[24:27], v[72:75], a[124:127], v[24:27]
    ds_read_b128 v[52:55], v1 offset:8192
    buffer_load_dwordx4 v1, s[4:7], s31 offen offset:3072 lds
    v_mfma_f32_16x16x32_bf16 v[28:31], v[76:79], a[124:127], v[28:31]
    ds_read_b128 v[56:59], v1 offset:9216
    v_mfma_f32_16x16x32_bf16 v[32:35], v[80:83], a[124:127], v[32:35]
    ds_read_b128 v[60:63], v1 offset:10240
    buffer_load_dwordx4 a[152:155], v1, s[4:7], s32 offen offset:2048 sc1
    s_waitcnt vmcnt(11) lgkmcnt(6)
    v_mfma_f32_16x16x32_bf16 v[16:19], v[84:87], a[128:131], v[16:19]
    ds_read_b128 v[64:67], v1 offset:11264
    v_mfma_f32_16x16x32_bf16 v[20:23], v[88:91], a[128:131], v[20:23]
    ds_read_b128 v[68:71], v1 offset:12288
    v_mfma_f32_16x16x32_bf16 v[24:27], v[92:95], a[128:131], v[24:27]
    ds_read_b128 v[72:75], v1 offset:13312
    s_add_u32 m0, s22, 81920
    s_add_u32 s31, s28, 245760
    buffer_load_dwordx4 v1, s[4:7], s31 offen offset:0 lds
    v_mfma_f32_16x16x32_bf16 v[28:31], v[96:99], a[128:131], v[28:31]
    ds_read_b128 v[76:79], v1 offset:14336
    v_mfma_f32_16x16x32_bf16 v[32:35], v[36:39], a[128:131], v[32:35]
    ds_read_b128 v[80:83], v1 offset:15360
    buffer_load_dwordx4 a[156:159], v1, s[4:7], s32 offen offset:3072 sc1
    s_waitcnt vmcnt(11) lgkmcnt(6)
    v_mfma_f32_16x16x32_bf16 v[16:19], v[40:43], a[132:135], v[16:19]
    ds_read_b128 v[84:87], v1 offset:16384
    v_mfma_f32_16x16x32_bf16 v[20:23], v[44:47], a[132:135], v[20:23]
    ds_read_b128 v[88:91], v1 offset:17408
    v_mfma_f32_16x16x32_bf16 v[24:27], v[48:51], a[132:135], v[24:27]
    ds_read_b128 v[92:95], v1 offset:18432
    v_mfma_f32_16x16x32_bf16 v[28:31], v[52:55], a[132:135], v[28:31]
    ds_read_b128 v[96:99], v1 offset:19456
    buffer_load_dwordx4 v1, s[4:7], s31 offen offset:1024 lds
    v_mfma_f32_16x16x32_bf16 v[32:35], v[56:59], a[132:135], v[32:35]
    ds_read_b128 v[36:39], v1 offset:20480
    s_add_u32 s32, s32, 4096
    buffer_load_dwordx4 a[160:163], v1, s[4:7], s32 offen offset:0 sc1
    s_waitcnt vmcnt(12) lgkmcnt(6)
    v_mfma_f32_16x16x32_bf16 v[16:19], v[60:63], a[136:139], v[16:19]
    ds_read_b128 v[40:43], v1 offset:21504
    v_mfma_f32_16x16x32_bf16 v[20:23], v[64:67], a[136:139], v[20:23]
    ds_read_b128 v[44:47], v1 offset:22528
    v_mfma_f32_16x16x32_bf16 v[24:27], v[68:71], a[136:139], v[24:27]
    ds_read_b128 v[48:51], v1 offset:23552
    v_mfma_f32_16x16x32_bf16 v[28:31], v[72:75], a[136:139], v[28:31]
    ds_read_b128 v[52:55], v1 offset:24576
    v_mfma_f32_16x16x32_bf16 v[32:35], v[76:79], a[136:139], v[32:35]
    ds_read_b128 v[56:59], v1 offset:25600
    buffer_load_dwordx4 a[164:167], v1, s[4:7], s32 offen offset:1024 sc1
    s_waitcnt vmcnt(10) lgkmcnt(6)
    v_mfma_f32_16x16x32_bf16 v[16:19], v[80:83], a[140:143], v[16:19]
    ds_read_b128 v[60:63], v1 offset:26624
    v_mfma_f32_16x16x32_bf16 v[20:23], v[84:87], a[140:143], v[20:23]
    ds_read_b128 v[64:67], v1 offset:27648
    buffer_load_dwordx4 v1, s[4:7], s31 offen offset:2048 lds
    v_mfma_f32_16x16x32_bf16 v[24:27], v[88:91], a[140:143], v[24:27]
    ds_read_b128 v[68:71], v1 offset:28672
    v_mfma_f32_16x16x32_bf16 v[28:31], v[92:95], a[140:143], v[28:31]
    ds_read_b128 v[72:75], v1 offset:29696
    v_mfma_f32_16x16x32_bf16 v[32:35], v[96:99], a[140:143], v[32:35]
    ds_read_b128 v[76:79], v1 offset:30720
    buffer_load_dwordx4 a[168:171], v1, s[4:7], s32 offen offset:2048 sc1
    s_waitcnt vmcnt(10) lgkmcnt(6)
    v_mfma_f32_16x16x32_bf16 v[16:19], v[36:39], a[144:147], v[16:19]
    ds_read_b128 v[80:83], v1 offset:31744
    v_mfma_f32_16x16x32_bf16 v[20:23], v[40:43], a[144:147], v[20:23]
    s_barrier
    ds_read_b128 v[84:87], v1 offset:32768
    v_mfma_f32_16x16x32_bf16 v[24:27], v[44:47], a[144:147], v[24:27]
    ds_read_b128 v[88:91], v1 offset:33792
    buffer_load_dwordx4 v1, s[4:7], s31 offen offset:3072 lds
    v_mfma_f32_16x16x32_bf16 v[28:31], v[48:51], a[144:147], v[28:31]
    ds_read_b128 v[92:95], v1 offset:34816
    v_mfma_f32_16x16x32_bf16 v[32:35], v[52:55], a[144:147], v[32:35]
    ds_read_b128 v[96:99], v1 offset:35840
    buffer_load_dwordx4 a[172:175], v1, s[4:7], s32 offen offset:3072 sc1
    s_waitcnt vmcnt(11) lgkmcnt(6)
    v_mfma_f32_16x16x32_bf16 v[16:19], v[56:59], a[148:151], v[16:19]
    ds_read_b128 v[36:39], v1 offset:36864
    v_mfma_f32_16x16x32_bf16 v[20:23], v[60:63], a[148:151], v[20:23]
    ds_read_b128 v[40:43], v1 offset:37888
    v_mfma_f32_16x16x32_bf16 v[24:27], v[64:67], a[148:151], v[24:27]
    ds_read_b128 v[44:47], v1 offset:38912
    v_mfma_f32_16x16x32_bf16 v[28:31], v[68:71], a[148:151], v[28:31]
    ds_read_b128 v[48:51], v1 offset:39936
    s_add_u32 m0, s22, 98304
    s_add_u32 s31, s28, 262144
    buffer_load_dwordx4 v1, s[4:7], s31 offen offset:0 lds
    v_mfma_f32_16x16x32_bf16 v[32:35], v[72:75], a[148:151], v[32:35]
    ds_read_b128 v[52:55], v1 offset:40960
    s_add_u32 s32, s32, 4096
    buffer_load_dwordx4 a[176:179], v1, s[4:7], s32 offen offset:0 sc1
    s_waitcnt vmcnt(11) lgkmcnt(6)
    v_mfma_f32_16x16x32_bf16 v[16:19], v[76:79], a[152:155], v[16:19]
    ds_read_b128 v[56:59], v1 offset:41984
    v_mfma_f32_16x16x32_bf16 v[20:23], v[80:83], a[152:155], v[20:23]
    ds_read_b128 v[60:63], v1 offset:43008
    v_mfma_f32_16x16x32_bf16 v[24:27], v[84:87], a[152:155], v[24:27]
    ds_read_b128 v[64:67], v1 offset:44032
    v_mfma_f32_16x16x32_bf16 v[28:31], v[88:91], a[152:155], v[28:31]
    ds_read_b128 v[68:71], v1 offset:45056
    buffer_load_dwordx4 v1, s[4:7], s31 offen offset:1024 lds
    v_mfma_f32_16x16x32_bf16 v[32:35], v[92:95], a[152:155], v[32:35]
    ds_read_b128 v[72:75], v1 offset:46080
    buffer_load_dwordx4 a[180:183], v1, s[4:7], s32 offen offset:1024 sc1
    s_waitcnt vmcnt(11) lgkmcnt(6)
    v_mfma_f32_16x16x32_bf16 v[16:19], v[96:99], a[156:159], v[16:19]
    ds_read_b128 v[76:79], v1 offset:47104
    v_mfma_f32_16x16x32_bf16 v[20:23], v[36:39], a[156:159], v[20:23]
    ds_read_b128 v[80:83], v1 offset:48128
    v_mfma_f32_16x16x32_bf16 v[24:27], v[40:43], a[156:159], v[24:27]
    ds_read_b128 v[84:87], v1 offset:49152
    v_mfma_f32_16x16x32_bf16 v[28:31], v[44:47], a[156:159], v[28:31]
    ds_read_b128 v[88:91], v1 offset:50176
    v_mfma_f32_16x16x32_bf16 v[32:35], v[48:51], a[156:159], v[32:35]
    ds_read_b128 v[92:95], v1 offset:51200
    buffer_load_dwordx4 a[184:187], v1, s[4:7], s32 offen offset:2048 sc1
    s_waitcnt vmcnt(10) lgkmcnt(6)
    v_mfma_f32_16x16x32_bf16 v[16:19], v[52:55], a[160:163], v[16:19]
    ds_read_b128 v[96:99], v1 offset:52224
    v_mfma_f32_16x16x32_bf16 v[20:23], v[56:59], a[160:163], v[20:23]
    ds_read_b128 v[36:39], v1 offset:53248
    v_mfma_f32_16x16x32_bf16 v[24:27], v[60:63], a[160:163], v[24:27]
    ds_read_b128 v[40:43], v1 offset:54272
    buffer_load_dwordx4 v1, s[4:7], s31 offen offset:2048 lds
    v_mfma_f32_16x16x32_bf16 v[28:31], v[64:67], a[160:163], v[28:31]
    ds_read_b128 v[44:47], v1 offset:55296
    v_mfma_f32_16x16x32_bf16 v[32:35], v[68:71], a[160:163], v[32:35]
    ds_read_b128 v[48:51], v1 offset:56320
    buffer_load_dwordx4 a[188:191], v1, s[4:7], s32 offen offset:3072 sc1
    s_waitcnt vmcnt(11) lgkmcnt(6)
    v_mfma_f32_16x16x32_bf16 v[16:19], v[72:75], a[164:167], v[16:19]
    ds_read_b128 v[52:55], v1 offset:57344
    v_mfma_f32_16x16x32_bf16 v[20:23], v[76:79], a[164:167], v[20:23]
    ds_read_b128 v[56:59], v1 offset:58368
    v_mfma_f32_16x16x32_bf16 v[24:27], v[80:83], a[164:167], v[24:27]
    ds_read_b128 v[60:63], v1 offset:59392
    buffer_load_dwordx4 v1, s[4:7], s31 offen offset:3072 lds
    v_mfma_f32_16x16x32_bf16 v[28:31], v[84:87], a[164:167], v[28:31]
    ds_read_b128 v[64:67], v1 offset:60416
    v_mfma_f32_16x16x32_bf16 v[32:35], v[88:91], a[164:167], v[32:35]
    ds_read_b128 v[68:71], v1 offset:61440
    s_add_u32 s32, s32, 4096
    buffer_load_dwordx4 a[192:195], v1, s[4:7], s32 offen offset:0 sc1
    s_waitcnt vmcnt(11) lgkmcnt(6)
    v_mfma_f32_16x16x32_bf16 v[16:19], v[92:95], a[168:171], v[16:19]
    ds_read_b128 v[72:75], v1 offset:62464
    v_mfma_f32_16x16x32_bf16 v[20:23], v[96:99], a[168:171], v[20:23]
    ds_read_b128 v[76:79], v1 offset:63488
    v_mfma_f32_16x16x32_bf16 v[24:27], v[36:39], a[168:171], v[24:27]
    ds_read_b128 v[80:83], v1 offset:64512
    v_mfma_f32_16x16x32_bf16 v[28:31], v[40:43], a[168:171], v[28:31]
    s_waitcnt vmcnt(10)
    s_barrier
    ds_read_b128 v[84:87], v2 offset:0
    v_mfma_f32_16x16x32_bf16 v[32:35], v[44:47], a[168:171], v[32:35]
    ds_read_b128 v[88:91], v2 offset:1024
    buffer_load_dwordx4 a[196:199], v1, s[4:7], s32 offen offset:1024 sc1
    s_waitcnt vmcnt(10) lgkmcnt(6)
    v_mfma_f32_16x16x32_bf16 v[16:19], v[48:51], a[172:175], v[16:19]
    ds_read_b128 v[92:95], v2 offset:2048
    v_mfma_f32_16x16x32_bf16 v[20:23], v[52:55], a[172:175], v[20:23]
    ds_read_b128 v[96:99], v2 offset:3072
    buffer_load_dwordx4 a[200:203], v1, s[4:7], s32 offen offset:2048 sc1
    v_mfma_f32_16x16x32_bf16 v[24:27], v[56:59], a[172:175], v[24:27]
    ds_read_b128 v[36:39], v2 offset:4096
    v_mfma_f32_16x16x32_bf16 v[28:31], v[60:63], a[172:175], v[28:31]
    ds_read_b128 v[40:43], v2 offset:5120
    buffer_load_dwordx4 a[204:207], v1, s[4:7], s32 offen offset:3072 sc1
    v_mfma_f32_16x16x32_bf16 v[32:35], v[64:67], a[172:175], v[32:35]
    ds_read_b128 v[44:47], v2 offset:6144
    s_waitcnt vmcnt(10) lgkmcnt(6)
    v_mfma_f32_16x16x32_bf16 v[16:19], v[68:71], a[176:179], v[16:19]
    ds_read_b128 v[48:51], v2 offset:7168
    v_mfma_f32_16x16x32_bf16 v[20:23], v[72:75], a[176:179], v[20:23]
    ds_read_b128 v[52:55], v2 offset:8192
    s_add_u32 s32, s32, 4096
    buffer_load_dwordx4 a[208:211], v1, s[4:7], s32 offen offset:0 sc1
    v_mfma_f32_16x16x32_bf16 v[24:27], v[76:79], a[176:179], v[24:27]
    ds_read_b128 v[56:59], v2 offset:9216
    v_mfma_f32_16x16x32_bf16 v[28:31], v[80:83], a[176:179], v[28:31]
    ds_read_b128 v[60:63], v2 offset:10240
    v_mfma_f32_16x16x32_bf16 v[32:35], v[84:87], a[176:179], v[32:35]
    ds_read_b128 v[64:67], v2 offset:11264
    s_waitcnt vmcnt(9) lgkmcnt(6)
    v_mfma_f32_16x16x32_bf16 v[16:19], v[88:91], a[180:183], v[16:19]
    ds_read_b128 v[68:71], v2 offset:12288
    buffer_load_dwordx4 a[212:215], v1, s[4:7], s32 offen offset:1024 sc1
    v_mfma_f32_16x16x32_bf16 v[20:23], v[92:95], a[180:183], v[20:23]
    ds_read_b128 v[72:75], v2 offset:13312
    v_mfma_f32_16x16x32_bf16 v[24:27], v[96:99], a[180:183], v[24:27]
    ds_read_b128 v[76:79], v2 offset:14336
    s_add_u32 m0, s22, 0
    s_add_u32 s31, s25, 0
    buffer_load_dwordx4 v1, s[12:15], s31 offen offset:0 lds
    v_mfma_f32_16x16x32_bf16 v[28:31], v[36:39], a[180:183], v[28:31]
    ds_read_b128 v[80:83], v2 offset:15360
    v_mfma_f32_16x16x32_bf16 v[32:35], v[40:43], a[180:183], v[32:35]
    ds_read_b128 v[84:87], v2 offset:16384
    s_waitcnt vmcnt(10) lgkmcnt(6)
    v_mfma_f32_16x16x32_bf16 v[16:19], v[44:47], a[184:187], v[16:19]
    ds_read_b128 v[88:91], v2 offset:17408
    buffer_load_dwordx4 v1, s[12:15], s31 offen offset:1024 lds
    v_mfma_f32_16x16x32_bf16 v[20:23], v[48:51], a[184:187], v[20:23]
    ds_read_b128 v[92:95], v2 offset:18432
    v_mfma_f32_16x16x32_bf16 v[24:27], v[52:55], a[184:187], v[24:27]
    ds_read_b128 v[96:99], v2 offset:19456
    buffer_load_dwordx4 v1, s[12:15], s31 offen offset:2048 lds
    v_mfma_f32_16x16x32_bf16 v[28:31], v[56:59], a[184:187], v[28:31]
    ds_read_b128 v[36:39], v2 offset:20480
    v_mfma_f32_16x16x32_bf16 v[32:35], v[60:63], a[184:187], v[32:35]
    ds_read_b128 v[40:43], v2 offset:21504
    s_waitcnt vmcnt(10) lgkmcnt(6)
    v_mfma_f32_16x16x32_bf16 v[16:19], v[64:67], a[188:191], v[16:19]
    ds_read_b128 v[44:47], v2 offset:22528
    buffer_load_dwordx4 v1, s[12:15], s31 offen offset:3072 lds
    v_mfma_f32_16x16x32_bf16 v[20:23], v[68:71], a[188:191], v[20:23]
    ds_read_b128 v[48:51], v2 offset:23552
    v_mfma_f32_16x16x32_bf16 v[24:27], v[72:75], a[188:191], v[24:27]
    ds_read_b128 v[52:55], v2 offset:24576
    v_mfma_f32_16x16x32_bf16 v[28:31], v[76:79], a[188:191], v[28:31]
    ds_read_b128 v[56:59], v2 offset:25600
    s_add_u32 m0, s22, 16384
    s_add_u32 s31, s25, 16384
    buffer_load_dwordx4 v1, s[12:15], s31 offen offset:0 lds
    v_mfma_f32_16x16x32_bf16 v[32:35], v[80:83], a[188:191], v[32:35]
    ds_read_b128 v[60:63], v2 offset:26624
    s_waitcnt vmcnt(10) lgkmcnt(6)
    v_mfma_f32_16x16x32_bf16 v[16:19], v[84:87], a[192:195], v[16:19]
    ds_read_b128 v[64:67], v2 offset:27648
    v_mfma_f32_16x16x32_bf16 v[20:23], v[88:91], a[192:195], v[20:23]
    ds_read_b128 v[68:71], v2 offset:28672
    buffer_load_dwordx4 v1, s[12:15], s31 offen offset:1024 lds
    v_mfma_f32_16x16x32_bf16 v[24:27], v[92:95], a[192:195], v[24:27]
    ds_read_b128 v[72:75], v2 offset:29696
    v_mfma_f32_16x16x32_bf16 v[28:31], v[96:99], a[192:195], v[28:31]
    ds_read_b128 v[76:79], v2 offset:30720
    v_mfma_f32_16x16x32_bf16 v[32:35], v[36:39], a[192:195], v[32:35]
    ds_read_b128 v[80:83], v2 offset:31744
    s_waitcnt vmcnt(10) lgkmcnt(6)
    v_mfma_f32_16x16x32_bf16 v[16:19], v[40:43], a[196:199], v[16:19]
    s_barrier
    ds_read_b128 v[84:87], v2 offset:32768
    v_mfma_f32_16x16x32_bf16 v[20:23], v[44:47], a[196:199], v[20:23]
    ds_read_b128 v[88:91], v2 offset:33792
    buffer_load_dwordx4 v1, s[12:15], s31 offen offset:2048 lds
    v_mfma_f32_16x16x32_bf16 v[24:27], v[48:51], a[196:199], v[24:27]
    ds_read_b128 v[92:95], v2 offset:34816
    buffer_load_dwordx4 v1, s[12:15], s31 offen offset:3072 lds
    v_mfma_f32_16x16x32_bf16 v[28:31], v[52:55], a[196:199], v[28:31]
    ds_read_b128 v[96:99], v2 offset:35840
    v_mfma_f32_16x16x32_bf16 v[32:35], v[56:59], a[196:199], v[32:35]
    ds_read_b128 v[36:39], v2 offset:36864
    s_waitcnt vmcnt(11) lgkmcnt(6)
    v_mfma_f32_16x16x32_bf16 v[16:19], v[60:63], a[200:203], v[16:19]
    ds_read_b128 v[40:43], v2 offset:37888
    s_add_u32 m0, s22, 32768
    s_add_u32 s31, s25, 32768
    buffer_load_dwordx4 v1, s[12:15], s31 offen offset:0 lds
    v_mfma_f32_16x16x32_bf16 v[20:23], v[64:67], a[200:203], v[20:23]
    ds_read_b128 v[44:47], v2 offset:38912
    v_mfma_f32_16x16x32_bf16 v[24:27], v[68:71], a[200:203], v[24:27]
    ds_read_b128 v[48:51], v2 offset:39936
    buffer_load_dwordx4 v1, s[12:15], s31 offen offset:1024 lds
    v_mfma_f32_16x16x32_bf16 v[28:31], v[72:75], a[200:203], v[28:31]
    ds_read_b128 v[52:55], v2 offset:40960
    v_mfma_f32_16x16x32_bf16 v[32:35], v[76:79], a[200:203], v[32:35]
    ds_read_b128 v[56:59], v2 offset:41984
    s_waitcnt vmcnt(12) lgkmcnt(6)
    v_mfma_f32_16x16x32_bf16 v[16:19], v[80:83], a[204:207], v[16:19]
    ds_read_b128 v[60:63], v2 offset:43008
    buffer_load_dwordx4 v1, s[12:15], s31 offen offset:2048 lds
    v_mfma_f32_16x16x32_bf16 v[20:23], v[84:87], a[204:207], v[20:23]
    ds_read_b128 v[64:67], v2 offset:44032
    v_mfma_f32_16x16x32_bf16 v[24:27], v[88:91], a[204:207], v[24:27]
    ds_read_b128 v[68:71], v2 offset:45056
    v_mfma_f32_16x16x32_bf16 v[28:31], v[92:95], a[204:207], v[28:31]
    ds_read_b128 v[72:75], v2 offset:46080
    buffer_load_dwordx4 v1, s[12:15], s31 offen offset:3072 lds
    v_mfma_f32_16x16x32_bf16 v[32:35], v[96:99], a[204:207], v[32:35]
    s_waitcnt vmcnt(13) lgkmcnt(5)
    v_mfma_f32_16x16x32_bf16 v[16:19], v[36:39], a[208:211], v[16:19]
    s_add_u32 m0, s22, 49152
    s_add_u32 s31, s25, 49152
    buffer_load_dwordx4 v1, s[12:15], s31 offen offset:0 lds
    v_mfma_f32_16x16x32_bf16 v[20:23], v[40:43], a[208:211], v[20:23]
    v_mfma_f32_16x16x32_bf16 v[24:27], v[44:47], a[208:211], v[24:27]
    v_mfma_f32_16x16x32_bf16 v[28:31], v[48:51], a[208:211], v[28:31]
    buffer_load_dwordx4 v1, s[12:15], s31 offen offset:1024 lds
    v_mfma_f32_16x16x32_bf16 v[32:35], v[52:55], a[208:211], v[32:35]
    s_waitcnt vmcnt(14) lgkmcnt(0)
    v_mfma_f32_16x16x32_bf16 v[16:19], v[56:59], a[212:215], v[16:19]
    v_mfma_f32_16x16x32_bf16 v[20:23], v[60:63], a[212:215], v[20:23]
    buffer_load_dwordx4 v1, s[12:15], s31 offen offset:2048 lds
    v_mfma_f32_16x16x32_bf16 v[24:27], v[64:67], a[212:215], v[24:27]
    v_mfma_f32_16x16x32_bf16 v[28:31], v[68:71], a[212:215], v[28:31]
    v_mfma_f32_16x16x32_bf16 v[32:35], v[72:75], a[212:215], v[32:35]
    buffer_load_dwordx4 v1, s[12:15], s31 offen offset:3072 lds
    s_nop 1
    v_cvt_pk_bf16_f32 v212, v16, v17
    v_cvt_pk_bf16_f32 v213, v18, v19
    v_cvt_pk_bf16_f32 v214, v20, v21
    v_cvt_pk_bf16_f32 v215, v22, v23
    v_cvt_pk_bf16_f32 v216, v24, v25
    v_cvt_pk_bf16_f32 v217, v26, v27
    v_cvt_pk_bf16_f32 v218, v28, v29
    v_cvt_pk_bf16_f32 v219, v30, v31
    v_cvt_pk_bf16_f32 v220, v32, v33
    v_cvt_pk_bf16_f32 v221, v34, v35
    s_cmp_eq_u32 s21, 1
    s_cbranch_scc1 Lfin14
    s_add_u32 s60, s60, 1
    s_mul_i32 s62, s60, 2621440
    s_mul_i32 s33, s43, 20480
    s_add_u32 s62, s62, s33
    s_add_u32 s62, s62, 4194304
    s_lshr_b32 s33, s20, 1
    s_mul_i32 s33, s33, 5
    s_lshl_b32 s34, s64, 1
    s_add_u32 s34, s34, s33
    s_lshl_b32 s34, s34, 10
    s_add_u32 s34, s34, s62
    buffer_store_dwordx4 v[212:215], v1, s[4:7], s34 offen sc1
    buffer_store_dwordx4 v[216:219], v1, s[4:7], s34 offen offset:1024 sc1
    s_add_u32 s33, s33, 4
    s_lshl_b32 s33, s33, 10
    s_add_u32 s33, s33, s62
    s_lshl_b32 s34, s64, 3
    s_add_u32 s33, s33, s34
    buffer_store_dwordx2 v[220:221], v1, s[4:7], s33 offen sc1
    v_add_f32 v224, v16, v17
    v_mul_f32 v225, v16, v16
    v_fmac_f32 v225, v17, v17
    v_add_f32 v226, v18, v19
    v_mul_f32 v227, v18, v18
    v_fmac_f32 v227, v19, v19
    v_add_f32 v224, v224, v20
    v_fmac_f32 v225, v20, v20
    v_add_f32 v226, v226, v21
    v_fmac_f32 v227, v21, v21
    v_add_f32 v224, v224, v22
    v_fmac_f32 v225, v22, v22
    v_add_f32 v226, v226, v23
    v_fmac_f32 v227, v23, v23
    v_add_f32 v224, v224, v24
    v_fmac_f32 v225, v24, v24
    v_add_f32 v226, v226, v25
    v_fmac_f32 v227, v25, v25
    v_add_f32 v224, v224, v26
    v_fmac_f32 v225, v26, v26
    v_add_f32 v226, v226, v27
    v_fmac_f32 v227, v27, v27
    v_add_f32 v224, v224, v28
    v_fmac_f32 v225, v28, v28
    v_add_f32 v226, v226, v29
    v_fmac_f32 v227, v29, v29
    v_add_f32 v224, v224, v30
    v_fmac_f32 v225, v30, v30
    v_add_f32 v226, v226, v31
    v_fmac_f32 v227, v31, v31
    v_add_f32 v224, v224, v32
    v_fmac_f32 v225, v32, v32
    v_add_f32 v226, v226, v33
    v_fmac_f32 v227, v33, v33
    v_add_f32 v224, v224, v34
    v_fmac_f32 v225, v34, v34
    v_add_f32 v226, v226, v35
    v_fmac_f32 v227, v35, v35
    v_add_f32 v224, v224, v226
    v_add_f32 v225, v225, v227
    v_mov_b32 v226, v224
    v_mov_b32 v227, v225
    s_nop 0
    v_permlane32_swap_b32 v224, v226
    v_permlane32_swap_b32 v225, v227
    v_add_f32 v224, v224, v226
    v_add_f32 v225, v225, v227
    v_mov_b32 v226, v224
    v_mov_b32 v227, v225
    s_nop 0
    v_permlane16_swap_b32 v224, v226
    v_permlane16_swap_b32 v225, v227
    v_add_f32 v224, v224, v226
    v_add_f32 v225, v225, v227
    s_mul_i32 s62, s60, 131072
    s_lshl_b32 s33, s43, 10
    s_add_u32 s62, s62, s33
    s_lshl_b32 s33, s20, 7
    s_add_u32 s62, s62, s33
    s_add_u32 s62, s62, 393216
    s_mov_b64 exec, s[48:49]
    buffer_store_dwordx2 v[224:225], v12, s[4:7], s62 offen sc1
    s_mov_b64 exec, -1
    s_branch Lfin14_x
Lfin14:
    s_mul_i32 s62, s43, 20480
    s_mul_i32 s33, s20, 160
    s_add_u32 s62, s62, s33
    buffer_store_dwordx2 v[212:213], v15, s[8:11], s62 offen offset:0
    buffer_store_dwordx2 v[214:215], v15, s[8:11], s62 offen offset:32
    buffer_store_dwordx2 v[216:217], v15, s[8:11], s62 offen offset:64
    buffer_store_dwordx2 v[218:219], v15, s[8:11], s62 offen offset:96
    buffer_store_dwordx2 v[220:221], v15, s[8:11], s62 offen offset:128
    s_waitcnt vmcnt(0)
    s_endpgm
Lfin14_x:
    s_cmp_lg_u32 s16, 0
    s_cbranch_scc1 Lt15_a
    s_waitcnt vmcnt(0)
    s_branch Lt15_b
Lt15_a:
    s_waitcnt vmcnt(0)
Lt15_b:
    s_barrier
    s_add_u32 s33, s41, 5
    v_mov_b32 v254, s33
    v_mov_b32 v255, 0
    s_mov_b64 exec, s[44:45]
    buffer_store_dword v254, v255, s[4:7], s37 offen sc1
    s_mov_b64 exec, -1
    s_cmp_lg_u32 s16, 0
    s_cbranch_scc1 Lt15_c
    s_add_u32 s33, s41, 5
    s_mov_b32 s47, 0
    v_subrev_u32 v252, 0x20000, v5
Lt15_p:
    buffer_load_dword v253, v252, s[4:7], s38 offen sc1
    s_waitcnt vmcnt(0)
    v_cmp_gt_u32 vcc, s33, v253
    s_add_u32 s47, s47, 1
    s_cmp_gt_u32 s47, 20000
    s_cbranch_scc1 Lt15_p_x
    s_nop 1
    s_cbranch_vccnz Lt15_p
Lt15_p_x:
    s_add_u32 m0, s22, 65536
    s_add_u32 s31, s25, 65536
    buffer_load_dwordx4 v1, s[12:15], s31 offen offset:0 lds
    buffer_load_dwordx4 v1, s[12:15], s31 offen offset:1024 lds
    buffer_load_dwordx4 v1, s[12:15], s31 offen offset:2048 lds
    buffer_load_dwordx4 v1, s[12:15], s31 offen offset:3072 lds
    s_branch Lt15_o
Lt15_c:
    s_add_u32 m0, s22, 65536
    s_add_u32 s31, s25, 65536
    buffer_load_dwordx4 v1, s[12:15], s31 offen offset:0 lds
    buffer_load_dwordx4 v1, s[12:15], s31 offen offset:1024 lds
    buffer_load_dwordx4 v1, s[12:15], s31 offen offset:2048 lds
    buffer_load_dwordx4 v1, s[12:15], s31 offen offset:3072 lds
Lt15_o:
    s_barrier
    s_add_u32 s21, s21, 1
    s_add_u32 s41, s41, 5
    s_branch Lm_layerS
Lm_done:
    s_endpgm
.section .rodata,"a"
.p2align 6
.amdhsa_kernel prep_kernel
  .amdhsa_next_free_vgpr 112
  .amdhsa_next_free_sgpr 96
  .amdhsa_accum_offset 112
  .amdhsa_group_segment_fixed_size 0
  .amdhsa_kernarg_size 80
  .amdhsa_user_sgpr_count 2
  .amdhsa_user_sgpr_kernarg_segment_ptr 1
  .amdhsa_system_sgpr_workgroup_id_x 1
.end_amdhsa_kernel

.section .rodata,"a"
.p2align 6
.amdhsa_kernel interleave_layers__linear_attn_block__swiglu_ffn__prompt_kernel
  .amdhsa_next_free_vgpr 512
  .amdhsa_next_free_sgpr 102
  .amdhsa_accum_offset 256
  .amdhsa_group_segment_fixed_size 0
  .amdhsa_kernarg_size 80
  .amdhsa_user_sgpr_count 2
  .amdhsa_user_sgpr_kernarg_segment_ptr 1
  .amdhsa_system_sgpr_workgroup_id_x 1
.end_amdhsa_kernel
```
